```python
import torch

def _softmax(x, axis=-1):
    return torch.softmax(x, dim=axis)
def _gelu(x):
    return torch.nn.functional.gelu(x, approximate="tanh")
def _silu(x):
    return torch.nn.functional.silu(x)
def _sigmoid(x):
    return torch.sigmoid(x)
def _layernorm(x, axis=-1, eps=1e-5):
    m = x.mean(dim=axis, keepdim=True)
    v = x.var(dim=axis, keepdim=True, unbiased=False)
    return (x - m) / torch.sqrt(v + eps)
def _scatter_add(tgt, idx, src, axis=0):
    return tgt.clone().index_add_(axis, idx, src)
def _segment_sum(src, seg, n):
    out = torch.zeros((n,) + src.shape[1:], dtype=src.dtype)
    return out.index_add_(0, seg, src)
def _pad(x, pw):
    flat = tuple(v for pair in reversed(pw) for v in pair)
    return torch.nn.functional.pad(x, flat)

kernel_name = 'recurrent_scan__softmax_full_mha__mixer_s_mlp__prompt'

def setup_inputs():

    _w = (lambda a: (lambda t: t.to(torch.bfloat16) if t.is_floating_point() else t)(torch.as_tensor(a)))
    def _A_setup():
        B, S, D = 1, 2048, 576
        return {
            "x": _w((lambda *s: torch.randn(*s, dtype=torch.bfloat16) * 0.05)(B, S, D)),
            "wqkv": _w((lambda *s: torch.randn(*s, dtype=torch.bfloat16) * 0.05)(D, 3 * D)),
            "wo": _w((lambda *s: torch.randn(*s, dtype=torch.bfloat16) * 0.05)(D, D)),
        }
    _A_in = _A_setup()

    def _B_setup():
        B, S, D, F = 1, 2048, 576, 4608
        return {
            "x":  _w((lambda *s: torch.randn(*s, dtype=torch.bfloat16) * 0.05)(B, S, D)),
            "w1": _w((lambda *s: torch.randn(*s, dtype=torch.bfloat16) * 3.2)(D, D) * (D ** -0.5)),
            "w2": _w((lambda *s: torch.randn(*s, dtype=torch.bfloat16) * 3.2)(D, D) * (D ** -0.5)),
            "w3": _w((lambda *s: torch.randn(*s, dtype=torch.bfloat16) * 3.2)(D, F) * (D ** -0.5)),
            "w4": _w((lambda *s: torch.randn(*s, dtype=torch.bfloat16) * 3.2)(F, D) * (F ** -0.5)),
        }
    _B_in = _B_setup()

    return {
        "A_x": _A_in["x"],
        "A_wqkv": _A_in["wqkv"],
        "A_wo": _A_in["wo"],
        "B_x": _B_in["x"],
        "B_w1": _B_in["w1"],
        "B_w2": _B_in["w2"],
        "B_w3": _B_in["w3"],
        "B_w4": _B_in["w4"],
    }

def reference(A_x, A_wqkv, A_wo, B_x, B_w1, B_w2, B_w3, B_w4):
    def _A_ref(x, wqkv, wo):
        B, S, D = x.shape
        H = 32; Dh = D // H
        qkv = (lambda x, *d: x.permute(*d))((x @ wqkv).reshape(B, S, 3, H, Dh), 2, 0, 3, 1, 4)
        q, k, v = qkv[0], qkv[1], qkv[2]
        scale = Dh ** -0.5
        scores = torch.einsum("bhqd,bhkd->bhqk", q, k) * scale
        p = _softmax(scores, axis=-1)
        o = torch.einsum("bhqk,bhkd->bhqd", p, v)
        return (lambda x, *d: x.permute(*d))(o, 0, 2, 1, 3).reshape(B, S, D) @ wo

    def _B_ref(x, w1, w2, w3, w4):
        B, S, D = x.shape
        h = _gelu(_layernorm(x, axis=-1) @ w1)
        c = D // 4
        g0 = _pad(h[:, :, 0*c:1*c], ((0, 0), (1, 0), (0, 0)))[:, :S, :]
        g1 = _pad(h[:, :, 1*c:2*c], ((0, 0), (0, 1), (0, 0)))[:, 1:, :]
        g2 = _pad(h[:, :, 2*c:3*c], ((0, 0), (2, 0), (0, 0)))[:, :S, :]
        g3 = _pad(h[:, :, 3*c:   ], ((0, 0), (0, 2), (0, 0)))[:, 2:, :]
        hs = torch.concatenate([g0, g1, g2, g3], axis=-1) @ w2
        x1 = x + hs
        h2 = _gelu(_layernorm(x1, axis=-1) @ w3) @ w4
        return x1 + h2

    x = A_x
    xn = _layernorm(x, axis=-1)
    s = _A_ref(xn, A_wqkv, A_wo)
    g = _silu(_B_ref(xn, B_w1, B_w2, B_w3, B_w4))
    return x + s * g
```

```asm
; @launch kernel=ka_kernel grid=(256,1,1) block=(256,1,1) lds=147456
; @launch kernel=kc_kernel grid=(256,1,1) block=(256,1,1) lds=163840
.amdgcn_target "amdgcn-amd-amdhsa--gfx950"
.text
L_code_begin:
.globl ka_kernel
.p2align 8
.type ka_kernel,@function
ka_kernel:
s_cmp_ge_u32 s2, 192
s_cbranch_scc1 L_ka_pf
s_load_dwordx2 s[4:5], s[0:1], 0
s_load_dwordx2 s[36:37], s[0:1], 8
s_load_dwordx2 s[38:39], s[0:1], 32
s_load_dwordx2 s[6:7], s[0:1], 80
s_getpc_b64 s[60:61]
s_mov_b32 s62, 0x4000
s_mov_b32 s63, 0x00020000
v_lshlrev_b32 v4, 6, v0
buffer_load_dword v56, v4, s[60:63], 0 offen
v_and_b32 v1, 63, v0
v_lshrrev_b32 v2, 6, v0
s_and_b32 s3, s2, 7
v_readfirstlane_b32 s24, v2
s_lshr_b32 s32, s2, 3
s_lshr_b32 s25, s3, 1
s_lshl_b32 s25, s25, 2
s_and_b32 s33, s32, 3
s_add_u32 s25, s25, s33
s_and_b32 s27, s3, 1
s_mul_i32 s27, s27, 6
s_lshr_b32 s32, s32, 2
s_add_u32 s27, s27, s32
s_add_u32 s51, s32, s33
s_mul_i32 s32, s51, 43
s_lshr_b32 s32, s32, 7
s_mul_i32 s32, s32, 3
s_sub_u32 s51, s51, s32
s_mul_i32 s26, s27, 43
s_lshr_b32 s26, s26, 7
s_mul_i32 s32, s26, 3
s_sub_u32 s27, s27, s32
s_lshl_b32 s32, s25, 2
s_add_u32 s35, s32, s24
s_mul_i32 s44, s35, 36864
s_mul_i32 s32, s51, 384
s_add_u32 s44, s44, s32
s_add_u32 s45, s44, 9216
s_add_u32 s46, s44, 18432
s_add_u32 s47, s44, 27648
s_mov_b32 s52, 384
s_cmp_eq_u32 s51, 2
s_cselect_b32 s53, -768, s52
s_cmp_eq_u32 s51, 1
s_cselect_b32 s54, -768, s52
s_mul_i32 s48, s24, 36864
v_lshrrev_b32 v9, 3, v1
v_and_b32 v3, 7, v1
v_lshrrev_b32 v10, 1, v9
v_xor_b32 v3, v3, v10
v_lshlrev_b32 v3, 4, v3
v_xor_b32 v11, 64, v3
v_mul_u32_u24 v9, 1152, v9
v_add_u32 v3, v3, v9
v_add_u32 v11, v11, v9
s_waitcnt lgkmcnt(0)
s_mov_b32 s12, s4
s_mov_b32 s13, s5
s_mov_b32 s14, 0x240000
s_mov_b32 s15, 0x00020000
s_add_u32 m0, s48, 0
s_nop 0
buffer_load_dwordx4 v3, s[12:15], s44 offen offset:0 lds
s_add_u32 m0, s48, 1024
s_nop 0
buffer_load_dwordx4 v11, s[12:15], s45 offen offset:0 lds
s_add_u32 m0, s48, 2048
s_nop 0
buffer_load_dwordx4 v3, s[12:15], s46 offen offset:0 lds
s_add_u32 m0, s48, 3072
s_nop 0
buffer_load_dwordx4 v11, s[12:15], s47 offen offset:0 lds
s_add_u32 m0, s48, 3968
s_nop 0
buffer_load_dwordx4 v3, s[12:15], s44 offen offset:128 lds
s_add_u32 m0, s48, 4992
s_nop 0
buffer_load_dwordx4 v11, s[12:15], s45 offen offset:128 lds
s_add_u32 m0, s48, 6016
s_nop 0
buffer_load_dwordx4 v3, s[12:15], s46 offen offset:128 lds
s_add_u32 m0, s48, 7040
s_nop 0
buffer_load_dwordx4 v11, s[12:15], s47 offen offset:128 lds
s_add_u32 m0, s48, 7936
s_nop 0
buffer_load_dwordx4 v3, s[12:15], s44 offen offset:256 lds
s_add_u32 m0, s48, 8960
s_nop 0
buffer_load_dwordx4 v11, s[12:15], s45 offen offset:256 lds
s_add_u32 m0, s48, 9984
s_nop 0
buffer_load_dwordx4 v3, s[12:15], s46 offen offset:256 lds
s_add_u32 m0, s48, 11008
s_nop 0
buffer_load_dwordx4 v11, s[12:15], s47 offen offset:256 lds
s_add_u32 s44, s44, s53
s_add_u32 s45, s45, s53
s_add_u32 s46, s46, s53
s_add_u32 s47, s47, s53
s_add_u32 m0, s48, 12288
s_nop 0
buffer_load_dwordx4 v3, s[12:15], s44 offen offset:0 lds
s_add_u32 m0, s48, 13312
s_nop 0
buffer_load_dwordx4 v11, s[12:15], s45 offen offset:0 lds
s_add_u32 m0, s48, 14336
s_nop 0
buffer_load_dwordx4 v3, s[12:15], s46 offen offset:0 lds
s_add_u32 m0, s48, 15360
s_nop 0
buffer_load_dwordx4 v11, s[12:15], s47 offen offset:0 lds
s_add_u32 m0, s48, 16256
s_nop 0
buffer_load_dwordx4 v3, s[12:15], s44 offen offset:128 lds
s_add_u32 m0, s48, 17280
s_nop 0
buffer_load_dwordx4 v11, s[12:15], s45 offen offset:128 lds
s_add_u32 m0, s48, 18304
s_nop 0
buffer_load_dwordx4 v3, s[12:15], s46 offen offset:128 lds
s_add_u32 m0, s48, 19328
s_nop 0
buffer_load_dwordx4 v11, s[12:15], s47 offen offset:128 lds
s_add_u32 m0, s48, 20224
s_nop 0
buffer_load_dwordx4 v3, s[12:15], s44 offen offset:256 lds
s_add_u32 m0, s48, 21248
s_nop 0
buffer_load_dwordx4 v11, s[12:15], s45 offen offset:256 lds
s_add_u32 m0, s48, 22272
s_nop 0
buffer_load_dwordx4 v3, s[12:15], s46 offen offset:256 lds
s_add_u32 m0, s48, 23296
s_nop 0
buffer_load_dwordx4 v11, s[12:15], s47 offen offset:256 lds
s_add_u32 s44, s44, s54
s_add_u32 s45, s45, s54
s_add_u32 s46, s46, s54
s_add_u32 s47, s47, s54
s_add_u32 m0, s48, 24576
s_nop 0
buffer_load_dwordx4 v3, s[12:15], s44 offen offset:0 lds
s_add_u32 m0, s48, 25600
s_nop 0
buffer_load_dwordx4 v11, s[12:15], s45 offen offset:0 lds
s_add_u32 m0, s48, 26624
s_nop 0
buffer_load_dwordx4 v3, s[12:15], s46 offen offset:0 lds
s_add_u32 m0, s48, 27648
s_nop 0
buffer_load_dwordx4 v11, s[12:15], s47 offen offset:0 lds
s_add_u32 m0, s48, 28544
s_nop 0
buffer_load_dwordx4 v3, s[12:15], s44 offen offset:128 lds
s_add_u32 m0, s48, 29568
s_nop 0
buffer_load_dwordx4 v11, s[12:15], s45 offen offset:128 lds
s_add_u32 m0, s48, 30592
s_nop 0
buffer_load_dwordx4 v3, s[12:15], s46 offen offset:128 lds
s_add_u32 m0, s48, 31616
s_nop 0
buffer_load_dwordx4 v11, s[12:15], s47 offen offset:128 lds
s_add_u32 m0, s48, 32512
s_nop 0
buffer_load_dwordx4 v3, s[12:15], s44 offen offset:256 lds
s_add_u32 m0, s48, 33536
s_nop 0
buffer_load_dwordx4 v11, s[12:15], s45 offen offset:256 lds
s_add_u32 m0, s48, 34560
s_nop 0
buffer_load_dwordx4 v3, s[12:15], s46 offen offset:256 lds
s_add_u32 m0, s48, 35584
s_nop 0
buffer_load_dwordx4 v11, s[12:15], s47 offen offset:256 lds
s_mov_b32 s10, 1990656
s_mov_b32 s28, 3456
s_cmp_eq_u32 s26, 3
s_cselect_b32 s8, s38, s36
s_cselect_b32 s9, s39, s37
s_cselect_b32 s10, 663552, s10
s_mov_b32 s11, 0x00020000
s_cselect_b32 s28, 1152, s28
s_cselect_b32 s32, 0, s26
s_mul_i32 s32, s32, 1152
s_mul_i32 s33, s27, 384
s_add_u32 s32, s32, s33
s_mul_i32 s33, s24, 48
s_mul_i32 s33, s33, s28
s_add_u32 s55, s32, s33
s_mul_i32 s29, s28, 192
s_mul_i32 s32, s29, s51
s_add_u32 s30, s55, s32
s_mul_i32 s32, s28, 24
s_add_u32 s31, s30, s32
s_mul_i32 s40, s28, -384
s_cmp_eq_u32 s51, 2
s_cselect_b32 s56, s40, s29
s_cmp_eq_u32 s51, 1
s_cselect_b32 s57, s40, s29
s_cmp_eq_u32 s51, 0
s_cselect_b32 s58, s40, s29
s_add_u32 s58, s58, 128
s_mul_i32 s34, s24, 6144
v_lshrrev_b32 v9, 3, v1
v_and_b32 v4, 7, v1
v_bfe_u32 v5, v1, 4, 1
v_lshlrev_b32 v5, 2, v5
v_xor_b32 v4, v4, v5
v_lshlrev_b32 v4, 4, v4
v_mul_u32_u24 v9, s28, v9
v_add_u32 v4, v4, v9
s_lshl_b32 s32, s28, 3
s_sub_u32 s32, s32, 1024
v_add_u32 v5, s32, v4
v_add_u32 v6, s32, v5
v_mul_u32_u24 v9, 43, v1
v_lshrrev_b32 v9, 8, v9
v_mul_u32_u24 v10, 6, v9
v_sub_u32 v10, v1, v10
v_mul_u32_u24 v9, s28, v9
v_lshl_add_u32 v9, v10, 6, v9
s_and_b32 s32, s25, 3
s_mul_i32 s32, s32, 144
s_mul_i32 s33, s24, 12
s_sub_u32 s32, s32, s33
s_mul_i32 s32, s32, s28
s_add_u32 s32, s32, s55
s_mul_i32 s33, s28, 9
buffer_load_dword v48, v9, s[8:11], s32 offen
s_add_u32 s32, s32, s33
buffer_load_dword v49, v9, s[8:11], s32 offen
s_add_u32 s32, s32, s33
buffer_load_dword v50, v9, s[8:11], s32 offen
s_add_u32 s32, s32, s33
buffer_load_dword v51, v9, s[8:11], s32 offen
v_bfe_u32 v16, v1, 2, 2
v_lshrrev_b32 v17, 5, v1
v_lshl_add_u32 v17, v17, 2, v16
v_lshlrev_b32 v7, 7, v17
v_bfe_u32 v17, v1, 4, 1
v_lshl_add_u32 v7, v17, 5, v7
v_and_b32 v17, 3, v1
v_lshl_add_u32 v7, v17, 3, v7
v_lshrrev_b32 v16, 1, v16
v_lshlrev_b32 v16, 6, v16
v_add_u32 v7, v7, v16
v_xor_b32 v8, 64, v7
v_add_u32 v12, 49152, v7
v_add_u32 v13, 49152, v8
v_add_u32 v14, 98304, v7
v_add_u32 v15, 98304, v8
s_mov_b32 s20, s6
s_mov_b32 s21, s7
s_mov_b32 s22, 0x10000
s_mov_b32 s23, 0x00020000
v_and_b32 v2, 31, v1
v_lshrrev_b32 v10, 5, v1
v_lshlrev_b32 v9, 7, v2
v_lshl_add_u32 v9, v10, 3, v9
v_add_u32 v9, s48, v9
v_bfe_u32 v16, v1, 1, 3
v_lshl_add_u32 v32, v16, 4, v9
v_lshlrev_b32 v11, 4, v1
s_mul_i32 s41, s35, 36864
v_xor_b32 v33, 16, v32
v_xor_b32 v34, 32, v32
v_xor_b32 v35, 48, v32
v_xor_b32 v36, 64, v32
v_xor_b32 v37, 80, v32
v_xor_b32 v38, 96, v32
v_xor_b32 v39, 112, v32
v_mov_b32 v24, 0x3f803f80
v_mov_b32 v16, 0
v_mov_b32 v17, 0
v_mov_b32 v18, 0
v_mov_b32 v19, 0
v_mov_b32 v20, 0
v_mov_b32 v21, 0
v_mov_b32 v22, 0
v_mov_b32 v23, 0
s_waitcnt vmcnt(36)
ds_read_b64 v[112:113], v32 offset:0
ds_read_b64 v[114:115], v33 offset:0
ds_read_b64 v[116:117], v34 offset:0
ds_read_b64 v[118:119], v35 offset:0
ds_read_b64 v[120:121], v36 offset:0
ds_read_b64 v[122:123], v37 offset:0
ds_read_b64 v[124:125], v38 offset:0
ds_read_b64 v[126:127], v39 offset:0
s_waitcnt vmcnt(32)
ds_read_b64 v[128:129], v32 offset:4096
ds_read_b64 v[130:131], v33 offset:4096
ds_read_b64 v[132:133], v34 offset:4096
ds_read_b64 v[134:135], v35 offset:4096
ds_read_b64 v[136:137], v36 offset:4096
ds_read_b64 v[138:139], v37 offset:4096
ds_read_b64 v[140:141], v38 offset:4096
ds_read_b64 v[142:143], v39 offset:4096
s_waitcnt lgkmcnt(8)
v_dot2c_f32_bf16 v16, v112, v24
v_dot2c_f32_bf16 v20, v112, v112
v_dot2c_f32_bf16 v17, v113, v24
v_dot2c_f32_bf16 v21, v113, v113
v_dot2c_f32_bf16 v18, v114, v24
v_dot2c_f32_bf16 v22, v114, v114
v_dot2c_f32_bf16 v19, v115, v24
v_dot2c_f32_bf16 v23, v115, v115
v_dot2c_f32_bf16 v16, v116, v24
v_dot2c_f32_bf16 v20, v116, v116
v_dot2c_f32_bf16 v17, v117, v24
v_dot2c_f32_bf16 v21, v117, v117
v_dot2c_f32_bf16 v18, v118, v24
v_dot2c_f32_bf16 v22, v118, v118
v_dot2c_f32_bf16 v19, v119, v24
v_dot2c_f32_bf16 v23, v119, v119
v_dot2c_f32_bf16 v16, v120, v24
v_dot2c_f32_bf16 v20, v120, v120
v_dot2c_f32_bf16 v17, v121, v24
v_dot2c_f32_bf16 v21, v121, v121
v_dot2c_f32_bf16 v18, v122, v24
v_dot2c_f32_bf16 v22, v122, v122
v_dot2c_f32_bf16 v19, v123, v24
v_dot2c_f32_bf16 v23, v123, v123
v_dot2c_f32_bf16 v16, v124, v24
v_dot2c_f32_bf16 v20, v124, v124
v_dot2c_f32_bf16 v17, v125, v24
v_dot2c_f32_bf16 v21, v125, v125
v_dot2c_f32_bf16 v18, v126, v24
v_dot2c_f32_bf16 v22, v126, v126
v_dot2c_f32_bf16 v19, v127, v24
v_dot2c_f32_bf16 v23, v127, v127
s_waitcnt vmcnt(28)
ds_read_b64 v[144:145], v32 offset:8192
ds_read_b64 v[146:147], v33 offset:8192
ds_read_b64 v[148:149], v34 offset:8192
ds_read_b64 v[150:151], v35 offset:8192
ds_read_b64 v[152:153], v36 offset:8192
ds_read_b64 v[154:155], v37 offset:8192
ds_read_b64 v[156:157], v38 offset:8192
ds_read_b64 v[158:159], v39 offset:8192
s_waitcnt lgkmcnt(8)
v_dot2c_f32_bf16 v16, v128, v24
v_dot2c_f32_bf16 v20, v128, v128
v_dot2c_f32_bf16 v17, v129, v24
v_dot2c_f32_bf16 v21, v129, v129
v_dot2c_f32_bf16 v18, v130, v24
v_dot2c_f32_bf16 v22, v130, v130
v_dot2c_f32_bf16 v19, v131, v24
v_dot2c_f32_bf16 v23, v131, v131
v_dot2c_f32_bf16 v16, v132, v24
v_dot2c_f32_bf16 v20, v132, v132
v_dot2c_f32_bf16 v17, v133, v24
v_dot2c_f32_bf16 v21, v133, v133
v_dot2c_f32_bf16 v18, v134, v24
v_dot2c_f32_bf16 v22, v134, v134
v_dot2c_f32_bf16 v19, v135, v24
v_dot2c_f32_bf16 v23, v135, v135
v_dot2c_f32_bf16 v16, v136, v24
v_dot2c_f32_bf16 v20, v136, v136
v_dot2c_f32_bf16 v17, v137, v24
v_dot2c_f32_bf16 v21, v137, v137
v_dot2c_f32_bf16 v18, v138, v24
v_dot2c_f32_bf16 v22, v138, v138
v_dot2c_f32_bf16 v19, v139, v24
v_dot2c_f32_bf16 v23, v139, v139
v_dot2c_f32_bf16 v16, v140, v24
v_dot2c_f32_bf16 v20, v140, v140
v_dot2c_f32_bf16 v17, v141, v24
v_dot2c_f32_bf16 v21, v141, v141
v_dot2c_f32_bf16 v18, v142, v24
v_dot2c_f32_bf16 v22, v142, v142
v_dot2c_f32_bf16 v19, v143, v24
v_dot2c_f32_bf16 v23, v143, v143
s_waitcnt vmcnt(24)
ds_read_b64 v[160:161], v32 offset:12288
ds_read_b64 v[162:163], v33 offset:12288
ds_read_b64 v[164:165], v34 offset:12288
ds_read_b64 v[166:167], v35 offset:12288
ds_read_b64 v[168:169], v36 offset:12288
ds_read_b64 v[170:171], v37 offset:12288
ds_read_b64 v[172:173], v38 offset:12288
ds_read_b64 v[174:175], v39 offset:12288
s_waitcnt lgkmcnt(8)
v_dot2c_f32_bf16 v16, v144, v24
v_dot2c_f32_bf16 v20, v144, v144
v_dot2c_f32_bf16 v17, v145, v24
v_dot2c_f32_bf16 v21, v145, v145
v_dot2c_f32_bf16 v18, v146, v24
v_dot2c_f32_bf16 v22, v146, v146
v_dot2c_f32_bf16 v19, v147, v24
v_dot2c_f32_bf16 v23, v147, v147
v_dot2c_f32_bf16 v16, v148, v24
v_dot2c_f32_bf16 v20, v148, v148
v_dot2c_f32_bf16 v17, v149, v24
v_dot2c_f32_bf16 v21, v149, v149
v_dot2c_f32_bf16 v18, v150, v24
v_dot2c_f32_bf16 v22, v150, v150
v_dot2c_f32_bf16 v19, v151, v24
v_dot2c_f32_bf16 v23, v151, v151
v_dot2c_f32_bf16 v16, v152, v24
v_dot2c_f32_bf16 v20, v152, v152
v_dot2c_f32_bf16 v17, v153, v24
v_dot2c_f32_bf16 v21, v153, v153
v_dot2c_f32_bf16 v18, v154, v24
v_dot2c_f32_bf16 v22, v154, v154
v_dot2c_f32_bf16 v19, v155, v24
v_dot2c_f32_bf16 v23, v155, v155
v_dot2c_f32_bf16 v16, v156, v24
v_dot2c_f32_bf16 v20, v156, v156
v_dot2c_f32_bf16 v17, v157, v24
v_dot2c_f32_bf16 v21, v157, v157
v_dot2c_f32_bf16 v18, v158, v24
v_dot2c_f32_bf16 v22, v158, v158
v_dot2c_f32_bf16 v19, v159, v24
v_dot2c_f32_bf16 v23, v159, v159
s_waitcnt vmcnt(20)
ds_read_b64 v[176:177], v32 offset:16384
ds_read_b64 v[178:179], v33 offset:16384
ds_read_b64 v[180:181], v34 offset:16384
ds_read_b64 v[182:183], v35 offset:16384
ds_read_b64 v[184:185], v36 offset:16384
ds_read_b64 v[186:187], v37 offset:16384
ds_read_b64 v[188:189], v38 offset:16384
ds_read_b64 v[190:191], v39 offset:16384
s_waitcnt lgkmcnt(8)
v_dot2c_f32_bf16 v16, v160, v24
v_dot2c_f32_bf16 v20, v160, v160
v_dot2c_f32_bf16 v17, v161, v24
v_dot2c_f32_bf16 v21, v161, v161
v_dot2c_f32_bf16 v18, v162, v24
v_dot2c_f32_bf16 v22, v162, v162
v_dot2c_f32_bf16 v19, v163, v24
v_dot2c_f32_bf16 v23, v163, v163
v_dot2c_f32_bf16 v16, v164, v24
v_dot2c_f32_bf16 v20, v164, v164
v_dot2c_f32_bf16 v17, v165, v24
v_dot2c_f32_bf16 v21, v165, v165
v_dot2c_f32_bf16 v18, v166, v24
v_dot2c_f32_bf16 v22, v166, v166
v_dot2c_f32_bf16 v19, v167, v24
v_dot2c_f32_bf16 v23, v167, v167
v_dot2c_f32_bf16 v16, v168, v24
v_dot2c_f32_bf16 v20, v168, v168
v_dot2c_f32_bf16 v17, v169, v24
v_dot2c_f32_bf16 v21, v169, v169
v_dot2c_f32_bf16 v18, v170, v24
v_dot2c_f32_bf16 v22, v170, v170
v_dot2c_f32_bf16 v19, v171, v24
v_dot2c_f32_bf16 v23, v171, v171
v_dot2c_f32_bf16 v16, v172, v24
v_dot2c_f32_bf16 v20, v172, v172
v_dot2c_f32_bf16 v17, v173, v24
v_dot2c_f32_bf16 v21, v173, v173
v_dot2c_f32_bf16 v18, v174, v24
v_dot2c_f32_bf16 v22, v174, v174
v_dot2c_f32_bf16 v19, v175, v24
v_dot2c_f32_bf16 v23, v175, v175
s_waitcnt vmcnt(16)
ds_read_b64 v[192:193], v32 offset:20480
ds_read_b64 v[194:195], v33 offset:20480
ds_read_b64 v[196:197], v34 offset:20480
ds_read_b64 v[198:199], v35 offset:20480
ds_read_b64 v[200:201], v36 offset:20480
ds_read_b64 v[202:203], v37 offset:20480
ds_read_b64 v[204:205], v38 offset:20480
ds_read_b64 v[206:207], v39 offset:20480
s_waitcnt lgkmcnt(8)
v_dot2c_f32_bf16 v16, v176, v24
v_dot2c_f32_bf16 v20, v176, v176
v_dot2c_f32_bf16 v17, v177, v24
v_dot2c_f32_bf16 v21, v177, v177
v_dot2c_f32_bf16 v18, v178, v24
v_dot2c_f32_bf16 v22, v178, v178
v_dot2c_f32_bf16 v19, v179, v24
v_dot2c_f32_bf16 v23, v179, v179
v_dot2c_f32_bf16 v16, v180, v24
v_dot2c_f32_bf16 v20, v180, v180
v_dot2c_f32_bf16 v17, v181, v24
v_dot2c_f32_bf16 v21, v181, v181
v_dot2c_f32_bf16 v18, v182, v24
v_dot2c_f32_bf16 v22, v182, v182
v_dot2c_f32_bf16 v19, v183, v24
v_dot2c_f32_bf16 v23, v183, v183
v_dot2c_f32_bf16 v16, v184, v24
v_dot2c_f32_bf16 v20, v184, v184
v_dot2c_f32_bf16 v17, v185, v24
v_dot2c_f32_bf16 v21, v185, v185
v_dot2c_f32_bf16 v18, v186, v24
v_dot2c_f32_bf16 v22, v186, v186
v_dot2c_f32_bf16 v19, v187, v24
v_dot2c_f32_bf16 v23, v187, v187
v_dot2c_f32_bf16 v16, v188, v24
v_dot2c_f32_bf16 v20, v188, v188
v_dot2c_f32_bf16 v17, v189, v24
v_dot2c_f32_bf16 v21, v189, v189
v_dot2c_f32_bf16 v18, v190, v24
v_dot2c_f32_bf16 v22, v190, v190
v_dot2c_f32_bf16 v19, v191, v24
v_dot2c_f32_bf16 v23, v191, v191
s_waitcnt vmcnt(12)
ds_read_b64 v[208:209], v32 offset:24576
ds_read_b64 v[210:211], v33 offset:24576
ds_read_b64 v[212:213], v34 offset:24576
ds_read_b64 v[214:215], v35 offset:24576
ds_read_b64 v[216:217], v36 offset:24576
ds_read_b64 v[218:219], v37 offset:24576
ds_read_b64 v[220:221], v38 offset:24576
ds_read_b64 v[222:223], v39 offset:24576
s_waitcnt lgkmcnt(8)
v_dot2c_f32_bf16 v16, v192, v24
v_dot2c_f32_bf16 v20, v192, v192
v_dot2c_f32_bf16 v17, v193, v24
v_dot2c_f32_bf16 v21, v193, v193
v_dot2c_f32_bf16 v18, v194, v24
v_dot2c_f32_bf16 v22, v194, v194
v_dot2c_f32_bf16 v19, v195, v24
v_dot2c_f32_bf16 v23, v195, v195
v_dot2c_f32_bf16 v16, v196, v24
v_dot2c_f32_bf16 v20, v196, v196
v_dot2c_f32_bf16 v17, v197, v24
v_dot2c_f32_bf16 v21, v197, v197
v_dot2c_f32_bf16 v18, v198, v24
v_dot2c_f32_bf16 v22, v198, v198
v_dot2c_f32_bf16 v19, v199, v24
v_dot2c_f32_bf16 v23, v199, v199
v_dot2c_f32_bf16 v16, v200, v24
v_dot2c_f32_bf16 v20, v200, v200
v_dot2c_f32_bf16 v17, v201, v24
v_dot2c_f32_bf16 v21, v201, v201
v_dot2c_f32_bf16 v18, v202, v24
v_dot2c_f32_bf16 v22, v202, v202
v_dot2c_f32_bf16 v19, v203, v24
v_dot2c_f32_bf16 v23, v203, v203
v_dot2c_f32_bf16 v16, v204, v24
v_dot2c_f32_bf16 v20, v204, v204
v_dot2c_f32_bf16 v17, v205, v24
v_dot2c_f32_bf16 v21, v205, v205
v_dot2c_f32_bf16 v18, v206, v24
v_dot2c_f32_bf16 v22, v206, v206
v_dot2c_f32_bf16 v19, v207, v24
v_dot2c_f32_bf16 v23, v207, v207
s_waitcnt vmcnt(8)
ds_read_b64 v[224:225], v32 offset:28672
ds_read_b64 v[226:227], v33 offset:28672
ds_read_b64 v[228:229], v34 offset:28672
ds_read_b64 v[230:231], v35 offset:28672
ds_read_b64 v[232:233], v36 offset:28672
ds_read_b64 v[234:235], v37 offset:28672
ds_read_b64 v[236:237], v38 offset:28672
ds_read_b64 v[238:239], v39 offset:28672
s_waitcnt lgkmcnt(8)
v_dot2c_f32_bf16 v16, v208, v24
v_dot2c_f32_bf16 v20, v208, v208
v_dot2c_f32_bf16 v17, v209, v24
v_dot2c_f32_bf16 v21, v209, v209
v_dot2c_f32_bf16 v18, v210, v24
v_dot2c_f32_bf16 v22, v210, v210
v_dot2c_f32_bf16 v19, v211, v24
v_dot2c_f32_bf16 v23, v211, v211
v_dot2c_f32_bf16 v16, v212, v24
v_dot2c_f32_bf16 v20, v212, v212
v_dot2c_f32_bf16 v17, v213, v24
v_dot2c_f32_bf16 v21, v213, v213
v_dot2c_f32_bf16 v18, v214, v24
v_dot2c_f32_bf16 v22, v214, v214
v_dot2c_f32_bf16 v19, v215, v24
v_dot2c_f32_bf16 v23, v215, v215
v_dot2c_f32_bf16 v16, v216, v24
v_dot2c_f32_bf16 v20, v216, v216
v_dot2c_f32_bf16 v17, v217, v24
v_dot2c_f32_bf16 v21, v217, v217
v_dot2c_f32_bf16 v18, v218, v24
v_dot2c_f32_bf16 v22, v218, v218
v_dot2c_f32_bf16 v19, v219, v24
v_dot2c_f32_bf16 v23, v219, v219
v_dot2c_f32_bf16 v16, v220, v24
v_dot2c_f32_bf16 v20, v220, v220
v_dot2c_f32_bf16 v17, v221, v24
v_dot2c_f32_bf16 v21, v221, v221
v_dot2c_f32_bf16 v18, v222, v24
v_dot2c_f32_bf16 v22, v222, v222
v_dot2c_f32_bf16 v19, v223, v24
v_dot2c_f32_bf16 v23, v223, v223
s_waitcnt vmcnt(4)
ds_read_b64 v[240:241], v32 offset:32768
ds_read_b64 v[242:243], v33 offset:32768
ds_read_b64 v[244:245], v34 offset:32768
ds_read_b64 v[246:247], v35 offset:32768
ds_read_b64 v[248:249], v36 offset:32768
ds_read_b64 v[250:251], v37 offset:32768
ds_read_b64 v[252:253], v38 offset:32768
ds_read_b64 v[254:255], v39 offset:32768
s_waitcnt lgkmcnt(8)
v_dot2c_f32_bf16 v16, v224, v24
v_dot2c_f32_bf16 v20, v224, v224
v_dot2c_f32_bf16 v17, v225, v24
v_dot2c_f32_bf16 v21, v225, v225
v_dot2c_f32_bf16 v18, v226, v24
v_dot2c_f32_bf16 v22, v226, v226
v_dot2c_f32_bf16 v19, v227, v24
v_dot2c_f32_bf16 v23, v227, v227
v_dot2c_f32_bf16 v16, v228, v24
v_dot2c_f32_bf16 v20, v228, v228
v_dot2c_f32_bf16 v17, v229, v24
v_dot2c_f32_bf16 v21, v229, v229
v_dot2c_f32_bf16 v18, v230, v24
v_dot2c_f32_bf16 v22, v230, v230
v_dot2c_f32_bf16 v19, v231, v24
v_dot2c_f32_bf16 v23, v231, v231
v_dot2c_f32_bf16 v16, v232, v24
v_dot2c_f32_bf16 v20, v232, v232
v_dot2c_f32_bf16 v17, v233, v24
v_dot2c_f32_bf16 v21, v233, v233
v_dot2c_f32_bf16 v18, v234, v24
v_dot2c_f32_bf16 v22, v234, v234
v_dot2c_f32_bf16 v19, v235, v24
v_dot2c_f32_bf16 v23, v235, v235
v_dot2c_f32_bf16 v16, v236, v24
v_dot2c_f32_bf16 v20, v236, v236
v_dot2c_f32_bf16 v17, v237, v24
v_dot2c_f32_bf16 v21, v237, v237
v_dot2c_f32_bf16 v18, v238, v24
v_dot2c_f32_bf16 v22, v238, v238
v_dot2c_f32_bf16 v19, v239, v24
v_dot2c_f32_bf16 v23, v239, v239
s_waitcnt lgkmcnt(0)
s_barrier
s_add_u32 m0, s34, 0
s_nop 0
buffer_load_dwordx4 v4, s[8:11], s30 offen lds
v_dot2c_f32_bf16 v16, v240, v24
v_dot2c_f32_bf16 v20, v240, v240
v_dot2c_f32_bf16 v17, v241, v24
v_dot2c_f32_bf16 v21, v241, v241
v_dot2c_f32_bf16 v18, v242, v24
v_dot2c_f32_bf16 v22, v242, v242
v_dot2c_f32_bf16 v19, v243, v24
v_dot2c_f32_bf16 v23, v243, v243
v_dot2c_f32_bf16 v16, v244, v24
v_dot2c_f32_bf16 v20, v244, v244
v_dot2c_f32_bf16 v17, v245, v24
v_dot2c_f32_bf16 v21, v245, v245
v_dot2c_f32_bf16 v18, v246, v24
v_dot2c_f32_bf16 v22, v246, v246
v_dot2c_f32_bf16 v19, v247, v24
v_dot2c_f32_bf16 v23, v247, v247
v_dot2c_f32_bf16 v16, v248, v24
v_dot2c_f32_bf16 v20, v248, v248
v_dot2c_f32_bf16 v17, v249, v24
v_dot2c_f32_bf16 v21, v249, v249
v_dot2c_f32_bf16 v18, v250, v24
v_dot2c_f32_bf16 v22, v250, v250
v_dot2c_f32_bf16 v19, v251, v24
v_dot2c_f32_bf16 v23, v251, v251
v_dot2c_f32_bf16 v16, v252, v24
v_dot2c_f32_bf16 v20, v252, v252
v_dot2c_f32_bf16 v17, v253, v24
v_dot2c_f32_bf16 v21, v253, v253
v_dot2c_f32_bf16 v18, v254, v24
v_dot2c_f32_bf16 v22, v254, v254
v_dot2c_f32_bf16 v19, v255, v24
v_dot2c_f32_bf16 v23, v255, v255
v_add_f32 v16, v16, v17
s_nop 0
v_add_f32 v18, v18, v19
v_add_f32 v20, v20, v21
v_add_f32 v22, v22, v23
v_add_f32 v16, v16, v18
v_add_f32 v20, v20, v22
v_mov_b32 v17, v16
v_mov_b32 v21, v20
s_nop 0
v_permlane32_swap_b32 v16, v17
v_permlane32_swap_b32 v20, v21
v_add_f32 v16, v16, v17
v_add_f32 v20, v20, v21
buffer_load_dwordx4 v5, s[8:11], s30 offen offset:1024 lds
v_mul_f32 v16, 0x3ae38e39, v16
v_mul_f32 v20, 0x3ae38e39, v20
v_fma_f32 v18, -v16, v16, v20
v_max_f32 v18, 0, v18
v_cvt_pk_bf16_f32 v17, v16, v16
v_and_b32 v17, 0xffff0000, v17
v_cvt_pk_bf16_f32 v19, v18, v18
v_and_b32 v19, 0xffff0000, v19
v_add_f32 v19, 0x3727c5ac, v19
v_cvt_pk_bf16_f32 v19, v19, v19
v_and_b32 v19, 0xffff0000, v19
v_sqrt_f32 v19, v19
s_nop 0
v_cvt_pk_bf16_f32 v19, v19, v19
v_and_b32 v19, 0xffff0000, v19
v_rcp_f32 v19, v19
s_nop 0
v_mul_f32 v22, v19, v19
v_mul_f32 v22, v22, v18
v_cvt_pk_bf16_f32 v22, v22, v22
v_and_b32 v22, 0xffff0000, v22
v_add_f32 v22, 0x3727c5ac, v22
v_cvt_pk_bf16_f32 v22, v22, v22
v_and_b32 v22, 0xffff0000, v22
v_sqrt_f32 v22, v22
s_nop 0
v_cvt_pk_bf16_f32 v22, v22, v22
v_and_b32 v22, 0xffff0000, v22
v_rcp_f32 v22, v22
s_cmp_eq_u32 s26, 3
s_cselect_b64 vcc, -1, 0
v_mul_f32 v22, v22, v19
v_mul_f32 v22, 0x3eeff558, v22
v_cndmask_b32 v24, v19, v22, vcc
v_cndmask_b32 v26, v17, v16, vcc
v_mov_b32 v25, v24
v_mul_f32 v26, v26, v24
v_sub_f32 v26, 0, v26
v_mov_b32 v27, v26
s_mov_b32 s60, 0xffff0000
v_lshlrev_b32 v16, 16, v112
v_and_b32 v17, s60, v112
v_lshlrev_b32 v18, 16, v113
v_and_b32 v19, s60, v113
v_pk_fma_f32 v[16:17], v[16:17], v[24:25], v[26:27]
v_pk_fma_f32 v[18:19], v[18:19], v[24:25], v[26:27]
v_cvt_pk_bf16_f32 v112, v16, v17
buffer_load_dwordx4 v6, s[8:11], s30 offen offset:2048 lds
v_cvt_pk_bf16_f32 v113, v18, v19
v_lshlrev_b32 v20, 16, v114
v_and_b32 v21, s60, v114
v_lshlrev_b32 v22, 16, v115
v_and_b32 v23, s60, v115
v_pk_fma_f32 v[20:21], v[20:21], v[24:25], v[26:27]
v_pk_fma_f32 v[22:23], v[22:23], v[24:25], v[26:27]
v_cvt_pk_bf16_f32 v114, v20, v21
v_cvt_pk_bf16_f32 v115, v22, v23
v_lshlrev_b32 v16, 16, v116
v_and_b32 v17, s60, v116
v_lshlrev_b32 v18, 16, v117
v_and_b32 v19, s60, v117
v_pk_fma_f32 v[16:17], v[16:17], v[24:25], v[26:27]
v_pk_fma_f32 v[18:19], v[18:19], v[24:25], v[26:27]
v_cvt_pk_bf16_f32 v116, v16, v17
v_cvt_pk_bf16_f32 v117, v18, v19
v_lshlrev_b32 v20, 16, v118
v_and_b32 v21, s60, v118
v_lshlrev_b32 v22, 16, v119
v_and_b32 v23, s60, v119
v_pk_fma_f32 v[20:21], v[20:21], v[24:25], v[26:27]
v_pk_fma_f32 v[22:23], v[22:23], v[24:25], v[26:27]
v_cvt_pk_bf16_f32 v118, v20, v21
v_cvt_pk_bf16_f32 v119, v22, v23
v_lshlrev_b32 v16, 16, v120
v_and_b32 v17, s60, v120
v_lshlrev_b32 v18, 16, v121
v_and_b32 v19, s60, v121
v_pk_fma_f32 v[16:17], v[16:17], v[24:25], v[26:27]
v_pk_fma_f32 v[18:19], v[18:19], v[24:25], v[26:27]
v_cvt_pk_bf16_f32 v120, v16, v17
v_cvt_pk_bf16_f32 v121, v18, v19
v_lshlrev_b32 v20, 16, v122
v_and_b32 v21, s60, v122
v_lshlrev_b32 v22, 16, v123
v_and_b32 v23, s60, v123
v_pk_fma_f32 v[20:21], v[20:21], v[24:25], v[26:27]
v_pk_fma_f32 v[22:23], v[22:23], v[24:25], v[26:27]
v_cvt_pk_bf16_f32 v122, v20, v21
v_cvt_pk_bf16_f32 v123, v22, v23
v_lshlrev_b32 v16, 16, v124
v_and_b32 v17, s60, v124
v_lshlrev_b32 v18, 16, v125
s_add_u32 m0, s34, 3072
s_nop 0
buffer_load_dwordx4 v4, s[8:11], s31 offen lds
v_and_b32 v19, s60, v125
v_pk_fma_f32 v[16:17], v[16:17], v[24:25], v[26:27]
v_pk_fma_f32 v[18:19], v[18:19], v[24:25], v[26:27]
v_cvt_pk_bf16_f32 v124, v16, v17
v_cvt_pk_bf16_f32 v125, v18, v19
v_lshlrev_b32 v20, 16, v126
v_and_b32 v21, s60, v126
v_lshlrev_b32 v22, 16, v127
v_and_b32 v23, s60, v127
v_pk_fma_f32 v[20:21], v[20:21], v[24:25], v[26:27]
v_pk_fma_f32 v[22:23], v[22:23], v[24:25], v[26:27]
v_cvt_pk_bf16_f32 v126, v20, v21
v_cvt_pk_bf16_f32 v127, v22, v23
v_lshlrev_b32 v16, 16, v128
v_and_b32 v17, s60, v128
v_lshlrev_b32 v18, 16, v129
v_and_b32 v19, s60, v129
v_pk_fma_f32 v[16:17], v[16:17], v[24:25], v[26:27]
v_pk_fma_f32 v[18:19], v[18:19], v[24:25], v[26:27]
v_cvt_pk_bf16_f32 v128, v16, v17
v_cvt_pk_bf16_f32 v129, v18, v19
v_lshlrev_b32 v20, 16, v130
v_and_b32 v21, s60, v130
v_lshlrev_b32 v22, 16, v131
v_and_b32 v23, s60, v131
v_pk_fma_f32 v[20:21], v[20:21], v[24:25], v[26:27]
v_pk_fma_f32 v[22:23], v[22:23], v[24:25], v[26:27]
v_cvt_pk_bf16_f32 v130, v20, v21
v_cvt_pk_bf16_f32 v131, v22, v23
v_lshlrev_b32 v16, 16, v132
v_and_b32 v17, s60, v132
v_lshlrev_b32 v18, 16, v133
v_and_b32 v19, s60, v133
v_pk_fma_f32 v[16:17], v[16:17], v[24:25], v[26:27]
v_pk_fma_f32 v[18:19], v[18:19], v[24:25], v[26:27]
v_cvt_pk_bf16_f32 v132, v16, v17
v_cvt_pk_bf16_f32 v133, v18, v19
v_lshlrev_b32 v20, 16, v134
v_and_b32 v21, s60, v134
v_lshlrev_b32 v22, 16, v135
v_and_b32 v23, s60, v135
v_pk_fma_f32 v[20:21], v[20:21], v[24:25], v[26:27]
v_pk_fma_f32 v[22:23], v[22:23], v[24:25], v[26:27]
v_cvt_pk_bf16_f32 v134, v20, v21
buffer_load_dwordx4 v5, s[8:11], s31 offen offset:1024 lds
v_cvt_pk_bf16_f32 v135, v22, v23
v_lshlrev_b32 v16, 16, v136
v_and_b32 v17, s60, v136
v_lshlrev_b32 v18, 16, v137
v_and_b32 v19, s60, v137
v_pk_fma_f32 v[16:17], v[16:17], v[24:25], v[26:27]
v_pk_fma_f32 v[18:19], v[18:19], v[24:25], v[26:27]
v_cvt_pk_bf16_f32 v136, v16, v17
v_cvt_pk_bf16_f32 v137, v18, v19
v_lshlrev_b32 v20, 16, v138
v_and_b32 v21, s60, v138
v_lshlrev_b32 v22, 16, v139
v_and_b32 v23, s60, v139
v_pk_fma_f32 v[20:21], v[20:21], v[24:25], v[26:27]
v_pk_fma_f32 v[22:23], v[22:23], v[24:25], v[26:27]
v_cvt_pk_bf16_f32 v138, v20, v21
v_cvt_pk_bf16_f32 v139, v22, v23
v_lshlrev_b32 v16, 16, v140
v_and_b32 v17, s60, v140
v_lshlrev_b32 v18, 16, v141
v_and_b32 v19, s60, v141
v_pk_fma_f32 v[16:17], v[16:17], v[24:25], v[26:27]
v_pk_fma_f32 v[18:19], v[18:19], v[24:25], v[26:27]
v_cvt_pk_bf16_f32 v140, v16, v17
v_cvt_pk_bf16_f32 v141, v18, v19
v_lshlrev_b32 v20, 16, v142
v_and_b32 v21, s60, v142
v_lshlrev_b32 v22, 16, v143
v_and_b32 v23, s60, v143
v_pk_fma_f32 v[20:21], v[20:21], v[24:25], v[26:27]
v_pk_fma_f32 v[22:23], v[22:23], v[24:25], v[26:27]
v_cvt_pk_bf16_f32 v142, v20, v21
v_cvt_pk_bf16_f32 v143, v22, v23
v_lshlrev_b32 v16, 16, v144
v_and_b32 v17, s60, v144
v_lshlrev_b32 v18, 16, v145
v_and_b32 v19, s60, v145
v_pk_fma_f32 v[16:17], v[16:17], v[24:25], v[26:27]
v_pk_fma_f32 v[18:19], v[18:19], v[24:25], v[26:27]
v_cvt_pk_bf16_f32 v144, v16, v17
v_cvt_pk_bf16_f32 v145, v18, v19
v_lshlrev_b32 v20, 16, v146
v_and_b32 v21, s60, v146
v_lshlrev_b32 v22, 16, v147
buffer_load_dwordx4 v6, s[8:11], s31 offen offset:2048 lds
s_add_u32 s30, s30, s56
s_add_u32 s31, s31, s56
v_and_b32 v23, s60, v147
v_pk_fma_f32 v[20:21], v[20:21], v[24:25], v[26:27]
v_pk_fma_f32 v[22:23], v[22:23], v[24:25], v[26:27]
v_cvt_pk_bf16_f32 v146, v20, v21
v_cvt_pk_bf16_f32 v147, v22, v23
v_lshlrev_b32 v16, 16, v148
v_and_b32 v17, s60, v148
v_lshlrev_b32 v18, 16, v149
v_and_b32 v19, s60, v149
v_pk_fma_f32 v[16:17], v[16:17], v[24:25], v[26:27]
v_pk_fma_f32 v[18:19], v[18:19], v[24:25], v[26:27]
v_cvt_pk_bf16_f32 v148, v16, v17
v_cvt_pk_bf16_f32 v149, v18, v19
v_lshlrev_b32 v20, 16, v150
v_and_b32 v21, s60, v150
v_lshlrev_b32 v22, 16, v151
v_and_b32 v23, s60, v151
v_pk_fma_f32 v[20:21], v[20:21], v[24:25], v[26:27]
v_pk_fma_f32 v[22:23], v[22:23], v[24:25], v[26:27]
v_cvt_pk_bf16_f32 v150, v20, v21
v_cvt_pk_bf16_f32 v151, v22, v23
v_lshlrev_b32 v16, 16, v152
v_and_b32 v17, s60, v152
v_lshlrev_b32 v18, 16, v153
v_and_b32 v19, s60, v153
v_pk_fma_f32 v[16:17], v[16:17], v[24:25], v[26:27]
v_pk_fma_f32 v[18:19], v[18:19], v[24:25], v[26:27]
v_cvt_pk_bf16_f32 v152, v16, v17
v_cvt_pk_bf16_f32 v153, v18, v19
v_lshlrev_b32 v20, 16, v154
v_and_b32 v21, s60, v154
v_lshlrev_b32 v22, 16, v155
v_and_b32 v23, s60, v155
v_pk_fma_f32 v[20:21], v[20:21], v[24:25], v[26:27]
v_pk_fma_f32 v[22:23], v[22:23], v[24:25], v[26:27]
v_cvt_pk_bf16_f32 v154, v20, v21
v_cvt_pk_bf16_f32 v155, v22, v23
v_lshlrev_b32 v16, 16, v156
v_and_b32 v17, s60, v156
v_lshlrev_b32 v18, 16, v157
v_and_b32 v19, s60, v157
v_pk_fma_f32 v[16:17], v[16:17], v[24:25], v[26:27]
v_pk_fma_f32 v[18:19], v[18:19], v[24:25], v[26:27]
v_cvt_pk_bf16_f32 v156, v16, v17
s_add_u32 m0, s34, 24576
s_nop 0
buffer_load_dwordx4 v4, s[8:11], s30 offen lds
v_cvt_pk_bf16_f32 v157, v18, v19
v_lshlrev_b32 v20, 16, v158
v_and_b32 v21, s60, v158
v_lshlrev_b32 v22, 16, v159
v_and_b32 v23, s60, v159
v_pk_fma_f32 v[20:21], v[20:21], v[24:25], v[26:27]
v_pk_fma_f32 v[22:23], v[22:23], v[24:25], v[26:27]
v_cvt_pk_bf16_f32 v158, v20, v21
v_cvt_pk_bf16_f32 v159, v22, v23
v_lshlrev_b32 v16, 16, v160
v_and_b32 v17, s60, v160
v_lshlrev_b32 v18, 16, v161
v_and_b32 v19, s60, v161
v_pk_fma_f32 v[16:17], v[16:17], v[24:25], v[26:27]
v_pk_fma_f32 v[18:19], v[18:19], v[24:25], v[26:27]
v_cvt_pk_bf16_f32 v160, v16, v17
v_cvt_pk_bf16_f32 v161, v18, v19
v_lshlrev_b32 v20, 16, v162
v_and_b32 v21, s60, v162
v_lshlrev_b32 v22, 16, v163
v_and_b32 v23, s60, v163
v_pk_fma_f32 v[20:21], v[20:21], v[24:25], v[26:27]
v_pk_fma_f32 v[22:23], v[22:23], v[24:25], v[26:27]
v_cvt_pk_bf16_f32 v162, v20, v21
v_cvt_pk_bf16_f32 v163, v22, v23
v_lshlrev_b32 v16, 16, v164
v_and_b32 v17, s60, v164
v_lshlrev_b32 v18, 16, v165
v_and_b32 v19, s60, v165
v_pk_fma_f32 v[16:17], v[16:17], v[24:25], v[26:27]
v_pk_fma_f32 v[18:19], v[18:19], v[24:25], v[26:27]
v_cvt_pk_bf16_f32 v164, v16, v17
v_cvt_pk_bf16_f32 v165, v18, v19
v_lshlrev_b32 v20, 16, v166
v_and_b32 v21, s60, v166
v_lshlrev_b32 v22, 16, v167
v_and_b32 v23, s60, v167
v_pk_fma_f32 v[20:21], v[20:21], v[24:25], v[26:27]
v_pk_fma_f32 v[22:23], v[22:23], v[24:25], v[26:27]
v_cvt_pk_bf16_f32 v166, v20, v21
v_cvt_pk_bf16_f32 v167, v22, v23
v_lshlrev_b32 v16, 16, v168
v_and_b32 v17, s60, v168
v_lshlrev_b32 v18, 16, v169
buffer_load_dwordx4 v5, s[8:11], s30 offen offset:1024 lds
v_and_b32 v19, s60, v169
v_pk_fma_f32 v[16:17], v[16:17], v[24:25], v[26:27]
v_pk_fma_f32 v[18:19], v[18:19], v[24:25], v[26:27]
v_cvt_pk_bf16_f32 v168, v16, v17
v_cvt_pk_bf16_f32 v169, v18, v19
v_lshlrev_b32 v20, 16, v170
v_and_b32 v21, s60, v170
v_lshlrev_b32 v22, 16, v171
v_and_b32 v23, s60, v171
v_pk_fma_f32 v[20:21], v[20:21], v[24:25], v[26:27]
v_pk_fma_f32 v[22:23], v[22:23], v[24:25], v[26:27]
v_cvt_pk_bf16_f32 v170, v20, v21
v_cvt_pk_bf16_f32 v171, v22, v23
v_lshlrev_b32 v16, 16, v172
v_and_b32 v17, s60, v172
v_lshlrev_b32 v18, 16, v173
v_and_b32 v19, s60, v173
v_pk_fma_f32 v[16:17], v[16:17], v[24:25], v[26:27]
v_pk_fma_f32 v[18:19], v[18:19], v[24:25], v[26:27]
v_cvt_pk_bf16_f32 v172, v16, v17
v_cvt_pk_bf16_f32 v173, v18, v19
v_lshlrev_b32 v20, 16, v174
v_and_b32 v21, s60, v174
v_lshlrev_b32 v22, 16, v175
v_and_b32 v23, s60, v175
v_pk_fma_f32 v[20:21], v[20:21], v[24:25], v[26:27]
v_pk_fma_f32 v[22:23], v[22:23], v[24:25], v[26:27]
v_cvt_pk_bf16_f32 v174, v20, v21
v_cvt_pk_bf16_f32 v175, v22, v23
v_lshlrev_b32 v16, 16, v176
v_and_b32 v17, s60, v176
v_lshlrev_b32 v18, 16, v177
v_and_b32 v19, s60, v177
v_pk_fma_f32 v[16:17], v[16:17], v[24:25], v[26:27]
v_pk_fma_f32 v[18:19], v[18:19], v[24:25], v[26:27]
v_cvt_pk_bf16_f32 v176, v16, v17
v_cvt_pk_bf16_f32 v177, v18, v19
v_lshlrev_b32 v20, 16, v178
v_and_b32 v21, s60, v178
v_lshlrev_b32 v22, 16, v179
v_and_b32 v23, s60, v179
v_pk_fma_f32 v[20:21], v[20:21], v[24:25], v[26:27]
v_pk_fma_f32 v[22:23], v[22:23], v[24:25], v[26:27]
v_cvt_pk_bf16_f32 v178, v20, v21
buffer_load_dwordx4 v6, s[8:11], s30 offen offset:2048 lds
v_cvt_pk_bf16_f32 v179, v22, v23
v_lshlrev_b32 v16, 16, v180
v_and_b32 v17, s60, v180
v_lshlrev_b32 v18, 16, v181
v_and_b32 v19, s60, v181
v_pk_fma_f32 v[16:17], v[16:17], v[24:25], v[26:27]
v_pk_fma_f32 v[18:19], v[18:19], v[24:25], v[26:27]
v_cvt_pk_bf16_f32 v180, v16, v17
v_cvt_pk_bf16_f32 v181, v18, v19
v_lshlrev_b32 v20, 16, v182
v_and_b32 v21, s60, v182
v_lshlrev_b32 v22, 16, v183
v_and_b32 v23, s60, v183
v_pk_fma_f32 v[20:21], v[20:21], v[24:25], v[26:27]
v_pk_fma_f32 v[22:23], v[22:23], v[24:25], v[26:27]
v_cvt_pk_bf16_f32 v182, v20, v21
v_cvt_pk_bf16_f32 v183, v22, v23
v_lshlrev_b32 v16, 16, v184
v_and_b32 v17, s60, v184
v_lshlrev_b32 v18, 16, v185
v_and_b32 v19, s60, v185
v_pk_fma_f32 v[16:17], v[16:17], v[24:25], v[26:27]
v_pk_fma_f32 v[18:19], v[18:19], v[24:25], v[26:27]
v_cvt_pk_bf16_f32 v184, v16, v17
v_cvt_pk_bf16_f32 v185, v18, v19
v_lshlrev_b32 v20, 16, v186
v_and_b32 v21, s60, v186
v_lshlrev_b32 v22, 16, v187
v_and_b32 v23, s60, v187
v_pk_fma_f32 v[20:21], v[20:21], v[24:25], v[26:27]
v_pk_fma_f32 v[22:23], v[22:23], v[24:25], v[26:27]
v_cvt_pk_bf16_f32 v186, v20, v21
v_cvt_pk_bf16_f32 v187, v22, v23
v_lshlrev_b32 v16, 16, v188
v_and_b32 v17, s60, v188
v_lshlrev_b32 v18, 16, v189
v_and_b32 v19, s60, v189
v_pk_fma_f32 v[16:17], v[16:17], v[24:25], v[26:27]
v_pk_fma_f32 v[18:19], v[18:19], v[24:25], v[26:27]
v_cvt_pk_bf16_f32 v188, v16, v17
v_cvt_pk_bf16_f32 v189, v18, v19
v_lshlrev_b32 v20, 16, v190
v_and_b32 v21, s60, v190
v_lshlrev_b32 v22, 16, v191
s_add_u32 m0, s34, 27648
s_nop 0
buffer_load_dwordx4 v4, s[8:11], s31 offen lds
v_and_b32 v23, s60, v191
v_pk_fma_f32 v[20:21], v[20:21], v[24:25], v[26:27]
v_pk_fma_f32 v[22:23], v[22:23], v[24:25], v[26:27]
v_cvt_pk_bf16_f32 v190, v20, v21
v_cvt_pk_bf16_f32 v191, v22, v23
v_lshlrev_b32 v16, 16, v192
v_and_b32 v17, s60, v192
v_lshlrev_b32 v18, 16, v193
v_and_b32 v19, s60, v193
v_pk_fma_f32 v[16:17], v[16:17], v[24:25], v[26:27]
v_pk_fma_f32 v[18:19], v[18:19], v[24:25], v[26:27]
v_cvt_pk_bf16_f32 v192, v16, v17
v_cvt_pk_bf16_f32 v193, v18, v19
v_lshlrev_b32 v20, 16, v194
v_and_b32 v21, s60, v194
v_lshlrev_b32 v22, 16, v195
v_and_b32 v23, s60, v195
v_pk_fma_f32 v[20:21], v[20:21], v[24:25], v[26:27]
v_pk_fma_f32 v[22:23], v[22:23], v[24:25], v[26:27]
v_cvt_pk_bf16_f32 v194, v20, v21
v_cvt_pk_bf16_f32 v195, v22, v23
v_lshlrev_b32 v16, 16, v196
v_and_b32 v17, s60, v196
v_lshlrev_b32 v18, 16, v197
v_and_b32 v19, s60, v197
v_pk_fma_f32 v[16:17], v[16:17], v[24:25], v[26:27]
v_pk_fma_f32 v[18:19], v[18:19], v[24:25], v[26:27]
v_cvt_pk_bf16_f32 v196, v16, v17
v_cvt_pk_bf16_f32 v197, v18, v19
v_lshlrev_b32 v20, 16, v198
v_and_b32 v21, s60, v198
v_lshlrev_b32 v22, 16, v199
v_and_b32 v23, s60, v199
v_pk_fma_f32 v[20:21], v[20:21], v[24:25], v[26:27]
v_pk_fma_f32 v[22:23], v[22:23], v[24:25], v[26:27]
v_cvt_pk_bf16_f32 v198, v20, v21
v_cvt_pk_bf16_f32 v199, v22, v23
v_lshlrev_b32 v16, 16, v200
v_and_b32 v17, s60, v200
v_lshlrev_b32 v18, 16, v201
v_and_b32 v19, s60, v201
v_pk_fma_f32 v[16:17], v[16:17], v[24:25], v[26:27]
v_pk_fma_f32 v[18:19], v[18:19], v[24:25], v[26:27]
v_cvt_pk_bf16_f32 v200, v16, v17
buffer_load_dwordx4 v5, s[8:11], s31 offen offset:1024 lds
v_cvt_pk_bf16_f32 v201, v18, v19
v_lshlrev_b32 v20, 16, v202
v_and_b32 v21, s60, v202
v_lshlrev_b32 v22, 16, v203
v_and_b32 v23, s60, v203
v_pk_fma_f32 v[20:21], v[20:21], v[24:25], v[26:27]
v_pk_fma_f32 v[22:23], v[22:23], v[24:25], v[26:27]
v_cvt_pk_bf16_f32 v202, v20, v21
v_cvt_pk_bf16_f32 v203, v22, v23
v_lshlrev_b32 v16, 16, v204
v_and_b32 v17, s60, v204
v_lshlrev_b32 v18, 16, v205
v_and_b32 v19, s60, v205
v_pk_fma_f32 v[16:17], v[16:17], v[24:25], v[26:27]
v_pk_fma_f32 v[18:19], v[18:19], v[24:25], v[26:27]
v_cvt_pk_bf16_f32 v204, v16, v17
v_cvt_pk_bf16_f32 v205, v18, v19
v_lshlrev_b32 v20, 16, v206
v_and_b32 v21, s60, v206
v_lshlrev_b32 v22, 16, v207
v_and_b32 v23, s60, v207
v_pk_fma_f32 v[20:21], v[20:21], v[24:25], v[26:27]
v_pk_fma_f32 v[22:23], v[22:23], v[24:25], v[26:27]
v_cvt_pk_bf16_f32 v206, v20, v21
v_cvt_pk_bf16_f32 v207, v22, v23
v_lshlrev_b32 v16, 16, v208
v_and_b32 v17, s60, v208
v_lshlrev_b32 v18, 16, v209
v_and_b32 v19, s60, v209
v_pk_fma_f32 v[16:17], v[16:17], v[24:25], v[26:27]
v_pk_fma_f32 v[18:19], v[18:19], v[24:25], v[26:27]
v_cvt_pk_bf16_f32 v208, v16, v17
v_cvt_pk_bf16_f32 v209, v18, v19
v_lshlrev_b32 v20, 16, v210
v_and_b32 v21, s60, v210
v_lshlrev_b32 v22, 16, v211
v_and_b32 v23, s60, v211
v_pk_fma_f32 v[20:21], v[20:21], v[24:25], v[26:27]
v_pk_fma_f32 v[22:23], v[22:23], v[24:25], v[26:27]
v_cvt_pk_bf16_f32 v210, v20, v21
v_cvt_pk_bf16_f32 v211, v22, v23
v_lshlrev_b32 v16, 16, v212
v_and_b32 v17, s60, v212
v_lshlrev_b32 v18, 16, v213
buffer_load_dwordx4 v6, s[8:11], s31 offen offset:2048 lds
s_add_u32 s30, s30, s57
s_add_u32 s31, s31, s57
v_and_b32 v19, s60, v213
v_pk_fma_f32 v[16:17], v[16:17], v[24:25], v[26:27]
v_pk_fma_f32 v[18:19], v[18:19], v[24:25], v[26:27]
v_cvt_pk_bf16_f32 v212, v16, v17
v_cvt_pk_bf16_f32 v213, v18, v19
v_lshlrev_b32 v20, 16, v214
v_and_b32 v21, s60, v214
v_lshlrev_b32 v22, 16, v215
v_and_b32 v23, s60, v215
v_pk_fma_f32 v[20:21], v[20:21], v[24:25], v[26:27]
v_pk_fma_f32 v[22:23], v[22:23], v[24:25], v[26:27]
v_cvt_pk_bf16_f32 v214, v20, v21
v_cvt_pk_bf16_f32 v215, v22, v23
v_lshlrev_b32 v16, 16, v216
v_and_b32 v17, s60, v216
v_lshlrev_b32 v18, 16, v217
v_and_b32 v19, s60, v217
v_pk_fma_f32 v[16:17], v[16:17], v[24:25], v[26:27]
v_pk_fma_f32 v[18:19], v[18:19], v[24:25], v[26:27]
v_cvt_pk_bf16_f32 v216, v16, v17
v_cvt_pk_bf16_f32 v217, v18, v19
v_lshlrev_b32 v20, 16, v218
v_and_b32 v21, s60, v218
v_lshlrev_b32 v22, 16, v219
v_and_b32 v23, s60, v219
v_pk_fma_f32 v[20:21], v[20:21], v[24:25], v[26:27]
v_pk_fma_f32 v[22:23], v[22:23], v[24:25], v[26:27]
v_cvt_pk_bf16_f32 v218, v20, v21
v_cvt_pk_bf16_f32 v219, v22, v23
v_lshlrev_b32 v16, 16, v220
v_and_b32 v17, s60, v220
v_lshlrev_b32 v18, 16, v221
v_and_b32 v19, s60, v221
v_pk_fma_f32 v[16:17], v[16:17], v[24:25], v[26:27]
v_pk_fma_f32 v[18:19], v[18:19], v[24:25], v[26:27]
v_cvt_pk_bf16_f32 v220, v16, v17
v_cvt_pk_bf16_f32 v221, v18, v19
v_lshlrev_b32 v20, 16, v222
v_and_b32 v21, s60, v222
v_lshlrev_b32 v22, 16, v223
v_and_b32 v23, s60, v223
v_pk_fma_f32 v[20:21], v[20:21], v[24:25], v[26:27]
v_pk_fma_f32 v[22:23], v[22:23], v[24:25], v[26:27]
v_cvt_pk_bf16_f32 v222, v20, v21
v_cvt_pk_bf16_f32 v223, v22, v23
v_lshlrev_b32 v16, 16, v224
v_and_b32 v17, s60, v224
v_lshlrev_b32 v18, 16, v225
v_and_b32 v19, s60, v225
v_pk_fma_f32 v[16:17], v[16:17], v[24:25], v[26:27]
v_pk_fma_f32 v[18:19], v[18:19], v[24:25], v[26:27]
v_cvt_pk_bf16_f32 v224, v16, v17
v_cvt_pk_bf16_f32 v225, v18, v19
v_lshlrev_b32 v20, 16, v226
v_and_b32 v21, s60, v226
v_lshlrev_b32 v22, 16, v227
v_and_b32 v23, s60, v227
v_pk_fma_f32 v[20:21], v[20:21], v[24:25], v[26:27]
v_pk_fma_f32 v[22:23], v[22:23], v[24:25], v[26:27]
v_cvt_pk_bf16_f32 v226, v20, v21
v_cvt_pk_bf16_f32 v227, v22, v23
v_lshlrev_b32 v16, 16, v228
v_and_b32 v17, s60, v228
v_lshlrev_b32 v18, 16, v229
v_and_b32 v19, s60, v229
v_pk_fma_f32 v[16:17], v[16:17], v[24:25], v[26:27]
v_pk_fma_f32 v[18:19], v[18:19], v[24:25], v[26:27]
v_cvt_pk_bf16_f32 v228, v16, v17
v_cvt_pk_bf16_f32 v229, v18, v19
v_lshlrev_b32 v20, 16, v230
v_and_b32 v21, s60, v230
v_lshlrev_b32 v22, 16, v231
v_and_b32 v23, s60, v231
v_pk_fma_f32 v[20:21], v[20:21], v[24:25], v[26:27]
v_pk_fma_f32 v[22:23], v[22:23], v[24:25], v[26:27]
v_cvt_pk_bf16_f32 v230, v20, v21
v_cvt_pk_bf16_f32 v231, v22, v23
v_lshlrev_b32 v16, 16, v232
v_and_b32 v17, s60, v232
v_lshlrev_b32 v18, 16, v233
v_and_b32 v19, s60, v233
v_pk_fma_f32 v[16:17], v[16:17], v[24:25], v[26:27]
v_pk_fma_f32 v[18:19], v[18:19], v[24:25], v[26:27]
v_cvt_pk_bf16_f32 v232, v16, v17
v_cvt_pk_bf16_f32 v233, v18, v19
v_lshlrev_b32 v20, 16, v234
v_and_b32 v21, s60, v234
v_lshlrev_b32 v22, 16, v235
v_and_b32 v23, s60, v235
v_pk_fma_f32 v[20:21], v[20:21], v[24:25], v[26:27]
v_pk_fma_f32 v[22:23], v[22:23], v[24:25], v[26:27]
v_cvt_pk_bf16_f32 v234, v20, v21
v_cvt_pk_bf16_f32 v235, v22, v23
v_lshlrev_b32 v16, 16, v236
v_and_b32 v17, s60, v236
v_lshlrev_b32 v18, 16, v237
v_and_b32 v19, s60, v237
v_pk_fma_f32 v[16:17], v[16:17], v[24:25], v[26:27]
v_pk_fma_f32 v[18:19], v[18:19], v[24:25], v[26:27]
v_cvt_pk_bf16_f32 v236, v16, v17
v_cvt_pk_bf16_f32 v237, v18, v19
v_lshlrev_b32 v20, 16, v238
v_and_b32 v21, s60, v238
v_lshlrev_b32 v22, 16, v239
v_and_b32 v23, s60, v239
v_pk_fma_f32 v[20:21], v[20:21], v[24:25], v[26:27]
v_pk_fma_f32 v[22:23], v[22:23], v[24:25], v[26:27]
v_cvt_pk_bf16_f32 v238, v20, v21
v_cvt_pk_bf16_f32 v239, v22, v23
v_lshlrev_b32 v16, 16, v240
v_and_b32 v17, s60, v240
v_lshlrev_b32 v18, 16, v241
v_and_b32 v19, s60, v241
v_pk_fma_f32 v[16:17], v[16:17], v[24:25], v[26:27]
v_pk_fma_f32 v[18:19], v[18:19], v[24:25], v[26:27]
v_cvt_pk_bf16_f32 v240, v16, v17
v_cvt_pk_bf16_f32 v241, v18, v19
v_lshlrev_b32 v20, 16, v242
v_and_b32 v21, s60, v242
v_lshlrev_b32 v22, 16, v243
v_and_b32 v23, s60, v243
v_pk_fma_f32 v[20:21], v[20:21], v[24:25], v[26:27]
v_pk_fma_f32 v[22:23], v[22:23], v[24:25], v[26:27]
v_cvt_pk_bf16_f32 v242, v20, v21
v_cvt_pk_bf16_f32 v243, v22, v23
v_lshlrev_b32 v16, 16, v244
v_and_b32 v17, s60, v244
v_lshlrev_b32 v18, 16, v245
v_and_b32 v19, s60, v245
v_pk_fma_f32 v[16:17], v[16:17], v[24:25], v[26:27]
v_pk_fma_f32 v[18:19], v[18:19], v[24:25], v[26:27]
v_cvt_pk_bf16_f32 v244, v16, v17
v_cvt_pk_bf16_f32 v245, v18, v19
v_lshlrev_b32 v20, 16, v246
v_and_b32 v21, s60, v246
v_lshlrev_b32 v22, 16, v247
v_and_b32 v23, s60, v247
v_pk_fma_f32 v[20:21], v[20:21], v[24:25], v[26:27]
v_pk_fma_f32 v[22:23], v[22:23], v[24:25], v[26:27]
v_cvt_pk_bf16_f32 v246, v20, v21
v_cvt_pk_bf16_f32 v247, v22, v23
v_lshlrev_b32 v16, 16, v248
v_and_b32 v17, s60, v248
v_lshlrev_b32 v18, 16, v249
v_and_b32 v19, s60, v249
v_pk_fma_f32 v[16:17], v[16:17], v[24:25], v[26:27]
v_pk_fma_f32 v[18:19], v[18:19], v[24:25], v[26:27]
v_cvt_pk_bf16_f32 v248, v16, v17
v_cvt_pk_bf16_f32 v249, v18, v19
v_lshlrev_b32 v20, 16, v250
v_and_b32 v21, s60, v250
v_lshlrev_b32 v22, 16, v251
v_and_b32 v23, s60, v251
v_pk_fma_f32 v[20:21], v[20:21], v[24:25], v[26:27]
v_pk_fma_f32 v[22:23], v[22:23], v[24:25], v[26:27]
v_cvt_pk_bf16_f32 v250, v20, v21
v_cvt_pk_bf16_f32 v251, v22, v23
v_lshlrev_b32 v16, 16, v252
v_and_b32 v17, s60, v252
v_lshlrev_b32 v18, 16, v253
v_and_b32 v19, s60, v253
v_pk_fma_f32 v[16:17], v[16:17], v[24:25], v[26:27]
v_pk_fma_f32 v[18:19], v[18:19], v[24:25], v[26:27]
v_cvt_pk_bf16_f32 v252, v16, v17
v_cvt_pk_bf16_f32 v253, v18, v19
v_lshlrev_b32 v20, 16, v254
v_and_b32 v21, s60, v254
v_lshlrev_b32 v22, 16, v255
v_and_b32 v23, s60, v255
v_pk_fma_f32 v[20:21], v[20:21], v[24:25], v[26:27]
v_pk_fma_f32 v[22:23], v[22:23], v[24:25], v[26:27]
v_cvt_pk_bf16_f32 v254, v20, v21
v_cvt_pk_bf16_f32 v255, v22, v23
s_cmp_eq_u32 s26, 3
s_cbranch_scc1 L_ka_h
s_cmp_eq_u32 s26, 2
s_cbranch_scc1 L_ka_v
s_mov_b32 s32, 0x340000
s_cmp_eq_u32 s26, 0
s_cselect_b32 s32, 0x100000, s32
s_cselect_b32 s49, 0x3eae1a93, 1.0
s_mov_b32 s42, 0x10000
s_cselect_b32 s42, 1024, s42
s_add_u32 s16, s6, s32
s_addc_u32 s17, s7, 0
s_mov_b32 s18, 0x240000
s_mov_b32 s19, 0x00020000
s_lshl_b32 s32, s35, 10
s_cmp_eq_u32 s26, 0
s_cselect_b32 s43, s41, s32
s_mul_i32 s32, s27, 12
s_mul_i32 s32, s32, s42
s_add_u32 s43, s43, s32
v_mov_b32 v28, 0
s_add_u32 s44, s6, 0xea0000
s_addc_u32 s45, s7, 0
s_mov_b32 s46, 0x240000
s_mov_b32 s47, 0x00020000
s_waitcnt vmcnt(6)
s_barrier
ds_read_b64_tr_b16 a[0:1], v7 offset:0
ds_read_b64_tr_b16 a[2:3], v7 offset:1024
ds_read_b64_tr_b16 a[4:5], v8 offset:0
ds_read_b64_tr_b16 a[6:7], v8 offset:1024
ds_read_b64_tr_b16 a[8:9], v7 offset:2048
ds_read_b64_tr_b16 a[10:11], v7 offset:3072
ds_read_b64_tr_b16 a[12:13], v8 offset:2048
ds_read_b64_tr_b16 a[14:15], v8 offset:3072
ds_read_b64_tr_b16 a[16:17], v7 offset:4096
ds_read_b64_tr_b16 a[18:19], v7 offset:5120
ds_read_b64_tr_b16 a[20:21], v8 offset:4096
ds_read_b64_tr_b16 a[22:23], v8 offset:5120
ds_read_b64_tr_b16 a[24:25], v7 offset:6144
ds_read_b64_tr_b16 a[26:27], v7 offset:7168
s_waitcnt lgkmcnt(6)
v_mfma_f32_32x32x16_bf16 v[48:63], a[0:3], v[112:115], 0
ds_read_b64_tr_b16 a[28:29], v8 offset:6144
ds_read_b64_tr_b16 a[30:31], v8 offset:7168
s_add_u32 m0, s34, 49152
s_nop 0
buffer_load_dwordx4 v4, s[8:11], s30 offen lds
buffer_load_dwordx4 v5, s[8:11], s30 offen offset:1024 lds
v_mfma_f32_32x32x16_bf16 v[64:79], a[4:7], v[112:115], 0
ds_read_b64_tr_b16 a[0:1], v7 offset:8192
ds_read_b64_tr_b16 a[2:3], v7 offset:9216
buffer_load_dwordx4 v6, s[8:11], s30 offen offset:2048 lds
v_mfma_f32_32x32x16_bf16 v[48:63], a[8:11], v[116:119], v[48:63]
ds_read_b64_tr_b16 a[4:5], v8 offset:8192
ds_read_b64_tr_b16 a[6:7], v8 offset:9216
s_mul_i32 s32, s26, 3
s_add_u32 s32, s32, s27
s_mul_i32 s59, s32, 6144
s_add_u32 s59, s59, s41
s_lshl_b32 s50, s51, 2
s_add_u32 s50, s50, s32
s_mul_i32 s32, s50, 43
s_lshr_b32 s32, s32, 8
s_mul_i32 s32, s32, 6
s_sub_u32 s50, s50, s32
s_add_u32 s33, s59, 3072
s_add_u32 m0, s34, 52224
s_nop 0
buffer_load_dwordx4 v4, s[8:11], s31 offen lds
v_mfma_f32_32x32x16_bf16 v[64:79], a[12:15], v[116:119], v[64:79]
ds_read_b64_tr_b16 a[8:9], v7 offset:10240
ds_read_b64_tr_b16 a[10:11], v7 offset:11264
buffer_load_dwordx4 v5, s[8:11], s31 offen offset:1024 lds
s_waitcnt lgkmcnt(6)
v_mfma_f32_32x32x16_bf16 v[48:63], a[16:19], v[120:123], v[48:63]
ds_read_b64_tr_b16 a[12:13], v8 offset:10240
ds_read_b64_tr_b16 a[14:15], v8 offset:11264
buffer_load_dwordx4 v6, s[8:11], s31 offen offset:2048 lds
s_add_u32 s30, s30, s58
s_add_u32 s31, s31, s58
v_mfma_f32_32x32x16_bf16 v[64:79], a[20:23], v[120:123], v[64:79]
ds_read_b64_tr_b16 a[16:17], v7 offset:12288
ds_read_b64_tr_b16 a[18:19], v7 offset:13312
s_add_u32 m0, s34, 73728
s_nop 0
buffer_load_dwordx4 v4, s[8:11], s30 offen lds
v_mfma_f32_32x32x16_bf16 v[48:63], a[24:27], v[124:127], v[48:63]
ds_read_b64_tr_b16 a[20:21], v8 offset:12288
ds_read_b64_tr_b16 a[22:23], v8 offset:13312
buffer_load_dwordx4 v5, s[8:11], s30 offen offset:1024 lds
v_mfma_f32_32x32x16_bf16 v[64:79], a[28:31], v[124:127], v[64:79]
ds_read_b64_tr_b16 a[24:25], v7 offset:14336
ds_read_b64_tr_b16 a[26:27], v7 offset:15360
buffer_load_dwordx4 v6, s[8:11], s30 offen offset:2048 lds
s_waitcnt lgkmcnt(6)
v_mfma_f32_32x32x16_bf16 v[48:63], a[0:3], v[128:131], v[48:63]
ds_read_b64_tr_b16 a[28:29], v8 offset:14336
ds_read_b64_tr_b16 a[30:31], v8 offset:15360
s_add_u32 m0, s34, 76800
s_nop 0
buffer_load_dwordx4 v4, s[8:11], s31 offen lds
buffer_load_dwordx4 v5, s[8:11], s31 offen offset:1024 lds
v_mfma_f32_32x32x16_bf16 v[64:79], a[4:7], v[128:131], v[64:79]
ds_read_b64_tr_b16 a[0:1], v7 offset:16384
ds_read_b64_tr_b16 a[2:3], v7 offset:17408
buffer_load_dwordx4 v6, s[8:11], s31 offen offset:2048 lds
s_add_u32 s30, s30, s56
s_add_u32 s31, s31, s56
v_mfma_f32_32x32x16_bf16 v[48:63], a[8:11], v[132:135], v[48:63]
ds_read_b64_tr_b16 a[4:5], v8 offset:16384
ds_read_b64_tr_b16 a[6:7], v8 offset:17408
s_add_u32 m0, s34, 98304
s_nop 0
buffer_load_dwordx4 v4, s[8:11], s30 offen lds
v_mfma_f32_32x32x16_bf16 v[64:79], a[12:15], v[132:135], v[64:79]
ds_read_b64_tr_b16 a[8:9], v7 offset:18432
ds_read_b64_tr_b16 a[10:11], v7 offset:19456
buffer_load_dwordx4 v5, s[8:11], s30 offen offset:1024 lds
s_waitcnt lgkmcnt(6)
v_mfma_f32_32x32x16_bf16 v[48:63], a[16:19], v[136:139], v[48:63]
ds_read_b64_tr_b16 a[12:13], v8 offset:18432
ds_read_b64_tr_b16 a[14:15], v8 offset:19456
buffer_load_dwordx4 v6, s[8:11], s30 offen offset:2048 lds
v_mfma_f32_32x32x16_bf16 v[64:79], a[20:23], v[136:139], v[64:79]
ds_read_b64_tr_b16 a[16:17], v7 offset:20480
ds_read_b64_tr_b16 a[18:19], v7 offset:21504
s_add_u32 m0, s34, 101376
s_nop 0
buffer_load_dwordx4 v4, s[8:11], s31 offen lds
v_mfma_f32_32x32x16_bf16 v[48:63], a[24:27], v[140:143], v[48:63]
ds_read_b64_tr_b16 a[20:21], v8 offset:20480
ds_read_b64_tr_b16 a[22:23], v8 offset:21504
buffer_load_dwordx4 v5, s[8:11], s31 offen offset:1024 lds
v_mfma_f32_32x32x16_bf16 v[64:79], a[28:31], v[140:143], v[64:79]
ds_read_b64_tr_b16 a[24:25], v7 offset:22528
ds_read_b64_tr_b16 a[26:27], v7 offset:23552
buffer_load_dwordx4 v6, s[8:11], s31 offen offset:2048 lds
s_add_u32 s30, s30, s57
s_add_u32 s31, s31, s57
s_waitcnt lgkmcnt(6)
v_mfma_f32_32x32x16_bf16 v[48:63], a[0:3], v[144:147], v[48:63]
ds_read_b64_tr_b16 a[28:29], v8 offset:22528
ds_read_b64_tr_b16 a[30:31], v8 offset:23552
s_waitcnt vmcnt(18)
s_barrier
v_mfma_f32_32x32x16_bf16 v[64:79], a[4:7], v[144:147], v[64:79]
ds_read_b64_tr_b16 a[0:1], v7 offset:24576
ds_read_b64_tr_b16 a[2:3], v7 offset:25600
s_add_u32 m0, s34, 122880
v_mfma_f32_32x32x16_bf16 v[48:63], a[8:11], v[148:151], v[48:63]
ds_read_b64_tr_b16 a[4:5], v8 offset:24576
ds_read_b64_tr_b16 a[6:7], v8 offset:25600
v_mfma_f32_32x32x16_bf16 v[64:79], a[12:15], v[148:151], v[64:79]
ds_read_b64_tr_b16 a[8:9], v7 offset:26624
ds_read_b64_tr_b16 a[10:11], v7 offset:27648
buffer_load_dwordx4 v4, s[8:11], s30 offen lds
s_waitcnt lgkmcnt(6)
v_mfma_f32_32x32x16_bf16 v[48:63], a[16:19], v[152:155], v[48:63]
ds_read_b64_tr_b16 a[12:13], v8 offset:26624
ds_read_b64_tr_b16 a[14:15], v8 offset:27648
v_mfma_f32_32x32x16_bf16 v[64:79], a[20:23], v[152:155], v[64:79]
ds_read_b64_tr_b16 a[16:17], v7 offset:28672
ds_read_b64_tr_b16 a[18:19], v7 offset:29696
buffer_load_dwordx4 v5, s[8:11], s30 offen offset:1024 lds
v_mfma_f32_32x32x16_bf16 v[48:63], a[24:27], v[156:159], v[48:63]
ds_read_b64_tr_b16 a[20:21], v8 offset:28672
ds_read_b64_tr_b16 a[22:23], v8 offset:29696
v_mfma_f32_32x32x16_bf16 v[64:79], a[28:31], v[156:159], v[64:79]
ds_read_b64_tr_b16 a[24:25], v7 offset:30720
ds_read_b64_tr_b16 a[26:27], v7 offset:31744
buffer_load_dwordx4 v6, s[8:11], s30 offen offset:2048 lds
s_waitcnt lgkmcnt(6)
v_mfma_f32_32x32x16_bf16 v[48:63], a[0:3], v[160:163], v[48:63]
ds_read_b64_tr_b16 a[28:29], v8 offset:30720
ds_read_b64_tr_b16 a[30:31], v8 offset:31744
v_mfma_f32_32x32x16_bf16 v[64:79], a[4:7], v[160:163], v[64:79]
ds_read_b64_tr_b16 a[0:1], v7 offset:32768
ds_read_b64_tr_b16 a[2:3], v7 offset:33792
s_add_u32 m0, s34, 125952
v_mfma_f32_32x32x16_bf16 v[48:63], a[8:11], v[164:167], v[48:63]
ds_read_b64_tr_b16 a[4:5], v8 offset:32768
ds_read_b64_tr_b16 a[6:7], v8 offset:33792
v_mfma_f32_32x32x16_bf16 v[64:79], a[12:15], v[164:167], v[64:79]
ds_read_b64_tr_b16 a[8:9], v7 offset:34816
ds_read_b64_tr_b16 a[10:11], v7 offset:35840
buffer_load_dwordx4 v4, s[8:11], s31 offen lds
s_waitcnt lgkmcnt(6)
v_mfma_f32_32x32x16_bf16 v[48:63], a[16:19], v[168:171], v[48:63]
ds_read_b64_tr_b16 a[12:13], v8 offset:34816
ds_read_b64_tr_b16 a[14:15], v8 offset:35840
v_mfma_f32_32x32x16_bf16 v[64:79], a[20:23], v[168:171], v[64:79]
ds_read_b64_tr_b16 a[16:17], v7 offset:36864
ds_read_b64_tr_b16 a[18:19], v7 offset:37888
buffer_load_dwordx4 v5, s[8:11], s31 offen offset:1024 lds
v_mfma_f32_32x32x16_bf16 v[48:63], a[24:27], v[172:175], v[48:63]
ds_read_b64_tr_b16 a[20:21], v8 offset:36864
ds_read_b64_tr_b16 a[22:23], v8 offset:37888
v_mfma_f32_32x32x16_bf16 v[64:79], a[28:31], v[172:175], v[64:79]
ds_read_b64_tr_b16 a[24:25], v7 offset:38912
ds_read_b64_tr_b16 a[26:27], v7 offset:39936
buffer_load_dwordx4 v6, s[8:11], s31 offen offset:2048 lds
s_waitcnt lgkmcnt(6)
v_mfma_f32_32x32x16_bf16 v[48:63], a[0:3], v[176:179], v[48:63]
ds_read_b64_tr_b16 a[28:29], v8 offset:38912
ds_read_b64_tr_b16 a[30:31], v8 offset:39936
v_mfma_f32_32x32x16_bf16 v[64:79], a[4:7], v[176:179], v[64:79]
ds_read_b64_tr_b16 a[0:1], v7 offset:40960
ds_read_b64_tr_b16 a[2:3], v7 offset:41984
s_add_u32 s30, s30, s58
v_mfma_f32_32x32x16_bf16 v[48:63], a[8:11], v[180:183], v[48:63]
ds_read_b64_tr_b16 a[4:5], v8 offset:40960
ds_read_b64_tr_b16 a[6:7], v8 offset:41984
v_mfma_f32_32x32x16_bf16 v[64:79], a[12:15], v[180:183], v[64:79]
ds_read_b64_tr_b16 a[8:9], v7 offset:43008
ds_read_b64_tr_b16 a[10:11], v7 offset:44032
s_add_u32 s31, s31, s58
s_waitcnt lgkmcnt(6)
v_mfma_f32_32x32x16_bf16 v[48:63], a[16:19], v[184:187], v[48:63]
ds_read_b64_tr_b16 a[12:13], v8 offset:43008
ds_read_b64_tr_b16 a[14:15], v8 offset:44032
v_mfma_f32_32x32x16_bf16 v[64:79], a[20:23], v[184:187], v[64:79]
ds_read_b64_tr_b16 a[16:17], v7 offset:45056
ds_read_b64_tr_b16 a[18:19], v7 offset:46080
v_mfma_f32_32x32x16_bf16 v[48:63], a[24:27], v[188:191], v[48:63]
ds_read_b64_tr_b16 a[20:21], v8 offset:45056
ds_read_b64_tr_b16 a[22:23], v8 offset:46080
v_mfma_f32_32x32x16_bf16 v[64:79], a[28:31], v[188:191], v[64:79]
ds_read_b64_tr_b16 a[24:25], v7 offset:47104
ds_read_b64_tr_b16 a[26:27], v7 offset:48128
s_waitcnt lgkmcnt(6)
v_mfma_f32_32x32x16_bf16 v[48:63], a[0:3], v[192:195], v[48:63]
ds_read_b64_tr_b16 a[28:29], v8 offset:47104
ds_read_b64_tr_b16 a[30:31], v8 offset:48128
s_waitcnt vmcnt(18)
s_barrier
v_mfma_f32_32x32x16_bf16 v[64:79], a[4:7], v[192:195], v[64:79]
ds_read_b64_tr_b16 a[0:1], v12 offset:0
ds_read_b64_tr_b16 a[2:3], v12 offset:1024
s_add_u32 m0, s34, 0
v_mfma_f32_32x32x16_bf16 v[48:63], a[8:11], v[196:199], v[48:63]
ds_read_b64_tr_b16 a[4:5], v13 offset:0
ds_read_b64_tr_b16 a[6:7], v13 offset:1024
v_mfma_f32_32x32x16_bf16 v[64:79], a[12:15], v[196:199], v[64:79]
ds_read_b64_tr_b16 a[8:9], v12 offset:2048
ds_read_b64_tr_b16 a[10:11], v12 offset:3072
buffer_load_dwordx4 v4, s[8:11], s30 offen lds
s_waitcnt lgkmcnt(6)
v_mfma_f32_32x32x16_bf16 v[48:63], a[16:19], v[200:203], v[48:63]
ds_read_b64_tr_b16 a[12:13], v13 offset:2048
ds_read_b64_tr_b16 a[14:15], v13 offset:3072
v_mfma_f32_32x32x16_bf16 v[64:79], a[20:23], v[200:203], v[64:79]
ds_read_b64_tr_b16 a[16:17], v12 offset:4096
ds_read_b64_tr_b16 a[18:19], v12 offset:5120
buffer_load_dwordx4 v5, s[8:11], s30 offen offset:1024 lds
v_mfma_f32_32x32x16_bf16 v[48:63], a[24:27], v[204:207], v[48:63]
ds_read_b64_tr_b16 a[20:21], v13 offset:4096
ds_read_b64_tr_b16 a[22:23], v13 offset:5120
v_mfma_f32_32x32x16_bf16 v[64:79], a[28:31], v[204:207], v[64:79]
ds_read_b64_tr_b16 a[24:25], v12 offset:6144
ds_read_b64_tr_b16 a[26:27], v12 offset:7168
buffer_load_dwordx4 v6, s[8:11], s30 offen offset:2048 lds
s_waitcnt lgkmcnt(6)
v_mfma_f32_32x32x16_bf16 v[48:63], a[0:3], v[208:211], v[48:63]
ds_read_b64_tr_b16 a[28:29], v13 offset:6144
ds_read_b64_tr_b16 a[30:31], v13 offset:7168
v_mfma_f32_32x32x16_bf16 v[64:79], a[4:7], v[208:211], v[64:79]
ds_read_b64_tr_b16 a[0:1], v12 offset:8192
ds_read_b64_tr_b16 a[2:3], v12 offset:9216
s_add_u32 m0, s34, 3072
v_mfma_f32_32x32x16_bf16 v[48:63], a[8:11], v[212:215], v[48:63]
ds_read_b64_tr_b16 a[4:5], v13 offset:8192
ds_read_b64_tr_b16 a[6:7], v13 offset:9216
v_mfma_f32_32x32x16_bf16 v[64:79], a[12:15], v[212:215], v[64:79]
ds_read_b64_tr_b16 a[8:9], v12 offset:10240
ds_read_b64_tr_b16 a[10:11], v12 offset:11264
buffer_load_dwordx4 v4, s[8:11], s31 offen lds
s_waitcnt lgkmcnt(6)
v_mfma_f32_32x32x16_bf16 v[48:63], a[16:19], v[216:219], v[48:63]
ds_read_b64_tr_b16 a[12:13], v13 offset:10240
ds_read_b64_tr_b16 a[14:15], v13 offset:11264
v_mfma_f32_32x32x16_bf16 v[64:79], a[20:23], v[216:219], v[64:79]
ds_read_b64_tr_b16 a[16:17], v12 offset:12288
ds_read_b64_tr_b16 a[18:19], v12 offset:13312
buffer_load_dwordx4 v5, s[8:11], s31 offen offset:1024 lds
v_mfma_f32_32x32x16_bf16 v[48:63], a[24:27], v[220:223], v[48:63]
ds_read_b64_tr_b16 a[20:21], v13 offset:12288
ds_read_b64_tr_b16 a[22:23], v13 offset:13312
v_mfma_f32_32x32x16_bf16 v[64:79], a[28:31], v[220:223], v[64:79]
ds_read_b64_tr_b16 a[24:25], v12 offset:14336
ds_read_b64_tr_b16 a[26:27], v12 offset:15360
buffer_load_dwordx4 v6, s[8:11], s31 offen offset:2048 lds
s_waitcnt lgkmcnt(6)
v_mfma_f32_32x32x16_bf16 v[48:63], a[0:3], v[224:227], v[48:63]
ds_read_b64_tr_b16 a[28:29], v13 offset:14336
ds_read_b64_tr_b16 a[30:31], v13 offset:15360
v_mfma_f32_32x32x16_bf16 v[64:79], a[4:7], v[224:227], v[64:79]
ds_read_b64_tr_b16 a[0:1], v12 offset:16384
ds_read_b64_tr_b16 a[2:3], v12 offset:17408
s_add_u32 s30, s30, s56
v_mfma_f32_32x32x16_bf16 v[48:63], a[8:11], v[228:231], v[48:63]
ds_read_b64_tr_b16 a[4:5], v13 offset:16384
ds_read_b64_tr_b16 a[6:7], v13 offset:17408
v_mfma_f32_32x32x16_bf16 v[64:79], a[12:15], v[228:231], v[64:79]
ds_read_b64_tr_b16 a[8:9], v12 offset:18432
ds_read_b64_tr_b16 a[10:11], v12 offset:19456
s_add_u32 s31, s31, s56
s_waitcnt lgkmcnt(6)
v_mfma_f32_32x32x16_bf16 v[48:63], a[16:19], v[232:235], v[48:63]
ds_read_b64_tr_b16 a[12:13], v13 offset:18432
ds_read_b64_tr_b16 a[14:15], v13 offset:19456
v_mfma_f32_32x32x16_bf16 v[64:79], a[20:23], v[232:235], v[64:79]
ds_read_b64_tr_b16 a[16:17], v12 offset:20480
ds_read_b64_tr_b16 a[18:19], v12 offset:21504
v_mfma_f32_32x32x16_bf16 v[48:63], a[24:27], v[236:239], v[48:63]
ds_read_b64_tr_b16 a[20:21], v13 offset:20480
ds_read_b64_tr_b16 a[22:23], v13 offset:21504
v_mfma_f32_32x32x16_bf16 v[64:79], a[28:31], v[236:239], v[64:79]
ds_read_b64_tr_b16 a[24:25], v12 offset:22528
ds_read_b64_tr_b16 a[26:27], v12 offset:23552
s_waitcnt lgkmcnt(6)
v_mfma_f32_32x32x16_bf16 v[48:63], a[0:3], v[240:243], v[48:63]
ds_read_b64_tr_b16 a[28:29], v13 offset:22528
ds_read_b64_tr_b16 a[30:31], v13 offset:23552
s_waitcnt vmcnt(18)
s_barrier
v_mfma_f32_32x32x16_bf16 v[64:79], a[4:7], v[240:243], v[64:79]
ds_read_b64_tr_b16 a[0:1], v12 offset:24576
ds_read_b64_tr_b16 a[2:3], v12 offset:25600
s_add_u32 m0, s34, 24576
v_mfma_f32_32x32x16_bf16 v[48:63], a[8:11], v[244:247], v[48:63]
ds_read_b64_tr_b16 a[4:5], v13 offset:24576
ds_read_b64_tr_b16 a[6:7], v13 offset:25600
v_mfma_f32_32x32x16_bf16 v[64:79], a[12:15], v[244:247], v[64:79]
ds_read_b64_tr_b16 a[8:9], v12 offset:26624
ds_read_b64_tr_b16 a[10:11], v12 offset:27648
buffer_load_dwordx4 v4, s[8:11], s30 offen lds
s_waitcnt lgkmcnt(6)
v_mfma_f32_32x32x16_bf16 v[48:63], a[16:19], v[248:251], v[48:63]
ds_read_b64_tr_b16 a[12:13], v13 offset:26624
ds_read_b64_tr_b16 a[14:15], v13 offset:27648
v_mfma_f32_32x32x16_bf16 v[64:79], a[20:23], v[248:251], v[64:79]
ds_read_b64_tr_b16 a[16:17], v12 offset:28672
ds_read_b64_tr_b16 a[18:19], v12 offset:29696
buffer_load_dwordx4 v5, s[8:11], s30 offen offset:1024 lds
v_mfma_f32_32x32x16_bf16 v[48:63], a[24:27], v[252:255], v[48:63]
ds_read_b64_tr_b16 a[20:21], v13 offset:28672
ds_read_b64_tr_b16 a[22:23], v13 offset:29696
v_mfma_f32_32x32x16_bf16 v[64:79], a[28:31], v[252:255], v[64:79]
ds_read_b64_tr_b16 a[24:25], v12 offset:30720
ds_read_b64_tr_b16 a[26:27], v12 offset:31744
buffer_load_dwordx4 v6, s[8:11], s30 offen offset:2048 lds
s_waitcnt lgkmcnt(6)
v_mfma_f32_32x32x16_bf16 v[80:95], a[0:3], v[112:115], 0
ds_read_b64_tr_b16 a[28:29], v13 offset:30720
ds_read_b64_tr_b16 a[30:31], v13 offset:31744
v_mfma_f32_32x32x16_bf16 v[96:111], a[4:7], v[112:115], 0
ds_read_b64_tr_b16 a[0:1], v12 offset:32768
ds_read_b64_tr_b16 a[2:3], v12 offset:33792
s_add_u32 m0, s34, 27648
v_mfma_f32_32x32x16_bf16 v[80:95], a[8:11], v[116:119], v[80:95]
ds_read_b64_tr_b16 a[4:5], v13 offset:32768
ds_read_b64_tr_b16 a[6:7], v13 offset:33792
v_mfma_f32_32x32x16_bf16 v[96:111], a[12:15], v[116:119], v[96:111]
ds_read_b64_tr_b16 a[8:9], v12 offset:34816
ds_read_b64_tr_b16 a[10:11], v12 offset:35840
buffer_load_dwordx4 v4, s[8:11], s31 offen lds
s_cmp_lg_u32 s50, 0
s_cbranch_scc1 L_ka_xn0
buffer_store_dwordx4 v[112:115], v11, s[44:47], s59 offen offset:0 sc1
buffer_store_dwordx4 v[116:119], v11, s[44:47], s59 offen offset:1024 sc1
buffer_store_dwordx4 v[120:123], v11, s[44:47], s59 offen offset:2048 sc1
buffer_store_dwordx4 v[124:127], v11, s[44:47], s33 offen offset:0 sc1
buffer_store_dwordx4 v[128:131], v11, s[44:47], s33 offen offset:1024 sc1
buffer_store_dwordx4 v[132:135], v11, s[44:47], s33 offen offset:2048 sc1
L_ka_xn0:
s_waitcnt lgkmcnt(6)
v_mfma_f32_32x32x16_bf16 v[80:95], a[16:19], v[120:123], v[80:95]
ds_read_b64_tr_b16 a[12:13], v13 offset:34816
ds_read_b64_tr_b16 a[14:15], v13 offset:35840
v_max3_f32 v28, |v48|, |v49|, v28
v_max3_f32 v28, |v50|, |v51|, v28
v_mfma_f32_32x32x16_bf16 v[96:111], a[20:23], v[120:123], v[96:111]
ds_read_b64_tr_b16 a[16:17], v12 offset:36864
ds_read_b64_tr_b16 a[18:19], v12 offset:37888
buffer_load_dwordx4 v5, s[8:11], s31 offen offset:1024 lds
v_mfma_f32_32x32x16_bf16 v[80:95], a[24:27], v[124:127], v[80:95]
ds_read_b64_tr_b16 a[20:21], v13 offset:36864
ds_read_b64_tr_b16 a[22:23], v13 offset:37888
v_max3_f32 v28, |v52|, |v53|, v28
v_max3_f32 v28, |v54|, |v55|, v28
v_mfma_f32_32x32x16_bf16 v[96:111], a[28:31], v[124:127], v[96:111]
ds_read_b64_tr_b16 a[24:25], v12 offset:38912
ds_read_b64_tr_b16 a[26:27], v12 offset:39936
buffer_load_dwordx4 v6, s[8:11], s31 offen offset:2048 lds
s_waitcnt lgkmcnt(6)
v_mfma_f32_32x32x16_bf16 v[80:95], a[0:3], v[128:131], v[80:95]
ds_read_b64_tr_b16 a[28:29], v13 offset:38912
ds_read_b64_tr_b16 a[30:31], v13 offset:39936
v_max3_f32 v28, |v56|, |v57|, v28
v_max3_f32 v28, |v58|, |v59|, v28
v_mfma_f32_32x32x16_bf16 v[96:111], a[4:7], v[128:131], v[96:111]
ds_read_b64_tr_b16 a[0:1], v12 offset:40960
ds_read_b64_tr_b16 a[2:3], v12 offset:41984
s_add_u32 s30, s30, s57
v_max3_f32 v28, |v60|, |v61|, v28
v_mfma_f32_32x32x16_bf16 v[80:95], a[8:11], v[132:135], v[80:95]
ds_read_b64_tr_b16 a[4:5], v13 offset:40960
ds_read_b64_tr_b16 a[6:7], v13 offset:41984
v_max3_f32 v28, |v62|, |v63|, v28
v_mul_f32 v48, s49, v48
v_mfma_f32_32x32x16_bf16 v[96:111], a[12:15], v[132:135], v[96:111]
ds_read_b64_tr_b16 a[8:9], v12 offset:43008
ds_read_b64_tr_b16 a[10:11], v12 offset:44032
s_add_u32 s31, s31, s57
s_cmp_lg_u32 s50, 1
s_cbranch_scc1 L_ka_xn1
buffer_store_dwordx4 v[136:139], v11, s[44:47], s59 offen offset:0 sc1
buffer_store_dwordx4 v[140:143], v11, s[44:47], s59 offen offset:1024 sc1
buffer_store_dwordx4 v[144:147], v11, s[44:47], s59 offen offset:2048 sc1
buffer_store_dwordx4 v[148:151], v11, s[44:47], s33 offen offset:0 sc1
buffer_store_dwordx4 v[152:155], v11, s[44:47], s33 offen offset:1024 sc1
buffer_store_dwordx4 v[156:159], v11, s[44:47], s33 offen offset:2048 sc1
L_ka_xn1:
s_waitcnt lgkmcnt(6)
v_mfma_f32_32x32x16_bf16 v[80:95], a[16:19], v[136:139], v[80:95]
ds_read_b64_tr_b16 a[12:13], v13 offset:43008
ds_read_b64_tr_b16 a[14:15], v13 offset:44032
v_mul_f32 v49, s49, v49
v_mul_f32 v50, s49, v50
v_mfma_f32_32x32x16_bf16 v[96:111], a[20:23], v[136:139], v[96:111]
ds_read_b64_tr_b16 a[16:17], v12 offset:45056
ds_read_b64_tr_b16 a[18:19], v12 offset:46080
v_mul_f32 v51, s49, v51
v_mul_f32 v52, s49, v52
v_mfma_f32_32x32x16_bf16 v[80:95], a[24:27], v[140:143], v[80:95]
ds_read_b64_tr_b16 a[20:21], v13 offset:45056
ds_read_b64_tr_b16 a[22:23], v13 offset:46080
v_mul_f32 v53, s49, v53
v_mul_f32 v54, s49, v54
v_mfma_f32_32x32x16_bf16 v[96:111], a[28:31], v[140:143], v[96:111]
ds_read_b64_tr_b16 a[24:25], v12 offset:47104
ds_read_b64_tr_b16 a[26:27], v12 offset:48128
v_mul_f32 v55, s49, v55
s_waitcnt lgkmcnt(6)
v_mfma_f32_32x32x16_bf16 v[80:95], a[0:3], v[144:147], v[80:95]
ds_read_b64_tr_b16 a[28:29], v13 offset:47104
ds_read_b64_tr_b16 a[30:31], v13 offset:48128
s_waitcnt vmcnt(18)
s_barrier
v_mfma_f32_32x32x16_bf16 v[96:111], a[4:7], v[144:147], v[96:111]
ds_read_b64_tr_b16 a[0:1], v14 offset:0
ds_read_b64_tr_b16 a[2:3], v14 offset:1024
s_add_u32 m0, s34, 49152
v_mul_f32 v56, s49, v56
v_mfma_f32_32x32x16_bf16 v[80:95], a[8:11], v[148:151], v[80:95]
ds_read_b64_tr_b16 a[4:5], v15 offset:0
ds_read_b64_tr_b16 a[6:7], v15 offset:1024
v_mul_f32 v57, s49, v57
v_mul_f32 v58, s49, v58
v_mfma_f32_32x32x16_bf16 v[96:111], a[12:15], v[148:151], v[96:111]
ds_read_b64_tr_b16 a[8:9], v14 offset:2048
ds_read_b64_tr_b16 a[10:11], v14 offset:3072
buffer_load_dwordx4 v4, s[8:11], s30 offen lds
s_cmp_lg_u32 s50, 2
s_cbranch_scc1 L_ka_xn2
buffer_store_dwordx4 v[160:163], v11, s[44:47], s59 offen offset:0 sc1
buffer_store_dwordx4 v[164:167], v11, s[44:47], s59 offen offset:1024 sc1
buffer_store_dwordx4 v[168:171], v11, s[44:47], s59 offen offset:2048 sc1
buffer_store_dwordx4 v[172:175], v11, s[44:47], s33 offen offset:0 sc1
buffer_store_dwordx4 v[176:179], v11, s[44:47], s33 offen offset:1024 sc1
buffer_store_dwordx4 v[180:183], v11, s[44:47], s33 offen offset:2048 sc1
L_ka_xn2:
s_waitcnt lgkmcnt(6)
v_mfma_f32_32x32x16_bf16 v[80:95], a[16:19], v[152:155], v[80:95]
ds_read_b64_tr_b16 a[12:13], v15 offset:2048
ds_read_b64_tr_b16 a[14:15], v15 offset:3072
v_mul_f32 v59, s49, v59
v_mul_f32 v60, s49, v60
v_mfma_f32_32x32x16_bf16 v[96:111], a[20:23], v[152:155], v[96:111]
ds_read_b64_tr_b16 a[16:17], v14 offset:4096
ds_read_b64_tr_b16 a[18:19], v14 offset:5120
buffer_load_dwordx4 v5, s[8:11], s30 offen offset:1024 lds
v_mfma_f32_32x32x16_bf16 v[80:95], a[24:27], v[156:159], v[80:95]
ds_read_b64_tr_b16 a[20:21], v15 offset:4096
ds_read_b64_tr_b16 a[22:23], v15 offset:5120
v_mul_f32 v61, s49, v61
v_mul_f32 v62, s49, v62
v_mfma_f32_32x32x16_bf16 v[96:111], a[28:31], v[156:159], v[96:111]
ds_read_b64_tr_b16 a[24:25], v14 offset:6144
ds_read_b64_tr_b16 a[26:27], v14 offset:7168
buffer_load_dwordx4 v6, s[8:11], s30 offen offset:2048 lds
s_waitcnt lgkmcnt(6)
v_mfma_f32_32x32x16_bf16 v[80:95], a[0:3], v[160:163], v[80:95]
ds_read_b64_tr_b16 a[28:29], v15 offset:6144
ds_read_b64_tr_b16 a[30:31], v15 offset:7168
v_mul_f32 v63, s49, v63
v_cvt_pk_bf16_f32 v48, v48, v49
v_mfma_f32_32x32x16_bf16 v[96:111], a[4:7], v[160:163], v[96:111]
ds_read_b64_tr_b16 a[0:1], v14 offset:8192
ds_read_b64_tr_b16 a[2:3], v14 offset:9216
s_add_u32 m0, s34, 52224
v_cvt_pk_bf16_f32 v49, v50, v51
v_mfma_f32_32x32x16_bf16 v[80:95], a[8:11], v[164:167], v[80:95]
ds_read_b64_tr_b16 a[4:5], v15 offset:8192
ds_read_b64_tr_b16 a[6:7], v15 offset:9216
v_cvt_pk_bf16_f32 v50, v52, v53
v_cvt_pk_bf16_f32 v51, v54, v55
v_mfma_f32_32x32x16_bf16 v[96:111], a[12:15], v[164:167], v[96:111]
ds_read_b64_tr_b16 a[8:9], v14 offset:10240
ds_read_b64_tr_b16 a[10:11], v14 offset:11264
buffer_load_dwordx4 v4, s[8:11], s31 offen lds
s_cmp_lg_u32 s50, 3
s_cbranch_scc1 L_ka_xn3
buffer_store_dwordx4 v[184:187], v11, s[44:47], s59 offen offset:0 sc1
buffer_store_dwordx4 v[188:191], v11, s[44:47], s59 offen offset:1024 sc1
buffer_store_dwordx4 v[192:195], v11, s[44:47], s59 offen offset:2048 sc1
buffer_store_dwordx4 v[196:199], v11, s[44:47], s33 offen offset:0 sc1
buffer_store_dwordx4 v[200:203], v11, s[44:47], s33 offen offset:1024 sc1
buffer_store_dwordx4 v[204:207], v11, s[44:47], s33 offen offset:2048 sc1
L_ka_xn3:
s_waitcnt lgkmcnt(6)
v_mfma_f32_32x32x16_bf16 v[80:95], a[16:19], v[168:171], v[80:95]
ds_read_b64_tr_b16 a[12:13], v15 offset:10240
ds_read_b64_tr_b16 a[14:15], v15 offset:11264
v_cvt_pk_bf16_f32 v52, v56, v57
v_cvt_pk_bf16_f32 v53, v58, v59
v_mfma_f32_32x32x16_bf16 v[96:111], a[20:23], v[168:171], v[96:111]
ds_read_b64_tr_b16 a[16:17], v14 offset:12288
ds_read_b64_tr_b16 a[18:19], v14 offset:13312
buffer_load_dwordx4 v5, s[8:11], s31 offen offset:1024 lds
v_mfma_f32_32x32x16_bf16 v[80:95], a[24:27], v[172:175], v[80:95]
ds_read_b64_tr_b16 a[20:21], v15 offset:12288
ds_read_b64_tr_b16 a[22:23], v15 offset:13312
v_cvt_pk_bf16_f32 v54, v60, v61
v_cvt_pk_bf16_f32 v55, v62, v63
v_mfma_f32_32x32x16_bf16 v[96:111], a[28:31], v[172:175], v[96:111]
ds_read_b64_tr_b16 a[24:25], v14 offset:14336
ds_read_b64_tr_b16 a[26:27], v14 offset:15360
buffer_load_dwordx4 v6, s[8:11], s31 offen offset:2048 lds
s_waitcnt lgkmcnt(6)
v_mfma_f32_32x32x16_bf16 v[80:95], a[0:3], v[176:179], v[80:95]
ds_read_b64_tr_b16 a[28:29], v15 offset:14336
ds_read_b64_tr_b16 a[30:31], v15 offset:15360
buffer_store_dwordx4 v[48:51], v11, s[16:19], s43 offen sc1
v_mfma_f32_32x32x16_bf16 v[96:111], a[4:7], v[176:179], v[96:111]
ds_read_b64_tr_b16 a[0:1], v14 offset:16384
ds_read_b64_tr_b16 a[2:3], v14 offset:17408
s_add_u32 s30, s30, s58
s_add_u32 s43, s43, s42
v_mfma_f32_32x32x16_bf16 v[80:95], a[8:11], v[180:183], v[80:95]
ds_read_b64_tr_b16 a[4:5], v15 offset:16384
ds_read_b64_tr_b16 a[6:7], v15 offset:17408
buffer_store_dwordx4 v[52:55], v11, s[16:19], s43 offen sc1
v_mfma_f32_32x32x16_bf16 v[96:111], a[12:15], v[180:183], v[96:111]
ds_read_b64_tr_b16 a[8:9], v14 offset:18432
ds_read_b64_tr_b16 a[10:11], v14 offset:19456
s_add_u32 s31, s31, s58
s_cmp_lg_u32 s50, 4
s_cbranch_scc1 L_ka_xn4
buffer_store_dwordx4 v[208:211], v11, s[44:47], s59 offen offset:0 sc1
buffer_store_dwordx4 v[212:215], v11, s[44:47], s59 offen offset:1024 sc1
buffer_store_dwordx4 v[216:219], v11, s[44:47], s59 offen offset:2048 sc1
buffer_store_dwordx4 v[220:223], v11, s[44:47], s33 offen offset:0 sc1
buffer_store_dwordx4 v[224:227], v11, s[44:47], s33 offen offset:1024 sc1
buffer_store_dwordx4 v[228:231], v11, s[44:47], s33 offen offset:2048 sc1
L_ka_xn4:
s_waitcnt lgkmcnt(6)
v_mfma_f32_32x32x16_bf16 v[80:95], a[16:19], v[184:187], v[80:95]
ds_read_b64_tr_b16 a[12:13], v15 offset:18432
ds_read_b64_tr_b16 a[14:15], v15 offset:19456
s_add_u32 s43, s43, s42
v_max3_f32 v28, |v64|, |v65|, v28
v_mfma_f32_32x32x16_bf16 v[96:111], a[20:23], v[184:187], v[96:111]
ds_read_b64_tr_b16 a[16:17], v14 offset:20480
ds_read_b64_tr_b16 a[18:19], v14 offset:21504
v_max3_f32 v28, |v66|, |v67|, v28
v_max3_f32 v28, |v68|, |v69|, v28
v_mfma_f32_32x32x16_bf16 v[80:95], a[24:27], v[188:191], v[80:95]
ds_read_b64_tr_b16 a[20:21], v15 offset:20480
ds_read_b64_tr_b16 a[22:23], v15 offset:21504
v_max3_f32 v28, |v70|, |v71|, v28
v_max3_f32 v28, |v72|, |v73|, v28
v_mfma_f32_32x32x16_bf16 v[96:111], a[28:31], v[188:191], v[96:111]
ds_read_b64_tr_b16 a[24:25], v14 offset:22528
ds_read_b64_tr_b16 a[26:27], v14 offset:23552
v_max3_f32 v28, |v74|, |v75|, v28
s_waitcnt lgkmcnt(6)
v_mfma_f32_32x32x16_bf16 v[80:95], a[0:3], v[192:195], v[80:95]
ds_read_b64_tr_b16 a[28:29], v15 offset:22528
ds_read_b64_tr_b16 a[30:31], v15 offset:23552
s_waitcnt vmcnt(20)
s_barrier
v_mfma_f32_32x32x16_bf16 v[96:111], a[4:7], v[192:195], v[96:111]
ds_read_b64_tr_b16 a[0:1], v14 offset:24576
ds_read_b64_tr_b16 a[2:3], v14 offset:25600
v_max3_f32 v28, |v76|, |v77|, v28
v_max3_f32 v28, |v78|, |v79|, v28
v_mfma_f32_32x32x16_bf16 v[80:95], a[8:11], v[196:199], v[80:95]
ds_read_b64_tr_b16 a[4:5], v15 offset:24576
ds_read_b64_tr_b16 a[6:7], v15 offset:25600
v_mul_f32 v64, s49, v64
v_mul_f32 v65, s49, v65
v_mfma_f32_32x32x16_bf16 v[96:111], a[12:15], v[196:199], v[96:111]
ds_read_b64_tr_b16 a[8:9], v14 offset:26624
ds_read_b64_tr_b16 a[10:11], v14 offset:27648
s_cmp_lg_u32 s50, 5
s_cbranch_scc1 L_ka_xn5
buffer_store_dwordx4 v[232:235], v11, s[44:47], s59 offen offset:0 sc1
buffer_store_dwordx4 v[236:239], v11, s[44:47], s59 offen offset:1024 sc1
buffer_store_dwordx4 v[240:243], v11, s[44:47], s59 offen offset:2048 sc1
buffer_store_dwordx4 v[244:247], v11, s[44:47], s33 offen offset:0 sc1
buffer_store_dwordx4 v[248:251], v11, s[44:47], s33 offen offset:1024 sc1
buffer_store_dwordx4 v[252:255], v11, s[44:47], s33 offen offset:2048 sc1
L_ka_xn5:
s_waitcnt lgkmcnt(6)
v_mfma_f32_32x32x16_bf16 v[80:95], a[16:19], v[200:203], v[80:95]
ds_read_b64_tr_b16 a[12:13], v15 offset:26624
ds_read_b64_tr_b16 a[14:15], v15 offset:27648
v_mul_f32 v66, s49, v66
v_mul_f32 v67, s49, v67
v_mfma_f32_32x32x16_bf16 v[96:111], a[20:23], v[200:203], v[96:111]
ds_read_b64_tr_b16 a[16:17], v14 offset:28672
ds_read_b64_tr_b16 a[18:19], v14 offset:29696
v_mul_f32 v68, s49, v68
v_mul_f32 v69, s49, v69
v_mfma_f32_32x32x16_bf16 v[80:95], a[24:27], v[204:207], v[80:95]
ds_read_b64_tr_b16 a[20:21], v15 offset:28672
ds_read_b64_tr_b16 a[22:23], v15 offset:29696
v_mul_f32 v70, s49, v70
v_mul_f32 v71, s49, v71
v_mfma_f32_32x32x16_bf16 v[96:111], a[28:31], v[204:207], v[96:111]
ds_read_b64_tr_b16 a[24:25], v14 offset:30720
ds_read_b64_tr_b16 a[26:27], v14 offset:31744
v_mul_f32 v72, s49, v72
s_waitcnt lgkmcnt(6)
v_mfma_f32_32x32x16_bf16 v[80:95], a[0:3], v[208:211], v[80:95]
ds_read_b64_tr_b16 a[28:29], v15 offset:30720
ds_read_b64_tr_b16 a[30:31], v15 offset:31744
v_mul_f32 v73, s49, v73
v_mul_f32 v74, s49, v74
v_mfma_f32_32x32x16_bf16 v[96:111], a[4:7], v[208:211], v[96:111]
ds_read_b64_tr_b16 a[0:1], v14 offset:32768
ds_read_b64_tr_b16 a[2:3], v14 offset:33792
v_mul_f32 v75, s49, v75
v_mul_f32 v76, s49, v76
v_mfma_f32_32x32x16_bf16 v[80:95], a[8:11], v[212:215], v[80:95]
ds_read_b64_tr_b16 a[4:5], v15 offset:32768
ds_read_b64_tr_b16 a[6:7], v15 offset:33792
v_mul_f32 v77, s49, v77
v_mul_f32 v78, s49, v78
v_mfma_f32_32x32x16_bf16 v[96:111], a[12:15], v[212:215], v[96:111]
ds_read_b64_tr_b16 a[8:9], v14 offset:34816
ds_read_b64_tr_b16 a[10:11], v14 offset:35840
v_mul_f32 v79, s49, v79
s_waitcnt lgkmcnt(6)
v_mfma_f32_32x32x16_bf16 v[80:95], a[16:19], v[216:219], v[80:95]
ds_read_b64_tr_b16 a[12:13], v15 offset:34816
ds_read_b64_tr_b16 a[14:15], v15 offset:35840
v_cvt_pk_bf16_f32 v64, v64, v65
v_cvt_pk_bf16_f32 v65, v66, v67
v_mfma_f32_32x32x16_bf16 v[96:111], a[20:23], v[216:219], v[96:111]
ds_read_b64_tr_b16 a[16:17], v14 offset:36864
ds_read_b64_tr_b16 a[18:19], v14 offset:37888
v_cvt_pk_bf16_f32 v66, v68, v69
v_cvt_pk_bf16_f32 v67, v70, v71
v_mfma_f32_32x32x16_bf16 v[80:95], a[24:27], v[220:223], v[80:95]
ds_read_b64_tr_b16 a[20:21], v15 offset:36864
ds_read_b64_tr_b16 a[22:23], v15 offset:37888
v_cvt_pk_bf16_f32 v68, v72, v73
v_cvt_pk_bf16_f32 v69, v74, v75
v_mfma_f32_32x32x16_bf16 v[96:111], a[28:31], v[220:223], v[96:111]
ds_read_b64_tr_b16 a[24:25], v14 offset:38912
ds_read_b64_tr_b16 a[26:27], v14 offset:39936
v_cvt_pk_bf16_f32 v70, v76, v77
s_waitcnt lgkmcnt(6)
v_mfma_f32_32x32x16_bf16 v[80:95], a[0:3], v[224:227], v[80:95]
ds_read_b64_tr_b16 a[28:29], v15 offset:38912
ds_read_b64_tr_b16 a[30:31], v15 offset:39936
v_cvt_pk_bf16_f32 v71, v78, v79
v_mfma_f32_32x32x16_bf16 v[96:111], a[4:7], v[224:227], v[96:111]
ds_read_b64_tr_b16 a[0:1], v14 offset:40960
ds_read_b64_tr_b16 a[2:3], v14 offset:41984
buffer_store_dwordx4 v[64:67], v11, s[16:19], s43 offen sc1
v_mfma_f32_32x32x16_bf16 v[80:95], a[8:11], v[228:231], v[80:95]
ds_read_b64_tr_b16 a[4:5], v15 offset:40960
ds_read_b64_tr_b16 a[6:7], v15 offset:41984
s_add_u32 s43, s43, s42
v_mfma_f32_32x32x16_bf16 v[96:111], a[12:15], v[228:231], v[96:111]
ds_read_b64_tr_b16 a[8:9], v14 offset:43008
ds_read_b64_tr_b16 a[10:11], v14 offset:44032
s_waitcnt lgkmcnt(6)
v_mfma_f32_32x32x16_bf16 v[80:95], a[16:19], v[232:235], v[80:95]
ds_read_b64_tr_b16 a[12:13], v15 offset:43008
ds_read_b64_tr_b16 a[14:15], v15 offset:44032
buffer_store_dwordx4 v[68:71], v11, s[16:19], s43 offen sc1
v_mfma_f32_32x32x16_bf16 v[96:111], a[20:23], v[232:235], v[96:111]
ds_read_b64_tr_b16 a[16:17], v14 offset:45056
ds_read_b64_tr_b16 a[18:19], v14 offset:46080
s_add_u32 s43, s43, s42
v_mfma_f32_32x32x16_bf16 v[80:95], a[24:27], v[236:239], v[80:95]
ds_read_b64_tr_b16 a[20:21], v15 offset:45056
ds_read_b64_tr_b16 a[22:23], v15 offset:46080
v_mfma_f32_32x32x16_bf16 v[96:111], a[28:31], v[236:239], v[96:111]
ds_read_b64_tr_b16 a[24:25], v14 offset:47104
ds_read_b64_tr_b16 a[26:27], v14 offset:48128
s_waitcnt lgkmcnt(6)
v_mfma_f32_32x32x16_bf16 v[80:95], a[0:3], v[240:243], v[80:95]
ds_read_b64_tr_b16 a[28:29], v15 offset:47104
ds_read_b64_tr_b16 a[30:31], v15 offset:48128
s_waitcnt vmcnt(16)
s_barrier
v_mfma_f32_32x32x16_bf16 v[96:111], a[4:7], v[240:243], v[96:111]
ds_read_b64_tr_b16 a[0:1], v7 offset:0
ds_read_b64_tr_b16 a[2:3], v7 offset:1024
v_mfma_f32_32x32x16_bf16 v[80:95], a[8:11], v[244:247], v[80:95]
ds_read_b64_tr_b16 a[4:5], v8 offset:0
ds_read_b64_tr_b16 a[6:7], v8 offset:1024
v_mfma_f32_32x32x16_bf16 v[96:111], a[12:15], v[244:247], v[96:111]
ds_read_b64_tr_b16 a[8:9], v7 offset:2048
ds_read_b64_tr_b16 a[10:11], v7 offset:3072
s_waitcnt lgkmcnt(6)
v_mfma_f32_32x32x16_bf16 v[80:95], a[16:19], v[248:251], v[80:95]
ds_read_b64_tr_b16 a[12:13], v8 offset:2048
ds_read_b64_tr_b16 a[14:15], v8 offset:3072
v_mfma_f32_32x32x16_bf16 v[96:111], a[20:23], v[248:251], v[96:111]
ds_read_b64_tr_b16 a[16:17], v7 offset:4096
ds_read_b64_tr_b16 a[18:19], v7 offset:5120
v_mfma_f32_32x32x16_bf16 v[80:95], a[24:27], v[252:255], v[80:95]
ds_read_b64_tr_b16 a[20:21], v8 offset:4096
ds_read_b64_tr_b16 a[22:23], v8 offset:5120
v_mfma_f32_32x32x16_bf16 v[96:111], a[28:31], v[252:255], v[96:111]
ds_read_b64_tr_b16 a[24:25], v7 offset:6144
ds_read_b64_tr_b16 a[26:27], v7 offset:7168
s_waitcnt lgkmcnt(6)
v_mfma_f32_32x32x16_bf16 v[48:63], a[0:3], v[112:115], 0
ds_read_b64_tr_b16 a[28:29], v8 offset:6144
ds_read_b64_tr_b16 a[30:31], v8 offset:7168
v_mfma_f32_32x32x16_bf16 v[64:79], a[4:7], v[112:115], 0
ds_read_b64_tr_b16 a[0:1], v7 offset:8192
ds_read_b64_tr_b16 a[2:3], v7 offset:9216
v_mfma_f32_32x32x16_bf16 v[48:63], a[8:11], v[116:119], v[48:63]
ds_read_b64_tr_b16 a[4:5], v8 offset:8192
ds_read_b64_tr_b16 a[6:7], v8 offset:9216
v_mfma_f32_32x32x16_bf16 v[64:79], a[12:15], v[116:119], v[64:79]
ds_read_b64_tr_b16 a[8:9], v7 offset:10240
ds_read_b64_tr_b16 a[10:11], v7 offset:11264
v_max3_f32 v28, |v80|, |v81|, v28
s_waitcnt lgkmcnt(6)
v_mfma_f32_32x32x16_bf16 v[48:63], a[16:19], v[120:123], v[48:63]
ds_read_b64_tr_b16 a[12:13], v8 offset:10240
ds_read_b64_tr_b16 a[14:15], v8 offset:11264
v_max3_f32 v28, |v82|, |v83|, v28
v_max3_f32 v28, |v84|, |v85|, v28
v_mfma_f32_32x32x16_bf16 v[64:79], a[20:23], v[120:123], v[64:79]
ds_read_b64_tr_b16 a[16:17], v7 offset:12288
ds_read_b64_tr_b16 a[18:19], v7 offset:13312
v_max3_f32 v28, |v86|, |v87|, v28
v_max3_f32 v28, |v88|, |v89|, v28
v_mfma_f32_32x32x16_bf16 v[48:63], a[24:27], v[124:127], v[48:63]
ds_read_b64_tr_b16 a[20:21], v8 offset:12288
ds_read_b64_tr_b16 a[22:23], v8 offset:13312
v_max3_f32 v28, |v90|, |v91|, v28
v_max3_f32 v28, |v92|, |v93|, v28
v_mfma_f32_32x32x16_bf16 v[64:79], a[28:31], v[124:127], v[64:79]
ds_read_b64_tr_b16 a[24:25], v7 offset:14336
ds_read_b64_tr_b16 a[26:27], v7 offset:15360
v_max3_f32 v28, |v94|, |v95|, v28
s_waitcnt lgkmcnt(6)
v_mfma_f32_32x32x16_bf16 v[48:63], a[0:3], v[128:131], v[48:63]
ds_read_b64_tr_b16 a[28:29], v8 offset:14336
ds_read_b64_tr_b16 a[30:31], v8 offset:15360
v_mul_f32 v80, s49, v80
v_mul_f32 v81, s49, v81
v_mfma_f32_32x32x16_bf16 v[64:79], a[4:7], v[128:131], v[64:79]
ds_read_b64_tr_b16 a[0:1], v7 offset:16384
ds_read_b64_tr_b16 a[2:3], v7 offset:17408
v_mul_f32 v82, s49, v82
v_mul_f32 v83, s49, v83
v_mfma_f32_32x32x16_bf16 v[48:63], a[8:11], v[132:135], v[48:63]
ds_read_b64_tr_b16 a[4:5], v8 offset:16384
ds_read_b64_tr_b16 a[6:7], v8 offset:17408
v_mul_f32 v84, s49, v84
v_mul_f32 v85, s49, v85
v_mfma_f32_32x32x16_bf16 v[64:79], a[12:15], v[132:135], v[64:79]
ds_read_b64_tr_b16 a[8:9], v7 offset:18432
ds_read_b64_tr_b16 a[10:11], v7 offset:19456
v_mul_f32 v86, s49, v86
s_waitcnt lgkmcnt(6)
v_mfma_f32_32x32x16_bf16 v[48:63], a[16:19], v[136:139], v[48:63]
ds_read_b64_tr_b16 a[12:13], v8 offset:18432
ds_read_b64_tr_b16 a[14:15], v8 offset:19456
v_mul_f32 v87, s49, v87
v_mul_f32 v88, s49, v88
v_mfma_f32_32x32x16_bf16 v[64:79], a[20:23], v[136:139], v[64:79]
ds_read_b64_tr_b16 a[16:17], v7 offset:20480
ds_read_b64_tr_b16 a[18:19], v7 offset:21504
v_mul_f32 v89, s49, v89
v_mul_f32 v90, s49, v90
v_mfma_f32_32x32x16_bf16 v[48:63], a[24:27], v[140:143], v[48:63]
ds_read_b64_tr_b16 a[20:21], v8 offset:20480
ds_read_b64_tr_b16 a[22:23], v8 offset:21504
v_mul_f32 v91, s49, v91
v_mul_f32 v92, s49, v92
v_mfma_f32_32x32x16_bf16 v[64:79], a[28:31], v[140:143], v[64:79]
ds_read_b64_tr_b16 a[24:25], v7 offset:22528
ds_read_b64_tr_b16 a[26:27], v7 offset:23552
v_mul_f32 v93, s49, v93
s_waitcnt lgkmcnt(6)
v_mfma_f32_32x32x16_bf16 v[48:63], a[0:3], v[144:147], v[48:63]
ds_read_b64_tr_b16 a[28:29], v8 offset:22528
ds_read_b64_tr_b16 a[30:31], v8 offset:23552
s_waitcnt vmcnt(10)
s_barrier
v_mfma_f32_32x32x16_bf16 v[64:79], a[4:7], v[144:147], v[64:79]
ds_read_b64_tr_b16 a[0:1], v7 offset:24576
ds_read_b64_tr_b16 a[2:3], v7 offset:25600
v_mul_f32 v94, s49, v94
v_mul_f32 v95, s49, v95
v_mfma_f32_32x32x16_bf16 v[48:63], a[8:11], v[148:151], v[48:63]
ds_read_b64_tr_b16 a[4:5], v8 offset:24576
ds_read_b64_tr_b16 a[6:7], v8 offset:25600
v_cvt_pk_bf16_f32 v80, v80, v81
v_cvt_pk_bf16_f32 v81, v82, v83
v_mfma_f32_32x32x16_bf16 v[64:79], a[12:15], v[148:151], v[64:79]
ds_read_b64_tr_b16 a[8:9], v7 offset:26624
ds_read_b64_tr_b16 a[10:11], v7 offset:27648
v_cvt_pk_bf16_f32 v82, v84, v85
s_waitcnt lgkmcnt(6)
v_mfma_f32_32x32x16_bf16 v[48:63], a[16:19], v[152:155], v[48:63]
ds_read_b64_tr_b16 a[12:13], v8 offset:26624
ds_read_b64_tr_b16 a[14:15], v8 offset:27648
v_cvt_pk_bf16_f32 v83, v86, v87
v_cvt_pk_bf16_f32 v84, v88, v89
v_mfma_f32_32x32x16_bf16 v[64:79], a[20:23], v[152:155], v[64:79]
ds_read_b64_tr_b16 a[16:17], v7 offset:28672
ds_read_b64_tr_b16 a[18:19], v7 offset:29696
v_cvt_pk_bf16_f32 v85, v90, v91
v_cvt_pk_bf16_f32 v86, v92, v93
v_mfma_f32_32x32x16_bf16 v[48:63], a[24:27], v[156:159], v[48:63]
ds_read_b64_tr_b16 a[20:21], v8 offset:28672
ds_read_b64_tr_b16 a[22:23], v8 offset:29696
v_cvt_pk_bf16_f32 v87, v94, v95
v_mfma_f32_32x32x16_bf16 v[64:79], a[28:31], v[156:159], v[64:79]
ds_read_b64_tr_b16 a[24:25], v7 offset:30720
ds_read_b64_tr_b16 a[26:27], v7 offset:31744
s_waitcnt lgkmcnt(6)
v_mfma_f32_32x32x16_bf16 v[48:63], a[0:3], v[160:163], v[48:63]
ds_read_b64_tr_b16 a[28:29], v8 offset:30720
ds_read_b64_tr_b16 a[30:31], v8 offset:31744
buffer_store_dwordx4 v[80:83], v11, s[16:19], s43 offen sc1
v_mfma_f32_32x32x16_bf16 v[64:79], a[4:7], v[160:163], v[64:79]
ds_read_b64_tr_b16 a[0:1], v7 offset:32768
ds_read_b64_tr_b16 a[2:3], v7 offset:33792
s_add_u32 s43, s43, s42
v_mfma_f32_32x32x16_bf16 v[48:63], a[8:11], v[164:167], v[48:63]
ds_read_b64_tr_b16 a[4:5], v8 offset:32768
ds_read_b64_tr_b16 a[6:7], v8 offset:33792
buffer_store_dwordx4 v[84:87], v11, s[16:19], s43 offen sc1
v_mfma_f32_32x32x16_bf16 v[64:79], a[12:15], v[164:167], v[64:79]
ds_read_b64_tr_b16 a[8:9], v7 offset:34816
ds_read_b64_tr_b16 a[10:11], v7 offset:35840
s_add_u32 s43, s43, s42
s_waitcnt lgkmcnt(6)
v_mfma_f32_32x32x16_bf16 v[48:63], a[16:19], v[168:171], v[48:63]
ds_read_b64_tr_b16 a[12:13], v8 offset:34816
ds_read_b64_tr_b16 a[14:15], v8 offset:35840
v_max3_f32 v28, |v96|, |v97|, v28
v_max3_f32 v28, |v98|, |v99|, v28
v_mfma_f32_32x32x16_bf16 v[64:79], a[20:23], v[168:171], v[64:79]
ds_read_b64_tr_b16 a[16:17], v7 offset:36864
ds_read_b64_tr_b16 a[18:19], v7 offset:37888
v_max3_f32 v28, |v100|, |v101|, v28
v_max3_f32 v28, |v102|, |v103|, v28
v_mfma_f32_32x32x16_bf16 v[48:63], a[24:27], v[172:175], v[48:63]
ds_read_b64_tr_b16 a[20:21], v8 offset:36864
ds_read_b64_tr_b16 a[22:23], v8 offset:37888
v_max3_f32 v28, |v104|, |v105|, v28
v_max3_f32 v28, |v106|, |v107|, v28
v_mfma_f32_32x32x16_bf16 v[64:79], a[28:31], v[172:175], v[64:79]
ds_read_b64_tr_b16 a[24:25], v7 offset:38912
ds_read_b64_tr_b16 a[26:27], v7 offset:39936
v_max3_f32 v28, |v108|, |v109|, v28
s_waitcnt lgkmcnt(6)
v_mfma_f32_32x32x16_bf16 v[48:63], a[0:3], v[176:179], v[48:63]
ds_read_b64_tr_b16 a[28:29], v8 offset:38912
ds_read_b64_tr_b16 a[30:31], v8 offset:39936
v_max3_f32 v28, |v110|, |v111|, v28
v_mul_f32 v96, s49, v96
v_mfma_f32_32x32x16_bf16 v[64:79], a[4:7], v[176:179], v[64:79]
ds_read_b64_tr_b16 a[0:1], v7 offset:40960
ds_read_b64_tr_b16 a[2:3], v7 offset:41984
v_mul_f32 v97, s49, v97
v_mul_f32 v98, s49, v98
v_mfma_f32_32x32x16_bf16 v[48:63], a[8:11], v[180:183], v[48:63]
ds_read_b64_tr_b16 a[4:5], v8 offset:40960
ds_read_b64_tr_b16 a[6:7], v8 offset:41984
v_mul_f32 v99, s49, v99
v_mul_f32 v100, s49, v100
v_mfma_f32_32x32x16_bf16 v[64:79], a[12:15], v[180:183], v[64:79]
ds_read_b64_tr_b16 a[8:9], v7 offset:43008
ds_read_b64_tr_b16 a[10:11], v7 offset:44032
v_mul_f32 v101, s49, v101
s_waitcnt lgkmcnt(6)
v_mfma_f32_32x32x16_bf16 v[48:63], a[16:19], v[184:187], v[48:63]
ds_read_b64_tr_b16 a[12:13], v8 offset:43008
ds_read_b64_tr_b16 a[14:15], v8 offset:44032
v_mul_f32 v102, s49, v102
v_mul_f32 v103, s49, v103
v_mfma_f32_32x32x16_bf16 v[64:79], a[20:23], v[184:187], v[64:79]
ds_read_b64_tr_b16 a[16:17], v7 offset:45056
ds_read_b64_tr_b16 a[18:19], v7 offset:46080
v_mul_f32 v104, s49, v104
v_mul_f32 v105, s49, v105
v_mfma_f32_32x32x16_bf16 v[48:63], a[24:27], v[188:191], v[48:63]
ds_read_b64_tr_b16 a[20:21], v8 offset:45056
ds_read_b64_tr_b16 a[22:23], v8 offset:46080
v_mul_f32 v106, s49, v106
v_mul_f32 v107, s49, v107
v_mfma_f32_32x32x16_bf16 v[64:79], a[28:31], v[188:191], v[64:79]
ds_read_b64_tr_b16 a[24:25], v7 offset:47104
ds_read_b64_tr_b16 a[26:27], v7 offset:48128
v_mul_f32 v108, s49, v108
s_waitcnt lgkmcnt(6)
v_mfma_f32_32x32x16_bf16 v[48:63], a[0:3], v[192:195], v[48:63]
ds_read_b64_tr_b16 a[28:29], v8 offset:47104
ds_read_b64_tr_b16 a[30:31], v8 offset:48128
s_waitcnt vmcnt(6)
s_barrier
v_mfma_f32_32x32x16_bf16 v[64:79], a[4:7], v[192:195], v[64:79]
ds_read_b64_tr_b16 a[0:1], v12 offset:0
ds_read_b64_tr_b16 a[2:3], v12 offset:1024
v_mul_f32 v109, s49, v109
v_mul_f32 v110, s49, v110
v_mfma_f32_32x32x16_bf16 v[48:63], a[8:11], v[196:199], v[48:63]
ds_read_b64_tr_b16 a[4:5], v13 offset:0
ds_read_b64_tr_b16 a[6:7], v13 offset:1024
v_mul_f32 v111, s49, v111
v_cvt_pk_bf16_f32 v96, v96, v97
v_mfma_f32_32x32x16_bf16 v[64:79], a[12:15], v[196:199], v[64:79]
ds_read_b64_tr_b16 a[8:9], v12 offset:2048
ds_read_b64_tr_b16 a[10:11], v12 offset:3072
v_cvt_pk_bf16_f32 v97, v98, v99
s_waitcnt lgkmcnt(6)
v_mfma_f32_32x32x16_bf16 v[48:63], a[16:19], v[200:203], v[48:63]
ds_read_b64_tr_b16 a[12:13], v13 offset:2048
ds_read_b64_tr_b16 a[14:15], v13 offset:3072
v_cvt_pk_bf16_f32 v98, v100, v101
v_cvt_pk_bf16_f32 v99, v102, v103
v_mfma_f32_32x32x16_bf16 v[64:79], a[20:23], v[200:203], v[64:79]
ds_read_b64_tr_b16 a[16:17], v12 offset:4096
ds_read_b64_tr_b16 a[18:19], v12 offset:5120
v_cvt_pk_bf16_f32 v100, v104, v105
v_cvt_pk_bf16_f32 v101, v106, v107
v_mfma_f32_32x32x16_bf16 v[48:63], a[24:27], v[204:207], v[48:63]
ds_read_b64_tr_b16 a[20:21], v13 offset:4096
ds_read_b64_tr_b16 a[22:23], v13 offset:5120
v_cvt_pk_bf16_f32 v102, v108, v109
v_cvt_pk_bf16_f32 v103, v110, v111
v_mfma_f32_32x32x16_bf16 v[64:79], a[28:31], v[204:207], v[64:79]
ds_read_b64_tr_b16 a[24:25], v12 offset:6144
ds_read_b64_tr_b16 a[26:27], v12 offset:7168
s_waitcnt lgkmcnt(6)
v_mfma_f32_32x32x16_bf16 v[48:63], a[0:3], v[208:211], v[48:63]
ds_read_b64_tr_b16 a[28:29], v13 offset:6144
ds_read_b64_tr_b16 a[30:31], v13 offset:7168
buffer_store_dwordx4 v[96:99], v11, s[16:19], s43 offen sc1
v_mfma_f32_32x32x16_bf16 v[64:79], a[4:7], v[208:211], v[64:79]
ds_read_b64_tr_b16 a[0:1], v12 offset:8192
ds_read_b64_tr_b16 a[2:3], v12 offset:9216
s_add_u32 s43, s43, s42
v_mfma_f32_32x32x16_bf16 v[48:63], a[8:11], v[212:215], v[48:63]
ds_read_b64_tr_b16 a[4:5], v13 offset:8192
ds_read_b64_tr_b16 a[6:7], v13 offset:9216
buffer_store_dwordx4 v[100:103], v11, s[16:19], s43 offen sc1
v_mfma_f32_32x32x16_bf16 v[64:79], a[12:15], v[212:215], v[64:79]
ds_read_b64_tr_b16 a[8:9], v12 offset:10240
ds_read_b64_tr_b16 a[10:11], v12 offset:11264
s_add_u32 s43, s43, s42
s_waitcnt lgkmcnt(6)
v_mfma_f32_32x32x16_bf16 v[48:63], a[16:19], v[216:219], v[48:63]
ds_read_b64_tr_b16 a[12:13], v13 offset:10240
ds_read_b64_tr_b16 a[14:15], v13 offset:11264
v_mfma_f32_32x32x16_bf16 v[64:79], a[20:23], v[216:219], v[64:79]
ds_read_b64_tr_b16 a[16:17], v12 offset:12288
ds_read_b64_tr_b16 a[18:19], v12 offset:13312
v_mfma_f32_32x32x16_bf16 v[48:63], a[24:27], v[220:223], v[48:63]
ds_read_b64_tr_b16 a[20:21], v13 offset:12288
ds_read_b64_tr_b16 a[22:23], v13 offset:13312
v_mfma_f32_32x32x16_bf16 v[64:79], a[28:31], v[220:223], v[64:79]
ds_read_b64_tr_b16 a[24:25], v12 offset:14336
ds_read_b64_tr_b16 a[26:27], v12 offset:15360
s_waitcnt lgkmcnt(6)
v_mfma_f32_32x32x16_bf16 v[48:63], a[0:3], v[224:227], v[48:63]
ds_read_b64_tr_b16 a[28:29], v13 offset:14336
ds_read_b64_tr_b16 a[30:31], v13 offset:15360
v_mfma_f32_32x32x16_bf16 v[64:79], a[4:7], v[224:227], v[64:79]
ds_read_b64_tr_b16 a[0:1], v12 offset:16384
ds_read_b64_tr_b16 a[2:3], v12 offset:17408
v_mfma_f32_32x32x16_bf16 v[48:63], a[8:11], v[228:231], v[48:63]
ds_read_b64_tr_b16 a[4:5], v13 offset:16384
ds_read_b64_tr_b16 a[6:7], v13 offset:17408
v_mfma_f32_32x32x16_bf16 v[64:79], a[12:15], v[228:231], v[64:79]
ds_read_b64_tr_b16 a[8:9], v12 offset:18432
ds_read_b64_tr_b16 a[10:11], v12 offset:19456
s_waitcnt lgkmcnt(6)
v_mfma_f32_32x32x16_bf16 v[48:63], a[16:19], v[232:235], v[48:63]
ds_read_b64_tr_b16 a[12:13], v13 offset:18432
ds_read_b64_tr_b16 a[14:15], v13 offset:19456
v_mfma_f32_32x32x16_bf16 v[64:79], a[20:23], v[232:235], v[64:79]
ds_read_b64_tr_b16 a[16:17], v12 offset:20480
ds_read_b64_tr_b16 a[18:19], v12 offset:21504
v_mfma_f32_32x32x16_bf16 v[48:63], a[24:27], v[236:239], v[48:63]
ds_read_b64_tr_b16 a[20:21], v13 offset:20480
ds_read_b64_tr_b16 a[22:23], v13 offset:21504
v_mfma_f32_32x32x16_bf16 v[64:79], a[28:31], v[236:239], v[64:79]
ds_read_b64_tr_b16 a[24:25], v12 offset:22528
ds_read_b64_tr_b16 a[26:27], v12 offset:23552
s_waitcnt lgkmcnt(6)
v_mfma_f32_32x32x16_bf16 v[48:63], a[0:3], v[240:243], v[48:63]
ds_read_b64_tr_b16 a[28:29], v13 offset:22528
ds_read_b64_tr_b16 a[30:31], v13 offset:23552
v_mfma_f32_32x32x16_bf16 v[64:79], a[4:7], v[240:243], v[64:79]
v_mfma_f32_32x32x16_bf16 v[48:63], a[8:11], v[244:247], v[48:63]
v_mfma_f32_32x32x16_bf16 v[64:79], a[12:15], v[244:247], v[64:79]
s_waitcnt lgkmcnt(0)
v_mfma_f32_32x32x16_bf16 v[48:63], a[16:19], v[248:251], v[48:63]
v_mfma_f32_32x32x16_bf16 v[64:79], a[20:23], v[248:251], v[64:79]
v_mfma_f32_32x32x16_bf16 v[48:63], a[24:27], v[252:255], v[48:63]
v_mfma_f32_32x32x16_bf16 v[64:79], a[28:31], v[252:255], v[64:79]
s_nop 10
v_max3_f32 v28, |v48|, |v49|, v28
v_max3_f32 v28, |v50|, |v51|, v28
v_max3_f32 v28, |v52|, |v53|, v28
v_max3_f32 v28, |v54|, |v55|, v28
v_max3_f32 v28, |v56|, |v57|, v28
v_max3_f32 v28, |v58|, |v59|, v28
v_max3_f32 v28, |v60|, |v61|, v28
v_max3_f32 v28, |v62|, |v63|, v28
v_mul_f32 v48, s49, v48
v_mul_f32 v49, s49, v49
v_mul_f32 v50, s49, v50
v_mul_f32 v51, s49, v51
v_mul_f32 v52, s49, v52
v_mul_f32 v53, s49, v53
v_mul_f32 v54, s49, v54
v_mul_f32 v55, s49, v55
v_mul_f32 v56, s49, v56
v_mul_f32 v57, s49, v57
v_mul_f32 v58, s49, v58
v_mul_f32 v59, s49, v59
v_mul_f32 v60, s49, v60
v_mul_f32 v61, s49, v61
v_mul_f32 v62, s49, v62
v_mul_f32 v63, s49, v63
v_cvt_pk_bf16_f32 v48, v48, v49
v_cvt_pk_bf16_f32 v49, v50, v51
v_cvt_pk_bf16_f32 v50, v52, v53
v_cvt_pk_bf16_f32 v51, v54, v55
v_cvt_pk_bf16_f32 v52, v56, v57
v_cvt_pk_bf16_f32 v53, v58, v59
v_cvt_pk_bf16_f32 v54, v60, v61
v_cvt_pk_bf16_f32 v55, v62, v63
buffer_store_dwordx4 v[48:51], v11, s[16:19], s43 offen sc1
s_add_u32 s43, s43, s42
buffer_store_dwordx4 v[52:55], v11, s[16:19], s43 offen sc1
s_add_u32 s43, s43, s42
v_max3_f32 v28, |v64|, |v65|, v28
v_max3_f32 v28, |v66|, |v67|, v28
v_max3_f32 v28, |v68|, |v69|, v28
v_max3_f32 v28, |v70|, |v71|, v28
v_max3_f32 v28, |v72|, |v73|, v28
v_max3_f32 v28, |v74|, |v75|, v28
v_max3_f32 v28, |v76|, |v77|, v28
v_max3_f32 v28, |v78|, |v79|, v28
v_mul_f32 v64, s49, v64
v_mul_f32 v65, s49, v65
v_mul_f32 v66, s49, v66
v_mul_f32 v67, s49, v67
v_mul_f32 v68, s49, v68
v_mul_f32 v69, s49, v69
v_mul_f32 v70, s49, v70
v_mul_f32 v71, s49, v71
v_mul_f32 v72, s49, v72
v_mul_f32 v73, s49, v73
v_mul_f32 v74, s49, v74
v_mul_f32 v75, s49, v75
v_mul_f32 v76, s49, v76
v_mul_f32 v77, s49, v77
v_mul_f32 v78, s49, v78
v_mul_f32 v79, s49, v79
v_cvt_pk_bf16_f32 v64, v64, v65
v_cvt_pk_bf16_f32 v65, v66, v67
v_cvt_pk_bf16_f32 v66, v68, v69
v_cvt_pk_bf16_f32 v67, v70, v71
v_cvt_pk_bf16_f32 v68, v72, v73
v_cvt_pk_bf16_f32 v69, v74, v75
v_cvt_pk_bf16_f32 v70, v76, v77
v_cvt_pk_bf16_f32 v71, v78, v79
buffer_store_dwordx4 v[64:67], v11, s[16:19], s43 offen sc1
s_add_u32 s43, s43, s42
buffer_store_dwordx4 v[68:71], v11, s[16:19], s43 offen sc1
s_add_u32 s43, s43, s42
s_cmp_lg_u32 s26, 1
s_cbranch_scc1 L_ka_end
v_max_f32_dpp v28, v28, v28 quad_perm:[1,0,3,2] row_mask:0xf bank_mask:0xf
s_nop 1
v_max_f32_dpp v28, v28, v28 quad_perm:[2,3,0,1] row_mask:0xf bank_mask:0xf
s_nop 1
v_max_f32_dpp v28, v28, v28 row_half_mirror row_mask:0xf bank_mask:0xf
s_nop 1
v_max_f32_dpp v28, v28, v28 row_mirror row_mask:0xf bank_mask:0xf
v_mov_b32 v29, v28
s_nop 1
v_permlane16_swap_b32 v28, v29
v_max_f32 v28, v28, v29
v_mov_b32 v29, v28
s_nop 1
v_permlane32_swap_b32 v28, v29
v_max_f32 v28, v28, v29
s_mul_i32 s32, s35, 3
s_add_u32 s32, s32, s27
s_lshl_b32 s32, s32, 2
s_add_u32 s32, s32, 0x8000
v_mov_b32 v11, s32
v_cmp_eq_u32 vcc, 0, v1
s_nop 0
s_and_saveexec_b64 s[42:43], vcc
buffer_store_dword v28, v11, s[20:23], 0 offen sc1
s_endpgm
L_ka_v:
s_add_u32 s16, s6, 0x580000
s_addc_u32 s17, s7, 0
s_mov_b32 s18, 0x250000
s_mov_b32 s19, 0x00020000
s_lshl_b32 s41, s35, 10
s_cmp_lg_u32 s27, 0
s_cbranch_scc1 L_ka_noones
v_mov_b32 v20, 0x3f803f80
v_mov_b32 v21, 0x3f803f80
v_mov_b32 v22, 0x3f803f80
v_mov_b32 v23, 0x3f803f80
s_add_u32 s32, s41, 2359296
buffer_store_dwordx4 v[20:23], v11, s[16:19], s32 offen sc1
L_ka_noones:
v_bfe_u32 v11, v1, 4, 1
v_lshlrev_b32 v11, 16, v11
v_lshl_add_u32 v11, v10, 8, v11
v_and_b32 v9, 15, v1
v_lshl_add_u32 v11, v9, 4, v11
s_mul_i32 s32, s27, 786432
s_add_u32 s41, s41, s32
s_waitcnt vmcnt(6)
s_barrier
ds_read_b64_tr_b16 a[0:1], v7 offset:0
ds_read_b64_tr_b16 a[2:3], v7 offset:1024
ds_read_b64_tr_b16 a[4:5], v8 offset:0
ds_read_b64_tr_b16 a[6:7], v8 offset:1024
ds_read_b64_tr_b16 a[8:9], v7 offset:2048
ds_read_b64_tr_b16 a[10:11], v7 offset:3072
ds_read_b64_tr_b16 a[12:13], v8 offset:2048
ds_read_b64_tr_b16 a[14:15], v8 offset:3072
ds_read_b64_tr_b16 a[16:17], v7 offset:4096
ds_read_b64_tr_b16 a[18:19], v7 offset:5120
ds_read_b64_tr_b16 a[20:21], v8 offset:4096
ds_read_b64_tr_b16 a[22:23], v8 offset:5120
ds_read_b64_tr_b16 a[24:25], v7 offset:6144
ds_read_b64_tr_b16 a[26:27], v7 offset:7168
s_waitcnt lgkmcnt(6)
v_mfma_f32_32x32x16_bf16 v[48:63], v[112:115], a[0:3], 0
ds_read_b64_tr_b16 a[28:29], v8 offset:6144
ds_read_b64_tr_b16 a[30:31], v8 offset:7168
s_add_u32 m0, s34, 49152
s_nop 0
buffer_load_dwordx4 v4, s[8:11], s30 offen lds
buffer_load_dwordx4 v5, s[8:11], s30 offen offset:1024 lds
v_mfma_f32_32x32x16_bf16 v[64:79], v[112:115], a[4:7], 0
ds_read_b64_tr_b16 a[0:1], v7 offset:8192
ds_read_b64_tr_b16 a[2:3], v7 offset:9216
buffer_load_dwordx4 v6, s[8:11], s30 offen offset:2048 lds
v_mfma_f32_32x32x16_bf16 v[48:63], v[116:119], a[8:11], v[48:63]
ds_read_b64_tr_b16 a[4:5], v8 offset:8192
ds_read_b64_tr_b16 a[6:7], v8 offset:9216
s_add_u32 m0, s34, 52224
s_nop 0
buffer_load_dwordx4 v4, s[8:11], s31 offen lds
v_mfma_f32_32x32x16_bf16 v[64:79], v[116:119], a[12:15], v[64:79]
ds_read_b64_tr_b16 a[8:9], v7 offset:10240
ds_read_b64_tr_b16 a[10:11], v7 offset:11264
buffer_load_dwordx4 v5, s[8:11], s31 offen offset:1024 lds
s_waitcnt lgkmcnt(6)
v_mfma_f32_32x32x16_bf16 v[48:63], v[120:123], a[16:19], v[48:63]
ds_read_b64_tr_b16 a[12:13], v8 offset:10240
ds_read_b64_tr_b16 a[14:15], v8 offset:11264
buffer_load_dwordx4 v6, s[8:11], s31 offen offset:2048 lds
s_add_u32 s30, s30, s58
s_add_u32 s31, s31, s58
v_mfma_f32_32x32x16_bf16 v[64:79], v[120:123], a[20:23], v[64:79]
ds_read_b64_tr_b16 a[16:17], v7 offset:12288
ds_read_b64_tr_b16 a[18:19], v7 offset:13312
s_add_u32 m0, s34, 73728
s_nop 0
buffer_load_dwordx4 v4, s[8:11], s30 offen lds
v_mfma_f32_32x32x16_bf16 v[48:63], v[124:127], a[24:27], v[48:63]
ds_read_b64_tr_b16 a[20:21], v8 offset:12288
ds_read_b64_tr_b16 a[22:23], v8 offset:13312
buffer_load_dwordx4 v5, s[8:11], s30 offen offset:1024 lds
v_mfma_f32_32x32x16_bf16 v[64:79], v[124:127], a[28:31], v[64:79]
ds_read_b64_tr_b16 a[24:25], v7 offset:14336
ds_read_b64_tr_b16 a[26:27], v7 offset:15360
buffer_load_dwordx4 v6, s[8:11], s30 offen offset:2048 lds
s_waitcnt lgkmcnt(6)
v_mfma_f32_32x32x16_bf16 v[48:63], v[128:131], a[0:3], v[48:63]
ds_read_b64_tr_b16 a[28:29], v8 offset:14336
ds_read_b64_tr_b16 a[30:31], v8 offset:15360
s_add_u32 m0, s34, 76800
s_nop 0
buffer_load_dwordx4 v4, s[8:11], s31 offen lds
buffer_load_dwordx4 v5, s[8:11], s31 offen offset:1024 lds
v_mfma_f32_32x32x16_bf16 v[64:79], v[128:131], a[4:7], v[64:79]
ds_read_b64_tr_b16 a[0:1], v7 offset:16384
ds_read_b64_tr_b16 a[2:3], v7 offset:17408
buffer_load_dwordx4 v6, s[8:11], s31 offen offset:2048 lds
s_add_u32 s30, s30, s56
s_add_u32 s31, s31, s56
v_mfma_f32_32x32x16_bf16 v[48:63], v[132:135], a[8:11], v[48:63]
ds_read_b64_tr_b16 a[4:5], v8 offset:16384
ds_read_b64_tr_b16 a[6:7], v8 offset:17408
s_add_u32 m0, s34, 98304
s_nop 0
buffer_load_dwordx4 v4, s[8:11], s30 offen lds
v_mfma_f32_32x32x16_bf16 v[64:79], v[132:135], a[12:15], v[64:79]
ds_read_b64_tr_b16 a[8:9], v7 offset:18432
ds_read_b64_tr_b16 a[10:11], v7 offset:19456
buffer_load_dwordx4 v5, s[8:11], s30 offen offset:1024 lds
s_waitcnt lgkmcnt(6)
v_mfma_f32_32x32x16_bf16 v[48:63], v[136:139], a[16:19], v[48:63]
ds_read_b64_tr_b16 a[12:13], v8 offset:18432
ds_read_b64_tr_b16 a[14:15], v8 offset:19456
buffer_load_dwordx4 v6, s[8:11], s30 offen offset:2048 lds
v_mfma_f32_32x32x16_bf16 v[64:79], v[136:139], a[20:23], v[64:79]
ds_read_b64_tr_b16 a[16:17], v7 offset:20480
ds_read_b64_tr_b16 a[18:19], v7 offset:21504
s_add_u32 m0, s34, 101376
s_nop 0
buffer_load_dwordx4 v4, s[8:11], s31 offen lds
v_mfma_f32_32x32x16_bf16 v[48:63], v[140:143], a[24:27], v[48:63]
ds_read_b64_tr_b16 a[20:21], v8 offset:20480
ds_read_b64_tr_b16 a[22:23], v8 offset:21504
buffer_load_dwordx4 v5, s[8:11], s31 offen offset:1024 lds
v_mfma_f32_32x32x16_bf16 v[64:79], v[140:143], a[28:31], v[64:79]
ds_read_b64_tr_b16 a[24:25], v7 offset:22528
ds_read_b64_tr_b16 a[26:27], v7 offset:23552
buffer_load_dwordx4 v6, s[8:11], s31 offen offset:2048 lds
s_add_u32 s30, s30, s57
s_add_u32 s31, s31, s57
s_waitcnt lgkmcnt(6)
v_mfma_f32_32x32x16_bf16 v[48:63], v[144:147], a[0:3], v[48:63]
ds_read_b64_tr_b16 a[28:29], v8 offset:22528
ds_read_b64_tr_b16 a[30:31], v8 offset:23552
s_waitcnt vmcnt(18)
s_barrier
v_mfma_f32_32x32x16_bf16 v[64:79], v[144:147], a[4:7], v[64:79]
ds_read_b64_tr_b16 a[0:1], v7 offset:24576
ds_read_b64_tr_b16 a[2:3], v7 offset:25600
s_add_u32 m0, s34, 122880
v_mfma_f32_32x32x16_bf16 v[48:63], v[148:151], a[8:11], v[48:63]
ds_read_b64_tr_b16 a[4:5], v8 offset:24576
ds_read_b64_tr_b16 a[6:7], v8 offset:25600
v_mfma_f32_32x32x16_bf16 v[64:79], v[148:151], a[12:15], v[64:79]
ds_read_b64_tr_b16 a[8:9], v7 offset:26624
ds_read_b64_tr_b16 a[10:11], v7 offset:27648
buffer_load_dwordx4 v4, s[8:11], s30 offen lds
s_waitcnt lgkmcnt(6)
v_mfma_f32_32x32x16_bf16 v[48:63], v[152:155], a[16:19], v[48:63]
ds_read_b64_tr_b16 a[12:13], v8 offset:26624
ds_read_b64_tr_b16 a[14:15], v8 offset:27648
v_mfma_f32_32x32x16_bf16 v[64:79], v[152:155], a[20:23], v[64:79]
ds_read_b64_tr_b16 a[16:17], v7 offset:28672
ds_read_b64_tr_b16 a[18:19], v7 offset:29696
buffer_load_dwordx4 v5, s[8:11], s30 offen offset:1024 lds
v_mfma_f32_32x32x16_bf16 v[48:63], v[156:159], a[24:27], v[48:63]
ds_read_b64_tr_b16 a[20:21], v8 offset:28672
ds_read_b64_tr_b16 a[22:23], v8 offset:29696
v_mfma_f32_32x32x16_bf16 v[64:79], v[156:159], a[28:31], v[64:79]
ds_read_b64_tr_b16 a[24:25], v7 offset:30720
ds_read_b64_tr_b16 a[26:27], v7 offset:31744
buffer_load_dwordx4 v6, s[8:11], s30 offen offset:2048 lds
s_waitcnt lgkmcnt(6)
v_mfma_f32_32x32x16_bf16 v[48:63], v[160:163], a[0:3], v[48:63]
ds_read_b64_tr_b16 a[28:29], v8 offset:30720
ds_read_b64_tr_b16 a[30:31], v8 offset:31744
v_mfma_f32_32x32x16_bf16 v[64:79], v[160:163], a[4:7], v[64:79]
ds_read_b64_tr_b16 a[0:1], v7 offset:32768
ds_read_b64_tr_b16 a[2:3], v7 offset:33792
s_add_u32 m0, s34, 125952
v_mfma_f32_32x32x16_bf16 v[48:63], v[164:167], a[8:11], v[48:63]
ds_read_b64_tr_b16 a[4:5], v8 offset:32768
ds_read_b64_tr_b16 a[6:7], v8 offset:33792
v_mfma_f32_32x32x16_bf16 v[64:79], v[164:167], a[12:15], v[64:79]
ds_read_b64_tr_b16 a[8:9], v7 offset:34816
ds_read_b64_tr_b16 a[10:11], v7 offset:35840
buffer_load_dwordx4 v4, s[8:11], s31 offen lds
s_waitcnt lgkmcnt(6)
v_mfma_f32_32x32x16_bf16 v[48:63], v[168:171], a[16:19], v[48:63]
ds_read_b64_tr_b16 a[12:13], v8 offset:34816
ds_read_b64_tr_b16 a[14:15], v8 offset:35840
v_mfma_f32_32x32x16_bf16 v[64:79], v[168:171], a[20:23], v[64:79]
ds_read_b64_tr_b16 a[16:17], v7 offset:36864
ds_read_b64_tr_b16 a[18:19], v7 offset:37888
buffer_load_dwordx4 v5, s[8:11], s31 offen offset:1024 lds
v_mfma_f32_32x32x16_bf16 v[48:63], v[172:175], a[24:27], v[48:63]
ds_read_b64_tr_b16 a[20:21], v8 offset:36864
ds_read_b64_tr_b16 a[22:23], v8 offset:37888
v_mfma_f32_32x32x16_bf16 v[64:79], v[172:175], a[28:31], v[64:79]
ds_read_b64_tr_b16 a[24:25], v7 offset:38912
ds_read_b64_tr_b16 a[26:27], v7 offset:39936
buffer_load_dwordx4 v6, s[8:11], s31 offen offset:2048 lds
s_waitcnt lgkmcnt(6)
v_mfma_f32_32x32x16_bf16 v[48:63], v[176:179], a[0:3], v[48:63]
ds_read_b64_tr_b16 a[28:29], v8 offset:38912
ds_read_b64_tr_b16 a[30:31], v8 offset:39936
v_mfma_f32_32x32x16_bf16 v[64:79], v[176:179], a[4:7], v[64:79]
ds_read_b64_tr_b16 a[0:1], v7 offset:40960
ds_read_b64_tr_b16 a[2:3], v7 offset:41984
s_add_u32 s30, s30, s58
v_mfma_f32_32x32x16_bf16 v[48:63], v[180:183], a[8:11], v[48:63]
ds_read_b64_tr_b16 a[4:5], v8 offset:40960
ds_read_b64_tr_b16 a[6:7], v8 offset:41984
v_mfma_f32_32x32x16_bf16 v[64:79], v[180:183], a[12:15], v[64:79]
ds_read_b64_tr_b16 a[8:9], v7 offset:43008
ds_read_b64_tr_b16 a[10:11], v7 offset:44032
s_add_u32 s31, s31, s58
s_waitcnt lgkmcnt(6)
v_mfma_f32_32x32x16_bf16 v[48:63], v[184:187], a[16:19], v[48:63]
ds_read_b64_tr_b16 a[12:13], v8 offset:43008
ds_read_b64_tr_b16 a[14:15], v8 offset:44032
v_mfma_f32_32x32x16_bf16 v[64:79], v[184:187], a[20:23], v[64:79]
ds_read_b64_tr_b16 a[16:17], v7 offset:45056
ds_read_b64_tr_b16 a[18:19], v7 offset:46080
v_mfma_f32_32x32x16_bf16 v[48:63], v[188:191], a[24:27], v[48:63]
ds_read_b64_tr_b16 a[20:21], v8 offset:45056
ds_read_b64_tr_b16 a[22:23], v8 offset:46080
v_mfma_f32_32x32x16_bf16 v[64:79], v[188:191], a[28:31], v[64:79]
ds_read_b64_tr_b16 a[24:25], v7 offset:47104
ds_read_b64_tr_b16 a[26:27], v7 offset:48128
s_waitcnt lgkmcnt(6)
v_mfma_f32_32x32x16_bf16 v[48:63], v[192:195], a[0:3], v[48:63]
ds_read_b64_tr_b16 a[28:29], v8 offset:47104
ds_read_b64_tr_b16 a[30:31], v8 offset:48128
s_waitcnt vmcnt(18)
s_barrier
v_mfma_f32_32x32x16_bf16 v[64:79], v[192:195], a[4:7], v[64:79]
ds_read_b64_tr_b16 a[0:1], v12 offset:0
ds_read_b64_tr_b16 a[2:3], v12 offset:1024
s_add_u32 m0, s34, 0
v_mfma_f32_32x32x16_bf16 v[48:63], v[196:199], a[8:11], v[48:63]
ds_read_b64_tr_b16 a[4:5], v13 offset:0
ds_read_b64_tr_b16 a[6:7], v13 offset:1024
v_mfma_f32_32x32x16_bf16 v[64:79], v[196:199], a[12:15], v[64:79]
ds_read_b64_tr_b16 a[8:9], v12 offset:2048
ds_read_b64_tr_b16 a[10:11], v12 offset:3072
buffer_load_dwordx4 v4, s[8:11], s30 offen lds
s_waitcnt lgkmcnt(6)
v_mfma_f32_32x32x16_bf16 v[48:63], v[200:203], a[16:19], v[48:63]
ds_read_b64_tr_b16 a[12:13], v13 offset:2048
ds_read_b64_tr_b16 a[14:15], v13 offset:3072
v_mfma_f32_32x32x16_bf16 v[64:79], v[200:203], a[20:23], v[64:79]
ds_read_b64_tr_b16 a[16:17], v12 offset:4096
ds_read_b64_tr_b16 a[18:19], v12 offset:5120
buffer_load_dwordx4 v5, s[8:11], s30 offen offset:1024 lds
v_mfma_f32_32x32x16_bf16 v[48:63], v[204:207], a[24:27], v[48:63]
ds_read_b64_tr_b16 a[20:21], v13 offset:4096
ds_read_b64_tr_b16 a[22:23], v13 offset:5120
v_mfma_f32_32x32x16_bf16 v[64:79], v[204:207], a[28:31], v[64:79]
ds_read_b64_tr_b16 a[24:25], v12 offset:6144
ds_read_b64_tr_b16 a[26:27], v12 offset:7168
buffer_load_dwordx4 v6, s[8:11], s30 offen offset:2048 lds
s_waitcnt lgkmcnt(6)
v_mfma_f32_32x32x16_bf16 v[48:63], v[208:211], a[0:3], v[48:63]
ds_read_b64_tr_b16 a[28:29], v13 offset:6144
ds_read_b64_tr_b16 a[30:31], v13 offset:7168
v_mfma_f32_32x32x16_bf16 v[64:79], v[208:211], a[4:7], v[64:79]
ds_read_b64_tr_b16 a[0:1], v12 offset:8192
ds_read_b64_tr_b16 a[2:3], v12 offset:9216
s_add_u32 m0, s34, 3072
v_mfma_f32_32x32x16_bf16 v[48:63], v[212:215], a[8:11], v[48:63]
ds_read_b64_tr_b16 a[4:5], v13 offset:8192
ds_read_b64_tr_b16 a[6:7], v13 offset:9216
v_mfma_f32_32x32x16_bf16 v[64:79], v[212:215], a[12:15], v[64:79]
ds_read_b64_tr_b16 a[8:9], v12 offset:10240
ds_read_b64_tr_b16 a[10:11], v12 offset:11264
buffer_load_dwordx4 v4, s[8:11], s31 offen lds
s_waitcnt lgkmcnt(6)
v_mfma_f32_32x32x16_bf16 v[48:63], v[216:219], a[16:19], v[48:63]
ds_read_b64_tr_b16 a[12:13], v13 offset:10240
ds_read_b64_tr_b16 a[14:15], v13 offset:11264
v_mfma_f32_32x32x16_bf16 v[64:79], v[216:219], a[20:23], v[64:79]
ds_read_b64_tr_b16 a[16:17], v12 offset:12288
ds_read_b64_tr_b16 a[18:19], v12 offset:13312
buffer_load_dwordx4 v5, s[8:11], s31 offen offset:1024 lds
v_mfma_f32_32x32x16_bf16 v[48:63], v[220:223], a[24:27], v[48:63]
ds_read_b64_tr_b16 a[20:21], v13 offset:12288
ds_read_b64_tr_b16 a[22:23], v13 offset:13312
v_mfma_f32_32x32x16_bf16 v[64:79], v[220:223], a[28:31], v[64:79]
ds_read_b64_tr_b16 a[24:25], v12 offset:14336
ds_read_b64_tr_b16 a[26:27], v12 offset:15360
buffer_load_dwordx4 v6, s[8:11], s31 offen offset:2048 lds
s_waitcnt lgkmcnt(6)
v_mfma_f32_32x32x16_bf16 v[48:63], v[224:227], a[0:3], v[48:63]
ds_read_b64_tr_b16 a[28:29], v13 offset:14336
ds_read_b64_tr_b16 a[30:31], v13 offset:15360
v_mfma_f32_32x32x16_bf16 v[64:79], v[224:227], a[4:7], v[64:79]
ds_read_b64_tr_b16 a[0:1], v12 offset:16384
ds_read_b64_tr_b16 a[2:3], v12 offset:17408
s_add_u32 s30, s30, s56
v_mfma_f32_32x32x16_bf16 v[48:63], v[228:231], a[8:11], v[48:63]
ds_read_b64_tr_b16 a[4:5], v13 offset:16384
ds_read_b64_tr_b16 a[6:7], v13 offset:17408
v_mfma_f32_32x32x16_bf16 v[64:79], v[228:231], a[12:15], v[64:79]
ds_read_b64_tr_b16 a[8:9], v12 offset:18432
ds_read_b64_tr_b16 a[10:11], v12 offset:19456
s_add_u32 s31, s31, s56
s_waitcnt lgkmcnt(6)
v_mfma_f32_32x32x16_bf16 v[48:63], v[232:235], a[16:19], v[48:63]
ds_read_b64_tr_b16 a[12:13], v13 offset:18432
ds_read_b64_tr_b16 a[14:15], v13 offset:19456
v_mfma_f32_32x32x16_bf16 v[64:79], v[232:235], a[20:23], v[64:79]
ds_read_b64_tr_b16 a[16:17], v12 offset:20480
ds_read_b64_tr_b16 a[18:19], v12 offset:21504
v_mfma_f32_32x32x16_bf16 v[48:63], v[236:239], a[24:27], v[48:63]
ds_read_b64_tr_b16 a[20:21], v13 offset:20480
ds_read_b64_tr_b16 a[22:23], v13 offset:21504
v_mfma_f32_32x32x16_bf16 v[64:79], v[236:239], a[28:31], v[64:79]
ds_read_b64_tr_b16 a[24:25], v12 offset:22528
ds_read_b64_tr_b16 a[26:27], v12 offset:23552
s_waitcnt lgkmcnt(6)
v_mfma_f32_32x32x16_bf16 v[48:63], v[240:243], a[0:3], v[48:63]
ds_read_b64_tr_b16 a[28:29], v13 offset:22528
ds_read_b64_tr_b16 a[30:31], v13 offset:23552
s_waitcnt vmcnt(18)
s_barrier
v_mfma_f32_32x32x16_bf16 v[64:79], v[240:243], a[4:7], v[64:79]
ds_read_b64_tr_b16 a[0:1], v12 offset:24576
ds_read_b64_tr_b16 a[2:3], v12 offset:25600
s_add_u32 m0, s34, 24576
v_mfma_f32_32x32x16_bf16 v[48:63], v[244:247], a[8:11], v[48:63]
ds_read_b64_tr_b16 a[4:5], v13 offset:24576
ds_read_b64_tr_b16 a[6:7], v13 offset:25600
v_mfma_f32_32x32x16_bf16 v[64:79], v[244:247], a[12:15], v[64:79]
ds_read_b64_tr_b16 a[8:9], v12 offset:26624
ds_read_b64_tr_b16 a[10:11], v12 offset:27648
buffer_load_dwordx4 v4, s[8:11], s30 offen lds
s_waitcnt lgkmcnt(6)
v_mfma_f32_32x32x16_bf16 v[48:63], v[248:251], a[16:19], v[48:63]
ds_read_b64_tr_b16 a[12:13], v13 offset:26624
ds_read_b64_tr_b16 a[14:15], v13 offset:27648
v_mfma_f32_32x32x16_bf16 v[64:79], v[248:251], a[20:23], v[64:79]
ds_read_b64_tr_b16 a[16:17], v12 offset:28672
ds_read_b64_tr_b16 a[18:19], v12 offset:29696
buffer_load_dwordx4 v5, s[8:11], s30 offen offset:1024 lds
v_mfma_f32_32x32x16_bf16 v[48:63], v[252:255], a[24:27], v[48:63]
ds_read_b64_tr_b16 a[20:21], v13 offset:28672
ds_read_b64_tr_b16 a[22:23], v13 offset:29696
v_mfma_f32_32x32x16_bf16 v[64:79], v[252:255], a[28:31], v[64:79]
ds_read_b64_tr_b16 a[24:25], v12 offset:30720
ds_read_b64_tr_b16 a[26:27], v12 offset:31744
buffer_load_dwordx4 v6, s[8:11], s30 offen offset:2048 lds
s_waitcnt lgkmcnt(6)
v_mfma_f32_32x32x16_bf16 v[80:95], v[112:115], a[0:3], 0
ds_read_b64_tr_b16 a[28:29], v13 offset:30720
ds_read_b64_tr_b16 a[30:31], v13 offset:31744
v_mfma_f32_32x32x16_bf16 v[96:111], v[112:115], a[4:7], 0
ds_read_b64_tr_b16 a[0:1], v12 offset:32768
ds_read_b64_tr_b16 a[2:3], v12 offset:33792
s_add_u32 m0, s34, 27648
v_mfma_f32_32x32x16_bf16 v[80:95], v[116:119], a[8:11], v[80:95]
ds_read_b64_tr_b16 a[4:5], v13 offset:32768
ds_read_b64_tr_b16 a[6:7], v13 offset:33792
v_mfma_f32_32x32x16_bf16 v[96:111], v[116:119], a[12:15], v[96:111]
ds_read_b64_tr_b16 a[8:9], v12 offset:34816
ds_read_b64_tr_b16 a[10:11], v12 offset:35840
buffer_load_dwordx4 v4, s[8:11], s31 offen lds
s_waitcnt lgkmcnt(6)
v_mfma_f32_32x32x16_bf16 v[80:95], v[120:123], a[16:19], v[80:95]
ds_read_b64_tr_b16 a[12:13], v13 offset:34816
ds_read_b64_tr_b16 a[14:15], v13 offset:35840
v_cvt_pk_bf16_f32 v48, v48, v49
v_mfma_f32_32x32x16_bf16 v[96:111], v[120:123], a[20:23], v[96:111]
ds_read_b64_tr_b16 a[16:17], v12 offset:36864
ds_read_b64_tr_b16 a[18:19], v12 offset:37888
buffer_load_dwordx4 v5, s[8:11], s31 offen offset:1024 lds
v_mfma_f32_32x32x16_bf16 v[80:95], v[124:127], a[24:27], v[80:95]
ds_read_b64_tr_b16 a[20:21], v13 offset:36864
ds_read_b64_tr_b16 a[22:23], v13 offset:37888
v_cvt_pk_bf16_f32 v49, v50, v51
v_mfma_f32_32x32x16_bf16 v[96:111], v[124:127], a[28:31], v[96:111]
ds_read_b64_tr_b16 a[24:25], v12 offset:38912
ds_read_b64_tr_b16 a[26:27], v12 offset:39936
buffer_load_dwordx4 v6, s[8:11], s31 offen offset:2048 lds
s_waitcnt lgkmcnt(6)
v_mfma_f32_32x32x16_bf16 v[80:95], v[128:131], a[0:3], v[80:95]
ds_read_b64_tr_b16 a[28:29], v13 offset:38912
ds_read_b64_tr_b16 a[30:31], v13 offset:39936
v_cvt_pk_bf16_f32 v50, v52, v53
v_mfma_f32_32x32x16_bf16 v[96:111], v[128:131], a[4:7], v[96:111]
ds_read_b64_tr_b16 a[0:1], v12 offset:40960
ds_read_b64_tr_b16 a[2:3], v12 offset:41984
s_add_u32 s30, s30, s57
v_mfma_f32_32x32x16_bf16 v[80:95], v[132:135], a[8:11], v[80:95]
ds_read_b64_tr_b16 a[4:5], v13 offset:40960
ds_read_b64_tr_b16 a[6:7], v13 offset:41984
v_cvt_pk_bf16_f32 v51, v54, v55
v_mfma_f32_32x32x16_bf16 v[96:111], v[132:135], a[12:15], v[96:111]
ds_read_b64_tr_b16 a[8:9], v12 offset:43008
ds_read_b64_tr_b16 a[10:11], v12 offset:44032
s_add_u32 s31, s31, s57
s_waitcnt lgkmcnt(6)
v_mfma_f32_32x32x16_bf16 v[80:95], v[136:139], a[16:19], v[80:95]
ds_read_b64_tr_b16 a[12:13], v13 offset:43008
ds_read_b64_tr_b16 a[14:15], v13 offset:44032
v_cvt_pk_bf16_f32 v52, v56, v57
v_mfma_f32_32x32x16_bf16 v[96:111], v[136:139], a[20:23], v[96:111]
ds_read_b64_tr_b16 a[16:17], v12 offset:45056
ds_read_b64_tr_b16 a[18:19], v12 offset:46080
v_cvt_pk_bf16_f32 v53, v58, v59
v_mfma_f32_32x32x16_bf16 v[80:95], v[140:143], a[24:27], v[80:95]
ds_read_b64_tr_b16 a[20:21], v13 offset:45056
ds_read_b64_tr_b16 a[22:23], v13 offset:46080
v_cvt_pk_bf16_f32 v54, v60, v61
v_mfma_f32_32x32x16_bf16 v[96:111], v[140:143], a[28:31], v[96:111]
ds_read_b64_tr_b16 a[24:25], v12 offset:47104
ds_read_b64_tr_b16 a[26:27], v12 offset:48128
s_waitcnt lgkmcnt(6)
v_mfma_f32_32x32x16_bf16 v[80:95], v[144:147], a[0:3], v[80:95]
ds_read_b64_tr_b16 a[28:29], v13 offset:47104
ds_read_b64_tr_b16 a[30:31], v13 offset:48128
s_waitcnt vmcnt(18)
s_barrier
v_mfma_f32_32x32x16_bf16 v[96:111], v[144:147], a[4:7], v[96:111]
ds_read_b64_tr_b16 a[0:1], v14 offset:0
ds_read_b64_tr_b16 a[2:3], v14 offset:1024
s_add_u32 m0, s34, 49152
v_mfma_f32_32x32x16_bf16 v[80:95], v[148:151], a[8:11], v[80:95]
ds_read_b64_tr_b16 a[4:5], v15 offset:0
ds_read_b64_tr_b16 a[6:7], v15 offset:1024
v_cvt_pk_bf16_f32 v55, v62, v63
v_mfma_f32_32x32x16_bf16 v[96:111], v[148:151], a[12:15], v[96:111]
ds_read_b64_tr_b16 a[8:9], v14 offset:2048
ds_read_b64_tr_b16 a[10:11], v14 offset:3072
buffer_load_dwordx4 v4, s[8:11], s30 offen lds
s_waitcnt lgkmcnt(6)
v_mfma_f32_32x32x16_bf16 v[80:95], v[152:155], a[16:19], v[80:95]
ds_read_b64_tr_b16 a[12:13], v15 offset:2048
ds_read_b64_tr_b16 a[14:15], v15 offset:3072
v_mfma_f32_32x32x16_bf16 v[96:111], v[152:155], a[20:23], v[96:111]
ds_read_b64_tr_b16 a[16:17], v14 offset:4096
ds_read_b64_tr_b16 a[18:19], v14 offset:5120
buffer_load_dwordx4 v5, s[8:11], s30 offen offset:1024 lds
v_mfma_f32_32x32x16_bf16 v[80:95], v[156:159], a[24:27], v[80:95]
ds_read_b64_tr_b16 a[20:21], v15 offset:4096
ds_read_b64_tr_b16 a[22:23], v15 offset:5120
v_mfma_f32_32x32x16_bf16 v[96:111], v[156:159], a[28:31], v[96:111]
ds_read_b64_tr_b16 a[24:25], v14 offset:6144
ds_read_b64_tr_b16 a[26:27], v14 offset:7168
buffer_load_dwordx4 v6, s[8:11], s30 offen offset:2048 lds
s_waitcnt lgkmcnt(6)
v_mfma_f32_32x32x16_bf16 v[80:95], v[160:163], a[0:3], v[80:95]
ds_read_b64_tr_b16 a[28:29], v15 offset:6144
ds_read_b64_tr_b16 a[30:31], v15 offset:7168
v_mfma_f32_32x32x16_bf16 v[96:111], v[160:163], a[4:7], v[96:111]
ds_read_b64_tr_b16 a[0:1], v14 offset:8192
ds_read_b64_tr_b16 a[2:3], v14 offset:9216
s_add_u32 m0, s34, 52224
v_mfma_f32_32x32x16_bf16 v[80:95], v[164:167], a[8:11], v[80:95]
ds_read_b64_tr_b16 a[4:5], v15 offset:8192
ds_read_b64_tr_b16 a[6:7], v15 offset:9216
v_mfma_f32_32x32x16_bf16 v[96:111], v[164:167], a[12:15], v[96:111]
ds_read_b64_tr_b16 a[8:9], v14 offset:10240
ds_read_b64_tr_b16 a[10:11], v14 offset:11264
buffer_load_dwordx4 v4, s[8:11], s31 offen lds
s_waitcnt lgkmcnt(6)
v_mfma_f32_32x32x16_bf16 v[80:95], v[168:171], a[16:19], v[80:95]
ds_read_b64_tr_b16 a[12:13], v15 offset:10240
ds_read_b64_tr_b16 a[14:15], v15 offset:11264
v_mfma_f32_32x32x16_bf16 v[96:111], v[168:171], a[20:23], v[96:111]
ds_read_b64_tr_b16 a[16:17], v14 offset:12288
ds_read_b64_tr_b16 a[18:19], v14 offset:13312
buffer_load_dwordx4 v5, s[8:11], s31 offen offset:1024 lds
v_mfma_f32_32x32x16_bf16 v[80:95], v[172:175], a[24:27], v[80:95]
ds_read_b64_tr_b16 a[20:21], v15 offset:12288
ds_read_b64_tr_b16 a[22:23], v15 offset:13312
v_mfma_f32_32x32x16_bf16 v[96:111], v[172:175], a[28:31], v[96:111]
ds_read_b64_tr_b16 a[24:25], v14 offset:14336
ds_read_b64_tr_b16 a[26:27], v14 offset:15360
buffer_load_dwordx4 v6, s[8:11], s31 offen offset:2048 lds
s_waitcnt lgkmcnt(6)
v_mfma_f32_32x32x16_bf16 v[80:95], v[176:179], a[0:3], v[80:95]
ds_read_b64_tr_b16 a[28:29], v15 offset:14336
ds_read_b64_tr_b16 a[30:31], v15 offset:15360
v_mfma_f32_32x32x16_bf16 v[96:111], v[176:179], a[4:7], v[96:111]
ds_read_b64_tr_b16 a[0:1], v14 offset:16384
ds_read_b64_tr_b16 a[2:3], v14 offset:17408
s_add_u32 s30, s30, s58
v_mfma_f32_32x32x16_bf16 v[80:95], v[180:183], a[8:11], v[80:95]
ds_read_b64_tr_b16 a[4:5], v15 offset:16384
ds_read_b64_tr_b16 a[6:7], v15 offset:17408
v_mfma_f32_32x32x16_bf16 v[96:111], v[180:183], a[12:15], v[96:111]
ds_read_b64_tr_b16 a[8:9], v14 offset:18432
ds_read_b64_tr_b16 a[10:11], v14 offset:19456
s_add_u32 s31, s31, s58
s_waitcnt lgkmcnt(6)
v_mfma_f32_32x32x16_bf16 v[80:95], v[184:187], a[16:19], v[80:95]
ds_read_b64_tr_b16 a[12:13], v15 offset:18432
ds_read_b64_tr_b16 a[14:15], v15 offset:19456
v_mfma_f32_32x32x16_bf16 v[96:111], v[184:187], a[20:23], v[96:111]
ds_read_b64_tr_b16 a[16:17], v14 offset:20480
ds_read_b64_tr_b16 a[18:19], v14 offset:21504
v_mfma_f32_32x32x16_bf16 v[80:95], v[188:191], a[24:27], v[80:95]
ds_read_b64_tr_b16 a[20:21], v15 offset:20480
ds_read_b64_tr_b16 a[22:23], v15 offset:21504
v_mfma_f32_32x32x16_bf16 v[96:111], v[188:191], a[28:31], v[96:111]
ds_read_b64_tr_b16 a[24:25], v14 offset:22528
ds_read_b64_tr_b16 a[26:27], v14 offset:23552
s_waitcnt lgkmcnt(6)
v_mfma_f32_32x32x16_bf16 v[80:95], v[192:195], a[0:3], v[80:95]
ds_read_b64_tr_b16 a[28:29], v15 offset:22528
ds_read_b64_tr_b16 a[30:31], v15 offset:23552
s_waitcnt vmcnt(18)
s_barrier
v_mfma_f32_32x32x16_bf16 v[96:111], v[192:195], a[4:7], v[96:111]
ds_read_b64_tr_b16 a[0:1], v14 offset:24576
ds_read_b64_tr_b16 a[2:3], v14 offset:25600
v_mfma_f32_32x32x16_bf16 v[80:95], v[196:199], a[8:11], v[80:95]
ds_read_b64_tr_b16 a[4:5], v15 offset:24576
ds_read_b64_tr_b16 a[6:7], v15 offset:25600
v_mfma_f32_32x32x16_bf16 v[96:111], v[196:199], a[12:15], v[96:111]
ds_read_b64_tr_b16 a[8:9], v14 offset:26624
ds_read_b64_tr_b16 a[10:11], v14 offset:27648
s_waitcnt lgkmcnt(6)
v_mfma_f32_32x32x16_bf16 v[80:95], v[200:203], a[16:19], v[80:95]
ds_read_b64_tr_b16 a[12:13], v15 offset:26624
ds_read_b64_tr_b16 a[14:15], v15 offset:27648
v_mfma_f32_32x32x16_bf16 v[96:111], v[200:203], a[20:23], v[96:111]
ds_read_b64_tr_b16 a[16:17], v14 offset:28672
ds_read_b64_tr_b16 a[18:19], v14 offset:29696
v_mfma_f32_32x32x16_bf16 v[80:95], v[204:207], a[24:27], v[80:95]
ds_read_b64_tr_b16 a[20:21], v15 offset:28672
ds_read_b64_tr_b16 a[22:23], v15 offset:29696
v_mfma_f32_32x32x16_bf16 v[96:111], v[204:207], a[28:31], v[96:111]
ds_read_b64_tr_b16 a[24:25], v14 offset:30720
ds_read_b64_tr_b16 a[26:27], v14 offset:31744
s_waitcnt lgkmcnt(6)
v_mfma_f32_32x32x16_bf16 v[80:95], v[208:211], a[0:3], v[80:95]
ds_read_b64_tr_b16 a[28:29], v15 offset:30720
ds_read_b64_tr_b16 a[30:31], v15 offset:31744
v_mfma_f32_32x32x16_bf16 v[96:111], v[208:211], a[4:7], v[96:111]
ds_read_b64_tr_b16 a[0:1], v14 offset:32768
ds_read_b64_tr_b16 a[2:3], v14 offset:33792
v_mfma_f32_32x32x16_bf16 v[80:95], v[212:215], a[8:11], v[80:95]
ds_read_b64_tr_b16 a[4:5], v15 offset:32768
ds_read_b64_tr_b16 a[6:7], v15 offset:33792
v_mfma_f32_32x32x16_bf16 v[96:111], v[212:215], a[12:15], v[96:111]
ds_read_b64_tr_b16 a[8:9], v14 offset:34816
ds_read_b64_tr_b16 a[10:11], v14 offset:35840
s_waitcnt lgkmcnt(6)
v_mfma_f32_32x32x16_bf16 v[80:95], v[216:219], a[16:19], v[80:95]
ds_read_b64_tr_b16 a[12:13], v15 offset:34816
ds_read_b64_tr_b16 a[14:15], v15 offset:35840
v_mfma_f32_32x32x16_bf16 v[96:111], v[216:219], a[20:23], v[96:111]
ds_read_b64_tr_b16 a[16:17], v14 offset:36864
ds_read_b64_tr_b16 a[18:19], v14 offset:37888
v_mfma_f32_32x32x16_bf16 v[80:95], v[220:223], a[24:27], v[80:95]
ds_read_b64_tr_b16 a[20:21], v15 offset:36864
ds_read_b64_tr_b16 a[22:23], v15 offset:37888
v_mfma_f32_32x32x16_bf16 v[96:111], v[220:223], a[28:31], v[96:111]
ds_read_b64_tr_b16 a[24:25], v14 offset:38912
ds_read_b64_tr_b16 a[26:27], v14 offset:39936
s_waitcnt lgkmcnt(6)
v_mfma_f32_32x32x16_bf16 v[80:95], v[224:227], a[0:3], v[80:95]
ds_read_b64_tr_b16 a[28:29], v15 offset:38912
ds_read_b64_tr_b16 a[30:31], v15 offset:39936
v_mfma_f32_32x32x16_bf16 v[96:111], v[224:227], a[4:7], v[96:111]
ds_read_b64_tr_b16 a[0:1], v14 offset:40960
ds_read_b64_tr_b16 a[2:3], v14 offset:41984
v_mfma_f32_32x32x16_bf16 v[80:95], v[228:231], a[8:11], v[80:95]
ds_read_b64_tr_b16 a[4:5], v15 offset:40960
ds_read_b64_tr_b16 a[6:7], v15 offset:41984
v_mfma_f32_32x32x16_bf16 v[96:111], v[228:231], a[12:15], v[96:111]
ds_read_b64_tr_b16 a[8:9], v14 offset:43008
ds_read_b64_tr_b16 a[10:11], v14 offset:44032
s_waitcnt lgkmcnt(6)
v_mfma_f32_32x32x16_bf16 v[80:95], v[232:235], a[16:19], v[80:95]
ds_read_b64_tr_b16 a[12:13], v15 offset:43008
ds_read_b64_tr_b16 a[14:15], v15 offset:44032
v_mfma_f32_32x32x16_bf16 v[96:111], v[232:235], a[20:23], v[96:111]
ds_read_b64_tr_b16 a[16:17], v14 offset:45056
ds_read_b64_tr_b16 a[18:19], v14 offset:46080
v_mfma_f32_32x32x16_bf16 v[80:95], v[236:239], a[24:27], v[80:95]
ds_read_b64_tr_b16 a[20:21], v15 offset:45056
ds_read_b64_tr_b16 a[22:23], v15 offset:46080
v_mfma_f32_32x32x16_bf16 v[96:111], v[236:239], a[28:31], v[96:111]
ds_read_b64_tr_b16 a[24:25], v14 offset:47104
ds_read_b64_tr_b16 a[26:27], v14 offset:48128
s_waitcnt lgkmcnt(6)
v_mfma_f32_32x32x16_bf16 v[80:95], v[240:243], a[0:3], v[80:95]
ds_read_b64_tr_b16 a[28:29], v15 offset:47104
ds_read_b64_tr_b16 a[30:31], v15 offset:48128
s_waitcnt vmcnt(12)
s_barrier
v_mfma_f32_32x32x16_bf16 v[96:111], v[240:243], a[4:7], v[96:111]
ds_read_b64_tr_b16 a[0:1], v7 offset:0
ds_read_b64_tr_b16 a[2:3], v7 offset:1024
v_mfma_f32_32x32x16_bf16 v[80:95], v[244:247], a[8:11], v[80:95]
ds_read_b64_tr_b16 a[4:5], v8 offset:0
ds_read_b64_tr_b16 a[6:7], v8 offset:1024
v_mfma_f32_32x32x16_bf16 v[96:111], v[244:247], a[12:15], v[96:111]
ds_read_b64_tr_b16 a[8:9], v7 offset:2048
ds_read_b64_tr_b16 a[10:11], v7 offset:3072
s_waitcnt lgkmcnt(6)
v_mfma_f32_32x32x16_bf16 v[80:95], v[248:251], a[16:19], v[80:95]
ds_read_b64_tr_b16 a[12:13], v8 offset:2048
ds_read_b64_tr_b16 a[14:15], v8 offset:3072
v_mfma_f32_32x32x16_bf16 v[96:111], v[248:251], a[20:23], v[96:111]
ds_read_b64_tr_b16 a[16:17], v7 offset:4096
ds_read_b64_tr_b16 a[18:19], v7 offset:5120
v_mfma_f32_32x32x16_bf16 v[80:95], v[252:255], a[24:27], v[80:95]
ds_read_b64_tr_b16 a[20:21], v8 offset:4096
ds_read_b64_tr_b16 a[22:23], v8 offset:5120
buffer_store_dwordx4 v[48:51], v11, s[16:19], s41 offen sc1
buffer_store_dwordx4 v[52:55], v11, s[16:19], s41 offen offset:512 sc1
s_add_u32 s41, s41, 131072
v_cvt_pk_bf16_f32 v64, v64, v65
v_cvt_pk_bf16_f32 v65, v66, v67
v_cvt_pk_bf16_f32 v66, v68, v69
v_cvt_pk_bf16_f32 v67, v70, v71
v_cvt_pk_bf16_f32 v68, v72, v73
v_cvt_pk_bf16_f32 v69, v74, v75
v_cvt_pk_bf16_f32 v70, v76, v77
v_cvt_pk_bf16_f32 v71, v78, v79
buffer_store_dwordx4 v[64:67], v11, s[16:19], s41 offen sc1
buffer_store_dwordx4 v[68:71], v11, s[16:19], s41 offen offset:512 sc1
s_add_u32 s41, s41, 131072
v_mfma_f32_32x32x16_bf16 v[96:111], v[252:255], a[28:31], v[96:111]
ds_read_b64_tr_b16 a[24:25], v7 offset:6144
ds_read_b64_tr_b16 a[26:27], v7 offset:7168
s_waitcnt lgkmcnt(6)
v_mfma_f32_32x32x16_bf16 v[48:63], v[112:115], a[0:3], 0
ds_read_b64_tr_b16 a[28:29], v8 offset:6144
ds_read_b64_tr_b16 a[30:31], v8 offset:7168
v_mfma_f32_32x32x16_bf16 v[64:79], v[112:115], a[4:7], 0
ds_read_b64_tr_b16 a[0:1], v7 offset:8192
ds_read_b64_tr_b16 a[2:3], v7 offset:9216
v_mfma_f32_32x32x16_bf16 v[48:63], v[116:119], a[8:11], v[48:63]
ds_read_b64_tr_b16 a[4:5], v8 offset:8192
ds_read_b64_tr_b16 a[6:7], v8 offset:9216
v_mfma_f32_32x32x16_bf16 v[64:79], v[116:119], a[12:15], v[64:79]
ds_read_b64_tr_b16 a[8:9], v7 offset:10240
ds_read_b64_tr_b16 a[10:11], v7 offset:11264
s_waitcnt lgkmcnt(6)
v_mfma_f32_32x32x16_bf16 v[48:63], v[120:123], a[16:19], v[48:63]
ds_read_b64_tr_b16 a[12:13], v8 offset:10240
ds_read_b64_tr_b16 a[14:15], v8 offset:11264
v_cvt_pk_bf16_f32 v80, v80, v81
v_mfma_f32_32x32x16_bf16 v[64:79], v[120:123], a[20:23], v[64:79]
ds_read_b64_tr_b16 a[16:17], v7 offset:12288
ds_read_b64_tr_b16 a[18:19], v7 offset:13312
v_cvt_pk_bf16_f32 v81, v82, v83
v_mfma_f32_32x32x16_bf16 v[48:63], v[124:127], a[24:27], v[48:63]
ds_read_b64_tr_b16 a[20:21], v8 offset:12288
ds_read_b64_tr_b16 a[22:23], v8 offset:13312
v_cvt_pk_bf16_f32 v82, v84, v85
v_mfma_f32_32x32x16_bf16 v[64:79], v[124:127], a[28:31], v[64:79]
ds_read_b64_tr_b16 a[24:25], v7 offset:14336
ds_read_b64_tr_b16 a[26:27], v7 offset:15360
s_waitcnt lgkmcnt(6)
v_mfma_f32_32x32x16_bf16 v[48:63], v[128:131], a[0:3], v[48:63]
ds_read_b64_tr_b16 a[28:29], v8 offset:14336
ds_read_b64_tr_b16 a[30:31], v8 offset:15360
v_cvt_pk_bf16_f32 v83, v86, v87
v_mfma_f32_32x32x16_bf16 v[64:79], v[128:131], a[4:7], v[64:79]
ds_read_b64_tr_b16 a[0:1], v7 offset:16384
ds_read_b64_tr_b16 a[2:3], v7 offset:17408
v_cvt_pk_bf16_f32 v84, v88, v89
v_mfma_f32_32x32x16_bf16 v[48:63], v[132:135], a[8:11], v[48:63]
ds_read_b64_tr_b16 a[4:5], v8 offset:16384
ds_read_b64_tr_b16 a[6:7], v8 offset:17408
v_cvt_pk_bf16_f32 v85, v90, v91
v_mfma_f32_32x32x16_bf16 v[64:79], v[132:135], a[12:15], v[64:79]
ds_read_b64_tr_b16 a[8:9], v7 offset:18432
ds_read_b64_tr_b16 a[10:11], v7 offset:19456
s_waitcnt lgkmcnt(6)
v_mfma_f32_32x32x16_bf16 v[48:63], v[136:139], a[16:19], v[48:63]
ds_read_b64_tr_b16 a[12:13], v8 offset:18432
ds_read_b64_tr_b16 a[14:15], v8 offset:19456
v_cvt_pk_bf16_f32 v86, v92, v93
v_mfma_f32_32x32x16_bf16 v[64:79], v[136:139], a[20:23], v[64:79]
ds_read_b64_tr_b16 a[16:17], v7 offset:20480
ds_read_b64_tr_b16 a[18:19], v7 offset:21504
v_cvt_pk_bf16_f32 v87, v94, v95
v_mfma_f32_32x32x16_bf16 v[48:63], v[140:143], a[24:27], v[48:63]
ds_read_b64_tr_b16 a[20:21], v8 offset:20480
ds_read_b64_tr_b16 a[22:23], v8 offset:21504
v_mfma_f32_32x32x16_bf16 v[64:79], v[140:143], a[28:31], v[64:79]
ds_read_b64_tr_b16 a[24:25], v7 offset:22528
ds_read_b64_tr_b16 a[26:27], v7 offset:23552
s_waitcnt lgkmcnt(6)
v_mfma_f32_32x32x16_bf16 v[48:63], v[144:147], a[0:3], v[48:63]
ds_read_b64_tr_b16 a[28:29], v8 offset:22528
ds_read_b64_tr_b16 a[30:31], v8 offset:23552
s_waitcnt vmcnt(10)
s_barrier
v_mfma_f32_32x32x16_bf16 v[64:79], v[144:147], a[4:7], v[64:79]
ds_read_b64_tr_b16 a[0:1], v7 offset:24576
ds_read_b64_tr_b16 a[2:3], v7 offset:25600
v_mfma_f32_32x32x16_bf16 v[48:63], v[148:151], a[8:11], v[48:63]
ds_read_b64_tr_b16 a[4:5], v8 offset:24576
ds_read_b64_tr_b16 a[6:7], v8 offset:25600
v_mfma_f32_32x32x16_bf16 v[64:79], v[148:151], a[12:15], v[64:79]
ds_read_b64_tr_b16 a[8:9], v7 offset:26624
ds_read_b64_tr_b16 a[10:11], v7 offset:27648
s_waitcnt lgkmcnt(6)
v_mfma_f32_32x32x16_bf16 v[48:63], v[152:155], a[16:19], v[48:63]
ds_read_b64_tr_b16 a[12:13], v8 offset:26624
ds_read_b64_tr_b16 a[14:15], v8 offset:27648
v_mfma_f32_32x32x16_bf16 v[64:79], v[152:155], a[20:23], v[64:79]
ds_read_b64_tr_b16 a[16:17], v7 offset:28672
ds_read_b64_tr_b16 a[18:19], v7 offset:29696
v_mfma_f32_32x32x16_bf16 v[48:63], v[156:159], a[24:27], v[48:63]
ds_read_b64_tr_b16 a[20:21], v8 offset:28672
ds_read_b64_tr_b16 a[22:23], v8 offset:29696
v_mfma_f32_32x32x16_bf16 v[64:79], v[156:159], a[28:31], v[64:79]
ds_read_b64_tr_b16 a[24:25], v7 offset:30720
ds_read_b64_tr_b16 a[26:27], v7 offset:31744
s_waitcnt lgkmcnt(6)
v_mfma_f32_32x32x16_bf16 v[48:63], v[160:163], a[0:3], v[48:63]
ds_read_b64_tr_b16 a[28:29], v8 offset:30720
ds_read_b64_tr_b16 a[30:31], v8 offset:31744
v_mfma_f32_32x32x16_bf16 v[64:79], v[160:163], a[4:7], v[64:79]
ds_read_b64_tr_b16 a[0:1], v7 offset:32768
ds_read_b64_tr_b16 a[2:3], v7 offset:33792
v_mfma_f32_32x32x16_bf16 v[48:63], v[164:167], a[8:11], v[48:63]
ds_read_b64_tr_b16 a[4:5], v8 offset:32768
ds_read_b64_tr_b16 a[6:7], v8 offset:33792
v_mfma_f32_32x32x16_bf16 v[64:79], v[164:167], a[12:15], v[64:79]
ds_read_b64_tr_b16 a[8:9], v7 offset:34816
ds_read_b64_tr_b16 a[10:11], v7 offset:35840
s_waitcnt lgkmcnt(6)
v_mfma_f32_32x32x16_bf16 v[48:63], v[168:171], a[16:19], v[48:63]
ds_read_b64_tr_b16 a[12:13], v8 offset:34816
ds_read_b64_tr_b16 a[14:15], v8 offset:35840
v_mfma_f32_32x32x16_bf16 v[64:79], v[168:171], a[20:23], v[64:79]
ds_read_b64_tr_b16 a[16:17], v7 offset:36864
ds_read_b64_tr_b16 a[18:19], v7 offset:37888
v_mfma_f32_32x32x16_bf16 v[48:63], v[172:175], a[24:27], v[48:63]
ds_read_b64_tr_b16 a[20:21], v8 offset:36864
ds_read_b64_tr_b16 a[22:23], v8 offset:37888
v_mfma_f32_32x32x16_bf16 v[64:79], v[172:175], a[28:31], v[64:79]
ds_read_b64_tr_b16 a[24:25], v7 offset:38912
ds_read_b64_tr_b16 a[26:27], v7 offset:39936
s_waitcnt lgkmcnt(6)
v_mfma_f32_32x32x16_bf16 v[48:63], v[176:179], a[0:3], v[48:63]
ds_read_b64_tr_b16 a[28:29], v8 offset:38912
ds_read_b64_tr_b16 a[30:31], v8 offset:39936
v_mfma_f32_32x32x16_bf16 v[64:79], v[176:179], a[4:7], v[64:79]
ds_read_b64_tr_b16 a[0:1], v7 offset:40960
ds_read_b64_tr_b16 a[2:3], v7 offset:41984
v_mfma_f32_32x32x16_bf16 v[48:63], v[180:183], a[8:11], v[48:63]
ds_read_b64_tr_b16 a[4:5], v8 offset:40960
ds_read_b64_tr_b16 a[6:7], v8 offset:41984
v_mfma_f32_32x32x16_bf16 v[64:79], v[180:183], a[12:15], v[64:79]
ds_read_b64_tr_b16 a[8:9], v7 offset:43008
ds_read_b64_tr_b16 a[10:11], v7 offset:44032
s_waitcnt lgkmcnt(6)
v_mfma_f32_32x32x16_bf16 v[48:63], v[184:187], a[16:19], v[48:63]
ds_read_b64_tr_b16 a[12:13], v8 offset:43008
ds_read_b64_tr_b16 a[14:15], v8 offset:44032
v_mfma_f32_32x32x16_bf16 v[64:79], v[184:187], a[20:23], v[64:79]
ds_read_b64_tr_b16 a[16:17], v7 offset:45056
ds_read_b64_tr_b16 a[18:19], v7 offset:46080
v_mfma_f32_32x32x16_bf16 v[48:63], v[188:191], a[24:27], v[48:63]
ds_read_b64_tr_b16 a[20:21], v8 offset:45056
ds_read_b64_tr_b16 a[22:23], v8 offset:46080
v_mfma_f32_32x32x16_bf16 v[64:79], v[188:191], a[28:31], v[64:79]
ds_read_b64_tr_b16 a[24:25], v7 offset:47104
ds_read_b64_tr_b16 a[26:27], v7 offset:48128
s_waitcnt lgkmcnt(6)
v_mfma_f32_32x32x16_bf16 v[48:63], v[192:195], a[0:3], v[48:63]
ds_read_b64_tr_b16 a[28:29], v8 offset:47104
ds_read_b64_tr_b16 a[30:31], v8 offset:48128
s_waitcnt vmcnt(4)
s_barrier
v_mfma_f32_32x32x16_bf16 v[64:79], v[192:195], a[4:7], v[64:79]
ds_read_b64_tr_b16 a[0:1], v12 offset:0
ds_read_b64_tr_b16 a[2:3], v12 offset:1024
v_mfma_f32_32x32x16_bf16 v[48:63], v[196:199], a[8:11], v[48:63]
ds_read_b64_tr_b16 a[4:5], v13 offset:0
ds_read_b64_tr_b16 a[6:7], v13 offset:1024
v_mfma_f32_32x32x16_bf16 v[64:79], v[196:199], a[12:15], v[64:79]
ds_read_b64_tr_b16 a[8:9], v12 offset:2048
ds_read_b64_tr_b16 a[10:11], v12 offset:3072
s_waitcnt lgkmcnt(6)
v_mfma_f32_32x32x16_bf16 v[48:63], v[200:203], a[16:19], v[48:63]
ds_read_b64_tr_b16 a[12:13], v13 offset:2048
ds_read_b64_tr_b16 a[14:15], v13 offset:3072
v_mfma_f32_32x32x16_bf16 v[64:79], v[200:203], a[20:23], v[64:79]
ds_read_b64_tr_b16 a[16:17], v12 offset:4096
ds_read_b64_tr_b16 a[18:19], v12 offset:5120
v_mfma_f32_32x32x16_bf16 v[48:63], v[204:207], a[24:27], v[48:63]
ds_read_b64_tr_b16 a[20:21], v13 offset:4096
ds_read_b64_tr_b16 a[22:23], v13 offset:5120
v_mfma_f32_32x32x16_bf16 v[64:79], v[204:207], a[28:31], v[64:79]
ds_read_b64_tr_b16 a[24:25], v12 offset:6144
ds_read_b64_tr_b16 a[26:27], v12 offset:7168
s_waitcnt lgkmcnt(6)
v_mfma_f32_32x32x16_bf16 v[48:63], v[208:211], a[0:3], v[48:63]
ds_read_b64_tr_b16 a[28:29], v13 offset:6144
ds_read_b64_tr_b16 a[30:31], v13 offset:7168
v_mfma_f32_32x32x16_bf16 v[64:79], v[208:211], a[4:7], v[64:79]
ds_read_b64_tr_b16 a[0:1], v12 offset:8192
ds_read_b64_tr_b16 a[2:3], v12 offset:9216
v_mfma_f32_32x32x16_bf16 v[48:63], v[212:215], a[8:11], v[48:63]
ds_read_b64_tr_b16 a[4:5], v13 offset:8192
ds_read_b64_tr_b16 a[6:7], v13 offset:9216
v_mfma_f32_32x32x16_bf16 v[64:79], v[212:215], a[12:15], v[64:79]
ds_read_b64_tr_b16 a[8:9], v12 offset:10240
ds_read_b64_tr_b16 a[10:11], v12 offset:11264
s_waitcnt lgkmcnt(6)
v_mfma_f32_32x32x16_bf16 v[48:63], v[216:219], a[16:19], v[48:63]
ds_read_b64_tr_b16 a[12:13], v13 offset:10240
ds_read_b64_tr_b16 a[14:15], v13 offset:11264
v_mfma_f32_32x32x16_bf16 v[64:79], v[216:219], a[20:23], v[64:79]
ds_read_b64_tr_b16 a[16:17], v12 offset:12288
ds_read_b64_tr_b16 a[18:19], v12 offset:13312
v_mfma_f32_32x32x16_bf16 v[48:63], v[220:223], a[24:27], v[48:63]
ds_read_b64_tr_b16 a[20:21], v13 offset:12288
ds_read_b64_tr_b16 a[22:23], v13 offset:13312
v_mfma_f32_32x32x16_bf16 v[64:79], v[220:223], a[28:31], v[64:79]
ds_read_b64_tr_b16 a[24:25], v12 offset:14336
ds_read_b64_tr_b16 a[26:27], v12 offset:15360
s_waitcnt lgkmcnt(6)
v_mfma_f32_32x32x16_bf16 v[48:63], v[224:227], a[0:3], v[48:63]
ds_read_b64_tr_b16 a[28:29], v13 offset:14336
ds_read_b64_tr_b16 a[30:31], v13 offset:15360
v_mfma_f32_32x32x16_bf16 v[64:79], v[224:227], a[4:7], v[64:79]
ds_read_b64_tr_b16 a[0:1], v12 offset:16384
ds_read_b64_tr_b16 a[2:3], v12 offset:17408
v_mfma_f32_32x32x16_bf16 v[48:63], v[228:231], a[8:11], v[48:63]
ds_read_b64_tr_b16 a[4:5], v13 offset:16384
ds_read_b64_tr_b16 a[6:7], v13 offset:17408
v_mfma_f32_32x32x16_bf16 v[64:79], v[228:231], a[12:15], v[64:79]
ds_read_b64_tr_b16 a[8:9], v12 offset:18432
ds_read_b64_tr_b16 a[10:11], v12 offset:19456
s_waitcnt lgkmcnt(6)
v_mfma_f32_32x32x16_bf16 v[48:63], v[232:235], a[16:19], v[48:63]
ds_read_b64_tr_b16 a[12:13], v13 offset:18432
ds_read_b64_tr_b16 a[14:15], v13 offset:19456
v_mfma_f32_32x32x16_bf16 v[64:79], v[232:235], a[20:23], v[64:79]
ds_read_b64_tr_b16 a[16:17], v12 offset:20480
ds_read_b64_tr_b16 a[18:19], v12 offset:21504
v_mfma_f32_32x32x16_bf16 v[48:63], v[236:239], a[24:27], v[48:63]
ds_read_b64_tr_b16 a[20:21], v13 offset:20480
ds_read_b64_tr_b16 a[22:23], v13 offset:21504
v_mfma_f32_32x32x16_bf16 v[64:79], v[236:239], a[28:31], v[64:79]
ds_read_b64_tr_b16 a[24:25], v12 offset:22528
ds_read_b64_tr_b16 a[26:27], v12 offset:23552
s_waitcnt lgkmcnt(6)
v_mfma_f32_32x32x16_bf16 v[48:63], v[240:243], a[0:3], v[48:63]
ds_read_b64_tr_b16 a[28:29], v13 offset:22528
ds_read_b64_tr_b16 a[30:31], v13 offset:23552
v_mfma_f32_32x32x16_bf16 v[64:79], v[240:243], a[4:7], v[64:79]
buffer_store_dwordx4 v[80:83], v11, s[16:19], s41 offen sc1
v_mfma_f32_32x32x16_bf16 v[48:63], v[244:247], a[8:11], v[48:63]
buffer_store_dwordx4 v[84:87], v11, s[16:19], s41 offen offset:512 sc1
s_add_u32 s41, s41, 131072
v_mfma_f32_32x32x16_bf16 v[64:79], v[244:247], a[12:15], v[64:79]
v_cvt_pk_bf16_f32 v96, v96, v97
v_cvt_pk_bf16_f32 v97, v98, v99
s_waitcnt lgkmcnt(0)
v_mfma_f32_32x32x16_bf16 v[48:63], v[248:251], a[16:19], v[48:63]
v_cvt_pk_bf16_f32 v98, v100, v101
v_cvt_pk_bf16_f32 v99, v102, v103
v_cvt_pk_bf16_f32 v100, v104, v105
v_mfma_f32_32x32x16_bf16 v[64:79], v[248:251], a[20:23], v[64:79]
v_cvt_pk_bf16_f32 v101, v106, v107
v_cvt_pk_bf16_f32 v102, v108, v109
v_cvt_pk_bf16_f32 v103, v110, v111
v_mfma_f32_32x32x16_bf16 v[48:63], v[252:255], a[24:27], v[48:63]
buffer_store_dwordx4 v[96:99], v11, s[16:19], s41 offen sc1
buffer_store_dwordx4 v[100:103], v11, s[16:19], s41 offen offset:512 sc1
s_add_u32 s41, s41, 131072
v_mfma_f32_32x32x16_bf16 v[64:79], v[252:255], a[28:31], v[64:79]
s_nop 7
v_cvt_pk_bf16_f32 v48, v48, v49
v_cvt_pk_bf16_f32 v49, v50, v51
v_cvt_pk_bf16_f32 v50, v52, v53
v_cvt_pk_bf16_f32 v51, v54, v55
v_cvt_pk_bf16_f32 v52, v56, v57
v_cvt_pk_bf16_f32 v53, v58, v59
v_cvt_pk_bf16_f32 v54, v60, v61
v_cvt_pk_bf16_f32 v55, v62, v63
buffer_store_dwordx4 v[48:51], v11, s[16:19], s41 offen sc1
buffer_store_dwordx4 v[52:55], v11, s[16:19], s41 offen offset:512 sc1
s_add_u32 s41, s41, 131072
v_cvt_pk_bf16_f32 v64, v64, v65
v_cvt_pk_bf16_f32 v65, v66, v67
v_cvt_pk_bf16_f32 v66, v68, v69
v_cvt_pk_bf16_f32 v67, v70, v71
v_cvt_pk_bf16_f32 v68, v72, v73
v_cvt_pk_bf16_f32 v69, v74, v75
v_cvt_pk_bf16_f32 v70, v76, v77
v_cvt_pk_bf16_f32 v71, v78, v79
buffer_store_dwordx4 v[64:67], v11, s[16:19], s41 offen sc1
buffer_store_dwordx4 v[68:71], v11, s[16:19], s41 offen offset:512 sc1
s_add_u32 s41, s41, 131072
s_endpgm
L_ka_h:
s_add_u32 s16, s6, 0x7e0000
s_addc_u32 s17, s7, 0
s_mov_b32 s18, 0x240000
s_mov_b32 s19, 0x00020000
s_mul_i32 s32, s27, 12288
s_add_u32 s41, s41, s32
s_mov_b32 s49, 0xc09d30fc
s_waitcnt vmcnt(6)
s_barrier
ds_read_b64_tr_b16 a[0:1], v7 offset:0
ds_read_b64_tr_b16 a[2:3], v7 offset:1024
ds_read_b64_tr_b16 a[4:5], v8 offset:0
ds_read_b64_tr_b16 a[6:7], v8 offset:1024
ds_read_b64_tr_b16 a[8:9], v7 offset:2048
ds_read_b64_tr_b16 a[10:11], v7 offset:3072
ds_read_b64_tr_b16 a[12:13], v8 offset:2048
ds_read_b64_tr_b16 a[14:15], v8 offset:3072
ds_read_b64_tr_b16 a[16:17], v7 offset:4096
ds_read_b64_tr_b16 a[18:19], v7 offset:5120
ds_read_b64_tr_b16 a[20:21], v8 offset:4096
ds_read_b64_tr_b16 a[22:23], v8 offset:5120
ds_read_b64_tr_b16 a[24:25], v7 offset:6144
ds_read_b64_tr_b16 a[26:27], v7 offset:7168
s_waitcnt lgkmcnt(6)
v_mfma_f32_32x32x16_bf16 v[48:63], a[0:3], v[112:115], 0
ds_read_b64_tr_b16 a[28:29], v8 offset:6144
ds_read_b64_tr_b16 a[30:31], v8 offset:7168
s_add_u32 m0, s34, 49152
s_nop 0
buffer_load_dwordx4 v4, s[8:11], s30 offen lds
buffer_load_dwordx4 v5, s[8:11], s30 offen offset:1024 lds
v_mfma_f32_32x32x16_bf16 v[64:79], a[4:7], v[112:115], 0
ds_read_b64_tr_b16 a[0:1], v7 offset:8192
ds_read_b64_tr_b16 a[2:3], v7 offset:9216
buffer_load_dwordx4 v6, s[8:11], s30 offen offset:2048 lds
v_mfma_f32_32x32x16_bf16 v[48:63], a[8:11], v[116:119], v[48:63]
ds_read_b64_tr_b16 a[4:5], v8 offset:8192
ds_read_b64_tr_b16 a[6:7], v8 offset:9216
s_add_u32 m0, s34, 52224
s_nop 0
buffer_load_dwordx4 v4, s[8:11], s31 offen lds
v_mfma_f32_32x32x16_bf16 v[64:79], a[12:15], v[116:119], v[64:79]
ds_read_b64_tr_b16 a[8:9], v7 offset:10240
ds_read_b64_tr_b16 a[10:11], v7 offset:11264
buffer_load_dwordx4 v5, s[8:11], s31 offen offset:1024 lds
s_waitcnt lgkmcnt(6)
v_mfma_f32_32x32x16_bf16 v[48:63], a[16:19], v[120:123], v[48:63]
ds_read_b64_tr_b16 a[12:13], v8 offset:10240
ds_read_b64_tr_b16 a[14:15], v8 offset:11264
buffer_load_dwordx4 v6, s[8:11], s31 offen offset:2048 lds
s_add_u32 s30, s30, s58
s_add_u32 s31, s31, s58
v_mfma_f32_32x32x16_bf16 v[64:79], a[20:23], v[120:123], v[64:79]
ds_read_b64_tr_b16 a[16:17], v7 offset:12288
ds_read_b64_tr_b16 a[18:19], v7 offset:13312
s_add_u32 m0, s34, 73728
s_nop 0
buffer_load_dwordx4 v4, s[8:11], s30 offen lds
v_mfma_f32_32x32x16_bf16 v[48:63], a[24:27], v[124:127], v[48:63]
ds_read_b64_tr_b16 a[20:21], v8 offset:12288
ds_read_b64_tr_b16 a[22:23], v8 offset:13312
buffer_load_dwordx4 v5, s[8:11], s30 offen offset:1024 lds
v_mfma_f32_32x32x16_bf16 v[64:79], a[28:31], v[124:127], v[64:79]
ds_read_b64_tr_b16 a[24:25], v7 offset:14336
ds_read_b64_tr_b16 a[26:27], v7 offset:15360
buffer_load_dwordx4 v6, s[8:11], s30 offen offset:2048 lds
s_waitcnt lgkmcnt(6)
v_mfma_f32_32x32x16_bf16 v[48:63], a[0:3], v[128:131], v[48:63]
ds_read_b64_tr_b16 a[28:29], v8 offset:14336
ds_read_b64_tr_b16 a[30:31], v8 offset:15360
s_add_u32 m0, s34, 76800
s_nop 0
buffer_load_dwordx4 v4, s[8:11], s31 offen lds
buffer_load_dwordx4 v5, s[8:11], s31 offen offset:1024 lds
v_mfma_f32_32x32x16_bf16 v[64:79], a[4:7], v[128:131], v[64:79]
ds_read_b64_tr_b16 a[0:1], v7 offset:16384
ds_read_b64_tr_b16 a[2:3], v7 offset:17408
buffer_load_dwordx4 v6, s[8:11], s31 offen offset:2048 lds
s_add_u32 s30, s30, s56
s_add_u32 s31, s31, s56
v_mfma_f32_32x32x16_bf16 v[48:63], a[8:11], v[132:135], v[48:63]
ds_read_b64_tr_b16 a[4:5], v8 offset:16384
ds_read_b64_tr_b16 a[6:7], v8 offset:17408
s_add_u32 m0, s34, 98304
s_nop 0
buffer_load_dwordx4 v4, s[8:11], s30 offen lds
v_mfma_f32_32x32x16_bf16 v[64:79], a[12:15], v[132:135], v[64:79]
ds_read_b64_tr_b16 a[8:9], v7 offset:18432
ds_read_b64_tr_b16 a[10:11], v7 offset:19456
buffer_load_dwordx4 v5, s[8:11], s30 offen offset:1024 lds
s_waitcnt lgkmcnt(6)
v_mfma_f32_32x32x16_bf16 v[48:63], a[16:19], v[136:139], v[48:63]
ds_read_b64_tr_b16 a[12:13], v8 offset:18432
ds_read_b64_tr_b16 a[14:15], v8 offset:19456
buffer_load_dwordx4 v6, s[8:11], s30 offen offset:2048 lds
v_mfma_f32_32x32x16_bf16 v[64:79], a[20:23], v[136:139], v[64:79]
ds_read_b64_tr_b16 a[16:17], v7 offset:20480
ds_read_b64_tr_b16 a[18:19], v7 offset:21504
s_add_u32 m0, s34, 101376
s_nop 0
buffer_load_dwordx4 v4, s[8:11], s31 offen lds
v_mfma_f32_32x32x16_bf16 v[48:63], a[24:27], v[140:143], v[48:63]
ds_read_b64_tr_b16 a[20:21], v8 offset:20480
ds_read_b64_tr_b16 a[22:23], v8 offset:21504
buffer_load_dwordx4 v5, s[8:11], s31 offen offset:1024 lds
v_mfma_f32_32x32x16_bf16 v[64:79], a[28:31], v[140:143], v[64:79]
ds_read_b64_tr_b16 a[24:25], v7 offset:22528
ds_read_b64_tr_b16 a[26:27], v7 offset:23552
buffer_load_dwordx4 v6, s[8:11], s31 offen offset:2048 lds
s_add_u32 s30, s30, s57
s_add_u32 s31, s31, s57
s_waitcnt lgkmcnt(6)
v_mfma_f32_32x32x16_bf16 v[48:63], a[0:3], v[144:147], v[48:63]
ds_read_b64_tr_b16 a[28:29], v8 offset:22528
ds_read_b64_tr_b16 a[30:31], v8 offset:23552
s_waitcnt vmcnt(18)
s_barrier
v_mfma_f32_32x32x16_bf16 v[64:79], a[4:7], v[144:147], v[64:79]
ds_read_b64_tr_b16 a[0:1], v7 offset:24576
ds_read_b64_tr_b16 a[2:3], v7 offset:25600
s_add_u32 m0, s34, 122880
v_mfma_f32_32x32x16_bf16 v[48:63], a[8:11], v[148:151], v[48:63]
ds_read_b64_tr_b16 a[4:5], v8 offset:24576
ds_read_b64_tr_b16 a[6:7], v8 offset:25600
v_mfma_f32_32x32x16_bf16 v[64:79], a[12:15], v[148:151], v[64:79]
ds_read_b64_tr_b16 a[8:9], v7 offset:26624
ds_read_b64_tr_b16 a[10:11], v7 offset:27648
buffer_load_dwordx4 v4, s[8:11], s30 offen lds
s_waitcnt lgkmcnt(6)
v_mfma_f32_32x32x16_bf16 v[48:63], a[16:19], v[152:155], v[48:63]
ds_read_b64_tr_b16 a[12:13], v8 offset:26624
ds_read_b64_tr_b16 a[14:15], v8 offset:27648
v_mfma_f32_32x32x16_bf16 v[64:79], a[20:23], v[152:155], v[64:79]
ds_read_b64_tr_b16 a[16:17], v7 offset:28672
ds_read_b64_tr_b16 a[18:19], v7 offset:29696
buffer_load_dwordx4 v5, s[8:11], s30 offen offset:1024 lds
v_mfma_f32_32x32x16_bf16 v[48:63], a[24:27], v[156:159], v[48:63]
ds_read_b64_tr_b16 a[20:21], v8 offset:28672
ds_read_b64_tr_b16 a[22:23], v8 offset:29696
v_mfma_f32_32x32x16_bf16 v[64:79], a[28:31], v[156:159], v[64:79]
ds_read_b64_tr_b16 a[24:25], v7 offset:30720
ds_read_b64_tr_b16 a[26:27], v7 offset:31744
buffer_load_dwordx4 v6, s[8:11], s30 offen offset:2048 lds
s_waitcnt lgkmcnt(6)
v_mfma_f32_32x32x16_bf16 v[48:63], a[0:3], v[160:163], v[48:63]
ds_read_b64_tr_b16 a[28:29], v8 offset:30720
ds_read_b64_tr_b16 a[30:31], v8 offset:31744
v_mfma_f32_32x32x16_bf16 v[64:79], a[4:7], v[160:163], v[64:79]
ds_read_b64_tr_b16 a[0:1], v7 offset:32768
ds_read_b64_tr_b16 a[2:3], v7 offset:33792
s_add_u32 m0, s34, 125952
v_mfma_f32_32x32x16_bf16 v[48:63], a[8:11], v[164:167], v[48:63]
ds_read_b64_tr_b16 a[4:5], v8 offset:32768
ds_read_b64_tr_b16 a[6:7], v8 offset:33792
v_mfma_f32_32x32x16_bf16 v[64:79], a[12:15], v[164:167], v[64:79]
ds_read_b64_tr_b16 a[8:9], v7 offset:34816
ds_read_b64_tr_b16 a[10:11], v7 offset:35840
buffer_load_dwordx4 v4, s[8:11], s31 offen lds
s_waitcnt lgkmcnt(6)
v_mfma_f32_32x32x16_bf16 v[48:63], a[16:19], v[168:171], v[48:63]
ds_read_b64_tr_b16 a[12:13], v8 offset:34816
ds_read_b64_tr_b16 a[14:15], v8 offset:35840
v_mfma_f32_32x32x16_bf16 v[64:79], a[20:23], v[168:171], v[64:79]
ds_read_b64_tr_b16 a[16:17], v7 offset:36864
ds_read_b64_tr_b16 a[18:19], v7 offset:37888
buffer_load_dwordx4 v5, s[8:11], s31 offen offset:1024 lds
v_mfma_f32_32x32x16_bf16 v[48:63], a[24:27], v[172:175], v[48:63]
ds_read_b64_tr_b16 a[20:21], v8 offset:36864
ds_read_b64_tr_b16 a[22:23], v8 offset:37888
v_mfma_f32_32x32x16_bf16 v[64:79], a[28:31], v[172:175], v[64:79]
ds_read_b64_tr_b16 a[24:25], v7 offset:38912
ds_read_b64_tr_b16 a[26:27], v7 offset:39936
buffer_load_dwordx4 v6, s[8:11], s31 offen offset:2048 lds
s_waitcnt lgkmcnt(6)
v_mfma_f32_32x32x16_bf16 v[48:63], a[0:3], v[176:179], v[48:63]
ds_read_b64_tr_b16 a[28:29], v8 offset:38912
ds_read_b64_tr_b16 a[30:31], v8 offset:39936
v_mfma_f32_32x32x16_bf16 v[64:79], a[4:7], v[176:179], v[64:79]
ds_read_b64_tr_b16 a[0:1], v7 offset:40960
ds_read_b64_tr_b16 a[2:3], v7 offset:41984
s_add_u32 s30, s30, s58
v_mfma_f32_32x32x16_bf16 v[48:63], a[8:11], v[180:183], v[48:63]
ds_read_b64_tr_b16 a[4:5], v8 offset:40960
ds_read_b64_tr_b16 a[6:7], v8 offset:41984
v_mfma_f32_32x32x16_bf16 v[64:79], a[12:15], v[180:183], v[64:79]
ds_read_b64_tr_b16 a[8:9], v7 offset:43008
ds_read_b64_tr_b16 a[10:11], v7 offset:44032
s_add_u32 s31, s31, s58
s_waitcnt lgkmcnt(6)
v_mfma_f32_32x32x16_bf16 v[48:63], a[16:19], v[184:187], v[48:63]
ds_read_b64_tr_b16 a[12:13], v8 offset:43008
ds_read_b64_tr_b16 a[14:15], v8 offset:44032
v_mfma_f32_32x32x16_bf16 v[64:79], a[20:23], v[184:187], v[64:79]
ds_read_b64_tr_b16 a[16:17], v7 offset:45056
ds_read_b64_tr_b16 a[18:19], v7 offset:46080
v_mfma_f32_32x32x16_bf16 v[48:63], a[24:27], v[188:191], v[48:63]
ds_read_b64_tr_b16 a[20:21], v8 offset:45056
ds_read_b64_tr_b16 a[22:23], v8 offset:46080
v_mfma_f32_32x32x16_bf16 v[64:79], a[28:31], v[188:191], v[64:79]
ds_read_b64_tr_b16 a[24:25], v7 offset:47104
ds_read_b64_tr_b16 a[26:27], v7 offset:48128
s_waitcnt lgkmcnt(6)
v_mfma_f32_32x32x16_bf16 v[48:63], a[0:3], v[192:195], v[48:63]
ds_read_b64_tr_b16 a[28:29], v8 offset:47104
ds_read_b64_tr_b16 a[30:31], v8 offset:48128
s_waitcnt vmcnt(18)
s_barrier
v_mfma_f32_32x32x16_bf16 v[64:79], a[4:7], v[192:195], v[64:79]
ds_read_b64_tr_b16 a[0:1], v12 offset:0
ds_read_b64_tr_b16 a[2:3], v12 offset:1024
s_add_u32 m0, s34, 0
v_mfma_f32_32x32x16_bf16 v[48:63], a[8:11], v[196:199], v[48:63]
ds_read_b64_tr_b16 a[4:5], v13 offset:0
ds_read_b64_tr_b16 a[6:7], v13 offset:1024
v_mfma_f32_32x32x16_bf16 v[64:79], a[12:15], v[196:199], v[64:79]
ds_read_b64_tr_b16 a[8:9], v12 offset:2048
ds_read_b64_tr_b16 a[10:11], v12 offset:3072
buffer_load_dwordx4 v4, s[8:11], s30 offen lds
s_waitcnt lgkmcnt(6)
v_mfma_f32_32x32x16_bf16 v[48:63], a[16:19], v[200:203], v[48:63]
ds_read_b64_tr_b16 a[12:13], v13 offset:2048
ds_read_b64_tr_b16 a[14:15], v13 offset:3072
v_mfma_f32_32x32x16_bf16 v[64:79], a[20:23], v[200:203], v[64:79]
ds_read_b64_tr_b16 a[16:17], v12 offset:4096
ds_read_b64_tr_b16 a[18:19], v12 offset:5120
buffer_load_dwordx4 v5, s[8:11], s30 offen offset:1024 lds
v_mfma_f32_32x32x16_bf16 v[48:63], a[24:27], v[204:207], v[48:63]
ds_read_b64_tr_b16 a[20:21], v13 offset:4096
ds_read_b64_tr_b16 a[22:23], v13 offset:5120
v_mfma_f32_32x32x16_bf16 v[64:79], a[28:31], v[204:207], v[64:79]
ds_read_b64_tr_b16 a[24:25], v12 offset:6144
ds_read_b64_tr_b16 a[26:27], v12 offset:7168
buffer_load_dwordx4 v6, s[8:11], s30 offen offset:2048 lds
s_waitcnt lgkmcnt(6)
v_mfma_f32_32x32x16_bf16 v[48:63], a[0:3], v[208:211], v[48:63]
ds_read_b64_tr_b16 a[28:29], v13 offset:6144
ds_read_b64_tr_b16 a[30:31], v13 offset:7168
v_mfma_f32_32x32x16_bf16 v[64:79], a[4:7], v[208:211], v[64:79]
ds_read_b64_tr_b16 a[0:1], v12 offset:8192
ds_read_b64_tr_b16 a[2:3], v12 offset:9216
s_add_u32 m0, s34, 3072
v_mfma_f32_32x32x16_bf16 v[48:63], a[8:11], v[212:215], v[48:63]
ds_read_b64_tr_b16 a[4:5], v13 offset:8192
ds_read_b64_tr_b16 a[6:7], v13 offset:9216
v_mfma_f32_32x32x16_bf16 v[64:79], a[12:15], v[212:215], v[64:79]
ds_read_b64_tr_b16 a[8:9], v12 offset:10240
ds_read_b64_tr_b16 a[10:11], v12 offset:11264
buffer_load_dwordx4 v4, s[8:11], s31 offen lds
s_waitcnt lgkmcnt(6)
v_mfma_f32_32x32x16_bf16 v[48:63], a[16:19], v[216:219], v[48:63]
ds_read_b64_tr_b16 a[12:13], v13 offset:10240
ds_read_b64_tr_b16 a[14:15], v13 offset:11264
v_mfma_f32_32x32x16_bf16 v[64:79], a[20:23], v[216:219], v[64:79]
ds_read_b64_tr_b16 a[16:17], v12 offset:12288
ds_read_b64_tr_b16 a[18:19], v12 offset:13312
buffer_load_dwordx4 v5, s[8:11], s31 offen offset:1024 lds
v_mfma_f32_32x32x16_bf16 v[48:63], a[24:27], v[220:223], v[48:63]
ds_read_b64_tr_b16 a[20:21], v13 offset:12288
ds_read_b64_tr_b16 a[22:23], v13 offset:13312
v_mfma_f32_32x32x16_bf16 v[64:79], a[28:31], v[220:223], v[64:79]
ds_read_b64_tr_b16 a[24:25], v12 offset:14336
ds_read_b64_tr_b16 a[26:27], v12 offset:15360
buffer_load_dwordx4 v6, s[8:11], s31 offen offset:2048 lds
s_waitcnt lgkmcnt(6)
v_mfma_f32_32x32x16_bf16 v[48:63], a[0:3], v[224:227], v[48:63]
ds_read_b64_tr_b16 a[28:29], v13 offset:14336
ds_read_b64_tr_b16 a[30:31], v13 offset:15360
v_mfma_f32_32x32x16_bf16 v[64:79], a[4:7], v[224:227], v[64:79]
ds_read_b64_tr_b16 a[0:1], v12 offset:16384
ds_read_b64_tr_b16 a[2:3], v12 offset:17408
s_add_u32 s30, s30, s56
v_mfma_f32_32x32x16_bf16 v[48:63], a[8:11], v[228:231], v[48:63]
ds_read_b64_tr_b16 a[4:5], v13 offset:16384
ds_read_b64_tr_b16 a[6:7], v13 offset:17408
v_mfma_f32_32x32x16_bf16 v[64:79], a[12:15], v[228:231], v[64:79]
ds_read_b64_tr_b16 a[8:9], v12 offset:18432
ds_read_b64_tr_b16 a[10:11], v12 offset:19456
s_add_u32 s31, s31, s56
s_waitcnt lgkmcnt(6)
v_mfma_f32_32x32x16_bf16 v[48:63], a[16:19], v[232:235], v[48:63]
ds_read_b64_tr_b16 a[12:13], v13 offset:18432
ds_read_b64_tr_b16 a[14:15], v13 offset:19456
v_mfma_f32_32x32x16_bf16 v[64:79], a[20:23], v[232:235], v[64:79]
ds_read_b64_tr_b16 a[16:17], v12 offset:20480
ds_read_b64_tr_b16 a[18:19], v12 offset:21504
v_mfma_f32_32x32x16_bf16 v[48:63], a[24:27], v[236:239], v[48:63]
ds_read_b64_tr_b16 a[20:21], v13 offset:20480
ds_read_b64_tr_b16 a[22:23], v13 offset:21504
v_mfma_f32_32x32x16_bf16 v[64:79], a[28:31], v[236:239], v[64:79]
ds_read_b64_tr_b16 a[24:25], v12 offset:22528
ds_read_b64_tr_b16 a[26:27], v12 offset:23552
s_waitcnt lgkmcnt(6)
v_mfma_f32_32x32x16_bf16 v[48:63], a[0:3], v[240:243], v[48:63]
ds_read_b64_tr_b16 a[28:29], v13 offset:22528
ds_read_b64_tr_b16 a[30:31], v13 offset:23552
s_waitcnt vmcnt(18)
s_barrier
v_mfma_f32_32x32x16_bf16 v[64:79], a[4:7], v[240:243], v[64:79]
ds_read_b64_tr_b16 a[0:1], v12 offset:24576
ds_read_b64_tr_b16 a[2:3], v12 offset:25600
s_add_u32 m0, s34, 24576
v_mfma_f32_32x32x16_bf16 v[48:63], a[8:11], v[244:247], v[48:63]
ds_read_b64_tr_b16 a[4:5], v13 offset:24576
ds_read_b64_tr_b16 a[6:7], v13 offset:25600
v_mfma_f32_32x32x16_bf16 v[64:79], a[12:15], v[244:247], v[64:79]
ds_read_b64_tr_b16 a[8:9], v12 offset:26624
ds_read_b64_tr_b16 a[10:11], v12 offset:27648
buffer_load_dwordx4 v4, s[8:11], s30 offen lds
s_waitcnt lgkmcnt(6)
v_mfma_f32_32x32x16_bf16 v[48:63], a[16:19], v[248:251], v[48:63]
ds_read_b64_tr_b16 a[12:13], v13 offset:26624
ds_read_b64_tr_b16 a[14:15], v13 offset:27648
v_mfma_f32_32x32x16_bf16 v[64:79], a[20:23], v[248:251], v[64:79]
ds_read_b64_tr_b16 a[16:17], v12 offset:28672
ds_read_b64_tr_b16 a[18:19], v12 offset:29696
buffer_load_dwordx4 v5, s[8:11], s30 offen offset:1024 lds
v_mfma_f32_32x32x16_bf16 v[48:63], a[24:27], v[252:255], v[48:63]
ds_read_b64_tr_b16 a[20:21], v13 offset:28672
ds_read_b64_tr_b16 a[22:23], v13 offset:29696
v_mfma_f32_32x32x16_bf16 v[64:79], a[28:31], v[252:255], v[64:79]
ds_read_b64_tr_b16 a[24:25], v12 offset:30720
ds_read_b64_tr_b16 a[26:27], v12 offset:31744
buffer_load_dwordx4 v6, s[8:11], s30 offen offset:2048 lds
s_waitcnt lgkmcnt(6)
v_mfma_f32_32x32x16_bf16 v[80:95], a[0:3], v[112:115], 0
ds_read_b64_tr_b16 a[28:29], v13 offset:30720
ds_read_b64_tr_b16 a[30:31], v13 offset:31744
v_mfma_f32_32x32x16_bf16 v[96:111], a[4:7], v[112:115], 0
ds_read_b64_tr_b16 a[0:1], v12 offset:32768
ds_read_b64_tr_b16 a[2:3], v12 offset:33792
s_add_u32 m0, s34, 27648
v_mfma_f32_32x32x16_bf16 v[80:95], a[8:11], v[116:119], v[80:95]
ds_read_b64_tr_b16 a[4:5], v13 offset:32768
ds_read_b64_tr_b16 a[6:7], v13 offset:33792
v_mfma_f32_32x32x16_bf16 v[96:111], a[12:15], v[116:119], v[96:111]
ds_read_b64_tr_b16 a[8:9], v12 offset:34816
ds_read_b64_tr_b16 a[10:11], v12 offset:35840
buffer_load_dwordx4 v4, s[8:11], s31 offen lds
v_fma_f32 v16, -v48, v48, s49
v_fma_f32 v17, -v49, v49, s49
s_waitcnt lgkmcnt(6)
v_mfma_f32_32x32x16_bf16 v[80:95], a[16:19], v[120:123], v[80:95]
ds_read_b64_tr_b16 a[12:13], v13 offset:34816
ds_read_b64_tr_b16 a[14:15], v13 offset:35840
v_fma_f32 v18, -v50, v50, s49
v_fma_f32 v19, -v51, v51, s49
v_mul_f32 v16, v16, v48
v_mul_f32 v17, v17, v49
v_mul_f32 v18, v18, v50
v_mfma_f32_32x32x16_bf16 v[96:111], a[20:23], v[120:123], v[96:111]
ds_read_b64_tr_b16 a[16:17], v12 offset:36864
ds_read_b64_tr_b16 a[18:19], v12 offset:37888
buffer_load_dwordx4 v5, s[8:11], s31 offen offset:1024 lds
v_mul_f32 v19, v19, v51
v_exp_f32 v16, v16
v_mfma_f32_32x32x16_bf16 v[80:95], a[24:27], v[124:127], v[80:95]
ds_read_b64_tr_b16 a[20:21], v13 offset:36864
ds_read_b64_tr_b16 a[22:23], v13 offset:37888
v_exp_f32 v17, v17
v_exp_f32 v18, v18
v_mfma_f32_32x32x16_bf16 v[96:111], a[28:31], v[124:127], v[96:111]
ds_read_b64_tr_b16 a[24:25], v12 offset:38912
ds_read_b64_tr_b16 a[26:27], v12 offset:39936
buffer_load_dwordx4 v6, s[8:11], s31 offen offset:2048 lds
v_exp_f32 v19, v19
s_waitcnt lgkmcnt(6)
v_mfma_f32_32x32x16_bf16 v[80:95], a[0:3], v[128:131], v[80:95]
ds_read_b64_tr_b16 a[28:29], v13 offset:38912
ds_read_b64_tr_b16 a[30:31], v13 offset:39936
v_add_f32 v16, 1.0, v16
v_add_f32 v17, 1.0, v17
v_add_f32 v18, 1.0, v18
v_add_f32 v19, 1.0, v19
v_mfma_f32_32x32x16_bf16 v[96:111], a[4:7], v[128:131], v[96:111]
ds_read_b64_tr_b16 a[0:1], v12 offset:40960
ds_read_b64_tr_b16 a[2:3], v12 offset:41984
s_add_u32 s30, s30, s57
v_rcp_f32 v16, v16
v_mfma_f32_32x32x16_bf16 v[80:95], a[8:11], v[132:135], v[80:95]
ds_read_b64_tr_b16 a[4:5], v13 offset:40960
ds_read_b64_tr_b16 a[6:7], v13 offset:41984
v_rcp_f32 v17, v17
v_rcp_f32 v18, v18
v_mfma_f32_32x32x16_bf16 v[96:111], a[12:15], v[132:135], v[96:111]
ds_read_b64_tr_b16 a[8:9], v12 offset:43008
ds_read_b64_tr_b16 a[10:11], v12 offset:44032
s_add_u32 s31, s31, s57
v_rcp_f32 v19, v19
v_mul_f32 v16, v16, v48
s_waitcnt lgkmcnt(6)
v_mfma_f32_32x32x16_bf16 v[80:95], a[16:19], v[136:139], v[80:95]
ds_read_b64_tr_b16 a[12:13], v13 offset:43008
ds_read_b64_tr_b16 a[14:15], v13 offset:44032
v_mul_f32 v17, v17, v49
v_mul_f32 v18, v18, v50
v_mul_f32 v19, v19, v51
v_cvt_pk_bf16_f32 v48, v16, v17
v_cvt_pk_bf16_f32 v49, v18, v19
v_mfma_f32_32x32x16_bf16 v[96:111], a[20:23], v[136:139], v[96:111]
ds_read_b64_tr_b16 a[16:17], v12 offset:45056
ds_read_b64_tr_b16 a[18:19], v12 offset:46080
v_fma_f32 v20, -v52, v52, s49
v_fma_f32 v21, -v53, v53, s49
v_fma_f32 v22, -v54, v54, s49
v_fma_f32 v23, -v55, v55, s49
v_mul_f32 v20, v20, v52
v_mfma_f32_32x32x16_bf16 v[80:95], a[24:27], v[140:143], v[80:95]
ds_read_b64_tr_b16 a[20:21], v13 offset:45056
ds_read_b64_tr_b16 a[22:23], v13 offset:46080
v_mul_f32 v21, v21, v53
v_mul_f32 v22, v22, v54
v_mul_f32 v23, v23, v55
v_exp_f32 v20, v20
v_mfma_f32_32x32x16_bf16 v[96:111], a[28:31], v[140:143], v[96:111]
ds_read_b64_tr_b16 a[24:25], v12 offset:47104
ds_read_b64_tr_b16 a[26:27], v12 offset:48128
v_exp_f32 v21, v21
v_exp_f32 v22, v22
s_waitcnt lgkmcnt(6)
v_mfma_f32_32x32x16_bf16 v[80:95], a[0:3], v[144:147], v[80:95]
ds_read_b64_tr_b16 a[28:29], v13 offset:47104
ds_read_b64_tr_b16 a[30:31], v13 offset:48128
s_waitcnt vmcnt(18)
s_barrier
v_exp_f32 v23, v23
v_mfma_f32_32x32x16_bf16 v[96:111], a[4:7], v[144:147], v[96:111]
ds_read_b64_tr_b16 a[0:1], v14 offset:0
ds_read_b64_tr_b16 a[2:3], v14 offset:1024
s_add_u32 m0, s34, 49152
v_add_f32 v20, 1.0, v20
v_add_f32 v21, 1.0, v21
v_add_f32 v22, 1.0, v22
v_add_f32 v23, 1.0, v23
v_mfma_f32_32x32x16_bf16 v[80:95], a[8:11], v[148:151], v[80:95]
ds_read_b64_tr_b16 a[4:5], v15 offset:0
ds_read_b64_tr_b16 a[6:7], v15 offset:1024
v_rcp_f32 v20, v20
v_rcp_f32 v21, v21
v_mfma_f32_32x32x16_bf16 v[96:111], a[12:15], v[148:151], v[96:111]
ds_read_b64_tr_b16 a[8:9], v14 offset:2048
ds_read_b64_tr_b16 a[10:11], v14 offset:3072
buffer_load_dwordx4 v4, s[8:11], s30 offen lds
v_rcp_f32 v22, v22
s_waitcnt lgkmcnt(6)
v_mfma_f32_32x32x16_bf16 v[80:95], a[16:19], v[152:155], v[80:95]
ds_read_b64_tr_b16 a[12:13], v15 offset:2048
ds_read_b64_tr_b16 a[14:15], v15 offset:3072
v_rcp_f32 v23, v23
v_mul_f32 v20, v20, v52
v_mul_f32 v21, v21, v53
v_mul_f32 v22, v22, v54
v_mfma_f32_32x32x16_bf16 v[96:111], a[20:23], v[152:155], v[96:111]
ds_read_b64_tr_b16 a[16:17], v14 offset:4096
ds_read_b64_tr_b16 a[18:19], v14 offset:5120
buffer_load_dwordx4 v5, s[8:11], s30 offen offset:1024 lds
v_mul_f32 v23, v23, v55
v_cvt_pk_bf16_f32 v50, v20, v21
v_cvt_pk_bf16_f32 v51, v22, v23
v_mfma_f32_32x32x16_bf16 v[80:95], a[24:27], v[156:159], v[80:95]
ds_read_b64_tr_b16 a[20:21], v15 offset:4096
ds_read_b64_tr_b16 a[22:23], v15 offset:5120
v_fma_f32 v16, -v56, v56, s49
v_fma_f32 v17, -v57, v57, s49
v_fma_f32 v18, -v58, v58, s49
v_fma_f32 v19, -v59, v59, s49
v_mul_f32 v16, v16, v56
v_mfma_f32_32x32x16_bf16 v[96:111], a[28:31], v[156:159], v[96:111]
ds_read_b64_tr_b16 a[24:25], v14 offset:6144
ds_read_b64_tr_b16 a[26:27], v14 offset:7168
buffer_load_dwordx4 v6, s[8:11], s30 offen offset:2048 lds
v_mul_f32 v17, v17, v57
s_waitcnt lgkmcnt(6)
v_mfma_f32_32x32x16_bf16 v[80:95], a[0:3], v[160:163], v[80:95]
ds_read_b64_tr_b16 a[28:29], v15 offset:6144
ds_read_b64_tr_b16 a[30:31], v15 offset:7168
v_mul_f32 v18, v18, v58
v_mul_f32 v19, v19, v59
v_exp_f32 v16, v16
v_mfma_f32_32x32x16_bf16 v[96:111], a[4:7], v[160:163], v[96:111]
ds_read_b64_tr_b16 a[0:1], v14 offset:8192
ds_read_b64_tr_b16 a[2:3], v14 offset:9216
s_add_u32 m0, s34, 52224
v_exp_f32 v17, v17
v_exp_f32 v18, v18
v_mfma_f32_32x32x16_bf16 v[80:95], a[8:11], v[164:167], v[80:95]
ds_read_b64_tr_b16 a[4:5], v15 offset:8192
ds_read_b64_tr_b16 a[6:7], v15 offset:9216
v_exp_f32 v19, v19
v_add_f32 v16, 1.0, v16
v_add_f32 v17, 1.0, v17
v_add_f32 v18, 1.0, v18
v_mfma_f32_32x32x16_bf16 v[96:111], a[12:15], v[164:167], v[96:111]
ds_read_b64_tr_b16 a[8:9], v14 offset:10240
ds_read_b64_tr_b16 a[10:11], v14 offset:11264
buffer_load_dwordx4 v4, s[8:11], s31 offen lds
v_add_f32 v19, 1.0, v19
s_waitcnt lgkmcnt(6)
v_mfma_f32_32x32x16_bf16 v[80:95], a[16:19], v[168:171], v[80:95]
ds_read_b64_tr_b16 a[12:13], v15 offset:10240
ds_read_b64_tr_b16 a[14:15], v15 offset:11264
v_rcp_f32 v16, v16
v_rcp_f32 v17, v17
v_mfma_f32_32x32x16_bf16 v[96:111], a[20:23], v[168:171], v[96:111]
ds_read_b64_tr_b16 a[16:17], v14 offset:12288
ds_read_b64_tr_b16 a[18:19], v14 offset:13312
buffer_load_dwordx4 v5, s[8:11], s31 offen offset:1024 lds
v_rcp_f32 v18, v18
v_mfma_f32_32x32x16_bf16 v[80:95], a[24:27], v[172:175], v[80:95]
ds_read_b64_tr_b16 a[20:21], v15 offset:12288
ds_read_b64_tr_b16 a[22:23], v15 offset:13312
v_rcp_f32 v19, v19
v_mul_f32 v16, v16, v56
v_mul_f32 v17, v17, v57
v_mfma_f32_32x32x16_bf16 v[96:111], a[28:31], v[172:175], v[96:111]
ds_read_b64_tr_b16 a[24:25], v14 offset:14336
ds_read_b64_tr_b16 a[26:27], v14 offset:15360
buffer_load_dwordx4 v6, s[8:11], s31 offen offset:2048 lds
v_mul_f32 v18, v18, v58
v_mul_f32 v19, v19, v59
s_waitcnt lgkmcnt(6)
v_mfma_f32_32x32x16_bf16 v[80:95], a[0:3], v[176:179], v[80:95]
ds_read_b64_tr_b16 a[28:29], v15 offset:14336
ds_read_b64_tr_b16 a[30:31], v15 offset:15360
v_cvt_pk_bf16_f32 v52, v16, v17
v_cvt_pk_bf16_f32 v53, v18, v19
v_fma_f32 v20, -v60, v60, s49
v_fma_f32 v21, -v61, v61, s49
v_fma_f32 v22, -v62, v62, s49
v_mfma_f32_32x32x16_bf16 v[96:111], a[4:7], v[176:179], v[96:111]
ds_read_b64_tr_b16 a[0:1], v14 offset:16384
ds_read_b64_tr_b16 a[2:3], v14 offset:17408
s_add_u32 s30, s30, s58
v_fma_f32 v23, -v63, v63, s49
v_mul_f32 v20, v20, v60
v_mul_f32 v21, v21, v61
v_mul_f32 v22, v22, v62
v_mfma_f32_32x32x16_bf16 v[80:95], a[8:11], v[180:183], v[80:95]
ds_read_b64_tr_b16 a[4:5], v15 offset:16384
ds_read_b64_tr_b16 a[6:7], v15 offset:17408
v_mul_f32 v23, v23, v63
v_exp_f32 v20, v20
v_exp_f32 v21, v21
v_mfma_f32_32x32x16_bf16 v[96:111], a[12:15], v[180:183], v[96:111]
ds_read_b64_tr_b16 a[8:9], v14 offset:18432
ds_read_b64_tr_b16 a[10:11], v14 offset:19456
s_add_u32 s31, s31, s58
v_exp_f32 v22, v22
s_waitcnt lgkmcnt(6)
v_mfma_f32_32x32x16_bf16 v[80:95], a[16:19], v[184:187], v[80:95]
ds_read_b64_tr_b16 a[12:13], v15 offset:18432
ds_read_b64_tr_b16 a[14:15], v15 offset:19456
v_exp_f32 v23, v23
v_add_f32 v20, 1.0, v20
v_add_f32 v21, 1.0, v21
v_mfma_f32_32x32x16_bf16 v[96:111], a[20:23], v[184:187], v[96:111]
ds_read_b64_tr_b16 a[16:17], v14 offset:20480
ds_read_b64_tr_b16 a[18:19], v14 offset:21504
v_add_f32 v22, 1.0, v22
v_add_f32 v23, 1.0, v23
v_rcp_f32 v20, v20
v_mfma_f32_32x32x16_bf16 v[80:95], a[24:27], v[188:191], v[80:95]
ds_read_b64_tr_b16 a[20:21], v15 offset:20480
ds_read_b64_tr_b16 a[22:23], v15 offset:21504
v_rcp_f32 v21, v21
v_rcp_f32 v22, v22
v_mfma_f32_32x32x16_bf16 v[96:111], a[28:31], v[188:191], v[96:111]
ds_read_b64_tr_b16 a[24:25], v14 offset:22528
ds_read_b64_tr_b16 a[26:27], v14 offset:23552
v_rcp_f32 v23, v23
v_mul_f32 v20, v20, v60
v_mul_f32 v21, v21, v61
s_waitcnt lgkmcnt(6)
v_mfma_f32_32x32x16_bf16 v[80:95], a[0:3], v[192:195], v[80:95]
ds_read_b64_tr_b16 a[28:29], v15 offset:22528
ds_read_b64_tr_b16 a[30:31], v15 offset:23552
s_waitcnt vmcnt(18)
s_barrier
v_mul_f32 v22, v22, v62
v_mul_f32 v23, v23, v63
v_cvt_pk_bf16_f32 v54, v20, v21
v_mfma_f32_32x32x16_bf16 v[96:111], a[4:7], v[192:195], v[96:111]
ds_read_b64_tr_b16 a[0:1], v14 offset:24576
ds_read_b64_tr_b16 a[2:3], v14 offset:25600
v_cvt_pk_bf16_f32 v55, v22, v23
buffer_store_dwordx4 v[48:51], v11, s[16:19], s41 offen offset:0 sc1
buffer_store_dwordx4 v[52:55], v11, s[16:19], s41 offen offset:1024 sc1
v_mfma_f32_32x32x16_bf16 v[80:95], a[8:11], v[196:199], v[80:95]
ds_read_b64_tr_b16 a[4:5], v15 offset:24576
ds_read_b64_tr_b16 a[6:7], v15 offset:25600
v_fma_f32 v16, -v64, v64, s49
v_fma_f32 v17, -v65, v65, s49
v_fma_f32 v18, -v66, v66, s49
v_fma_f32 v19, -v67, v67, s49
v_mul_f32 v16, v16, v64
v_mfma_f32_32x32x16_bf16 v[96:111], a[12:15], v[196:199], v[96:111]
ds_read_b64_tr_b16 a[8:9], v14 offset:26624
ds_read_b64_tr_b16 a[10:11], v14 offset:27648
v_mul_f32 v17, v17, v65
v_mul_f32 v18, v18, v66
v_mul_f32 v19, v19, v67
s_waitcnt lgkmcnt(6)
v_mfma_f32_32x32x16_bf16 v[80:95], a[16:19], v[200:203], v[80:95]
ds_read_b64_tr_b16 a[12:13], v15 offset:26624
ds_read_b64_tr_b16 a[14:15], v15 offset:27648
v_exp_f32 v16, v16
v_exp_f32 v17, v17
v_mfma_f32_32x32x16_bf16 v[96:111], a[20:23], v[200:203], v[96:111]
ds_read_b64_tr_b16 a[16:17], v14 offset:28672
ds_read_b64_tr_b16 a[18:19], v14 offset:29696
v_exp_f32 v18, v18
v_exp_f32 v19, v19
v_add_f32 v16, 1.0, v16
v_mfma_f32_32x32x16_bf16 v[80:95], a[24:27], v[204:207], v[80:95]
ds_read_b64_tr_b16 a[20:21], v15 offset:28672
ds_read_b64_tr_b16 a[22:23], v15 offset:29696
v_add_f32 v17, 1.0, v17
v_add_f32 v18, 1.0, v18
v_add_f32 v19, 1.0, v19
v_rcp_f32 v16, v16
v_mfma_f32_32x32x16_bf16 v[96:111], a[28:31], v[204:207], v[96:111]
ds_read_b64_tr_b16 a[24:25], v14 offset:30720
ds_read_b64_tr_b16 a[26:27], v14 offset:31744
v_rcp_f32 v17, v17
v_rcp_f32 v18, v18
s_waitcnt lgkmcnt(6)
v_mfma_f32_32x32x16_bf16 v[80:95], a[0:3], v[208:211], v[80:95]
ds_read_b64_tr_b16 a[28:29], v15 offset:30720
ds_read_b64_tr_b16 a[30:31], v15 offset:31744
v_rcp_f32 v19, v19
v_mul_f32 v16, v16, v64
v_mul_f32 v17, v17, v65
v_mul_f32 v18, v18, v66
v_mfma_f32_32x32x16_bf16 v[96:111], a[4:7], v[208:211], v[96:111]
ds_read_b64_tr_b16 a[0:1], v14 offset:32768
ds_read_b64_tr_b16 a[2:3], v14 offset:33792
v_mul_f32 v19, v19, v67
v_cvt_pk_bf16_f32 v64, v16, v17
v_cvt_pk_bf16_f32 v65, v18, v19
v_fma_f32 v20, -v68, v68, s49
v_fma_f32 v21, -v69, v69, s49
v_mfma_f32_32x32x16_bf16 v[80:95], a[8:11], v[212:215], v[80:95]
ds_read_b64_tr_b16 a[4:5], v15 offset:32768
ds_read_b64_tr_b16 a[6:7], v15 offset:33792
v_fma_f32 v22, -v70, v70, s49
v_fma_f32 v23, -v71, v71, s49
v_mul_f32 v20, v20, v68
v_mul_f32 v21, v21, v69
v_mfma_f32_32x32x16_bf16 v[96:111], a[12:15], v[212:215], v[96:111]
ds_read_b64_tr_b16 a[8:9], v14 offset:34816
ds_read_b64_tr_b16 a[10:11], v14 offset:35840
v_mul_f32 v22, v22, v70
v_mul_f32 v23, v23, v71
v_exp_f32 v20, v20
s_waitcnt lgkmcnt(6)
v_mfma_f32_32x32x16_bf16 v[80:95], a[16:19], v[216:219], v[80:95]
ds_read_b64_tr_b16 a[12:13], v15 offset:34816
ds_read_b64_tr_b16 a[14:15], v15 offset:35840
v_exp_f32 v21, v21
v_exp_f32 v22, v22
v_mfma_f32_32x32x16_bf16 v[96:111], a[20:23], v[216:219], v[96:111]
ds_read_b64_tr_b16 a[16:17], v14 offset:36864
ds_read_b64_tr_b16 a[18:19], v14 offset:37888
v_exp_f32 v23, v23
v_add_f32 v20, 1.0, v20
v_add_f32 v21, 1.0, v21
v_add_f32 v22, 1.0, v22
v_mfma_f32_32x32x16_bf16 v[80:95], a[24:27], v[220:223], v[80:95]
ds_read_b64_tr_b16 a[20:21], v15 offset:36864
ds_read_b64_tr_b16 a[22:23], v15 offset:37888
v_add_f32 v23, 1.0, v23
v_rcp_f32 v20, v20
v_rcp_f32 v21, v21
v_mfma_f32_32x32x16_bf16 v[96:111], a[28:31], v[220:223], v[96:111]
ds_read_b64_tr_b16 a[24:25], v14 offset:38912
ds_read_b64_tr_b16 a[26:27], v14 offset:39936
v_rcp_f32 v22, v22
v_rcp_f32 v23, v23
s_waitcnt lgkmcnt(6)
v_mfma_f32_32x32x16_bf16 v[80:95], a[0:3], v[224:227], v[80:95]
ds_read_b64_tr_b16 a[28:29], v15 offset:38912
ds_read_b64_tr_b16 a[30:31], v15 offset:39936
v_mul_f32 v20, v20, v68
v_mul_f32 v21, v21, v69
v_mul_f32 v22, v22, v70
v_mul_f32 v23, v23, v71
v_cvt_pk_bf16_f32 v66, v20, v21
v_mfma_f32_32x32x16_bf16 v[96:111], a[4:7], v[224:227], v[96:111]
ds_read_b64_tr_b16 a[0:1], v14 offset:40960
ds_read_b64_tr_b16 a[2:3], v14 offset:41984
v_cvt_pk_bf16_f32 v67, v22, v23
v_fma_f32 v16, -v72, v72, s49
v_fma_f32 v17, -v73, v73, s49
v_fma_f32 v18, -v74, v74, s49
v_mfma_f32_32x32x16_bf16 v[80:95], a[8:11], v[228:231], v[80:95]
ds_read_b64_tr_b16 a[4:5], v15 offset:40960
ds_read_b64_tr_b16 a[6:7], v15 offset:41984
v_fma_f32 v19, -v75, v75, s49
v_mul_f32 v16, v16, v72
v_mul_f32 v17, v17, v73
v_mul_f32 v18, v18, v74
v_mul_f32 v19, v19, v75
v_mfma_f32_32x32x16_bf16 v[96:111], a[12:15], v[228:231], v[96:111]
ds_read_b64_tr_b16 a[8:9], v14 offset:43008
ds_read_b64_tr_b16 a[10:11], v14 offset:44032
v_exp_f32 v16, v16
v_exp_f32 v17, v17
s_waitcnt lgkmcnt(6)
v_mfma_f32_32x32x16_bf16 v[80:95], a[16:19], v[232:235], v[80:95]
ds_read_b64_tr_b16 a[12:13], v15 offset:43008
ds_read_b64_tr_b16 a[14:15], v15 offset:44032
v_exp_f32 v18, v18
v_exp_f32 v19, v19
v_add_f32 v16, 1.0, v16
v_mfma_f32_32x32x16_bf16 v[96:111], a[20:23], v[232:235], v[96:111]
ds_read_b64_tr_b16 a[16:17], v14 offset:45056
ds_read_b64_tr_b16 a[18:19], v14 offset:46080
v_add_f32 v17, 1.0, v17
v_add_f32 v18, 1.0, v18
v_add_f32 v19, 1.0, v19
v_rcp_f32 v16, v16
v_mfma_f32_32x32x16_bf16 v[80:95], a[24:27], v[236:239], v[80:95]
ds_read_b64_tr_b16 a[20:21], v15 offset:45056
ds_read_b64_tr_b16 a[22:23], v15 offset:46080
v_rcp_f32 v17, v17
v_rcp_f32 v18, v18
v_mfma_f32_32x32x16_bf16 v[96:111], a[28:31], v[236:239], v[96:111]
ds_read_b64_tr_b16 a[24:25], v14 offset:47104
ds_read_b64_tr_b16 a[26:27], v14 offset:48128
v_rcp_f32 v19, v19
v_mul_f32 v16, v16, v72
v_mul_f32 v17, v17, v73
s_waitcnt lgkmcnt(6)
v_mfma_f32_32x32x16_bf16 v[80:95], a[0:3], v[240:243], v[80:95]
ds_read_b64_tr_b16 a[28:29], v15 offset:47104
ds_read_b64_tr_b16 a[30:31], v15 offset:48128
s_waitcnt vmcnt(14)
s_barrier
v_mul_f32 v18, v18, v74
v_mul_f32 v19, v19, v75
v_mfma_f32_32x32x16_bf16 v[96:111], a[4:7], v[240:243], v[96:111]
ds_read_b64_tr_b16 a[0:1], v7 offset:0
ds_read_b64_tr_b16 a[2:3], v7 offset:1024
v_cvt_pk_bf16_f32 v68, v16, v17
v_cvt_pk_bf16_f32 v69, v18, v19
v_fma_f32 v20, -v76, v76, s49
v_fma_f32 v21, -v77, v77, s49
v_fma_f32 v22, -v78, v78, s49
v_mfma_f32_32x32x16_bf16 v[80:95], a[8:11], v[244:247], v[80:95]
ds_read_b64_tr_b16 a[4:5], v8 offset:0
ds_read_b64_tr_b16 a[6:7], v8 offset:1024
v_fma_f32 v23, -v79, v79, s49
v_mul_f32 v20, v20, v76
v_mul_f32 v21, v21, v77
v_mul_f32 v22, v22, v78
v_mul_f32 v23, v23, v79
v_mfma_f32_32x32x16_bf16 v[96:111], a[12:15], v[244:247], v[96:111]
ds_read_b64_tr_b16 a[8:9], v7 offset:2048
ds_read_b64_tr_b16 a[10:11], v7 offset:3072
v_exp_f32 v20, v20
v_exp_f32 v21, v21
s_waitcnt lgkmcnt(6)
v_mfma_f32_32x32x16_bf16 v[80:95], a[16:19], v[248:251], v[80:95]
ds_read_b64_tr_b16 a[12:13], v8 offset:2048
ds_read_b64_tr_b16 a[14:15], v8 offset:3072
v_exp_f32 v22, v22
v_exp_f32 v23, v23
v_add_f32 v20, 1.0, v20
v_mfma_f32_32x32x16_bf16 v[96:111], a[20:23], v[248:251], v[96:111]
ds_read_b64_tr_b16 a[16:17], v7 offset:4096
ds_read_b64_tr_b16 a[18:19], v7 offset:5120
v_add_f32 v21, 1.0, v21
v_add_f32 v22, 1.0, v22
v_add_f32 v23, 1.0, v23
v_rcp_f32 v20, v20
v_mfma_f32_32x32x16_bf16 v[80:95], a[24:27], v[252:255], v[80:95]
ds_read_b64_tr_b16 a[20:21], v8 offset:4096
ds_read_b64_tr_b16 a[22:23], v8 offset:5120
v_rcp_f32 v21, v21
v_rcp_f32 v22, v22
v_rcp_f32 v23, v23
v_mul_f32 v20, v20, v76
v_mul_f32 v21, v21, v77
v_mul_f32 v22, v22, v78
v_mul_f32 v23, v23, v79
v_cvt_pk_bf16_f32 v70, v20, v21
v_cvt_pk_bf16_f32 v71, v22, v23
buffer_store_dwordx4 v[64:67], v11, s[16:19], s41 offen offset:2048 sc1
buffer_store_dwordx4 v[68:71], v11, s[16:19], s41 offen offset:3072 sc1
s_add_u32 s41, s41, 4096
v_mfma_f32_32x32x16_bf16 v[96:111], a[28:31], v[252:255], v[96:111]
ds_read_b64_tr_b16 a[24:25], v7 offset:6144
ds_read_b64_tr_b16 a[26:27], v7 offset:7168
s_waitcnt lgkmcnt(6)
v_mfma_f32_32x32x16_bf16 v[48:63], a[0:3], v[112:115], 0
ds_read_b64_tr_b16 a[28:29], v8 offset:6144
ds_read_b64_tr_b16 a[30:31], v8 offset:7168
v_mfma_f32_32x32x16_bf16 v[64:79], a[4:7], v[112:115], 0
ds_read_b64_tr_b16 a[0:1], v7 offset:8192
ds_read_b64_tr_b16 a[2:3], v7 offset:9216
v_mfma_f32_32x32x16_bf16 v[48:63], a[8:11], v[116:119], v[48:63]
ds_read_b64_tr_b16 a[4:5], v8 offset:8192
ds_read_b64_tr_b16 a[6:7], v8 offset:9216
v_mfma_f32_32x32x16_bf16 v[64:79], a[12:15], v[116:119], v[64:79]
ds_read_b64_tr_b16 a[8:9], v7 offset:10240
ds_read_b64_tr_b16 a[10:11], v7 offset:11264
v_fma_f32 v16, -v80, v80, s49
v_fma_f32 v17, -v81, v81, s49
v_fma_f32 v18, -v82, v82, s49
v_fma_f32 v19, -v83, v83, s49
s_waitcnt lgkmcnt(6)
v_mfma_f32_32x32x16_bf16 v[48:63], a[16:19], v[120:123], v[48:63]
ds_read_b64_tr_b16 a[12:13], v8 offset:10240
ds_read_b64_tr_b16 a[14:15], v8 offset:11264
v_mul_f32 v16, v16, v80
v_mul_f32 v17, v17, v81
v_mul_f32 v18, v18, v82
v_mul_f32 v19, v19, v83
v_mfma_f32_32x32x16_bf16 v[64:79], a[20:23], v[120:123], v[64:79]
ds_read_b64_tr_b16 a[16:17], v7 offset:12288
ds_read_b64_tr_b16 a[18:19], v7 offset:13312
v_exp_f32 v16, v16
v_exp_f32 v17, v17
v_mfma_f32_32x32x16_bf16 v[48:63], a[24:27], v[124:127], v[48:63]
ds_read_b64_tr_b16 a[20:21], v8 offset:12288
ds_read_b64_tr_b16 a[22:23], v8 offset:13312
v_exp_f32 v18, v18
v_exp_f32 v19, v19
v_add_f32 v16, 1.0, v16
v_mfma_f32_32x32x16_bf16 v[64:79], a[28:31], v[124:127], v[64:79]
ds_read_b64_tr_b16 a[24:25], v7 offset:14336
ds_read_b64_tr_b16 a[26:27], v7 offset:15360
v_add_f32 v17, 1.0, v17
v_add_f32 v18, 1.0, v18
v_add_f32 v19, 1.0, v19
s_waitcnt lgkmcnt(6)
v_mfma_f32_32x32x16_bf16 v[48:63], a[0:3], v[128:131], v[48:63]
ds_read_b64_tr_b16 a[28:29], v8 offset:14336
ds_read_b64_tr_b16 a[30:31], v8 offset:15360
v_rcp_f32 v16, v16
v_rcp_f32 v17, v17
v_mfma_f32_32x32x16_bf16 v[64:79], a[4:7], v[128:131], v[64:79]
ds_read_b64_tr_b16 a[0:1], v7 offset:16384
ds_read_b64_tr_b16 a[2:3], v7 offset:17408
v_rcp_f32 v18, v18
v_rcp_f32 v19, v19
v_mul_f32 v16, v16, v80
v_mfma_f32_32x32x16_bf16 v[48:63], a[8:11], v[132:135], v[48:63]
ds_read_b64_tr_b16 a[4:5], v8 offset:16384
ds_read_b64_tr_b16 a[6:7], v8 offset:17408
v_mul_f32 v17, v17, v81
v_mul_f32 v18, v18, v82
v_mul_f32 v19, v19, v83
v_cvt_pk_bf16_f32 v80, v16, v17
v_mfma_f32_32x32x16_bf16 v[64:79], a[12:15], v[132:135], v[64:79]
ds_read_b64_tr_b16 a[8:9], v7 offset:18432
ds_read_b64_tr_b16 a[10:11], v7 offset:19456
v_cvt_pk_bf16_f32 v81, v18, v19
v_fma_f32 v20, -v84, v84, s49
v_fma_f32 v21, -v85, v85, s49
s_waitcnt lgkmcnt(6)
v_mfma_f32_32x32x16_bf16 v[48:63], a[16:19], v[136:139], v[48:63]
ds_read_b64_tr_b16 a[12:13], v8 offset:18432
ds_read_b64_tr_b16 a[14:15], v8 offset:19456
v_fma_f32 v22, -v86, v86, s49
v_fma_f32 v23, -v87, v87, s49
v_mul_f32 v20, v20, v84
v_mul_f32 v21, v21, v85
v_mfma_f32_32x32x16_bf16 v[64:79], a[20:23], v[136:139], v[64:79]
ds_read_b64_tr_b16 a[16:17], v7 offset:20480
ds_read_b64_tr_b16 a[18:19], v7 offset:21504
v_mul_f32 v22, v22, v86
v_mul_f32 v23, v23, v87
v_exp_f32 v20, v20
v_mfma_f32_32x32x16_bf16 v[48:63], a[24:27], v[140:143], v[48:63]
ds_read_b64_tr_b16 a[20:21], v8 offset:20480
ds_read_b64_tr_b16 a[22:23], v8 offset:21504
v_exp_f32 v21, v21
v_exp_f32 v22, v22
v_mfma_f32_32x32x16_bf16 v[64:79], a[28:31], v[140:143], v[64:79]
ds_read_b64_tr_b16 a[24:25], v7 offset:22528
ds_read_b64_tr_b16 a[26:27], v7 offset:23552
v_exp_f32 v23, v23
v_add_f32 v20, 1.0, v20
s_waitcnt lgkmcnt(6)
v_mfma_f32_32x32x16_bf16 v[48:63], a[0:3], v[144:147], v[48:63]
ds_read_b64_tr_b16 a[28:29], v8 offset:22528
ds_read_b64_tr_b16 a[30:31], v8 offset:23552
s_waitcnt vmcnt(10)
s_barrier
v_add_f32 v21, 1.0, v21
v_add_f32 v22, 1.0, v22
v_add_f32 v23, 1.0, v23
v_mfma_f32_32x32x16_bf16 v[64:79], a[4:7], v[144:147], v[64:79]
ds_read_b64_tr_b16 a[0:1], v7 offset:24576
ds_read_b64_tr_b16 a[2:3], v7 offset:25600
v_rcp_f32 v20, v20
v_rcp_f32 v21, v21
v_mfma_f32_32x32x16_bf16 v[48:63], a[8:11], v[148:151], v[48:63]
ds_read_b64_tr_b16 a[4:5], v8 offset:24576
ds_read_b64_tr_b16 a[6:7], v8 offset:25600
v_rcp_f32 v22, v22
v_rcp_f32 v23, v23
v_mfma_f32_32x32x16_bf16 v[64:79], a[12:15], v[148:151], v[64:79]
ds_read_b64_tr_b16 a[8:9], v7 offset:26624
ds_read_b64_tr_b16 a[10:11], v7 offset:27648
v_mul_f32 v20, v20, v84
v_mul_f32 v21, v21, v85
v_mul_f32 v22, v22, v86
s_waitcnt lgkmcnt(6)
v_mfma_f32_32x32x16_bf16 v[48:63], a[16:19], v[152:155], v[48:63]
ds_read_b64_tr_b16 a[12:13], v8 offset:26624
ds_read_b64_tr_b16 a[14:15], v8 offset:27648
v_mul_f32 v23, v23, v87
v_cvt_pk_bf16_f32 v82, v20, v21
v_cvt_pk_bf16_f32 v83, v22, v23
v_fma_f32 v16, -v88, v88, s49
v_fma_f32 v17, -v89, v89, s49
v_mfma_f32_32x32x16_bf16 v[64:79], a[20:23], v[152:155], v[64:79]
ds_read_b64_tr_b16 a[16:17], v7 offset:28672
ds_read_b64_tr_b16 a[18:19], v7 offset:29696
v_fma_f32 v18, -v90, v90, s49
v_fma_f32 v19, -v91, v91, s49
v_mul_f32 v16, v16, v88
v_mul_f32 v17, v17, v89
v_mfma_f32_32x32x16_bf16 v[48:63], a[24:27], v[156:159], v[48:63]
ds_read_b64_tr_b16 a[20:21], v8 offset:28672
ds_read_b64_tr_b16 a[22:23], v8 offset:29696
v_mul_f32 v18, v18, v90
v_mul_f32 v19, v19, v91
v_exp_f32 v16, v16
v_mfma_f32_32x32x16_bf16 v[64:79], a[28:31], v[156:159], v[64:79]
ds_read_b64_tr_b16 a[24:25], v7 offset:30720
ds_read_b64_tr_b16 a[26:27], v7 offset:31744
v_exp_f32 v17, v17
v_exp_f32 v18, v18
s_waitcnt lgkmcnt(6)
v_mfma_f32_32x32x16_bf16 v[48:63], a[0:3], v[160:163], v[48:63]
ds_read_b64_tr_b16 a[28:29], v8 offset:30720
ds_read_b64_tr_b16 a[30:31], v8 offset:31744
v_exp_f32 v19, v19
v_add_f32 v16, 1.0, v16
v_add_f32 v17, 1.0, v17
v_mfma_f32_32x32x16_bf16 v[64:79], a[4:7], v[160:163], v[64:79]
ds_read_b64_tr_b16 a[0:1], v7 offset:32768
ds_read_b64_tr_b16 a[2:3], v7 offset:33792
v_add_f32 v18, 1.0, v18
v_add_f32 v19, 1.0, v19
v_rcp_f32 v16, v16
v_mfma_f32_32x32x16_bf16 v[48:63], a[8:11], v[164:167], v[48:63]
ds_read_b64_tr_b16 a[4:5], v8 offset:32768
ds_read_b64_tr_b16 a[6:7], v8 offset:33792
v_rcp_f32 v17, v17
v_rcp_f32 v18, v18
v_mfma_f32_32x32x16_bf16 v[64:79], a[12:15], v[164:167], v[64:79]
ds_read_b64_tr_b16 a[8:9], v7 offset:34816
ds_read_b64_tr_b16 a[10:11], v7 offset:35840
v_rcp_f32 v19, v19
v_mul_f32 v16, v16, v88
s_waitcnt lgkmcnt(6)
v_mfma_f32_32x32x16_bf16 v[48:63], a[16:19], v[168:171], v[48:63]
ds_read_b64_tr_b16 a[12:13], v8 offset:34816
ds_read_b64_tr_b16 a[14:15], v8 offset:35840
v_mul_f32 v17, v17, v89
v_mul_f32 v18, v18, v90
v_mul_f32 v19, v19, v91
v_cvt_pk_bf16_f32 v84, v16, v17
v_mfma_f32_32x32x16_bf16 v[64:79], a[20:23], v[168:171], v[64:79]
ds_read_b64_tr_b16 a[16:17], v7 offset:36864
ds_read_b64_tr_b16 a[18:19], v7 offset:37888
v_cvt_pk_bf16_f32 v85, v18, v19
v_fma_f32 v20, -v92, v92, s49
v_fma_f32 v21, -v93, v93, s49
v_fma_f32 v22, -v94, v94, s49
v_mfma_f32_32x32x16_bf16 v[48:63], a[24:27], v[172:175], v[48:63]
ds_read_b64_tr_b16 a[20:21], v8 offset:36864
ds_read_b64_tr_b16 a[22:23], v8 offset:37888
v_fma_f32 v23, -v95, v95, s49
v_mul_f32 v20, v20, v92
v_mul_f32 v21, v21, v93
v_mul_f32 v22, v22, v94
v_mul_f32 v23, v23, v95
v_mfma_f32_32x32x16_bf16 v[64:79], a[28:31], v[172:175], v[64:79]
ds_read_b64_tr_b16 a[24:25], v7 offset:38912
ds_read_b64_tr_b16 a[26:27], v7 offset:39936
v_exp_f32 v20, v20
s_waitcnt lgkmcnt(6)
v_mfma_f32_32x32x16_bf16 v[48:63], a[0:3], v[176:179], v[48:63]
ds_read_b64_tr_b16 a[28:29], v8 offset:38912
ds_read_b64_tr_b16 a[30:31], v8 offset:39936
v_exp_f32 v21, v21
v_exp_f32 v22, v22
v_mfma_f32_32x32x16_bf16 v[64:79], a[4:7], v[176:179], v[64:79]
ds_read_b64_tr_b16 a[0:1], v7 offset:40960
ds_read_b64_tr_b16 a[2:3], v7 offset:41984
v_exp_f32 v23, v23
v_add_f32 v20, 1.0, v20
v_add_f32 v21, 1.0, v21
v_add_f32 v22, 1.0, v22
v_mfma_f32_32x32x16_bf16 v[48:63], a[8:11], v[180:183], v[48:63]
ds_read_b64_tr_b16 a[4:5], v8 offset:40960
ds_read_b64_tr_b16 a[6:7], v8 offset:41984
v_add_f32 v23, 1.0, v23
v_rcp_f32 v20, v20
v_mfma_f32_32x32x16_bf16 v[64:79], a[12:15], v[180:183], v[64:79]
ds_read_b64_tr_b16 a[8:9], v7 offset:43008
ds_read_b64_tr_b16 a[10:11], v7 offset:44032
v_rcp_f32 v21, v21
s_waitcnt lgkmcnt(6)
v_mfma_f32_32x32x16_bf16 v[48:63], a[16:19], v[184:187], v[48:63]
ds_read_b64_tr_b16 a[12:13], v8 offset:43008
ds_read_b64_tr_b16 a[14:15], v8 offset:44032
v_rcp_f32 v22, v22
v_rcp_f32 v23, v23
v_mfma_f32_32x32x16_bf16 v[64:79], a[20:23], v[184:187], v[64:79]
ds_read_b64_tr_b16 a[16:17], v7 offset:45056
ds_read_b64_tr_b16 a[18:19], v7 offset:46080
v_mul_f32 v20, v20, v92
v_mul_f32 v21, v21, v93
v_mul_f32 v22, v22, v94
v_mul_f32 v23, v23, v95
v_cvt_pk_bf16_f32 v86, v20, v21
v_mfma_f32_32x32x16_bf16 v[48:63], a[24:27], v[188:191], v[48:63]
ds_read_b64_tr_b16 a[20:21], v8 offset:45056
ds_read_b64_tr_b16 a[22:23], v8 offset:46080
v_cvt_pk_bf16_f32 v87, v22, v23
buffer_store_dwordx4 v[80:83], v11, s[16:19], s41 offen offset:0 sc1
v_mfma_f32_32x32x16_bf16 v[64:79], a[28:31], v[188:191], v[64:79]
ds_read_b64_tr_b16 a[24:25], v7 offset:47104
ds_read_b64_tr_b16 a[26:27], v7 offset:48128
buffer_store_dwordx4 v[84:87], v11, s[16:19], s41 offen offset:1024 sc1
v_fma_f32 v16, -v96, v96, s49
s_waitcnt lgkmcnt(6)
v_mfma_f32_32x32x16_bf16 v[48:63], a[0:3], v[192:195], v[48:63]
ds_read_b64_tr_b16 a[28:29], v8 offset:47104
ds_read_b64_tr_b16 a[30:31], v8 offset:48128
s_waitcnt vmcnt(6)
s_barrier
v_fma_f32 v17, -v97, v97, s49
v_fma_f32 v18, -v98, v98, s49
v_fma_f32 v19, -v99, v99, s49
v_mfma_f32_32x32x16_bf16 v[64:79], a[4:7], v[192:195], v[64:79]
ds_read_b64_tr_b16 a[0:1], v12 offset:0
ds_read_b64_tr_b16 a[2:3], v12 offset:1024
v_mul_f32 v16, v16, v96
v_mul_f32 v17, v17, v97
v_mul_f32 v18, v18, v98
v_mul_f32 v19, v19, v99
v_mfma_f32_32x32x16_bf16 v[48:63], a[8:11], v[196:199], v[48:63]
ds_read_b64_tr_b16 a[4:5], v13 offset:0
ds_read_b64_tr_b16 a[6:7], v13 offset:1024
v_exp_f32 v16, v16
v_exp_f32 v17, v17
v_mfma_f32_32x32x16_bf16 v[64:79], a[12:15], v[196:199], v[64:79]
ds_read_b64_tr_b16 a[8:9], v12 offset:2048
ds_read_b64_tr_b16 a[10:11], v12 offset:3072
v_exp_f32 v18, v18
v_exp_f32 v19, v19
s_waitcnt lgkmcnt(6)
v_mfma_f32_32x32x16_bf16 v[48:63], a[16:19], v[200:203], v[48:63]
ds_read_b64_tr_b16 a[12:13], v13 offset:2048
ds_read_b64_tr_b16 a[14:15], v13 offset:3072
v_add_f32 v16, 1.0, v16
v_add_f32 v17, 1.0, v17
v_add_f32 v18, 1.0, v18
v_add_f32 v19, 1.0, v19
v_mfma_f32_32x32x16_bf16 v[64:79], a[20:23], v[200:203], v[64:79]
ds_read_b64_tr_b16 a[16:17], v12 offset:4096
ds_read_b64_tr_b16 a[18:19], v12 offset:5120
v_rcp_f32 v16, v16
v_rcp_f32 v17, v17
v_mfma_f32_32x32x16_bf16 v[48:63], a[24:27], v[204:207], v[48:63]
ds_read_b64_tr_b16 a[20:21], v13 offset:4096
ds_read_b64_tr_b16 a[22:23], v13 offset:5120
v_rcp_f32 v18, v18
v_rcp_f32 v19, v19
v_mfma_f32_32x32x16_bf16 v[64:79], a[28:31], v[204:207], v[64:79]
ds_read_b64_tr_b16 a[24:25], v12 offset:6144
ds_read_b64_tr_b16 a[26:27], v12 offset:7168
v_mul_f32 v16, v16, v96
v_mul_f32 v17, v17, v97
v_mul_f32 v18, v18, v98
v_mul_f32 v19, v19, v99
s_waitcnt lgkmcnt(6)
v_mfma_f32_32x32x16_bf16 v[48:63], a[0:3], v[208:211], v[48:63]
ds_read_b64_tr_b16 a[28:29], v13 offset:6144
ds_read_b64_tr_b16 a[30:31], v13 offset:7168
v_cvt_pk_bf16_f32 v96, v16, v17
v_cvt_pk_bf16_f32 v97, v18, v19
v_fma_f32 v20, -v100, v100, s49
v_fma_f32 v21, -v101, v101, s49
v_mfma_f32_32x32x16_bf16 v[64:79], a[4:7], v[208:211], v[64:79]
ds_read_b64_tr_b16 a[0:1], v12 offset:8192
ds_read_b64_tr_b16 a[2:3], v12 offset:9216
v_fma_f32 v22, -v102, v102, s49
v_fma_f32 v23, -v103, v103, s49
v_mul_f32 v20, v20, v100
v_mul_f32 v21, v21, v101
v_mfma_f32_32x32x16_bf16 v[48:63], a[8:11], v[212:215], v[48:63]
ds_read_b64_tr_b16 a[4:5], v13 offset:8192
ds_read_b64_tr_b16 a[6:7], v13 offset:9216
v_mul_f32 v22, v22, v102
v_mul_f32 v23, v23, v103
v_exp_f32 v20, v20
v_mfma_f32_32x32x16_bf16 v[64:79], a[12:15], v[212:215], v[64:79]
ds_read_b64_tr_b16 a[8:9], v12 offset:10240
ds_read_b64_tr_b16 a[10:11], v12 offset:11264
v_exp_f32 v21, v21
s_waitcnt lgkmcnt(6)
v_mfma_f32_32x32x16_bf16 v[48:63], a[16:19], v[216:219], v[48:63]
ds_read_b64_tr_b16 a[12:13], v13 offset:10240
ds_read_b64_tr_b16 a[14:15], v13 offset:11264
v_exp_f32 v22, v22
v_exp_f32 v23, v23
v_mfma_f32_32x32x16_bf16 v[64:79], a[20:23], v[216:219], v[64:79]
ds_read_b64_tr_b16 a[16:17], v12 offset:12288
ds_read_b64_tr_b16 a[18:19], v12 offset:13312
v_add_f32 v20, 1.0, v20
v_add_f32 v21, 1.0, v21
v_add_f32 v22, 1.0, v22
v_add_f32 v23, 1.0, v23
v_mfma_f32_32x32x16_bf16 v[48:63], a[24:27], v[220:223], v[48:63]
ds_read_b64_tr_b16 a[20:21], v13 offset:12288
ds_read_b64_tr_b16 a[22:23], v13 offset:13312
v_rcp_f32 v20, v20
v_rcp_f32 v21, v21
v_mfma_f32_32x32x16_bf16 v[64:79], a[28:31], v[220:223], v[64:79]
ds_read_b64_tr_b16 a[24:25], v12 offset:14336
ds_read_b64_tr_b16 a[26:27], v12 offset:15360
v_rcp_f32 v22, v22
s_waitcnt lgkmcnt(6)
v_mfma_f32_32x32x16_bf16 v[48:63], a[0:3], v[224:227], v[48:63]
ds_read_b64_tr_b16 a[28:29], v13 offset:14336
ds_read_b64_tr_b16 a[30:31], v13 offset:15360
v_rcp_f32 v23, v23
v_mul_f32 v20, v20, v100
v_mul_f32 v21, v21, v101
v_mfma_f32_32x32x16_bf16 v[64:79], a[4:7], v[224:227], v[64:79]
ds_read_b64_tr_b16 a[0:1], v12 offset:16384
ds_read_b64_tr_b16 a[2:3], v12 offset:17408
v_mul_f32 v22, v22, v102
v_mul_f32 v23, v23, v103
v_cvt_pk_bf16_f32 v98, v20, v21
v_cvt_pk_bf16_f32 v99, v22, v23
v_fma_f32 v16, -v104, v104, s49
v_mfma_f32_32x32x16_bf16 v[48:63], a[8:11], v[228:231], v[48:63]
ds_read_b64_tr_b16 a[4:5], v13 offset:16384
ds_read_b64_tr_b16 a[6:7], v13 offset:17408
v_fma_f32 v17, -v105, v105, s49
v_fma_f32 v18, -v106, v106, s49
v_fma_f32 v19, -v107, v107, s49
v_mul_f32 v16, v16, v104
v_mfma_f32_32x32x16_bf16 v[64:79], a[12:15], v[228:231], v[64:79]
ds_read_b64_tr_b16 a[8:9], v12 offset:18432
ds_read_b64_tr_b16 a[10:11], v12 offset:19456
v_mul_f32 v17, v17, v105
v_mul_f32 v18, v18, v106
v_mul_f32 v19, v19, v107
s_waitcnt lgkmcnt(6)
v_mfma_f32_32x32x16_bf16 v[48:63], a[16:19], v[232:235], v[48:63]
ds_read_b64_tr_b16 a[12:13], v13 offset:18432
ds_read_b64_tr_b16 a[14:15], v13 offset:19456
v_exp_f32 v16, v16
v_exp_f32 v17, v17
v_mfma_f32_32x32x16_bf16 v[64:79], a[20:23], v[232:235], v[64:79]
ds_read_b64_tr_b16 a[16:17], v12 offset:20480
ds_read_b64_tr_b16 a[18:19], v12 offset:21504
v_exp_f32 v18, v18
v_exp_f32 v19, v19
v_mfma_f32_32x32x16_bf16 v[48:63], a[24:27], v[236:239], v[48:63]
ds_read_b64_tr_b16 a[20:21], v13 offset:20480
ds_read_b64_tr_b16 a[22:23], v13 offset:21504
v_add_f32 v16, 1.0, v16
v_add_f32 v17, 1.0, v17
v_add_f32 v18, 1.0, v18
v_add_f32 v19, 1.0, v19
v_mfma_f32_32x32x16_bf16 v[64:79], a[28:31], v[236:239], v[64:79]
ds_read_b64_tr_b16 a[24:25], v12 offset:22528
ds_read_b64_tr_b16 a[26:27], v12 offset:23552
v_rcp_f32 v16, v16
s_waitcnt lgkmcnt(6)
v_mfma_f32_32x32x16_bf16 v[48:63], a[0:3], v[240:243], v[48:63]
ds_read_b64_tr_b16 a[28:29], v13 offset:22528
ds_read_b64_tr_b16 a[30:31], v13 offset:23552
v_rcp_f32 v17, v17
v_rcp_f32 v18, v18
v_mfma_f32_32x32x16_bf16 v[64:79], a[4:7], v[240:243], v[64:79]
v_rcp_f32 v19, v19
v_mul_f32 v16, v16, v104
v_mul_f32 v17, v17, v105
v_mul_f32 v18, v18, v106
v_mul_f32 v19, v19, v107
v_mfma_f32_32x32x16_bf16 v[48:63], a[8:11], v[244:247], v[48:63]
v_cvt_pk_bf16_f32 v100, v16, v17
v_cvt_pk_bf16_f32 v101, v18, v19
v_fma_f32 v20, -v108, v108, s49
v_fma_f32 v21, -v109, v109, s49
v_fma_f32 v22, -v110, v110, s49
v_fma_f32 v23, -v111, v111, s49
v_mfma_f32_32x32x16_bf16 v[64:79], a[12:15], v[244:247], v[64:79]
v_mul_f32 v20, v20, v108
v_mul_f32 v21, v21, v109
v_mul_f32 v22, v22, v110
v_mul_f32 v23, v23, v111
v_exp_f32 v20, v20
s_waitcnt lgkmcnt(0)
v_mfma_f32_32x32x16_bf16 v[48:63], a[16:19], v[248:251], v[48:63]
v_exp_f32 v21, v21
v_exp_f32 v22, v22
v_exp_f32 v23, v23
v_mfma_f32_32x32x16_bf16 v[64:79], a[20:23], v[248:251], v[64:79]
v_add_f32 v20, 1.0, v20
v_add_f32 v21, 1.0, v21
v_add_f32 v22, 1.0, v22
v_add_f32 v23, 1.0, v23
v_rcp_f32 v20, v20
v_mfma_f32_32x32x16_bf16 v[48:63], a[24:27], v[252:255], v[48:63]
v_rcp_f32 v21, v21
v_rcp_f32 v22, v22
v_rcp_f32 v23, v23
v_mul_f32 v20, v20, v108
v_mul_f32 v21, v21, v109
v_mul_f32 v22, v22, v110
v_mul_f32 v23, v23, v111
v_cvt_pk_bf16_f32 v102, v20, v21
v_cvt_pk_bf16_f32 v103, v22, v23
buffer_store_dwordx4 v[96:99], v11, s[16:19], s41 offen offset:2048 sc1
buffer_store_dwordx4 v[100:103], v11, s[16:19], s41 offen offset:3072 sc1
s_add_u32 s41, s41, 4096
v_mfma_f32_32x32x16_bf16 v[64:79], a[28:31], v[252:255], v[64:79]
v_fma_f32 v16, -v48, v48, s49
v_fma_f32 v17, -v49, v49, s49
v_fma_f32 v18, -v50, v50, s49
v_fma_f32 v19, -v51, v51, s49
v_mul_f32 v16, v16, v48
v_mul_f32 v17, v17, v49
v_mul_f32 v18, v18, v50
v_mul_f32 v19, v19, v51
v_exp_f32 v16, v16
v_exp_f32 v17, v17
v_exp_f32 v18, v18
v_exp_f32 v19, v19
v_add_f32 v16, 1.0, v16
v_add_f32 v17, 1.0, v17
v_add_f32 v18, 1.0, v18
v_add_f32 v19, 1.0, v19
v_rcp_f32 v16, v16
v_rcp_f32 v17, v17
v_rcp_f32 v18, v18
v_rcp_f32 v19, v19
v_mul_f32 v16, v16, v48
v_mul_f32 v17, v17, v49
v_mul_f32 v18, v18, v50
v_mul_f32 v19, v19, v51
v_cvt_pk_bf16_f32 v48, v16, v17
v_cvt_pk_bf16_f32 v49, v18, v19
v_fma_f32 v20, -v52, v52, s49
v_fma_f32 v21, -v53, v53, s49
v_fma_f32 v22, -v54, v54, s49
v_fma_f32 v23, -v55, v55, s49
v_mul_f32 v20, v20, v52
v_mul_f32 v21, v21, v53
v_mul_f32 v22, v22, v54
v_mul_f32 v23, v23, v55
v_exp_f32 v20, v20
v_exp_f32 v21, v21
v_exp_f32 v22, v22
v_exp_f32 v23, v23
v_add_f32 v20, 1.0, v20
v_add_f32 v21, 1.0, v21
v_add_f32 v22, 1.0, v22
v_add_f32 v23, 1.0, v23
v_rcp_f32 v20, v20
v_rcp_f32 v21, v21
v_rcp_f32 v22, v22
v_rcp_f32 v23, v23
v_mul_f32 v20, v20, v52
v_mul_f32 v21, v21, v53
v_mul_f32 v22, v22, v54
v_mul_f32 v23, v23, v55
v_cvt_pk_bf16_f32 v50, v20, v21
v_cvt_pk_bf16_f32 v51, v22, v23
v_fma_f32 v16, -v56, v56, s49
v_fma_f32 v17, -v57, v57, s49
v_fma_f32 v18, -v58, v58, s49
v_fma_f32 v19, -v59, v59, s49
v_mul_f32 v16, v16, v56
v_mul_f32 v17, v17, v57
v_mul_f32 v18, v18, v58
v_mul_f32 v19, v19, v59
v_exp_f32 v16, v16
v_exp_f32 v17, v17
v_exp_f32 v18, v18
v_exp_f32 v19, v19
v_add_f32 v16, 1.0, v16
v_add_f32 v17, 1.0, v17
v_add_f32 v18, 1.0, v18
v_add_f32 v19, 1.0, v19
v_rcp_f32 v16, v16
v_rcp_f32 v17, v17
v_rcp_f32 v18, v18
v_rcp_f32 v19, v19
v_mul_f32 v16, v16, v56
v_mul_f32 v17, v17, v57
v_mul_f32 v18, v18, v58
v_mul_f32 v19, v19, v59
v_cvt_pk_bf16_f32 v52, v16, v17
v_cvt_pk_bf16_f32 v53, v18, v19
v_fma_f32 v20, -v60, v60, s49
v_fma_f32 v21, -v61, v61, s49
v_fma_f32 v22, -v62, v62, s49
v_fma_f32 v23, -v63, v63, s49
v_mul_f32 v20, v20, v60
v_mul_f32 v21, v21, v61
v_mul_f32 v22, v22, v62
v_mul_f32 v23, v23, v63
v_exp_f32 v20, v20
v_exp_f32 v21, v21
v_exp_f32 v22, v22
v_exp_f32 v23, v23
v_add_f32 v20, 1.0, v20
v_add_f32 v21, 1.0, v21
v_add_f32 v22, 1.0, v22
v_add_f32 v23, 1.0, v23
v_rcp_f32 v20, v20
v_rcp_f32 v21, v21
v_rcp_f32 v22, v22
v_rcp_f32 v23, v23
v_mul_f32 v20, v20, v60
v_mul_f32 v21, v21, v61
v_mul_f32 v22, v22, v62
v_mul_f32 v23, v23, v63
v_cvt_pk_bf16_f32 v54, v20, v21
v_cvt_pk_bf16_f32 v55, v22, v23
buffer_store_dwordx4 v[48:51], v11, s[16:19], s41 offen offset:0 sc1
buffer_store_dwordx4 v[52:55], v11, s[16:19], s41 offen offset:1024 sc1
v_fma_f32 v16, -v64, v64, s49
v_fma_f32 v17, -v65, v65, s49
v_fma_f32 v18, -v66, v66, s49
v_fma_f32 v19, -v67, v67, s49
v_mul_f32 v16, v16, v64
v_mul_f32 v17, v17, v65
v_mul_f32 v18, v18, v66
v_mul_f32 v19, v19, v67
v_exp_f32 v16, v16
v_exp_f32 v17, v17
v_exp_f32 v18, v18
v_exp_f32 v19, v19
v_add_f32 v16, 1.0, v16
v_add_f32 v17, 1.0, v17
v_add_f32 v18, 1.0, v18
v_add_f32 v19, 1.0, v19
v_rcp_f32 v16, v16
v_rcp_f32 v17, v17
v_rcp_f32 v18, v18
v_rcp_f32 v19, v19
v_mul_f32 v16, v16, v64
v_mul_f32 v17, v17, v65
v_mul_f32 v18, v18, v66
v_mul_f32 v19, v19, v67
v_cvt_pk_bf16_f32 v64, v16, v17
v_cvt_pk_bf16_f32 v65, v18, v19
v_fma_f32 v20, -v68, v68, s49
v_fma_f32 v21, -v69, v69, s49
v_fma_f32 v22, -v70, v70, s49
v_fma_f32 v23, -v71, v71, s49
v_mul_f32 v20, v20, v68
v_mul_f32 v21, v21, v69
v_mul_f32 v22, v22, v70
v_mul_f32 v23, v23, v71
v_exp_f32 v20, v20
v_exp_f32 v21, v21
v_exp_f32 v22, v22
v_exp_f32 v23, v23
v_add_f32 v20, 1.0, v20
v_add_f32 v21, 1.0, v21
v_add_f32 v22, 1.0, v22
v_add_f32 v23, 1.0, v23
v_rcp_f32 v20, v20
v_rcp_f32 v21, v21
v_rcp_f32 v22, v22
v_rcp_f32 v23, v23
v_mul_f32 v20, v20, v68
v_mul_f32 v21, v21, v69
v_mul_f32 v22, v22, v70
v_mul_f32 v23, v23, v71
v_cvt_pk_bf16_f32 v66, v20, v21
v_cvt_pk_bf16_f32 v67, v22, v23
v_fma_f32 v16, -v72, v72, s49
v_fma_f32 v17, -v73, v73, s49
v_fma_f32 v18, -v74, v74, s49
v_fma_f32 v19, -v75, v75, s49
v_mul_f32 v16, v16, v72
v_mul_f32 v17, v17, v73
v_mul_f32 v18, v18, v74
v_mul_f32 v19, v19, v75
v_exp_f32 v16, v16
v_exp_f32 v17, v17
v_exp_f32 v18, v18
v_exp_f32 v19, v19
v_add_f32 v16, 1.0, v16
v_add_f32 v17, 1.0, v17
v_add_f32 v18, 1.0, v18
v_add_f32 v19, 1.0, v19
v_rcp_f32 v16, v16
v_rcp_f32 v17, v17
v_rcp_f32 v18, v18
v_rcp_f32 v19, v19
v_mul_f32 v16, v16, v72
v_mul_f32 v17, v17, v73
v_mul_f32 v18, v18, v74
v_mul_f32 v19, v19, v75
v_cvt_pk_bf16_f32 v68, v16, v17
v_cvt_pk_bf16_f32 v69, v18, v19
v_fma_f32 v20, -v76, v76, s49
v_fma_f32 v21, -v77, v77, s49
v_fma_f32 v22, -v78, v78, s49
v_fma_f32 v23, -v79, v79, s49
v_mul_f32 v20, v20, v76
v_mul_f32 v21, v21, v77
v_mul_f32 v22, v22, v78
v_mul_f32 v23, v23, v79
v_exp_f32 v20, v20
v_exp_f32 v21, v21
v_exp_f32 v22, v22
v_exp_f32 v23, v23
v_add_f32 v20, 1.0, v20
v_add_f32 v21, 1.0, v21
v_add_f32 v22, 1.0, v22
v_add_f32 v23, 1.0, v23
v_rcp_f32 v20, v20
v_rcp_f32 v21, v21
v_rcp_f32 v22, v22
v_rcp_f32 v23, v23
v_mul_f32 v20, v20, v76
v_mul_f32 v21, v21, v77
v_mul_f32 v22, v22, v78
v_mul_f32 v23, v23, v79
v_cvt_pk_bf16_f32 v70, v20, v21
v_cvt_pk_bf16_f32 v71, v22, v23
buffer_store_dwordx4 v[64:67], v11, s[16:19], s41 offen offset:2048 sc1
buffer_store_dwordx4 v[68:71], v11, s[16:19], s41 offen offset:3072 sc1
s_add_u32 s41, s41, 4096
L_ka_end:
s_endpgm
L_ka_pf:
s_cmp_ge_u32 s2, 256
s_cbranch_scc1 L_ka_pf_end
s_load_dwordx2 s[4:5], s[0:1], 48
s_load_dwordx2 s[36:37], s[0:1], 40
s_load_dwordx2 s[38:39], s[0:1], 16
s_load_dwordx2 s[40:41], s[0:1], 80
s_load_dwordx2 s[68:69], s[0:1], 56
s_load_dwordx2 s[72:73], s[0:1], 32
s_load_dwordx2 s[60:61], s[0:1], 72
v_and_b32 v1, 63, v0
v_lshrrev_b32 v2, 6, v0
s_and_b32 s3, s2, 7
v_readfirstlane_b32 s24, v2
s_sub_u32 s25, s2, 192
s_lshr_b32 s26, s25, 3
s_and_b32 s28, s25, 3
s_lshr_b32 s29, s25, 2
s_lshl_b32 s27, s26, 2
s_add_u32 s27, s27, s24
v_add_u32 v3, 0, v1
v_mul_u32_u24 v4, 1821, v3
v_lshrrev_b32 v4, 16, v4
v_mul_u32_u24 v5, 36, v4
v_sub_u32 v3, v3, v5
v_mul_u32_u24 v5, 1152, v4
v_lshl_add_u32 v212, v3, 4, v5
v_mul_u32_u24 v4, 9216, v4
v_lshl_add_u32 v20, v3, 4, v4
v_add_u32 v3, 64, v1
v_mul_u32_u24 v4, 1821, v3
v_lshrrev_b32 v4, 16, v4
v_mul_u32_u24 v5, 36, v4
v_sub_u32 v3, v3, v5
v_mul_u32_u24 v5, 1152, v4
v_lshl_add_u32 v213, v3, 4, v5
v_mul_u32_u24 v4, 9216, v4
v_lshl_add_u32 v21, v3, 4, v4
v_add_u32 v3, 128, v1
v_mul_u32_u24 v4, 1821, v3
v_lshrrev_b32 v4, 16, v4
v_mul_u32_u24 v5, 36, v4
v_sub_u32 v3, v3, v5
v_mul_u32_u24 v5, 1152, v4
v_lshl_add_u32 v214, v3, 4, v5
v_mul_u32_u24 v4, 9216, v4
v_lshl_add_u32 v22, v3, 4, v4
v_add_u32 v3, 192, v1
v_mul_u32_u24 v4, 1821, v3
v_lshrrev_b32 v4, 16, v4
v_mul_u32_u24 v5, 36, v4
v_sub_u32 v3, v3, v5
v_mul_u32_u24 v5, 1152, v4
v_lshl_add_u32 v215, v3, 4, v5
v_mul_u32_u24 v4, 9216, v4
v_lshl_add_u32 v23, v3, 4, v4
v_add_u32 v3, 256, v1
v_mul_u32_u24 v4, 1821, v3
v_lshrrev_b32 v4, 16, v4
v_mul_u32_u24 v5, 36, v4
v_sub_u32 v3, v3, v5
v_mul_u32_u24 v5, 1152, v4
v_lshl_add_u32 v216, v3, 4, v5
v_mul_u32_u24 v4, 9216, v4
v_lshl_add_u32 v24, v3, 4, v4
v_add_u32 v3, 320, v1
v_mul_u32_u24 v4, 1821, v3
v_lshrrev_b32 v4, 16, v4
v_mul_u32_u24 v5, 36, v4
v_sub_u32 v3, v3, v5
v_mul_u32_u24 v5, 1152, v4
v_lshl_add_u32 v217, v3, 4, v5
v_mul_u32_u24 v4, 9216, v4
v_lshl_add_u32 v25, v3, 4, v4
v_add_u32 v3, 384, v1
v_mul_u32_u24 v4, 1821, v3
v_lshrrev_b32 v4, 16, v4
v_mul_u32_u24 v5, 36, v4
v_sub_u32 v3, v3, v5
v_mul_u32_u24 v5, 1152, v4
v_lshl_add_u32 v218, v3, 4, v5
v_mul_u32_u24 v4, 9216, v4
v_lshl_add_u32 v26, v3, 4, v4
v_add_u32 v3, 448, v1
v_mul_u32_u24 v4, 1821, v3
v_lshrrev_b32 v4, 16, v4
v_mul_u32_u24 v5, 36, v4
v_sub_u32 v3, v3, v5
v_mul_u32_u24 v5, 1152, v4
v_lshl_add_u32 v219, v3, 4, v5
v_mul_u32_u24 v4, 9216, v4
v_lshl_add_u32 v27, v3, 4, v4
v_add_u32 v3, 512, v1
v_mul_u32_u24 v4, 1821, v3
v_lshrrev_b32 v4, 16, v4
v_mul_u32_u24 v5, 36, v4
v_sub_u32 v3, v3, v5
v_mul_u32_u24 v5, 1152, v4
v_lshl_add_u32 v220, v3, 4, v5
v_mul_u32_u24 v4, 9216, v4
v_lshl_add_u32 v28, v3, 4, v4
s_mul_i32 s30, s28, 1327104
s_mul_i32 s32, s29, 576
s_add_u32 s30, s30, s32
s_mul_i32 s32, s24, 147456
s_add_u32 s30, s30, s32
s_mul_i32 s34, s24, 9216
s_waitcnt lgkmcnt(0)
s_mov_b32 s8, s4
s_mov_b32 s9, s5
s_mov_b32 s10, 0x510000
s_mov_b32 s11, 0x00020000
s_mov_b32 s16, s36
s_mov_b32 s17, s37
s_mov_b32 s18, 0xa2000
s_mov_b32 s19, 0x00020000
s_mov_b32 s12, s38
s_mov_b32 s13, s39
s_mov_b32 s14, 0xa2000
s_mov_b32 s15, 0x00020000
s_add_u32 s44, s40, 0x2600000
s_addc_u32 s45, s41, 0
s_mov_b32 s46, 0xa20000
s_mov_b32 s47, 0x00020000
s_add_u32 s20, s40, 0xc000
s_addc_u32 s21, s41, 0
s_mov_b32 s22, 0x12000
s_mov_b32 s23, 0x00020000
s_add_u32 s64, s40, 0xc0000
s_addc_u32 s65, s41, 0
s_mov_b32 s66, 0x30000
s_mov_b32 s67, 0x00020000
s_lshl_b32 s42, s27, 1
s_getpc_b64 s[56:57]
L_ka_pc:
s_sub_u32 s56, s56, L_ka_pc-L_code_begin
s_subb_u32 s57, s57, 0
s_mov_b32 s58, L_code_end-L_code_begin
s_mov_b32 s59, 0x00020000
v_lshlrev_b32 v6, 6, v1
s_lshl_b32 s42, s42, 12
buffer_load_dword v6, v6, s[56:59], s42 offen
v_lshlrev_b32 v7, 6, v1
s_add_u32 s42, s42, 4096
buffer_load_dword v7, v7, s[56:59], s42 offen
s_cmp_eq_u32 s24, 3
s_cbranch_scc1 L_ka_pf_3
s_add_u32 m0, s34, 0
s_nop 0
buffer_load_dwordx4 v20, s[8:11], s30 offen lds
s_add_u32 m0, s34, 1024
s_nop 0
buffer_load_dwordx4 v21, s[8:11], s30 offen lds
s_add_u32 m0, s34, 2048
s_nop 0
buffer_load_dwordx4 v22, s[8:11], s30 offen lds
s_add_u32 m0, s34, 3072
s_nop 0
buffer_load_dwordx4 v23, s[8:11], s30 offen lds
s_add_u32 m0, s34, 4096
s_nop 0
buffer_load_dwordx4 v24, s[8:11], s30 offen lds
s_add_u32 m0, s34, 5120
s_nop 0
buffer_load_dwordx4 v25, s[8:11], s30 offen lds
s_add_u32 m0, s34, 6144
s_nop 0
buffer_load_dwordx4 v26, s[8:11], s30 offen lds
s_add_u32 m0, s34, 7168
s_nop 0
buffer_load_dwordx4 v27, s[8:11], s30 offen lds
s_add_u32 m0, s34, 8192
s_nop 0
buffer_load_dwordx4 v28, s[8:11], s30 offen lds
s_add_u32 s30, s30, 442368
s_add_u32 m0, s34, 27648
s_nop 0
buffer_load_dwordx4 v20, s[8:11], s30 offen lds
s_add_u32 m0, s34, 28672
s_nop 0
buffer_load_dwordx4 v21, s[8:11], s30 offen lds
s_add_u32 m0, s34, 29696
s_nop 0
buffer_load_dwordx4 v22, s[8:11], s30 offen lds
s_add_u32 m0, s34, 30720
s_nop 0
buffer_load_dwordx4 v23, s[8:11], s30 offen lds
s_add_u32 m0, s34, 31744
s_nop 0
buffer_load_dwordx4 v24, s[8:11], s30 offen lds
s_add_u32 m0, s34, 32768
s_nop 0
buffer_load_dwordx4 v25, s[8:11], s30 offen lds
s_add_u32 m0, s34, 33792
s_nop 0
buffer_load_dwordx4 v26, s[8:11], s30 offen lds
s_add_u32 m0, s34, 34816
s_nop 0
buffer_load_dwordx4 v27, s[8:11], s30 offen lds
s_add_u32 m0, s34, 35840
s_nop 0
buffer_load_dwordx4 v28, s[8:11], s30 offen lds
s_add_u32 s30, s30, 442368
s_add_u32 m0, s34, 55296
s_nop 0
buffer_load_dwordx4 v20, s[8:11], s30 offen lds
s_add_u32 m0, s34, 56320
s_nop 0
buffer_load_dwordx4 v21, s[8:11], s30 offen lds
s_add_u32 m0, s34, 57344
s_nop 0
buffer_load_dwordx4 v22, s[8:11], s30 offen lds
s_add_u32 m0, s34, 58368
s_nop 0
buffer_load_dwordx4 v23, s[8:11], s30 offen lds
s_add_u32 m0, s34, 59392
s_nop 0
buffer_load_dwordx4 v24, s[8:11], s30 offen lds
s_add_u32 m0, s34, 60416
s_nop 0
buffer_load_dwordx4 v25, s[8:11], s30 offen lds
s_add_u32 m0, s34, 61440
s_nop 0
buffer_load_dwordx4 v26, s[8:11], s30 offen lds
s_add_u32 m0, s34, 62464
s_nop 0
buffer_load_dwordx4 v27, s[8:11], s30 offen lds
s_add_u32 m0, s34, 63488
s_nop 0
buffer_load_dwordx4 v28, s[8:11], s30 offen lds
L_ka_pf_3:
s_mul_i32 s42, s25, 3072
v_lshlrev_b32 v3, 7, v0
v_mov_b32 v4, 0x80000000
v_cmp_gt_u32 vcc, 24, v0
s_nop 1
v_cndmask_b32 v3, v4, v3, vcc
v_mov_b32 v16, 0
buffer_store_dword v16, v3, s[64:67], s42 offen sc1
v_mul_u32_u24 v3, 205, v1
v_lshrrev_b32 v3, 11, v3
v_mul_u32_u24 v9, 10, v3
v_sub_u32 v9, v1, v9
v_min_u32 v3, 5, v3
s_and_b32 s33, s3, 1
s_lshl_b32 s33, s33, 9
v_lshlrev_b32 v10, 6, v9
v_add_u32 v10, s33, v10
v_lshlrev_b32 v9, 6, v9
v_add_u32 v11, 512, v9
v_cmp_gt_u32 vcc, 512, v9
s_nop 1
v_cndmask_b32 v9, v11, v10, vcc
v_mul_u32_u24 v3, 1152, v3
v_add_u32 v3, v3, v9
s_mul_i32 s33, s27, 20736
buffer_load_dword v29, v3, s[16:19], s33 offen
s_add_u32 s33, s33, 6912
buffer_load_dword v30, v3, s[16:19], s33 offen
s_add_u32 s33, s33, 6912
buffer_load_dword v31, v3, s[16:19], s33 offen
s_add_u32 s33, s33, 6912
s_lshl_b32 s32, s25, 2
s_add_u32 s32, s32, s24
s_mul_i32 s32, s32, 2592
v_lshlrev_b32 v9, 6, v1
v_min_u32 v9, 2560, v9
buffer_load_dword v19, v9, s[12:15], s32 offen
v_bfe_u32 v3, v1, 2, 2
v_lshrrev_b32 v4, 5, v1
v_lshl_add_u32 v3, v4, 2, v3
v_mul_u32_u24 v3, 576, v3
v_bfe_u32 v4, v1, 4, 1
v_lshl_add_u32 v3, v4, 5, v3
v_and_b32 v4, 3, v1
v_lshl_add_u32 v3, v4, 3, v3
s_lshl_b32 s32, s24, 6
v_add_u32 v12, s32, v3
v_add_u32 v13, 36864, v12
v_add_u32 v14, s34, v3
v_lshlrev_b32 v11, 4, v1
v_mov_b32 v17, 0x3f803f80
v_lshlrev_b32 v10, 2, v0
v_add_u32 v10, 82944, v10
v_lshlrev_b32 v15, 2, v1
s_mul_i32 s32, s29, 9
s_add_u32 s32, s32, s24
s_lshl_b32 s53, s32, 7
s_lshr_b32 s33, s32, 1
s_mul_i32 s33, s33, 73728
s_and_b32 s32, s32, 1
s_lshl_b32 s32, s32, 10
s_add_u32 s33, s33, s32
s_mul_i32 s32, s28, 18432
s_add_u32 s50, s33, s32
s_mul_i32 s32, s28, 18432
s_add_u32 s53, s53, s32
s_mul_i32 s32, s29, 9
s_add_u32 s32, s32, s24
s_add_u32 s32, s32, 4
s_lshl_b32 s54, s32, 7
s_lshr_b32 s33, s32, 1
s_mul_i32 s33, s33, 73728
s_and_b32 s32, s32, 1
s_lshl_b32 s32, s32, 10
s_add_u32 s33, s33, s32
s_mul_i32 s32, s28, 18432
s_add_u32 s51, s33, s32
s_mul_i32 s32, s28, 18432
s_add_u32 s54, s54, s32
s_mul_i32 s32, s29, 9
s_add_u32 s32, s32, 8
s_lshl_b32 s55, s32, 7
s_lshr_b32 s33, s32, 1
s_mul_i32 s33, s33, 73728
s_and_b32 s32, s32, 1
s_lshl_b32 s32, s32, 10
s_add_u32 s33, s33, s32
s_mul_i32 s32, s28, 18432
s_add_u32 s52, s33, s32
s_mul_i32 s32, s28, 18432
s_add_u32 s55, s55, s32
s_lshl_b32 s32, s24, 11
s_add_u32 s52, s52, s32
s_waitcnt vmcnt(0) lgkmcnt(0)
s_barrier
ds_read_b64_tr_b16 v[32:33], v12 offset:0
ds_read_b64_tr_b16 v[34:35], v12 offset:4608
ds_read_b64_tr_b16 v[36:37], v12 offset:9216
ds_read_b64_tr_b16 v[38:39], v12 offset:13824
ds_read_b64_tr_b16 v[40:41], v12 offset:18432
ds_read_b64_tr_b16 v[42:43], v12 offset:23040
ds_read_b64_tr_b16 v[44:45], v12 offset:27648
ds_read_b64_tr_b16 v[46:47], v12 offset:32256
ds_read_b64_tr_b16 v[48:49], v13 offset:0
ds_read_b64_tr_b16 v[50:51], v13 offset:4608
ds_read_b64_tr_b16 v[52:53], v13 offset:9216
ds_read_b64_tr_b16 v[54:55], v13 offset:13824
ds_read_b64_tr_b16 v[56:57], v13 offset:18432
ds_read_b64_tr_b16 v[58:59], v13 offset:23040
ds_read_b64_tr_b16 v[60:61], v13 offset:27648
ds_read_b64_tr_b16 v[62:63], v13 offset:32256
ds_read_b64_tr_b16 v[64:65], v13 offset:36864
ds_read_b64_tr_b16 v[66:67], v13 offset:41472
ds_read_b64_tr_b16 v[68:69], v12 offset:256
ds_read_b64_tr_b16 v[70:71], v12 offset:4864
ds_read_b64_tr_b16 v[72:73], v12 offset:9472
ds_read_b64_tr_b16 v[74:75], v12 offset:14080
ds_read_b64_tr_b16 v[76:77], v12 offset:18688
ds_read_b64_tr_b16 v[78:79], v12 offset:23296
ds_read_b64_tr_b16 v[80:81], v12 offset:27904
ds_read_b64_tr_b16 v[82:83], v12 offset:32512
ds_read_b64_tr_b16 v[84:85], v13 offset:256
ds_read_b64_tr_b16 v[86:87], v13 offset:4864
ds_read_b64_tr_b16 v[88:89], v13 offset:9472
ds_read_b64_tr_b16 v[90:91], v13 offset:14080
ds_read_b64_tr_b16 v[92:93], v13 offset:18688
ds_read_b64_tr_b16 v[94:95], v13 offset:23296
ds_read_b64_tr_b16 v[96:97], v13 offset:27904
ds_read_b64_tr_b16 v[98:99], v13 offset:32512
ds_read_b64_tr_b16 v[100:101], v13 offset:37120
ds_read_b64_tr_b16 v[102:103], v13 offset:41728
ds_read_b64_tr_b16 v[104:105], v14 offset:512
ds_read_b64_tr_b16 v[106:107], v14 offset:5120
ds_read_b64_tr_b16 v[108:109], v14 offset:37376
ds_read_b64_tr_b16 v[110:111], v14 offset:41984
ds_read_b64_tr_b16 v[112:113], v13 offset:37376
ds_read_b64_tr_b16 v[114:115], v13 offset:41984
v_mov_b32 v18, 0
v_mov_b32 v19, 0
v_mov_b32 v9, 0
s_waitcnt lgkmcnt(15)
s_add_u32 s32, s50, 0
buffer_store_dwordx4 v[32:35], v11, s[44:47], s32 offen offset:0 sc1
v_dot2c_f32_bf16 v18, v32, v17
v_dot2c_f32_bf16 v18, v33, v17
v_dot2c_f32_bf16 v18, v34, v17
v_dot2c_f32_bf16 v18, v35, v17
buffer_store_dwordx4 v[36:39], v11, s[44:47], s32 offen offset:2048 sc1
v_dot2c_f32_bf16 v18, v36, v17
v_dot2c_f32_bf16 v18, v37, v17
v_dot2c_f32_bf16 v18, v38, v17
v_dot2c_f32_bf16 v18, v39, v17
s_add_u32 s32, s50, 4096
buffer_store_dwordx4 v[40:43], v11, s[44:47], s32 offen offset:0 sc1
v_dot2c_f32_bf16 v18, v40, v17
v_dot2c_f32_bf16 v18, v41, v17
v_dot2c_f32_bf16 v18, v42, v17
v_dot2c_f32_bf16 v18, v43, v17
buffer_store_dwordx4 v[44:47], v11, s[44:47], s32 offen offset:2048 sc1
v_dot2c_f32_bf16 v18, v44, v17
v_dot2c_f32_bf16 v18, v45, v17
v_dot2c_f32_bf16 v18, v46, v17
v_dot2c_f32_bf16 v18, v47, v17
s_add_u32 s32, s50, 8192
buffer_store_dwordx4 v[48:51], v11, s[44:47], s32 offen offset:0 sc1
v_dot2c_f32_bf16 v18, v48, v17
v_dot2c_f32_bf16 v18, v49, v17
v_dot2c_f32_bf16 v18, v50, v17
v_dot2c_f32_bf16 v18, v51, v17
s_waitcnt lgkmcnt(6)
buffer_store_dwordx4 v[52:55], v11, s[44:47], s32 offen offset:2048 sc1
v_dot2c_f32_bf16 v18, v52, v17
v_dot2c_f32_bf16 v18, v53, v17
v_dot2c_f32_bf16 v18, v54, v17
v_dot2c_f32_bf16 v18, v55, v17
s_add_u32 s32, s50, 12288
buffer_store_dwordx4 v[56:59], v11, s[44:47], s32 offen offset:0 sc1
v_dot2c_f32_bf16 v18, v56, v17
v_dot2c_f32_bf16 v18, v57, v17
v_dot2c_f32_bf16 v18, v58, v17
v_dot2c_f32_bf16 v18, v59, v17
buffer_store_dwordx4 v[60:63], v11, s[44:47], s32 offen offset:2048 sc1
v_dot2c_f32_bf16 v18, v60, v17
v_dot2c_f32_bf16 v18, v61, v17
v_dot2c_f32_bf16 v18, v62, v17
v_dot2c_f32_bf16 v18, v63, v17
s_add_u32 s32, s50, 16384
buffer_store_dwordx4 v[64:67], v11, s[44:47], s32 offen offset:0 sc1
v_dot2c_f32_bf16 v18, v64, v17
v_dot2c_f32_bf16 v18, v65, v17
v_dot2c_f32_bf16 v18, v66, v17
v_dot2c_f32_bf16 v18, v67, v17
s_waitcnt lgkmcnt(6)
s_add_u32 s32, s51, 0
buffer_store_dwordx4 v[68:71], v11, s[44:47], s32 offen offset:0 sc1
v_dot2c_f32_bf16 v19, v68, v17
v_dot2c_f32_bf16 v19, v69, v17
v_dot2c_f32_bf16 v19, v70, v17
v_dot2c_f32_bf16 v19, v71, v17
buffer_store_dwordx4 v[72:75], v11, s[44:47], s32 offen offset:2048 sc1
v_dot2c_f32_bf16 v19, v72, v17
v_dot2c_f32_bf16 v19, v73, v17
v_dot2c_f32_bf16 v19, v74, v17
v_dot2c_f32_bf16 v19, v75, v17
s_add_u32 s32, s51, 4096
buffer_store_dwordx4 v[76:79], v11, s[44:47], s32 offen offset:0 sc1
v_dot2c_f32_bf16 v19, v76, v17
v_dot2c_f32_bf16 v19, v77, v17
v_dot2c_f32_bf16 v19, v78, v17
v_dot2c_f32_bf16 v19, v79, v17
buffer_store_dwordx4 v[80:83], v11, s[44:47], s32 offen offset:2048 sc1
v_dot2c_f32_bf16 v19, v80, v17
v_dot2c_f32_bf16 v19, v81, v17
v_dot2c_f32_bf16 v19, v82, v17
v_dot2c_f32_bf16 v19, v83, v17
s_add_u32 s32, s51, 8192
buffer_store_dwordx4 v[84:87], v11, s[44:47], s32 offen offset:0 sc1
v_dot2c_f32_bf16 v19, v84, v17
v_dot2c_f32_bf16 v19, v85, v17
v_dot2c_f32_bf16 v19, v86, v17
v_dot2c_f32_bf16 v19, v87, v17
buffer_store_dwordx4 v[88:91], v11, s[44:47], s32 offen offset:2048 sc1
v_dot2c_f32_bf16 v19, v88, v17
v_dot2c_f32_bf16 v19, v89, v17
v_dot2c_f32_bf16 v19, v90, v17
v_dot2c_f32_bf16 v19, v91, v17
s_add_u32 s32, s51, 12288
buffer_store_dwordx4 v[92:95], v11, s[44:47], s32 offen offset:0 sc1
v_dot2c_f32_bf16 v19, v92, v17
v_dot2c_f32_bf16 v19, v93, v17
v_dot2c_f32_bf16 v19, v94, v17
v_dot2c_f32_bf16 v19, v95, v17
buffer_store_dwordx4 v[96:99], v11, s[44:47], s32 offen offset:2048 sc1
v_dot2c_f32_bf16 v19, v96, v17
v_dot2c_f32_bf16 v19, v97, v17
v_dot2c_f32_bf16 v19, v98, v17
v_dot2c_f32_bf16 v19, v99, v17
s_add_u32 s32, s51, 16384
buffer_store_dwordx4 v[100:103], v11, s[44:47], s32 offen offset:0 sc1
v_dot2c_f32_bf16 v19, v100, v17
v_dot2c_f32_bf16 v19, v101, v17
v_dot2c_f32_bf16 v19, v102, v17
v_dot2c_f32_bf16 v19, v103, v17
s_waitcnt lgkmcnt(0)
s_add_u32 s32, s52, 0
buffer_store_dwordx4 v[104:107], v11, s[44:47], s32 offen sc1
v_dot2c_f32_bf16 v9, v104, v17
v_dot2c_f32_bf16 v9, v105, v17
v_dot2c_f32_bf16 v9, v106, v17
v_dot2c_f32_bf16 v9, v107, v17
s_add_u32 s32, s52, 8192
buffer_store_dwordx4 v[108:111], v11, s[44:47], s32 offen sc1
v_dot2c_f32_bf16 v9, v108, v17
v_dot2c_f32_bf16 v9, v109, v17
v_dot2c_f32_bf16 v9, v110, v17
v_dot2c_f32_bf16 v9, v111, v17
s_cmp_lg_u32 s24, 0
s_cbranch_scc1 L_ka_pf_4
s_add_u32 s32, s52, 16384
buffer_store_dwordx4 v[112:115], v11, s[44:47], s32 offen sc1
v_dot2c_f32_bf16 v9, v112, v17
v_dot2c_f32_bf16 v9, v113, v17
v_dot2c_f32_bf16 v9, v114, v17
v_dot2c_f32_bf16 v9, v115, v17
L_ka_pf_4:
s_nop 2
ds_write_b32 v10, v9
v_mov_b32 v3, v18
v_mov_b32 v4, v19
s_nop 0
v_permlane32_swap_b32 v18, v3
v_permlane32_swap_b32 v19, v4
v_add_f32 v18, v18, v3
v_add_f32 v19, v19, v4
v_mov_b32 v4, 0x80000000
v_cmp_gt_u32 vcc, 32, v1
s_nop 1
v_cndmask_b32 v15, v4, v15, vcc
buffer_store_dword v18, v15, s[20:23], s53 offen sc1
buffer_store_dword v19, v15, s[20:23], s54 offen sc1
s_waitcnt lgkmcnt(0)
s_barrier
s_cmp_lg_u32 s24, 0
s_cbranch_scc1 L_ka_pf_6
ds_read2st64_b32 v[18:19], v10 offset0:0 offset1:1
ds_read2st64_b32 v[20:21], v10 offset0:2 offset1:3
s_waitcnt lgkmcnt(0)
v_add_f32 v18, v18, v19
v_add_f32 v20, v20, v21
v_add_f32 v18, v18, v20
v_mov_b32 v19, v18
s_nop 1
v_permlane32_swap_b32 v18, v19
v_add_f32 v18, v18, v19
buffer_store_dword v18, v15, s[20:23], s55 offen sc1
L_ka_pf_6:
L_ka_pf_end:
s_endpgm
.globl kc_kernel
.p2align 8
.type kc_kernel,@function
kc_kernel:
s_cmp_ge_u32 s2, 256
s_cbranch_scc1 L_kc_end
s_load_dwordx2 s[6:7], s[0:1], 80
v_and_b32 v1, 63, v0
v_lshrrev_b32 v2, 6, v0
s_and_b32 s25, s2, 7
v_readfirstlane_b32 s24, v2
s_lshr_b32 s26, s2, 3
s_waitcnt lgkmcnt(0)
s_cmp_lt_u32 s26, 16
s_cbranch_scc1 L_kc_mlp
L_kc_att:
s_load_dwordx2 s[64:65], s[0:1], 16
s_load_dwordx2 s[68:69], s[0:1], 0
s_load_dwordx2 s[72:73], s[0:1], 64
s_mov_b32 s46, 0x42200000
s_mov_b32 s47, 0x71800000
s_sub_u32 s26, s26, 16
s_lshr_b32 s50, s26, 3
s_lshl_b32 s32, s25, 1
s_add_u32 s50, s50, s32
s_and_b32 s51, s26, 7
s_lshl_b32 s52, s50, 2
s_add_u32 s52, s52, s24
s_mul_i32 s52, s52, 36864
s_min_u32 s32, s51, 6
s_lshl_b32 s32, s32, 7
s_add_u32 s53, s52, s32
s_lshr_b32 s48, s51, 1
s_add_u32 s48, s48, 7
s_cmp_lt_u32 s51, 4
s_cselect_b32 s48, s48, 6
s_lshl_b32 s54, s24, 12
s_add_u32 s54, s54, 147456
s_lshr_b32 s27, s26, 2
s_lshl_b32 s32, s25, 2
s_add_u32 s27, s27, s32
s_and_b32 s26, s26, 3
s_lshl_b32 s35, s26, 4
s_lshl_b32 s32, s24, 2
s_add_u32 s35, s35, s32
s_mul_i32 s28, s27, 18
s_and_b32 s29, s28, 15
s_lshr_b32 s28, s28, 4
s_mul_i32 s41, s35, 36
s_add_u32 s41, s41, s28
s_lshl_b32 s41, s41, 10
v_lshlrev_b32 v2, 4, v1
v_lshrrev_b32 v3, 5, v1
s_lshl_b32 s32, s28, 16
v_add_u32 v4, s32, v2
v_add_u32 v5, 0x10000, v4
s_add_u32 s8, s6, 0x340000
s_addc_u32 s9, s7, 0
s_mov_b32 s10, 0x240000
s_mov_b32 s11, 0x00020000
s_add_u32 s12, s6, 0x100000
s_addc_u32 s13, s7, 0
s_mov_b32 s14, 0x240000
s_mov_b32 s15, 0x00020000
s_add_u32 s16, s6, 0xc60000
s_addc_u32 s17, s7, 0
s_mov_b32 s18, 0x240000
s_mov_b32 s19, 0x00020000
s_mov_b32 s20, s6
s_mov_b32 s21, s7
s_mov_b32 s22, 0x10000
s_mov_b32 s23, 0x00020000
s_add_u32 s36, s6, 0x580000
s_addc_u32 s37, s7, 0
s_mov_b32 s38, 0x250000
s_mov_b32 s39, 0x00020000
s_add_u32 s60, s6, 0xc0000
s_addc_u32 s61, s7, 0
s_mov_b32 s62, 0x30000
s_mov_b32 s63, 0x00020000
s_mul_i32 s33, s27, 18
v_and_b32 v232, 31, v1
v_add_u32 v234, s33, v232
v_lshrrev_b32 v233, 4, v234
v_lshlrev_b32 v233, 16, v233
v_and_b32 v234, 15, v234
v_lshl_add_u32 v233, v234, 4, v233
v_mov_b32 v235, 0x80000000
v_cmp_gt_u32 vcc, 18, v232
s_nop 1
v_cndmask_b32 v6, v235, v233, vcc
v_and_b32 v234, 27, v232
v_mov_b32 v235, 2359296
v_cmp_eq_u32 vcc, 27, v234
s_nop 1
v_cndmask_b32 v6, v6, v235, vcc
v_lshl_add_u32 v6, v3, 8, v6
v_lshlrev_b32 v232, 2, v1
s_mov_b32 s32, 0x8000
buffer_load_dword v236, v232, s[20:23], s32 offen offset:0
buffer_load_dword v237, v232, s[20:23], s32 offen offset:256
buffer_load_dword v238, v232, s[20:23], s32 offen offset:512
s_add_u32 s32, s41, 0
buffer_load_dwordx4 v[16:19], v2, s[12:15], s32 offen offset:0
buffer_load_dwordx4 v[20:23], v2, s[12:15], s32 offen offset:1024
s_add_u32 s32, s41, 36864
buffer_load_dwordx4 v[24:27], v2, s[12:15], s32 offen offset:0
buffer_load_dwordx4 v[28:31], v2, s[12:15], s32 offen offset:1024
s_add_u32 s32, s41, 73728
buffer_load_dwordx4 v[32:35], v2, s[12:15], s32 offen offset:0
buffer_load_dwordx4 v[36:39], v2, s[12:15], s32 offen offset:1024
s_add_u32 s32, s41, 110592
buffer_load_dwordx4 v[40:43], v2, s[12:15], s32 offen offset:0
buffer_load_dwordx4 v[44:47], v2, s[12:15], s32 offen offset:1024
v_lshrrev_b32 v10, 3, v1
v_and_b32 v15, 7, v1
v_lshrrev_b32 v14, 4, v1
v_xor_b32 v11, v14, v15
v_lshlrev_b32 v11, 4, v11
v_mul_u32_u24 v10, 1152, v10
v_add_u32 v12, v11, v10
v_xor_b32 v11, 64, v11
v_add_u32 v13, v11, v10
v_and_b32 v14, 1, v14
v_lshlrev_b32 v14, 2, v14
v_xor_b32 v14, v14, v15
v_lshl_add_u32 v7, v14, 4, v10
s_waitcnt lgkmcnt(0)
s_mov_b32 s64, s64
s_mov_b32 s65, s65
s_mov_b32 s66, 0xa2000
s_mov_b32 s67, 0x00020000
s_mov_b32 s68, s68
s_mov_b32 s69, s69
s_mov_b32 s70, 0x240000
s_mov_b32 s71, 0x00020000
s_mov_b32 s72, s72
s_mov_b32 s73, s73
s_mov_b32 s74, 0x240000
s_mov_b32 s75, 0x00020000
buffer_load_dwordx4 a[0:3], v4, s[8:11], 0 offen offset:0
buffer_load_dwordx4 a[4:7], v5, s[8:11], 0 offen offset:0
buffer_load_dwordx4 a[8:11], v6, s[36:39], 0 offen offset:0
buffer_load_dwordx4 a[12:15], v6, s[36:39], 0 offen offset:512
buffer_load_dwordx4 a[16:19], v4, s[8:11], 0 offen offset:1024
buffer_load_dwordx4 a[20:23], v5, s[8:11], 0 offen offset:1024
buffer_load_dwordx4 a[24:27], v6, s[36:39], 0 offen offset:1024
buffer_load_dwordx4 a[28:31], v6, s[36:39], 0 offen offset:1536
s_add_u32 m0, s54, 0
s_add_u32 s32, s53, 0
buffer_load_dwordx4 v12, s[68:71], s32 offen lds
buffer_load_dwordx4 a[32:35], v4, s[8:11], 0 offen offset:2048
buffer_load_dwordx4 a[36:39], v5, s[8:11], 0 offen offset:2048
buffer_load_dwordx4 a[40:43], v6, s[36:39], 0 offen offset:2048
buffer_load_dwordx4 a[44:47], v6, s[36:39], 0 offen offset:2560
s_add_u32 m0, s54, 1024
s_add_u32 s32, s53, 9216
buffer_load_dwordx4 v13, s[68:71], s32 offen lds
v_lshl_add_u32 v232, v3, 2, 0
v_subrev_u32 v232, s29, v232
v_cmp_gt_u32 vcc, 18, v232
s_nop 1
v_cndmask_b32 v224, 0, -1, vcc
v_lshl_add_u32 v232, v3, 2, 2
v_subrev_u32 v232, s29, v232
v_cmp_gt_u32 vcc, 18, v232
s_nop 1
v_cndmask_b32 v225, 0, -1, vcc
v_lshl_add_u32 v232, v3, 2, 8
v_subrev_u32 v232, s29, v232
v_cmp_gt_u32 vcc, 18, v232
s_nop 1
v_cndmask_b32 v226, 0, -1, vcc
v_lshl_add_u32 v232, v3, 2, 10
v_subrev_u32 v232, s29, v232
v_cmp_gt_u32 vcc, 18, v232
s_nop 1
v_cndmask_b32 v227, 0, -1, vcc
v_lshl_add_u32 v232, v3, 2, 16
v_subrev_u32 v232, s29, v232
v_cmp_gt_u32 vcc, 18, v232
s_nop 1
v_cndmask_b32 v228, 0, -1, vcc
v_lshl_add_u32 v232, v3, 2, 18
v_subrev_u32 v232, s29, v232
v_cmp_gt_u32 vcc, 18, v232
s_nop 1
v_cndmask_b32 v229, 0, -1, vcc
v_lshl_add_u32 v232, v3, 2, 24
v_subrev_u32 v232, s29, v232
v_cmp_gt_u32 vcc, 18, v232
s_nop 1
v_cndmask_b32 v230, 0, -1, vcc
v_lshl_add_u32 v232, v3, 2, 26
v_subrev_u32 v232, s29, v232
v_cmp_gt_u32 vcc, 18, v232
s_nop 1
v_cndmask_b32 v231, 0, -1, vcc
v_mov_b32 v242, 0x3f803f80
s_mov_b32 s43, 0
s_waitcnt vmcnt(22)
v_max3_f32 v236, v236, v237, v238
s_nop 1
v_max_f32_dpp v236, v236, v236 quad_perm:[1,0,3,2] row_mask:0xf bank_mask:0xf
s_nop 1
v_max_f32_dpp v236, v236, v236 quad_perm:[2,3,0,1] row_mask:0xf bank_mask:0xf
s_nop 1
v_max_f32_dpp v236, v236, v236 row_half_mirror row_mask:0xf bank_mask:0xf
s_nop 1
v_max_f32_dpp v236, v236, v236 row_mirror row_mask:0xf bank_mask:0xf
v_mov_b32 v237, v236
s_nop 1
v_permlane16_swap_b32 v236, v237
v_max_f32 v236, v236, v237
v_mov_b32 v237, v236
s_nop 1
v_permlane32_swap_b32 v236, v237
v_max_f32 v236, v236, v237
v_mul_f32 v236, 0xbf808312, v236
s_waitcnt vmcnt(20)
v_mov_b32 v160, 0
v_and_b32 v16, v224, v16
v_and_b32 v232, 0x7fff7fff, v16
v_dot2c_f32_bf16 v160, v232, v242
v_and_b32 v17, v225, v17
v_and_b32 v233, 0x7fff7fff, v17
v_dot2c_f32_bf16 v160, v233, v242
v_and_b32 v18, v226, v18
v_and_b32 v232, 0x7fff7fff, v18
v_dot2c_f32_bf16 v160, v232, v242
v_and_b32 v19, v227, v19
v_and_b32 v233, 0x7fff7fff, v19
v_dot2c_f32_bf16 v160, v233, v242
v_and_b32 v20, v228, v20
v_and_b32 v232, 0x7fff7fff, v20
v_dot2c_f32_bf16 v160, v232, v242
v_and_b32 v21, v229, v21
v_and_b32 v233, 0x7fff7fff, v21
v_dot2c_f32_bf16 v160, v233, v242
v_and_b32 v22, v230, v22
v_and_b32 v232, 0x7fff7fff, v22
v_dot2c_f32_bf16 v160, v232, v242
v_and_b32 v23, v231, v23
v_and_b32 v233, 0x7fff7fff, v23
v_dot2c_f32_bf16 v160, v233, v242
s_waitcnt vmcnt(18)
v_mov_b32 v176, 0
v_and_b32 v24, v224, v24
v_and_b32 v232, 0x7fff7fff, v24
v_dot2c_f32_bf16 v176, v232, v242
v_and_b32 v25, v225, v25
v_and_b32 v233, 0x7fff7fff, v25
v_dot2c_f32_bf16 v176, v233, v242
v_and_b32 v26, v226, v26
v_and_b32 v232, 0x7fff7fff, v26
v_dot2c_f32_bf16 v176, v232, v242
v_and_b32 v27, v227, v27
v_and_b32 v233, 0x7fff7fff, v27
v_dot2c_f32_bf16 v176, v233, v242
v_and_b32 v28, v228, v28
v_and_b32 v232, 0x7fff7fff, v28
v_dot2c_f32_bf16 v176, v232, v242
v_and_b32 v29, v229, v29
v_and_b32 v233, 0x7fff7fff, v29
v_dot2c_f32_bf16 v176, v233, v242
v_and_b32 v30, v230, v30
v_and_b32 v232, 0x7fff7fff, v30
v_dot2c_f32_bf16 v176, v232, v242
v_and_b32 v31, v231, v31
v_and_b32 v233, 0x7fff7fff, v31
v_dot2c_f32_bf16 v176, v233, v242
s_waitcnt vmcnt(16)
v_mov_b32 v192, 0
v_and_b32 v32, v224, v32
v_and_b32 v232, 0x7fff7fff, v32
v_dot2c_f32_bf16 v192, v232, v242
v_and_b32 v33, v225, v33
v_and_b32 v233, 0x7fff7fff, v33
v_dot2c_f32_bf16 v192, v233, v242
v_and_b32 v34, v226, v34
v_and_b32 v232, 0x7fff7fff, v34
v_dot2c_f32_bf16 v192, v232, v242
v_and_b32 v35, v227, v35
v_and_b32 v233, 0x7fff7fff, v35
v_dot2c_f32_bf16 v192, v233, v242
v_and_b32 v36, v228, v36
v_and_b32 v232, 0x7fff7fff, v36
v_dot2c_f32_bf16 v192, v232, v242
v_and_b32 v37, v229, v37
v_and_b32 v233, 0x7fff7fff, v37
v_dot2c_f32_bf16 v192, v233, v242
v_and_b32 v38, v230, v38
v_and_b32 v232, 0x7fff7fff, v38
v_dot2c_f32_bf16 v192, v232, v242
v_and_b32 v39, v231, v39
v_and_b32 v233, 0x7fff7fff, v39
v_dot2c_f32_bf16 v192, v233, v242
s_waitcnt vmcnt(14)
v_mov_b32 v208, 0
v_and_b32 v40, v224, v40
v_and_b32 v232, 0x7fff7fff, v40
v_dot2c_f32_bf16 v208, v232, v242
v_and_b32 v41, v225, v41
v_and_b32 v233, 0x7fff7fff, v41
v_dot2c_f32_bf16 v208, v233, v242
v_and_b32 v42, v226, v42
v_and_b32 v232, 0x7fff7fff, v42
v_dot2c_f32_bf16 v208, v232, v242
v_and_b32 v43, v227, v43
v_and_b32 v233, 0x7fff7fff, v43
v_dot2c_f32_bf16 v208, v233, v242
v_and_b32 v44, v228, v44
v_and_b32 v232, 0x7fff7fff, v44
v_dot2c_f32_bf16 v208, v232, v242
v_and_b32 v45, v229, v45
v_and_b32 v233, 0x7fff7fff, v45
v_dot2c_f32_bf16 v208, v233, v242
v_and_b32 v46, v230, v46
v_and_b32 v232, 0x7fff7fff, v46
v_dot2c_f32_bf16 v208, v232, v242
v_and_b32 v47, v231, v47
v_and_b32 v233, 0x7fff7fff, v47
v_dot2c_f32_bf16 v208, v233, v242
v_mov_b32 v232, v160
s_nop 1
v_permlane32_swap_b32 v160, v232
v_add_f32 v160, v160, v232
v_fma_f32 v160, v160, v236, s46
v_mov_b32 v232, v176
s_nop 1
v_permlane32_swap_b32 v176, v232
v_add_f32 v176, v176, v232
v_fma_f32 v176, v176, v236, s46
v_mov_b32 v232, v192
s_nop 1
v_permlane32_swap_b32 v192, v232
v_add_f32 v192, v192, v232
v_fma_f32 v192, v192, v236, s46
v_mov_b32 v232, v208
s_nop 1
v_permlane32_swap_b32 v208, v232
v_add_f32 v208, v208, v232
v_fma_f32 v208, v208, v236, s46
s_branch L_att_go
L_att_start:
buffer_load_dwordx4 a[0:3], v4, s[8:11], 0 offen offset:0
buffer_load_dwordx4 a[4:7], v5, s[8:11], 0 offen offset:0
buffer_load_dwordx4 a[8:11], v6, s[36:39], 0 offen offset:0
buffer_load_dwordx4 a[12:15], v6, s[36:39], 0 offen offset:512
buffer_load_dwordx4 a[16:19], v4, s[8:11], 0 offen offset:1024
buffer_load_dwordx4 a[20:23], v5, s[8:11], 0 offen offset:1024
buffer_load_dwordx4 a[24:27], v6, s[36:39], 0 offen offset:1024
buffer_load_dwordx4 a[28:31], v6, s[36:39], 0 offen offset:1536
s_add_u32 m0, s54, 0
s_add_u32 s32, s53, 0
buffer_load_dwordx4 v12, s[68:71], s32 offen lds
buffer_load_dwordx4 a[32:35], v4, s[8:11], 0 offen offset:2048
buffer_load_dwordx4 a[36:39], v5, s[8:11], 0 offen offset:2048
buffer_load_dwordx4 a[40:43], v6, s[36:39], 0 offen offset:2048
buffer_load_dwordx4 a[44:47], v6, s[36:39], 0 offen offset:2560
s_add_u32 m0, s54, 1024
s_add_u32 s32, s53, 9216
buffer_load_dwordx4 v13, s[68:71], s32 offen lds
L_att_go:
v_mov_b32 v161, v160
v_mov_b32 v162, v160
v_mov_b32 v163, v160
v_mov_b32 v164, v160
v_mov_b32 v165, v160
v_mov_b32 v166, v160
v_mov_b32 v167, v160
v_mov_b32 v168, v160
v_mov_b32 v169, v160
v_mov_b32 v170, v160
v_mov_b32 v171, v160
v_mov_b32 v172, v160
v_mov_b32 v173, v160
v_mov_b32 v174, v160
v_mov_b32 v175, v160
v_mov_b32 v177, v176
v_mov_b32 v178, v176
v_mov_b32 v179, v176
v_mov_b32 v180, v176
v_mov_b32 v181, v176
v_mov_b32 v182, v176
v_mov_b32 v183, v176
v_mov_b32 v184, v176
v_mov_b32 v185, v176
v_mov_b32 v186, v176
v_mov_b32 v187, v176
v_mov_b32 v188, v176
v_mov_b32 v189, v176
v_mov_b32 v190, v176
v_mov_b32 v191, v176
v_mov_b32 v193, v192
v_mov_b32 v194, v192
v_mov_b32 v195, v192
v_mov_b32 v196, v192
v_mov_b32 v197, v192
v_mov_b32 v198, v192
v_mov_b32 v199, v192
v_mov_b32 v200, v192
v_mov_b32 v201, v192
v_mov_b32 v202, v192
v_mov_b32 v203, v192
v_mov_b32 v204, v192
v_mov_b32 v205, v192
v_mov_b32 v206, v192
v_mov_b32 v207, v192
v_mov_b32 v209, v208
v_mov_b32 v210, v208
v_mov_b32 v211, v208
v_mov_b32 v212, v208
v_mov_b32 v213, v208
v_mov_b32 v214, v208
v_mov_b32 v215, v208
v_mov_b32 v216, v208
v_mov_b32 v217, v208
v_mov_b32 v218, v208
v_mov_b32 v219, v208
v_mov_b32 v220, v208
v_mov_b32 v221, v208
v_mov_b32 v222, v208
v_mov_b32 v223, v208
v_mov_b32 v48, 0
v_mov_b32 v49, 0
v_mov_b32 v50, 0
v_mov_b32 v51, 0
v_mov_b32 v52, 0
v_mov_b32 v53, 0
v_mov_b32 v54, 0
v_mov_b32 v55, 0
v_mov_b32 v56, 0
v_mov_b32 v57, 0
v_mov_b32 v58, 0
v_mov_b32 v59, 0
v_mov_b32 v60, 0
v_mov_b32 v61, 0
v_mov_b32 v62, 0
v_mov_b32 v63, 0
v_mov_b32 v64, 0
v_mov_b32 v65, 0
v_mov_b32 v66, 0
v_mov_b32 v67, 0
v_mov_b32 v68, 0
v_mov_b32 v69, 0
v_mov_b32 v70, 0
v_mov_b32 v71, 0
v_mov_b32 v72, 0
v_mov_b32 v73, 0
v_mov_b32 v74, 0
v_mov_b32 v75, 0
v_mov_b32 v76, 0
v_mov_b32 v77, 0
v_mov_b32 v78, 0
v_mov_b32 v79, 0
v_mov_b32 v80, 0
v_mov_b32 v81, 0
v_mov_b32 v82, 0
v_mov_b32 v83, 0
v_mov_b32 v84, 0
v_mov_b32 v85, 0
v_mov_b32 v86, 0
v_mov_b32 v87, 0
v_mov_b32 v88, 0
v_mov_b32 v89, 0
v_mov_b32 v90, 0
v_mov_b32 v91, 0
v_mov_b32 v92, 0
v_mov_b32 v93, 0
v_mov_b32 v94, 0
v_mov_b32 v95, 0
v_mov_b32 v96, 0
v_mov_b32 v97, 0
v_mov_b32 v98, 0
v_mov_b32 v99, 0
v_mov_b32 v100, 0
v_mov_b32 v101, 0
v_mov_b32 v102, 0
v_mov_b32 v103, 0
v_mov_b32 v104, 0
v_mov_b32 v105, 0
v_mov_b32 v106, 0
v_mov_b32 v107, 0
v_mov_b32 v108, 0
v_mov_b32 v109, 0
v_mov_b32 v110, 0
v_mov_b32 v111, 0
v_mov_b32 v156, 0
v_accvgpr_write_b32 a60, 0
v_mov_b32 v157, 0
v_accvgpr_write_b32 a61, 0
v_mov_b32 v158, 0
v_accvgpr_write_b32 a62, 0
v_mov_b32 v159, 0
v_accvgpr_write_b32 a63, 0
s_lshl_b32 s55, s24, 10
s_mul_i32 s56, s24, 9216
s_add_u32 s57, s55, 73728
s_lshl_b32 s32, s48, 7
s_add_u32 s58, s56, s32
s_lshl_b32 s32, s51, 7
s_add_u32 s56, s56, s32
s_waitcnt vmcnt(10)
v_mfma_f32_32x32x16_bf16 v[112:127], a[0:3], v[16:19], v[160:175]
v_mfma_f32_32x32x16_bf16 v[112:127], a[4:7], v[20:23], v[112:127]
s_mov_b32 s40, 9
s_mov_b32 s44, 0
s_mov_b32 s45, 4096
s_nop 7
s_nop 3
L_att_loopA:
v_exp_f32 v112, v112
v_exp_f32 v113, v113
v_mfma_f32_32x32x16_bf16 v[128:143], a[0:3], v[24:27], v[176:191]
v_exp_f32 v114, v114
v_exp_f32 v115, v115
v_cvt_pk_bf16_f32 v144, v112, v113
v_cvt_pk_bf16_f32 v145, v114, v115
v_exp_f32 v116, v116
v_exp_f32 v117, v117
v_mfma_f32_32x32x16_bf16 v[128:143], a[4:7], v[28:31], v[128:143]
v_exp_f32 v118, v118
v_exp_f32 v119, v119
v_cvt_pk_bf16_f32 v146, v116, v117
v_cvt_pk_bf16_f32 v147, v118, v119
v_exp_f32 v120, v120
v_exp_f32 v121, v121
v_mfma_f32_32x32x16_bf16 v[96:111], a[60:63], v[156:159], v[96:111]
v_exp_f32 v122, v122
v_exp_f32 v123, v123
v_cvt_pk_bf16_f32 v148, v120, v121
v_cvt_pk_bf16_f32 v149, v122, v123
v_exp_f32 v124, v124
v_exp_f32 v125, v125
v_mfma_f32_32x32x16_bf16 v[48:63], a[8:11], v[144:147], v[48:63]
v_exp_f32 v126, v126
v_exp_f32 v127, v127
v_cvt_pk_bf16_f32 v150, v124, v125
v_cvt_pk_bf16_f32 v151, v126, v127
v_exp_f32 v128, v128
v_exp_f32 v129, v129
v_mfma_f32_32x32x16_bf16 v[112:127], a[0:3], v[32:35], v[192:207]
buffer_load_dwordx4 a[48:51], v4, s[8:11], s44 offen offset:3072
v_exp_f32 v130, v130
v_exp_f32 v131, v131
v_cvt_pk_bf16_f32 v152, v128, v129
v_cvt_pk_bf16_f32 v153, v130, v131
v_exp_f32 v132, v132
v_exp_f32 v133, v133
v_mfma_f32_32x32x16_bf16 v[112:127], a[4:7], v[36:39], v[112:127]
buffer_load_dwordx4 a[52:55], v5, s[8:11], s44 offen offset:3072
v_exp_f32 v134, v134
v_exp_f32 v135, v135
v_cvt_pk_bf16_f32 v154, v132, v133
v_cvt_pk_bf16_f32 v155, v134, v135
v_exp_f32 v136, v136
v_exp_f32 v137, v137
v_mfma_f32_32x32x16_bf16 v[48:63], a[12:15], v[148:151], v[48:63]
buffer_load_dwordx4 a[56:59], v6, s[36:39], s44 offen offset:3072
v_exp_f32 v138, v138
v_exp_f32 v139, v139
v_cvt_pk_bf16_f32 v156, v136, v137
v_cvt_pk_bf16_f32 v157, v138, v139
v_exp_f32 v140, v140
v_exp_f32 v141, v141
v_mfma_f32_32x32x16_bf16 v[64:79], a[8:11], v[152:155], v[64:79]
buffer_load_dwordx4 a[60:63], v6, s[36:39], s44 offen offset:3584
v_exp_f32 v142, v142
v_exp_f32 v143, v143
v_cvt_pk_bf16_f32 v158, v140, v141
v_cvt_pk_bf16_f32 v159, v142, v143
v_exp_f32 v112, v112
v_exp_f32 v113, v113
v_mfma_f32_32x32x16_bf16 v[128:143], a[0:3], v[40:43], v[208:223]
s_mov_b32 m0, s55
v_exp_f32 v114, v114
v_exp_f32 v115, v115
v_cvt_pk_bf16_f32 v144, v112, v113
v_cvt_pk_bf16_f32 v145, v114, v115
v_exp_f32 v116, v116
v_exp_f32 v117, v117
v_mfma_f32_32x32x16_bf16 v[128:143], a[4:7], v[44:47], v[128:143]
buffer_load_dwordx4 v7, s[64:67], s56 offen lds
v_exp_f32 v118, v118
v_exp_f32 v119, v119
v_cvt_pk_bf16_f32 v146, v116, v117
v_cvt_pk_bf16_f32 v147, v118, v119
v_exp_f32 v120, v120
v_exp_f32 v121, v121
v_mfma_f32_32x32x16_bf16 v[64:79], a[12:15], v[156:159], v[64:79]
s_add_u32 s55, s55, 4096
v_exp_f32 v122, v122
v_exp_f32 v123, v123
v_cvt_pk_bf16_f32 v148, v120, v121
v_cvt_pk_bf16_f32 v149, v122, v123
v_exp_f32 v124, v124
v_exp_f32 v125, v125
v_mfma_f32_32x32x16_bf16 v[80:95], a[8:11], v[144:147], v[80:95]
s_add_u32 s56, s56, 36864
v_exp_f32 v126, v126
v_exp_f32 v127, v127
v_cvt_pk_bf16_f32 v150, v124, v125
v_cvt_pk_bf16_f32 v151, v126, v127
s_waitcnt vmcnt(11)
v_exp_f32 v128, v128
v_exp_f32 v129, v129
v_mfma_f32_32x32x16_bf16 v[112:127], a[16:19], v[16:19], v[160:175]
v_exp_f32 v130, v130
v_exp_f32 v131, v131
v_cvt_pk_bf16_f32 v152, v128, v129
v_cvt_pk_bf16_f32 v153, v130, v131
v_exp_f32 v132, v132
v_exp_f32 v133, v133
v_mfma_f32_32x32x16_bf16 v[112:127], a[20:23], v[20:23], v[112:127]
v_exp_f32 v134, v134
v_exp_f32 v135, v135
v_cvt_pk_bf16_f32 v154, v132, v133
v_cvt_pk_bf16_f32 v155, v134, v135
v_exp_f32 v136, v136
v_exp_f32 v137, v137
v_mfma_f32_32x32x16_bf16 v[80:95], a[12:15], v[148:151], v[80:95]
v_exp_f32 v138, v138
v_exp_f32 v139, v139
v_cvt_pk_bf16_f32 v156, v136, v137
v_cvt_pk_bf16_f32 v157, v138, v139
v_exp_f32 v140, v140
v_exp_f32 v141, v141
v_mfma_f32_32x32x16_bf16 v[96:111], a[8:11], v[152:155], v[96:111]
v_exp_f32 v142, v142
v_exp_f32 v143, v143
v_cvt_pk_bf16_f32 v158, v140, v141
v_cvt_pk_bf16_f32 v159, v142, v143
v_exp_f32 v112, v112
v_exp_f32 v113, v113
v_mfma_f32_32x32x16_bf16 v[128:143], a[16:19], v[24:27], v[176:191]
v_exp_f32 v114, v114
v_exp_f32 v115, v115
v_cvt_pk_bf16_f32 v144, v112, v113
v_cvt_pk_bf16_f32 v145, v114, v115
v_exp_f32 v116, v116
v_exp_f32 v117, v117
v_mfma_f32_32x32x16_bf16 v[128:143], a[20:23], v[28:31], v[128:143]
v_exp_f32 v118, v118
v_exp_f32 v119, v119
v_cvt_pk_bf16_f32 v146, v116, v117
v_cvt_pk_bf16_f32 v147, v118, v119
v_exp_f32 v120, v120
v_exp_f32 v121, v121
v_mfma_f32_32x32x16_bf16 v[96:111], a[12:15], v[156:159], v[96:111]
v_exp_f32 v122, v122
v_exp_f32 v123, v123
v_cvt_pk_bf16_f32 v148, v120, v121
v_cvt_pk_bf16_f32 v149, v122, v123
v_exp_f32 v124, v124
v_exp_f32 v125, v125
v_mfma_f32_32x32x16_bf16 v[48:63], a[24:27], v[144:147], v[48:63]
v_exp_f32 v126, v126
v_exp_f32 v127, v127
v_cvt_pk_bf16_f32 v150, v124, v125
v_cvt_pk_bf16_f32 v151, v126, v127
v_exp_f32 v128, v128
v_exp_f32 v129, v129
v_mfma_f32_32x32x16_bf16 v[112:127], a[16:19], v[32:35], v[192:207]
buffer_load_dwordx4 a[0:3], v4, s[8:11], s45 offen offset:0
v_exp_f32 v130, v130
v_exp_f32 v131, v131
v_cvt_pk_bf16_f32 v152, v128, v129
v_cvt_pk_bf16_f32 v153, v130, v131
v_exp_f32 v132, v132
v_exp_f32 v133, v133
v_mfma_f32_32x32x16_bf16 v[112:127], a[20:23], v[36:39], v[112:127]
buffer_load_dwordx4 a[4:7], v5, s[8:11], s45 offen offset:0
v_exp_f32 v134, v134
v_exp_f32 v135, v135
v_cvt_pk_bf16_f32 v154, v132, v133
v_cvt_pk_bf16_f32 v155, v134, v135
v_exp_f32 v136, v136
v_exp_f32 v137, v137
v_mfma_f32_32x32x16_bf16 v[48:63], a[28:31], v[148:151], v[48:63]
buffer_load_dwordx4 a[8:11], v6, s[36:39], s45 offen offset:0
v_exp_f32 v138, v138
v_exp_f32 v139, v139
v_cvt_pk_bf16_f32 v156, v136, v137
v_cvt_pk_bf16_f32 v157, v138, v139
v_exp_f32 v140, v140
v_exp_f32 v141, v141
v_mfma_f32_32x32x16_bf16 v[64:79], a[24:27], v[152:155], v[64:79]
buffer_load_dwordx4 a[12:15], v6, s[36:39], s45 offen offset:512
v_exp_f32 v142, v142
v_exp_f32 v143, v143
v_cvt_pk_bf16_f32 v158, v140, v141
v_cvt_pk_bf16_f32 v159, v142, v143
v_exp_f32 v112, v112
v_exp_f32 v113, v113
v_mfma_f32_32x32x16_bf16 v[128:143], a[16:19], v[40:43], v[208:223]
s_mov_b32 m0, s57
v_exp_f32 v114, v114
v_exp_f32 v115, v115
v_cvt_pk_bf16_f32 v144, v112, v113
v_cvt_pk_bf16_f32 v145, v114, v115
v_exp_f32 v116, v116
v_exp_f32 v117, v117
v_mfma_f32_32x32x16_bf16 v[128:143], a[20:23], v[44:47], v[128:143]
buffer_load_dwordx4 v7, s[64:67], s58 offen lds
v_exp_f32 v118, v118
v_exp_f32 v119, v119
v_cvt_pk_bf16_f32 v146, v116, v117
v_cvt_pk_bf16_f32 v147, v118, v119
v_exp_f32 v120, v120
v_exp_f32 v121, v121
v_mfma_f32_32x32x16_bf16 v[64:79], a[28:31], v[156:159], v[64:79]
s_add_u32 s57, s57, 4096
v_exp_f32 v122, v122
v_exp_f32 v123, v123
v_cvt_pk_bf16_f32 v148, v120, v121
v_cvt_pk_bf16_f32 v149, v122, v123
v_exp_f32 v124, v124
v_exp_f32 v125, v125
v_mfma_f32_32x32x16_bf16 v[80:95], a[24:27], v[144:147], v[80:95]
s_add_u32 s58, s58, 36864
v_exp_f32 v126, v126
v_exp_f32 v127, v127
v_cvt_pk_bf16_f32 v150, v124, v125
v_cvt_pk_bf16_f32 v151, v126, v127
s_waitcnt vmcnt(11)
v_exp_f32 v128, v128
v_exp_f32 v129, v129
v_mfma_f32_32x32x16_bf16 v[112:127], a[32:35], v[16:19], v[160:175]
v_exp_f32 v130, v130
v_exp_f32 v131, v131
v_cvt_pk_bf16_f32 v152, v128, v129
v_cvt_pk_bf16_f32 v153, v130, v131
v_exp_f32 v132, v132
v_exp_f32 v133, v133
v_mfma_f32_32x32x16_bf16 v[112:127], a[36:39], v[20:23], v[112:127]
v_exp_f32 v134, v134
v_exp_f32 v135, v135
v_cvt_pk_bf16_f32 v154, v132, v133
v_cvt_pk_bf16_f32 v155, v134, v135
v_exp_f32 v136, v136
v_exp_f32 v137, v137
v_mfma_f32_32x32x16_bf16 v[80:95], a[28:31], v[148:151], v[80:95]
v_exp_f32 v138, v138
v_exp_f32 v139, v139
v_cvt_pk_bf16_f32 v156, v136, v137
v_cvt_pk_bf16_f32 v157, v138, v139
v_exp_f32 v140, v140
v_exp_f32 v141, v141
v_mfma_f32_32x32x16_bf16 v[96:111], a[24:27], v[152:155], v[96:111]
v_exp_f32 v142, v142
v_exp_f32 v143, v143
v_cvt_pk_bf16_f32 v158, v140, v141
v_cvt_pk_bf16_f32 v159, v142, v143
v_exp_f32 v112, v112
v_exp_f32 v113, v113
v_mfma_f32_32x32x16_bf16 v[128:143], a[32:35], v[24:27], v[176:191]
v_exp_f32 v114, v114
v_exp_f32 v115, v115
v_cvt_pk_bf16_f32 v144, v112, v113
v_cvt_pk_bf16_f32 v145, v114, v115
v_exp_f32 v116, v116
v_exp_f32 v117, v117
v_mfma_f32_32x32x16_bf16 v[128:143], a[36:39], v[28:31], v[128:143]
v_exp_f32 v118, v118
v_exp_f32 v119, v119
v_cvt_pk_bf16_f32 v146, v116, v117
v_cvt_pk_bf16_f32 v147, v118, v119
v_exp_f32 v120, v120
v_exp_f32 v121, v121
v_mfma_f32_32x32x16_bf16 v[96:111], a[28:31], v[156:159], v[96:111]
v_exp_f32 v122, v122
v_exp_f32 v123, v123
v_cvt_pk_bf16_f32 v148, v120, v121
v_cvt_pk_bf16_f32 v149, v122, v123
v_exp_f32 v124, v124
v_exp_f32 v125, v125
v_mfma_f32_32x32x16_bf16 v[48:63], a[40:43], v[144:147], v[48:63]
v_exp_f32 v126, v126
v_exp_f32 v127, v127
v_cvt_pk_bf16_f32 v150, v124, v125
v_cvt_pk_bf16_f32 v151, v126, v127
v_exp_f32 v128, v128
v_exp_f32 v129, v129
v_mfma_f32_32x32x16_bf16 v[112:127], a[32:35], v[32:35], v[192:207]
buffer_load_dwordx4 a[16:19], v4, s[8:11], s45 offen offset:1024
v_exp_f32 v130, v130
v_exp_f32 v131, v131
v_cvt_pk_bf16_f32 v152, v128, v129
v_cvt_pk_bf16_f32 v153, v130, v131
v_exp_f32 v132, v132
v_exp_f32 v133, v133
v_mfma_f32_32x32x16_bf16 v[112:127], a[36:39], v[36:39], v[112:127]
buffer_load_dwordx4 a[20:23], v5, s[8:11], s45 offen offset:1024
v_exp_f32 v134, v134
v_exp_f32 v135, v135
v_cvt_pk_bf16_f32 v154, v132, v133
v_cvt_pk_bf16_f32 v155, v134, v135
v_exp_f32 v136, v136
v_exp_f32 v137, v137
v_mfma_f32_32x32x16_bf16 v[48:63], a[44:47], v[148:151], v[48:63]
buffer_load_dwordx4 a[24:27], v6, s[36:39], s45 offen offset:1024
v_exp_f32 v138, v138
v_exp_f32 v139, v139
v_cvt_pk_bf16_f32 v156, v136, v137
v_cvt_pk_bf16_f32 v157, v138, v139
v_exp_f32 v140, v140
v_exp_f32 v141, v141
v_mfma_f32_32x32x16_bf16 v[64:79], a[40:43], v[152:155], v[64:79]
buffer_load_dwordx4 a[28:31], v6, s[36:39], s45 offen offset:1536
v_exp_f32 v142, v142
v_exp_f32 v143, v143
v_cvt_pk_bf16_f32 v158, v140, v141
v_cvt_pk_bf16_f32 v159, v142, v143
v_exp_f32 v112, v112
v_exp_f32 v113, v113
v_mfma_f32_32x32x16_bf16 v[128:143], a[32:35], v[40:43], v[208:223]
s_mov_b32 m0, s55
v_exp_f32 v114, v114
v_exp_f32 v115, v115
v_cvt_pk_bf16_f32 v144, v112, v113
v_cvt_pk_bf16_f32 v145, v114, v115
v_exp_f32 v116, v116
v_exp_f32 v117, v117
v_mfma_f32_32x32x16_bf16 v[128:143], a[36:39], v[44:47], v[128:143]
buffer_load_dwordx4 v7, s[64:67], s56 offen lds
v_exp_f32 v118, v118
v_exp_f32 v119, v119
v_cvt_pk_bf16_f32 v146, v116, v117
v_cvt_pk_bf16_f32 v147, v118, v119
v_exp_f32 v120, v120
v_exp_f32 v121, v121
v_mfma_f32_32x32x16_bf16 v[64:79], a[44:47], v[156:159], v[64:79]
s_add_u32 s55, s55, 4096
v_exp_f32 v122, v122
v_exp_f32 v123, v123
v_cvt_pk_bf16_f32 v148, v120, v121
v_cvt_pk_bf16_f32 v149, v122, v123
v_exp_f32 v124, v124
v_exp_f32 v125, v125
v_mfma_f32_32x32x16_bf16 v[80:95], a[40:43], v[144:147], v[80:95]
s_add_u32 s56, s56, 36864
v_exp_f32 v126, v126
v_exp_f32 v127, v127
v_cvt_pk_bf16_f32 v150, v124, v125
v_cvt_pk_bf16_f32 v151, v126, v127
s_waitcnt vmcnt(11)
v_exp_f32 v128, v128
v_exp_f32 v129, v129
v_mfma_f32_32x32x16_bf16 v[112:127], a[48:51], v[16:19], v[160:175]
v_exp_f32 v130, v130
v_exp_f32 v131, v131
v_cvt_pk_bf16_f32 v152, v128, v129
v_cvt_pk_bf16_f32 v153, v130, v131
v_exp_f32 v132, v132
v_exp_f32 v133, v133
v_mfma_f32_32x32x16_bf16 v[112:127], a[52:55], v[20:23], v[112:127]
v_exp_f32 v134, v134
v_exp_f32 v135, v135
v_cvt_pk_bf16_f32 v154, v132, v133
v_cvt_pk_bf16_f32 v155, v134, v135
v_exp_f32 v136, v136
v_exp_f32 v137, v137
v_mfma_f32_32x32x16_bf16 v[80:95], a[44:47], v[148:151], v[80:95]
v_exp_f32 v138, v138
v_exp_f32 v139, v139
v_cvt_pk_bf16_f32 v156, v136, v137
v_cvt_pk_bf16_f32 v157, v138, v139
v_exp_f32 v140, v140
v_exp_f32 v141, v141
v_mfma_f32_32x32x16_bf16 v[96:111], a[40:43], v[152:155], v[96:111]
v_exp_f32 v142, v142
v_exp_f32 v143, v143
v_cvt_pk_bf16_f32 v158, v140, v141
v_cvt_pk_bf16_f32 v159, v142, v143
v_exp_f32 v112, v112
v_exp_f32 v113, v113
v_mfma_f32_32x32x16_bf16 v[128:143], a[48:51], v[24:27], v[176:191]
v_exp_f32 v114, v114
v_exp_f32 v115, v115
v_cvt_pk_bf16_f32 v144, v112, v113
v_cvt_pk_bf16_f32 v145, v114, v115
v_exp_f32 v116, v116
v_exp_f32 v117, v117
v_mfma_f32_32x32x16_bf16 v[128:143], a[52:55], v[28:31], v[128:143]
v_exp_f32 v118, v118
v_exp_f32 v119, v119
v_cvt_pk_bf16_f32 v146, v116, v117
v_cvt_pk_bf16_f32 v147, v118, v119
v_exp_f32 v120, v120
v_exp_f32 v121, v121
v_mfma_f32_32x32x16_bf16 v[96:111], a[44:47], v[156:159], v[96:111]
v_exp_f32 v122, v122
v_exp_f32 v123, v123
v_cvt_pk_bf16_f32 v148, v120, v121
v_cvt_pk_bf16_f32 v149, v122, v123
v_exp_f32 v124, v124
v_exp_f32 v125, v125
v_mfma_f32_32x32x16_bf16 v[48:63], a[56:59], v[144:147], v[48:63]
v_exp_f32 v126, v126
v_exp_f32 v127, v127
v_cvt_pk_bf16_f32 v150, v124, v125
v_cvt_pk_bf16_f32 v151, v126, v127
v_exp_f32 v128, v128
v_exp_f32 v129, v129
v_mfma_f32_32x32x16_bf16 v[112:127], a[48:51], v[32:35], v[192:207]
buffer_load_dwordx4 a[32:35], v4, s[8:11], s45 offen offset:2048
v_exp_f32 v130, v130
v_exp_f32 v131, v131
v_cvt_pk_bf16_f32 v152, v128, v129
v_cvt_pk_bf16_f32 v153, v130, v131
v_exp_f32 v132, v132
v_exp_f32 v133, v133
v_mfma_f32_32x32x16_bf16 v[112:127], a[52:55], v[36:39], v[112:127]
buffer_load_dwordx4 a[36:39], v5, s[8:11], s45 offen offset:2048
v_exp_f32 v134, v134
v_exp_f32 v135, v135
v_cvt_pk_bf16_f32 v154, v132, v133
v_cvt_pk_bf16_f32 v155, v134, v135
v_exp_f32 v136, v136
v_exp_f32 v137, v137
v_mfma_f32_32x32x16_bf16 v[48:63], a[60:63], v[148:151], v[48:63]
buffer_load_dwordx4 a[40:43], v6, s[36:39], s45 offen offset:2048
v_exp_f32 v138, v138
v_exp_f32 v139, v139
v_cvt_pk_bf16_f32 v156, v136, v137
v_cvt_pk_bf16_f32 v157, v138, v139
v_exp_f32 v140, v140
v_exp_f32 v141, v141
v_mfma_f32_32x32x16_bf16 v[64:79], a[56:59], v[152:155], v[64:79]
buffer_load_dwordx4 a[44:47], v6, s[36:39], s45 offen offset:2560
v_exp_f32 v142, v142
v_exp_f32 v143, v143
v_cvt_pk_bf16_f32 v158, v140, v141
v_cvt_pk_bf16_f32 v159, v142, v143
v_exp_f32 v112, v112
v_exp_f32 v113, v113
v_mfma_f32_32x32x16_bf16 v[128:143], a[48:51], v[40:43], v[208:223]
s_mov_b32 m0, s57
v_exp_f32 v114, v114
v_exp_f32 v115, v115
v_cvt_pk_bf16_f32 v144, v112, v113
v_cvt_pk_bf16_f32 v145, v114, v115
v_exp_f32 v116, v116
v_exp_f32 v117, v117
v_mfma_f32_32x32x16_bf16 v[128:143], a[52:55], v[44:47], v[128:143]
buffer_load_dwordx4 v7, s[64:67], s58 offen lds
v_exp_f32 v118, v118
v_exp_f32 v119, v119
v_cvt_pk_bf16_f32 v146, v116, v117
v_cvt_pk_bf16_f32 v147, v118, v119
v_exp_f32 v120, v120
v_exp_f32 v121, v121
v_mfma_f32_32x32x16_bf16 v[64:79], a[60:63], v[156:159], v[64:79]
s_add_u32 s57, s57, 4096
v_exp_f32 v122, v122
v_exp_f32 v123, v123
v_cvt_pk_bf16_f32 v148, v120, v121
v_cvt_pk_bf16_f32 v149, v122, v123
v_exp_f32 v124, v124
v_exp_f32 v125, v125
v_mfma_f32_32x32x16_bf16 v[80:95], a[56:59], v[144:147], v[80:95]
s_add_u32 s58, s58, 36864
v_exp_f32 v126, v126
v_exp_f32 v127, v127
v_cvt_pk_bf16_f32 v150, v124, v125
v_cvt_pk_bf16_f32 v151, v126, v127
s_waitcnt vmcnt(11)
v_exp_f32 v128, v128
v_exp_f32 v129, v129
v_mfma_f32_32x32x16_bf16 v[112:127], a[0:3], v[16:19], v[160:175]
v_exp_f32 v130, v130
v_exp_f32 v131, v131
v_cvt_pk_bf16_f32 v152, v128, v129
v_cvt_pk_bf16_f32 v153, v130, v131
v_exp_f32 v132, v132
v_exp_f32 v133, v133
v_mfma_f32_32x32x16_bf16 v[112:127], a[4:7], v[20:23], v[112:127]
v_exp_f32 v134, v134
v_exp_f32 v135, v135
v_cvt_pk_bf16_f32 v154, v132, v133
v_cvt_pk_bf16_f32 v155, v134, v135
v_exp_f32 v136, v136
v_exp_f32 v137, v137
v_mfma_f32_32x32x16_bf16 v[80:95], a[60:63], v[148:151], v[80:95]
v_exp_f32 v138, v138
v_exp_f32 v139, v139
v_cvt_pk_bf16_f32 v156, v136, v137
v_cvt_pk_bf16_f32 v157, v138, v139
v_exp_f32 v140, v140
v_exp_f32 v141, v141
v_mfma_f32_32x32x16_bf16 v[96:111], a[56:59], v[152:155], v[96:111]
v_exp_f32 v142, v142
v_exp_f32 v143, v143
v_cvt_pk_bf16_f32 v158, v140, v141
v_cvt_pk_bf16_f32 v159, v142, v143
s_mov_b32 s44, s45
s_add_u32 s45, s45, 4096
s_sub_u32 s40, s40, 1
s_cmp_lg_u32 s40, 0
s_cbranch_scc1 L_att_loopA
s_mov_b32 s40, 7
L_att_loopB:
v_exp_f32 v112, v112
v_exp_f32 v113, v113
v_mfma_f32_32x32x16_bf16 v[128:143], a[0:3], v[24:27], v[176:191]
v_exp_f32 v114, v114
v_exp_f32 v115, v115
v_cvt_pk_bf16_f32 v144, v112, v113
v_cvt_pk_bf16_f32 v145, v114, v115
v_exp_f32 v116, v116
v_exp_f32 v117, v117
v_mfma_f32_32x32x16_bf16 v[128:143], a[4:7], v[28:31], v[128:143]
v_exp_f32 v118, v118
v_exp_f32 v119, v119
v_cvt_pk_bf16_f32 v146, v116, v117
v_cvt_pk_bf16_f32 v147, v118, v119
v_exp_f32 v120, v120
v_exp_f32 v121, v121
v_mfma_f32_32x32x16_bf16 v[96:111], a[60:63], v[156:159], v[96:111]
v_exp_f32 v122, v122
v_exp_f32 v123, v123
v_cvt_pk_bf16_f32 v148, v120, v121
v_cvt_pk_bf16_f32 v149, v122, v123
v_exp_f32 v124, v124
v_exp_f32 v125, v125
v_mfma_f32_32x32x16_bf16 v[48:63], a[8:11], v[144:147], v[48:63]
v_exp_f32 v126, v126
v_exp_f32 v127, v127
v_cvt_pk_bf16_f32 v150, v124, v125
v_cvt_pk_bf16_f32 v151, v126, v127
v_exp_f32 v128, v128
v_exp_f32 v129, v129
v_mfma_f32_32x32x16_bf16 v[112:127], a[0:3], v[32:35], v[192:207]
buffer_load_dwordx4 a[48:51], v4, s[8:11], s44 offen offset:3072
v_exp_f32 v130, v130
v_exp_f32 v131, v131
v_cvt_pk_bf16_f32 v152, v128, v129
v_cvt_pk_bf16_f32 v153, v130, v131
v_exp_f32 v132, v132
v_exp_f32 v133, v133
v_mfma_f32_32x32x16_bf16 v[112:127], a[4:7], v[36:39], v[112:127]
buffer_load_dwordx4 a[52:55], v5, s[8:11], s44 offen offset:3072
v_exp_f32 v134, v134
v_exp_f32 v135, v135
v_cvt_pk_bf16_f32 v154, v132, v133
v_cvt_pk_bf16_f32 v155, v134, v135
v_exp_f32 v136, v136
v_exp_f32 v137, v137
v_mfma_f32_32x32x16_bf16 v[48:63], a[12:15], v[148:151], v[48:63]
buffer_load_dwordx4 a[56:59], v6, s[36:39], s44 offen offset:3072
v_exp_f32 v138, v138
v_exp_f32 v139, v139
v_cvt_pk_bf16_f32 v156, v136, v137
v_cvt_pk_bf16_f32 v157, v138, v139
v_exp_f32 v140, v140
v_exp_f32 v141, v141
v_mfma_f32_32x32x16_bf16 v[64:79], a[8:11], v[152:155], v[64:79]
buffer_load_dwordx4 a[60:63], v6, s[36:39], s44 offen offset:3584
v_exp_f32 v142, v142
v_exp_f32 v143, v143
v_cvt_pk_bf16_f32 v158, v140, v141
v_cvt_pk_bf16_f32 v159, v142, v143
v_exp_f32 v112, v112
v_exp_f32 v113, v113
v_mfma_f32_32x32x16_bf16 v[128:143], a[0:3], v[40:43], v[208:223]
v_exp_f32 v114, v114
v_exp_f32 v115, v115
v_cvt_pk_bf16_f32 v144, v112, v113
v_cvt_pk_bf16_f32 v145, v114, v115
v_exp_f32 v116, v116
v_exp_f32 v117, v117
v_mfma_f32_32x32x16_bf16 v[128:143], a[4:7], v[44:47], v[128:143]
v_exp_f32 v118, v118
v_exp_f32 v119, v119
v_cvt_pk_bf16_f32 v146, v116, v117
v_cvt_pk_bf16_f32 v147, v118, v119
v_exp_f32 v120, v120
v_exp_f32 v121, v121
v_mfma_f32_32x32x16_bf16 v[64:79], a[12:15], v[156:159], v[64:79]
v_exp_f32 v122, v122
v_exp_f32 v123, v123
v_cvt_pk_bf16_f32 v148, v120, v121
v_cvt_pk_bf16_f32 v149, v122, v123
v_exp_f32 v124, v124
v_exp_f32 v125, v125
v_mfma_f32_32x32x16_bf16 v[80:95], a[8:11], v[144:147], v[80:95]
v_exp_f32 v126, v126
v_exp_f32 v127, v127
v_cvt_pk_bf16_f32 v150, v124, v125
v_cvt_pk_bf16_f32 v151, v126, v127
s_waitcnt vmcnt(8)
v_exp_f32 v128, v128
v_exp_f32 v129, v129
v_mfma_f32_32x32x16_bf16 v[112:127], a[16:19], v[16:19], v[160:175]
v_exp_f32 v130, v130
v_exp_f32 v131, v131
v_cvt_pk_bf16_f32 v152, v128, v129
v_cvt_pk_bf16_f32 v153, v130, v131
v_exp_f32 v132, v132
v_exp_f32 v133, v133
v_mfma_f32_32x32x16_bf16 v[112:127], a[20:23], v[20:23], v[112:127]
v_exp_f32 v134, v134
v_exp_f32 v135, v135
v_cvt_pk_bf16_f32 v154, v132, v133
v_cvt_pk_bf16_f32 v155, v134, v135
v_exp_f32 v136, v136
v_exp_f32 v137, v137
v_mfma_f32_32x32x16_bf16 v[80:95], a[12:15], v[148:151], v[80:95]
v_exp_f32 v138, v138
v_exp_f32 v139, v139
v_cvt_pk_bf16_f32 v156, v136, v137
v_cvt_pk_bf16_f32 v157, v138, v139
v_exp_f32 v140, v140
v_exp_f32 v141, v141
v_mfma_f32_32x32x16_bf16 v[96:111], a[8:11], v[152:155], v[96:111]
v_exp_f32 v142, v142
v_exp_f32 v143, v143
v_cvt_pk_bf16_f32 v158, v140, v141
v_cvt_pk_bf16_f32 v159, v142, v143
v_exp_f32 v112, v112
v_exp_f32 v113, v113
v_mfma_f32_32x32x16_bf16 v[128:143], a[16:19], v[24:27], v[176:191]
v_exp_f32 v114, v114
v_exp_f32 v115, v115
v_cvt_pk_bf16_f32 v144, v112, v113
v_cvt_pk_bf16_f32 v145, v114, v115
v_exp_f32 v116, v116
v_exp_f32 v117, v117
v_mfma_f32_32x32x16_bf16 v[128:143], a[20:23], v[28:31], v[128:143]
v_exp_f32 v118, v118
v_exp_f32 v119, v119
v_cvt_pk_bf16_f32 v146, v116, v117
v_cvt_pk_bf16_f32 v147, v118, v119
v_exp_f32 v120, v120
v_exp_f32 v121, v121
v_mfma_f32_32x32x16_bf16 v[96:111], a[12:15], v[156:159], v[96:111]
v_exp_f32 v122, v122
v_exp_f32 v123, v123
v_cvt_pk_bf16_f32 v148, v120, v121
v_cvt_pk_bf16_f32 v149, v122, v123
v_exp_f32 v124, v124
v_exp_f32 v125, v125
v_mfma_f32_32x32x16_bf16 v[48:63], a[24:27], v[144:147], v[48:63]
v_exp_f32 v126, v126
v_exp_f32 v127, v127
v_cvt_pk_bf16_f32 v150, v124, v125
v_cvt_pk_bf16_f32 v151, v126, v127
v_exp_f32 v128, v128
v_exp_f32 v129, v129
v_mfma_f32_32x32x16_bf16 v[112:127], a[16:19], v[32:35], v[192:207]
buffer_load_dwordx4 a[0:3], v4, s[8:11], s45 offen offset:0
v_exp_f32 v130, v130
v_exp_f32 v131, v131
v_cvt_pk_bf16_f32 v152, v128, v129
v_cvt_pk_bf16_f32 v153, v130, v131
v_exp_f32 v132, v132
v_exp_f32 v133, v133
v_mfma_f32_32x32x16_bf16 v[112:127], a[20:23], v[36:39], v[112:127]
buffer_load_dwordx4 a[4:7], v5, s[8:11], s45 offen offset:0
v_exp_f32 v134, v134
v_exp_f32 v135, v135
v_cvt_pk_bf16_f32 v154, v132, v133
v_cvt_pk_bf16_f32 v155, v134, v135
v_exp_f32 v136, v136
v_exp_f32 v137, v137
v_mfma_f32_32x32x16_bf16 v[48:63], a[28:31], v[148:151], v[48:63]
buffer_load_dwordx4 a[8:11], v6, s[36:39], s45 offen offset:0
v_exp_f32 v138, v138
v_exp_f32 v139, v139
v_cvt_pk_bf16_f32 v156, v136, v137
v_cvt_pk_bf16_f32 v157, v138, v139
v_exp_f32 v140, v140
v_exp_f32 v141, v141
v_mfma_f32_32x32x16_bf16 v[64:79], a[24:27], v[152:155], v[64:79]
buffer_load_dwordx4 a[12:15], v6, s[36:39], s45 offen offset:512
v_exp_f32 v142, v142
v_exp_f32 v143, v143
v_cvt_pk_bf16_f32 v158, v140, v141
v_cvt_pk_bf16_f32 v159, v142, v143
v_exp_f32 v112, v112
v_exp_f32 v113, v113
v_mfma_f32_32x32x16_bf16 v[128:143], a[16:19], v[40:43], v[208:223]
v_exp_f32 v114, v114
v_exp_f32 v115, v115
v_cvt_pk_bf16_f32 v144, v112, v113
v_cvt_pk_bf16_f32 v145, v114, v115
v_exp_f32 v116, v116
v_exp_f32 v117, v117
v_mfma_f32_32x32x16_bf16 v[128:143], a[20:23], v[44:47], v[128:143]
v_exp_f32 v118, v118
v_exp_f32 v119, v119
v_cvt_pk_bf16_f32 v146, v116, v117
v_cvt_pk_bf16_f32 v147, v118, v119
v_exp_f32 v120, v120
v_exp_f32 v121, v121
v_mfma_f32_32x32x16_bf16 v[64:79], a[28:31], v[156:159], v[64:79]
v_exp_f32 v122, v122
v_exp_f32 v123, v123
v_cvt_pk_bf16_f32 v148, v120, v121
v_cvt_pk_bf16_f32 v149, v122, v123
v_exp_f32 v124, v124
v_exp_f32 v125, v125
v_mfma_f32_32x32x16_bf16 v[80:95], a[24:27], v[144:147], v[80:95]
v_exp_f32 v126, v126
v_exp_f32 v127, v127
v_cvt_pk_bf16_f32 v150, v124, v125
v_cvt_pk_bf16_f32 v151, v126, v127
s_waitcnt vmcnt(8)
v_exp_f32 v128, v128
v_exp_f32 v129, v129
v_mfma_f32_32x32x16_bf16 v[112:127], a[32:35], v[16:19], v[160:175]
v_exp_f32 v130, v130
v_exp_f32 v131, v131
v_cvt_pk_bf16_f32 v152, v128, v129
v_cvt_pk_bf16_f32 v153, v130, v131
v_exp_f32 v132, v132
v_exp_f32 v133, v133
v_mfma_f32_32x32x16_bf16 v[112:127], a[36:39], v[20:23], v[112:127]
v_exp_f32 v134, v134
v_exp_f32 v135, v135
v_cvt_pk_bf16_f32 v154, v132, v133
v_cvt_pk_bf16_f32 v155, v134, v135
v_exp_f32 v136, v136
v_exp_f32 v137, v137
v_mfma_f32_32x32x16_bf16 v[80:95], a[28:31], v[148:151], v[80:95]
v_exp_f32 v138, v138
v_exp_f32 v139, v139
v_cvt_pk_bf16_f32 v156, v136, v137
v_cvt_pk_bf16_f32 v157, v138, v139
v_exp_f32 v140, v140
v_exp_f32 v141, v141
v_mfma_f32_32x32x16_bf16 v[96:111], a[24:27], v[152:155], v[96:111]
v_exp_f32 v142, v142
v_exp_f32 v143, v143
v_cvt_pk_bf16_f32 v158, v140, v141
v_cvt_pk_bf16_f32 v159, v142, v143
v_exp_f32 v112, v112
v_exp_f32 v113, v113
v_mfma_f32_32x32x16_bf16 v[128:143], a[32:35], v[24:27], v[176:191]
v_exp_f32 v114, v114
v_exp_f32 v115, v115
v_cvt_pk_bf16_f32 v144, v112, v113
v_cvt_pk_bf16_f32 v145, v114, v115
v_exp_f32 v116, v116
v_exp_f32 v117, v117
v_mfma_f32_32x32x16_bf16 v[128:143], a[36:39], v[28:31], v[128:143]
v_exp_f32 v118, v118
v_exp_f32 v119, v119
v_cvt_pk_bf16_f32 v146, v116, v117
v_cvt_pk_bf16_f32 v147, v118, v119
v_exp_f32 v120, v120
v_exp_f32 v121, v121
v_mfma_f32_32x32x16_bf16 v[96:111], a[28:31], v[156:159], v[96:111]
v_exp_f32 v122, v122
v_exp_f32 v123, v123
v_cvt_pk_bf16_f32 v148, v120, v121
v_cvt_pk_bf16_f32 v149, v122, v123
v_exp_f32 v124, v124
v_exp_f32 v125, v125
v_mfma_f32_32x32x16_bf16 v[48:63], a[40:43], v[144:147], v[48:63]
v_exp_f32 v126, v126
v_exp_f32 v127, v127
v_cvt_pk_bf16_f32 v150, v124, v125
v_cvt_pk_bf16_f32 v151, v126, v127
v_exp_f32 v128, v128
v_exp_f32 v129, v129
v_mfma_f32_32x32x16_bf16 v[112:127], a[32:35], v[32:35], v[192:207]
buffer_load_dwordx4 a[16:19], v4, s[8:11], s45 offen offset:1024
v_exp_f32 v130, v130
v_exp_f32 v131, v131
v_cvt_pk_bf16_f32 v152, v128, v129
v_cvt_pk_bf16_f32 v153, v130, v131
v_exp_f32 v132, v132
v_exp_f32 v133, v133
v_mfma_f32_32x32x16_bf16 v[112:127], a[36:39], v[36:39], v[112:127]
buffer_load_dwordx4 a[20:23], v5, s[8:11], s45 offen offset:1024
v_exp_f32 v134, v134
v_exp_f32 v135, v135
v_cvt_pk_bf16_f32 v154, v132, v133
v_cvt_pk_bf16_f32 v155, v134, v135
v_exp_f32 v136, v136
v_exp_f32 v137, v137
v_mfma_f32_32x32x16_bf16 v[48:63], a[44:47], v[148:151], v[48:63]
buffer_load_dwordx4 a[24:27], v6, s[36:39], s45 offen offset:1024
v_exp_f32 v138, v138
v_exp_f32 v139, v139
v_cvt_pk_bf16_f32 v156, v136, v137
v_cvt_pk_bf16_f32 v157, v138, v139
v_exp_f32 v140, v140
v_exp_f32 v141, v141
v_mfma_f32_32x32x16_bf16 v[64:79], a[40:43], v[152:155], v[64:79]
buffer_load_dwordx4 a[28:31], v6, s[36:39], s45 offen offset:1536
v_exp_f32 v142, v142
v_exp_f32 v143, v143
v_cvt_pk_bf16_f32 v158, v140, v141
v_cvt_pk_bf16_f32 v159, v142, v143
v_exp_f32 v112, v112
v_exp_f32 v113, v113
v_mfma_f32_32x32x16_bf16 v[128:143], a[32:35], v[40:43], v[208:223]
v_exp_f32 v114, v114
v_exp_f32 v115, v115
v_cvt_pk_bf16_f32 v144, v112, v113
v_cvt_pk_bf16_f32 v145, v114, v115
v_exp_f32 v116, v116
v_exp_f32 v117, v117
v_mfma_f32_32x32x16_bf16 v[128:143], a[36:39], v[44:47], v[128:143]
v_exp_f32 v118, v118
v_exp_f32 v119, v119
v_cvt_pk_bf16_f32 v146, v116, v117
v_cvt_pk_bf16_f32 v147, v118, v119
v_exp_f32 v120, v120
v_exp_f32 v121, v121
v_mfma_f32_32x32x16_bf16 v[64:79], a[44:47], v[156:159], v[64:79]
v_exp_f32 v122, v122
v_exp_f32 v123, v123
v_cvt_pk_bf16_f32 v148, v120, v121
v_cvt_pk_bf16_f32 v149, v122, v123
v_exp_f32 v124, v124
v_exp_f32 v125, v125
v_mfma_f32_32x32x16_bf16 v[80:95], a[40:43], v[144:147], v[80:95]
v_exp_f32 v126, v126
v_exp_f32 v127, v127
v_cvt_pk_bf16_f32 v150, v124, v125
v_cvt_pk_bf16_f32 v151, v126, v127
s_waitcnt vmcnt(8)
v_exp_f32 v128, v128
v_exp_f32 v129, v129
v_mfma_f32_32x32x16_bf16 v[112:127], a[48:51], v[16:19], v[160:175]
v_exp_f32 v130, v130
v_exp_f32 v131, v131
v_cvt_pk_bf16_f32 v152, v128, v129
v_cvt_pk_bf16_f32 v153, v130, v131
v_exp_f32 v132, v132
v_exp_f32 v133, v133
v_mfma_f32_32x32x16_bf16 v[112:127], a[52:55], v[20:23], v[112:127]
v_exp_f32 v134, v134
v_exp_f32 v135, v135
v_cvt_pk_bf16_f32 v154, v132, v133
v_cvt_pk_bf16_f32 v155, v134, v135
v_exp_f32 v136, v136
v_exp_f32 v137, v137
v_mfma_f32_32x32x16_bf16 v[80:95], a[44:47], v[148:151], v[80:95]
v_exp_f32 v138, v138
v_exp_f32 v139, v139
v_cvt_pk_bf16_f32 v156, v136, v137
v_cvt_pk_bf16_f32 v157, v138, v139
v_exp_f32 v140, v140
v_exp_f32 v141, v141
v_mfma_f32_32x32x16_bf16 v[96:111], a[40:43], v[152:155], v[96:111]
v_exp_f32 v142, v142
v_exp_f32 v143, v143
v_cvt_pk_bf16_f32 v158, v140, v141
v_cvt_pk_bf16_f32 v159, v142, v143
v_exp_f32 v112, v112
v_exp_f32 v113, v113
v_mfma_f32_32x32x16_bf16 v[128:143], a[48:51], v[24:27], v[176:191]
v_exp_f32 v114, v114
v_exp_f32 v115, v115
v_cvt_pk_bf16_f32 v144, v112, v113
v_cvt_pk_bf16_f32 v145, v114, v115
v_exp_f32 v116, v116
v_exp_f32 v117, v117
v_mfma_f32_32x32x16_bf16 v[128:143], a[52:55], v[28:31], v[128:143]
v_exp_f32 v118, v118
v_exp_f32 v119, v119
v_cvt_pk_bf16_f32 v146, v116, v117
v_cvt_pk_bf16_f32 v147, v118, v119
v_exp_f32 v120, v120
v_exp_f32 v121, v121
v_mfma_f32_32x32x16_bf16 v[96:111], a[44:47], v[156:159], v[96:111]
v_exp_f32 v122, v122
v_exp_f32 v123, v123
v_cvt_pk_bf16_f32 v148, v120, v121
v_cvt_pk_bf16_f32 v149, v122, v123
v_exp_f32 v124, v124
v_exp_f32 v125, v125
v_mfma_f32_32x32x16_bf16 v[48:63], a[56:59], v[144:147], v[48:63]
v_exp_f32 v126, v126
v_exp_f32 v127, v127
v_cvt_pk_bf16_f32 v150, v124, v125
v_cvt_pk_bf16_f32 v151, v126, v127
v_exp_f32 v128, v128
v_exp_f32 v129, v129
v_mfma_f32_32x32x16_bf16 v[112:127], a[48:51], v[32:35], v[192:207]
buffer_load_dwordx4 a[32:35], v4, s[8:11], s45 offen offset:2048
v_exp_f32 v130, v130
v_exp_f32 v131, v131
v_cvt_pk_bf16_f32 v152, v128, v129
v_cvt_pk_bf16_f32 v153, v130, v131
v_exp_f32 v132, v132
v_exp_f32 v133, v133
v_mfma_f32_32x32x16_bf16 v[112:127], a[52:55], v[36:39], v[112:127]
buffer_load_dwordx4 a[36:39], v5, s[8:11], s45 offen offset:2048
v_exp_f32 v134, v134
v_exp_f32 v135, v135
v_cvt_pk_bf16_f32 v154, v132, v133
v_cvt_pk_bf16_f32 v155, v134, v135
v_exp_f32 v136, v136
v_exp_f32 v137, v137
v_mfma_f32_32x32x16_bf16 v[48:63], a[60:63], v[148:151], v[48:63]
buffer_load_dwordx4 a[40:43], v6, s[36:39], s45 offen offset:2048
v_exp_f32 v138, v138
v_exp_f32 v139, v139
v_cvt_pk_bf16_f32 v156, v136, v137
v_cvt_pk_bf16_f32 v157, v138, v139
v_exp_f32 v140, v140
v_exp_f32 v141, v141
v_mfma_f32_32x32x16_bf16 v[64:79], a[56:59], v[152:155], v[64:79]
buffer_load_dwordx4 a[44:47], v6, s[36:39], s45 offen offset:2560
v_exp_f32 v142, v142
v_exp_f32 v143, v143
v_cvt_pk_bf16_f32 v158, v140, v141
v_cvt_pk_bf16_f32 v159, v142, v143
v_exp_f32 v112, v112
v_exp_f32 v113, v113
v_mfma_f32_32x32x16_bf16 v[128:143], a[48:51], v[40:43], v[208:223]
v_exp_f32 v114, v114
v_exp_f32 v115, v115
v_cvt_pk_bf16_f32 v144, v112, v113
v_cvt_pk_bf16_f32 v145, v114, v115
v_exp_f32 v116, v116
v_exp_f32 v117, v117
v_mfma_f32_32x32x16_bf16 v[128:143], a[52:55], v[44:47], v[128:143]
v_exp_f32 v118, v118
v_exp_f32 v119, v119
v_cvt_pk_bf16_f32 v146, v116, v117
v_cvt_pk_bf16_f32 v147, v118, v119
v_exp_f32 v120, v120
v_exp_f32 v121, v121
v_mfma_f32_32x32x16_bf16 v[64:79], a[60:63], v[156:159], v[64:79]
v_exp_f32 v122, v122
v_exp_f32 v123, v123
v_cvt_pk_bf16_f32 v148, v120, v121
v_cvt_pk_bf16_f32 v149, v122, v123
v_exp_f32 v124, v124
v_exp_f32 v125, v125
v_mfma_f32_32x32x16_bf16 v[80:95], a[56:59], v[144:147], v[80:95]
v_exp_f32 v126, v126
v_exp_f32 v127, v127
v_cvt_pk_bf16_f32 v150, v124, v125
v_cvt_pk_bf16_f32 v151, v126, v127
s_waitcnt vmcnt(8)
v_exp_f32 v128, v128
v_exp_f32 v129, v129
v_mfma_f32_32x32x16_bf16 v[112:127], a[0:3], v[16:19], v[160:175]
v_exp_f32 v130, v130
v_exp_f32 v131, v131
v_cvt_pk_bf16_f32 v152, v128, v129
v_cvt_pk_bf16_f32 v153, v130, v131
v_exp_f32 v132, v132
v_exp_f32 v133, v133
v_mfma_f32_32x32x16_bf16 v[112:127], a[4:7], v[20:23], v[112:127]
v_exp_f32 v134, v134
v_exp_f32 v135, v135
v_cvt_pk_bf16_f32 v154, v132, v133
v_cvt_pk_bf16_f32 v155, v134, v135
v_exp_f32 v136, v136
v_exp_f32 v137, v137
v_mfma_f32_32x32x16_bf16 v[80:95], a[60:63], v[148:151], v[80:95]
v_exp_f32 v138, v138
v_exp_f32 v139, v139
v_cvt_pk_bf16_f32 v156, v136, v137
v_cvt_pk_bf16_f32 v157, v138, v139
v_exp_f32 v140, v140
v_exp_f32 v141, v141
v_mfma_f32_32x32x16_bf16 v[96:111], a[56:59], v[152:155], v[96:111]
v_exp_f32 v142, v142
v_exp_f32 v143, v143
v_cvt_pk_bf16_f32 v158, v140, v141
v_cvt_pk_bf16_f32 v159, v142, v143
s_mov_b32 s44, s45
s_add_u32 s45, s45, 4096
s_sub_u32 s40, s40, 1
s_cmp_lg_u32 s40, 0
s_cbranch_scc1 L_att_loopB
v_mfma_f32_32x32x16_bf16 v[96:111], a[60:63], v[156:159], v[96:111]
s_waitcnt vmcnt(0)
s_nop 7
s_nop 3
v_mov_b32 v232, v63
v_mov_b32 v233, v79
v_mov_b32 v234, v95
v_mov_b32 v235, v111
s_cmp_lg_u32 s43, 0
s_cbranch_scc1 L_att_fin
v_min3_f32 v237, v232, v233, v234
v_max3_f32 v238, v232, v233, v234
v_min_f32 v237, v237, v235
v_max_f32 v238, v238, v235
v_cmp_nle_f32 vcc, 0x21800000, v237
v_cmp_nge_f32 s[32:33], s47, v238
s_nop 0
s_or_b64 vcc, vcc, s[32:33]
s_cbranch_vccz L_att_fin
s_mov_b32 s43, 1
s_mov_b32 s44, 0
v_mov_b32 v160, 0xff800000
v_mov_b32 v176, 0xff800000
v_mov_b32 v192, 0xff800000
v_mov_b32 v208, 0xff800000
L_att_mx:
buffer_load_dwordx4 a[0:3], v4, s[8:11], s44 offen offset:0
buffer_load_dwordx4 a[4:7], v5, s[8:11], s44 offen offset:0
s_waitcnt vmcnt(0)
v_mfma_f32_32x32x16_bf16 v[48:63], a[0:3], v[16:19], 0
v_mfma_f32_32x32x16_bf16 v[48:63], a[4:7], v[20:23], v[48:63]
v_mfma_f32_32x32x16_bf16 v[64:79], a[0:3], v[24:27], 0
v_mfma_f32_32x32x16_bf16 v[64:79], a[4:7], v[28:31], v[64:79]
v_mfma_f32_32x32x16_bf16 v[80:95], a[0:3], v[32:35], 0
v_mfma_f32_32x32x16_bf16 v[80:95], a[4:7], v[36:39], v[80:95]
v_mfma_f32_32x32x16_bf16 v[96:111], a[0:3], v[40:43], 0
v_mfma_f32_32x32x16_bf16 v[96:111], a[4:7], v[44:47], v[96:111]
s_nop 15
v_max3_f32 v160, v48, v49, v160
v_max3_f32 v160, v50, v51, v160
v_max3_f32 v160, v52, v53, v160
v_max3_f32 v160, v54, v55, v160
v_max3_f32 v160, v56, v57, v160
v_max3_f32 v160, v58, v59, v160
v_max3_f32 v160, v60, v61, v160
v_max3_f32 v160, v62, v63, v160
v_max3_f32 v176, v64, v65, v176
v_max3_f32 v176, v66, v67, v176
v_max3_f32 v176, v68, v69, v176
v_max3_f32 v176, v70, v71, v176
v_max3_f32 v176, v72, v73, v176
v_max3_f32 v176, v74, v75, v176
v_max3_f32 v176, v76, v77, v176
v_max3_f32 v176, v78, v79, v176
v_max3_f32 v192, v80, v81, v192
v_max3_f32 v192, v82, v83, v192
v_max3_f32 v192, v84, v85, v192
v_max3_f32 v192, v86, v87, v192
v_max3_f32 v192, v88, v89, v192
v_max3_f32 v192, v90, v91, v192
v_max3_f32 v192, v92, v93, v192
v_max3_f32 v192, v94, v95, v192
v_max3_f32 v208, v96, v97, v208
v_max3_f32 v208, v98, v99, v208
v_max3_f32 v208, v100, v101, v208
v_max3_f32 v208, v102, v103, v208
v_max3_f32 v208, v104, v105, v208
v_max3_f32 v208, v106, v107, v208
v_max3_f32 v208, v108, v109, v208
v_max3_f32 v208, v110, v111, v208
s_add_u32 s44, s44, 1024
s_cmp_lg_u32 s44, 0x10000
s_cbranch_scc1 L_att_mx
v_mov_b32 v232, v160
s_nop 1
v_permlane32_swap_b32 v160, v232
v_max_f32 v160, v160, v232
v_sub_f32 v160, 0, v160
v_mov_b32 v232, v176
s_nop 1
v_permlane32_swap_b32 v176, v232
v_max_f32 v176, v176, v232
v_sub_f32 v176, 0, v176
v_mov_b32 v232, v192
s_nop 1
v_permlane32_swap_b32 v192, v232
v_max_f32 v192, v192, v232
v_sub_f32 v192, 0, v192
v_mov_b32 v232, v208
s_nop 1
v_permlane32_swap_b32 v208, v232
v_max_f32 v208, v208, v232
v_sub_f32 v208, 0, v208
s_branch L_att_start
L_att_fin:
v_rcp_f32 v232, v232
v_rcp_f32 v233, v233
v_rcp_f32 v234, v234
v_rcp_f32 v235, v235
s_mul_i32 s41, s35, 36
s_add_u32 s41, s41, s27
s_lshl_b32 s41, s41, 10
s_lshl_b32 s42, s35, 5
s_add_u32 s42, s42, s27
s_lshl_b32 s42, s42, 7
v_lshlrev_b32 v10, 2, v1
v_mov_b32 v11, 0x80000000
v_cmp_gt_u32 vcc, 32, v1
s_nop 1
v_cndmask_b32 v10, v11, v10, vcc
s_add_u32 s8, s6, 0x80000
s_addc_u32 s9, s7, 0
s_mov_b32 s10, 0x40000
s_mov_b32 s11, 0x00020000
s_lshr_b32 s32, s50, 2
s_lshl_b32 s32, s32, 12
s_add_u32 s32, s32, 180224
v_and_b32 v14, 31, v1
v_lshl_add_u32 v14, v14, 7, s32
s_mul_i32 s32, s50, 11264
v_and_b32 v27, 7, v1
v_lshl_add_u32 v27, v27, 7, s32
s_lshl_b32 s33, s51, 10
v_add_u32 v15, s33, v27
s_lshl_b32 s33, s48, 10
v_add_u32 v27, s33, v27
buffer_load_dword v30, v15, s[60:63], 0 offen offset:1024 sc1
v_mul_f32 v48, v232, v48
v_mul_f32 v49, v232, v49
v_mul_f32 v50, v232, v50
v_mul_f32 v51, v232, v51
v_mul_f32 v52, v232, v52
v_mul_f32 v53, v232, v53
v_mul_f32 v54, v232, v54
v_mul_f32 v55, v232, v55
v_mul_f32 v56, v232, v56
v_mul_f32 v57, v232, v57
v_cvt_pk_bf16_f32 v48, v48, v49
v_cvt_pk_bf16_f32 v49, v50, v51
v_cvt_pk_bf16_f32 v50, v52, v53
v_cvt_pk_bf16_f32 v51, v54, v55
v_cvt_pk_bf16_f32 v52, v56, v57
buffer_store_dwordx4 v[48:51], v2, s[16:19], s41 offen sc1
buffer_store_dword v52, v10, s[8:11], s42 offen sc1
s_add_u32 s41, s41, 36864
s_add_u32 s42, s42, 4096
v_mul_f32 v64, v233, v64
v_mul_f32 v65, v233, v65
v_mul_f32 v66, v233, v66
v_mul_f32 v67, v233, v67
v_mul_f32 v68, v233, v68
v_mul_f32 v69, v233, v69
v_mul_f32 v70, v233, v70
v_mul_f32 v71, v233, v71
v_mul_f32 v72, v233, v72
v_mul_f32 v73, v233, v73
v_cvt_pk_bf16_f32 v64, v64, v65
v_cvt_pk_bf16_f32 v65, v66, v67
v_cvt_pk_bf16_f32 v66, v68, v69
v_cvt_pk_bf16_f32 v67, v70, v71
v_cvt_pk_bf16_f32 v68, v72, v73
buffer_store_dwordx4 v[64:67], v2, s[16:19], s41 offen sc1
buffer_store_dword v68, v10, s[8:11], s42 offen sc1
s_add_u32 s41, s41, 36864
s_add_u32 s42, s42, 4096
v_mul_f32 v80, v234, v80
v_mul_f32 v81, v234, v81
v_mul_f32 v82, v234, v82
v_mul_f32 v83, v234, v83
v_mul_f32 v84, v234, v84
v_mul_f32 v85, v234, v85
v_mul_f32 v86, v234, v86
v_mul_f32 v87, v234, v87
v_mul_f32 v88, v234, v88
v_mul_f32 v89, v234, v89
v_cvt_pk_bf16_f32 v80, v80, v81
v_cvt_pk_bf16_f32 v81, v82, v83
v_cvt_pk_bf16_f32 v82, v84, v85
v_cvt_pk_bf16_f32 v83, v86, v87
v_cvt_pk_bf16_f32 v84, v88, v89
buffer_store_dwordx4 v[80:83], v2, s[16:19], s41 offen sc1
buffer_store_dword v84, v10, s[8:11], s42 offen sc1
s_add_u32 s41, s41, 36864
s_add_u32 s42, s42, 4096
v_mul_f32 v96, v235, v96
v_mul_f32 v97, v235, v97
v_mul_f32 v98, v235, v98
v_mul_f32 v99, v235, v99
v_mul_f32 v100, v235, v100
v_mul_f32 v101, v235, v101
v_mul_f32 v102, v235, v102
v_mul_f32 v103, v235, v103
v_mul_f32 v104, v235, v104
v_mul_f32 v105, v235, v105
v_cvt_pk_bf16_f32 v96, v96, v97
v_cvt_pk_bf16_f32 v97, v98, v99
v_cvt_pk_bf16_f32 v98, v100, v101
v_cvt_pk_bf16_f32 v99, v102, v103
v_cvt_pk_bf16_f32 v100, v104, v105
buffer_store_dwordx4 v[96:99], v2, s[16:19], s41 offen sc1
buffer_store_dword v100, v10, s[8:11], s42 offen sc1
v_bfe_u32 v8, v1, 2, 2
v_lshrrev_b32 v9, 5, v1
v_lshl_add_u32 v9, v9, 2, v8
v_lshlrev_b32 v16, 7, v9
v_bfe_u32 v9, v1, 4, 1
v_lshl_add_u32 v16, v9, 5, v16
v_and_b32 v9, 3, v1
v_lshl_add_u32 v16, v9, 3, v16
v_lshrrev_b32 v8, 1, v8
v_lshlrev_b32 v8, 6, v8
v_add_u32 v16, v16, v8
v_xor_b32 v17, 64, v16
v_add_u32 v18, 36864, v16
v_add_u32 v19, 36864, v17
v_bfe_u32 v8, v1, 2, 2
v_lshrrev_b32 v9, 1, v8
v_lshl_add_u32 v20, v3, 2, v9
v_mul_u32_u24 v20, 18, v20
v_and_b32 v8, 1, v8
v_add3_u32 v20, v20, v8, 16
v_lshlrev_b32 v20, 7, v20
v_and_b32 v8, 127, v16
v_add_u32 v20, v20, v8
v_xor_b32 v21, 64, v20
s_and_b32 s43, s51, 1
s_lshl_b32 s43, s43, 6
v_xor_b32 v22, s43, v16
v_add_u32 v22, 73728, v22
v_xor_b32 v23, 64, v22
v_add_u32 v24, 36864, v22
v_add_u32 v25, 36864, v23
v_xor_b32 v26, s43, v20
v_add_u32 v26, 73728, v26
s_lshl_b32 s32, s26, 12
s_lshl_b32 s33, s27, 7
s_add_u32 s32, s32, s33
s_add_u32 s32, s32, 180224
v_mov_b32 v8, s32
v_cmp_eq_u32 vcc, 0, v0
s_nop 1
v_cndmask_b32 v8, v11, v8, vcc
v_mov_b32 v9, 1
s_waitcnt vmcnt(0)
s_barrier
buffer_store_dword v9, v8, s[60:63], 0 offen sc1
s_add_u32 m0, s54, 2048
s_add_u32 s32, s53, 18432
buffer_load_dwordx4 v12, s[68:71], s32 offen lds
s_add_u32 m0, s54, 3072
s_add_u32 s32, s53, 27648
buffer_load_dwordx4 v13, s[68:71], s32 offen lds
s_add_u32 s12, s6, 0xa20000
s_addc_u32 s13, s7, 0
s_mov_b32 s14, 0x240000
s_mov_b32 s15, 0x00020000
s_add_u32 s20, s6, 0x1320000
s_addc_u32 s21, s7, 0
s_mov_b32 s22, 0x1200000
s_mov_b32 s23, 0x00020000
s_mov_b32 s42, 0xbfb8aa3b
v_and_b32 v6, 31, v1
v_lshlrev_b32 v5, 2, v6
v_lshl_add_u32 v5, v3, 9, v5
v_lshlrev_b32 v8, 2, v3
v_sub_u32 v8, v6, v8
v_lshlrev_b32 v6, 7, v6
v_lshl_add_u32 v6, v3, 3, v6
v_bfe_u32 v7, v1, 1, 3
v_lshl_add_u32 v6, v7, 4, v6
v_add_u32 v6, s54, v6
v_add_u32 v7, s54, v2
s_lshl_b32 s32, s51, 12
s_add_u32 s40, s52, s32
s_lshl_b32 s41, s50, 2
s_add_u32 s41, s41, s24
s_lshl_b32 s41, s41, 12
v_mov_b32 v28, 0x3f80
v_mov_b32 v29, 0x3f800000
v_cmp_eq_u32 vcc, 0, v8
s_nop 1
v_cndmask_b32 v9, 0, v28, vcc
v_cmp_eq_u32 vcc, 1, v8
s_nop 1
v_cndmask_b32 v9, v9, v29, vcc
v_accvgpr_write_b32 a176, v9
v_cmp_eq_u32 vcc, 2, v8
s_nop 1
v_cndmask_b32 v9, 0, v28, vcc
v_cmp_eq_u32 vcc, 3, v8
s_nop 1
v_cndmask_b32 v9, v9, v29, vcc
v_accvgpr_write_b32 a177, v9
v_cmp_eq_u32 vcc, 8, v8
s_nop 1
v_cndmask_b32 v9, 0, v28, vcc
v_cmp_eq_u32 vcc, 9, v8
s_nop 1
v_cndmask_b32 v9, v9, v29, vcc
v_accvgpr_write_b32 a178, v9
v_cmp_eq_u32 vcc, 10, v8
s_nop 1
v_cndmask_b32 v9, 0, v28, vcc
v_cmp_eq_u32 vcc, 11, v8
s_nop 1
v_cndmask_b32 v9, v9, v29, vcc
v_accvgpr_write_b32 a179, v9
v_cmp_eq_u32 vcc, 16, v8
s_nop 1
v_cndmask_b32 v9, 0, v28, vcc
v_cmp_eq_u32 vcc, 17, v8
s_nop 1
v_cndmask_b32 v9, v9, v29, vcc
v_accvgpr_write_b32 a180, v9
v_cmp_eq_u32 vcc, 18, v8
s_nop 1
v_cndmask_b32 v9, 0, v28, vcc
v_cmp_eq_u32 vcc, 19, v8
s_nop 1
v_cndmask_b32 v9, v9, v29, vcc
v_accvgpr_write_b32 a181, v9
v_cmp_eq_u32 vcc, 24, v8
s_nop 1
v_cndmask_b32 v9, 0, v28, vcc
v_cmp_eq_u32 vcc, 25, v8
s_nop 1
v_cndmask_b32 v9, v9, v29, vcc
v_accvgpr_write_b32 a182, v9
v_cmp_eq_u32 vcc, 26, v8
s_nop 1
v_cndmask_b32 v9, 0, v28, vcc
v_cmp_eq_u32 vcc, 27, v8
s_nop 1
v_cndmask_b32 v9, v9, v29, vcc
v_accvgpr_write_b32 a183, v9
s_cmp_lt_u32 s51, 4
s_cbranch_scc1 L_fin_g3
s_cmp_ge_u32 s51, 6
s_cbranch_scc1 L_fin_g1
s_cmp_lg_u32 s24, 0
s_cbranch_scc1 L_fin_po_ok
s_mov_b32 s59, 0x40000
L_fin_po:
buffer_load_dword v11, v14, s[60:63], 0 offen offset:0 sc1
s_waitcnt vmcnt(0)
v_cmp_ne_u32 vcc, 0, v11
s_sub_u32 s59, s59, 1
s_cmp_eq_u32 s59, 0
s_cbranch_scc1 L_fin_po_ok
s_cmp_eq_u64 vcc, -1
s_cbranch_scc1 L_fin_po_ok
s_sleep 2
s_branch L_fin_po
L_fin_po_ok:
s_barrier
s_add_u32 s32, s52, 0
buffer_load_dwordx4 a[32:35], v2, s[16:19], s32 offen offset:0 sc1
buffer_load_dwordx4 a[36:39], v2, s[16:19], s32 offen offset:1024 sc1
buffer_load_dwordx4 a[40:43], v2, s[16:19], s32 offen offset:2048 sc1
buffer_load_dwordx4 a[44:47], v2, s[16:19], s32 offen offset:3072 sc1
s_add_u32 s32, s52, 4096
buffer_load_dwordx4 a[48:51], v2, s[16:19], s32 offen offset:0 sc1
buffer_load_dwordx4 a[52:55], v2, s[16:19], s32 offen offset:1024 sc1
buffer_load_dwordx4 a[56:59], v2, s[16:19], s32 offen offset:2048 sc1
buffer_load_dwordx4 a[60:63], v2, s[16:19], s32 offen offset:3072 sc1
s_add_u32 s32, s52, 8192
buffer_load_dwordx4 a[64:67], v2, s[16:19], s32 offen offset:0 sc1
buffer_load_dwordx4 a[68:71], v2, s[16:19], s32 offen offset:1024 sc1
buffer_load_dwordx4 a[72:75], v2, s[16:19], s32 offen offset:2048 sc1
buffer_load_dwordx4 a[76:79], v2, s[16:19], s32 offen offset:3072 sc1
s_add_u32 s32, s52, 12288
buffer_load_dwordx4 a[80:83], v2, s[16:19], s32 offen offset:0 sc1
buffer_load_dwordx4 a[84:87], v2, s[16:19], s32 offen offset:1024 sc1
buffer_load_dwordx4 a[88:91], v2, s[16:19], s32 offen offset:2048 sc1
buffer_load_dwordx4 a[92:95], v2, s[16:19], s32 offen offset:3072 sc1
s_add_u32 s32, s52, 16384
buffer_load_dwordx4 a[96:99], v2, s[16:19], s32 offen offset:0 sc1
buffer_load_dwordx4 a[100:103], v2, s[16:19], s32 offen offset:1024 sc1
buffer_load_dwordx4 a[104:107], v2, s[16:19], s32 offen offset:2048 sc1
buffer_load_dwordx4 a[108:111], v2, s[16:19], s32 offen offset:3072 sc1
s_add_u32 s32, s52, 20480
buffer_load_dwordx4 a[112:115], v2, s[16:19], s32 offen offset:0 sc1
buffer_load_dwordx4 a[116:119], v2, s[16:19], s32 offen offset:1024 sc1
buffer_load_dwordx4 a[120:123], v2, s[16:19], s32 offen offset:2048 sc1
buffer_load_dwordx4 a[124:127], v2, s[16:19], s32 offen offset:3072 sc1
s_add_u32 s32, s52, 24576
buffer_load_dwordx4 a[128:131], v2, s[16:19], s32 offen offset:0 sc1
buffer_load_dwordx4 a[132:135], v2, s[16:19], s32 offen offset:1024 sc1
buffer_load_dwordx4 a[136:139], v2, s[16:19], s32 offen offset:2048 sc1
buffer_load_dwordx4 a[140:143], v2, s[16:19], s32 offen offset:3072 sc1
s_add_u32 s32, s52, 28672
buffer_load_dwordx4 a[144:147], v2, s[16:19], s32 offen offset:0 sc1
buffer_load_dwordx4 a[148:151], v2, s[16:19], s32 offen offset:1024 sc1
buffer_load_dwordx4 a[152:155], v2, s[16:19], s32 offen offset:2048 sc1
buffer_load_dwordx4 a[156:159], v2, s[16:19], s32 offen offset:3072 sc1
buffer_load_dword a160, v5, s[8:11], s41 offen offset:0 sc1
buffer_load_dword a161, v5, s[8:11], s41 offen offset:128 sc1
buffer_load_dword a162, v5, s[8:11], s41 offen offset:256 sc1
buffer_load_dword a163, v5, s[8:11], s41 offen offset:384 sc1
buffer_load_dword a164, v5, s[8:11], s41 offen offset:1024 sc1
buffer_load_dword a165, v5, s[8:11], s41 offen offset:1152 sc1
buffer_load_dword a166, v5, s[8:11], s41 offen offset:1280 sc1
buffer_load_dword a167, v5, s[8:11], s41 offen offset:1408 sc1
buffer_load_dword a168, v5, s[8:11], s41 offen offset:2048 sc1
buffer_load_dword a169, v5, s[8:11], s41 offen offset:2176 sc1
buffer_load_dword a170, v5, s[8:11], s41 offen offset:2304 sc1
buffer_load_dword a171, v5, s[8:11], s41 offen offset:2432 sc1
buffer_load_dword a172, v5, s[8:11], s41 offen offset:3072 sc1
buffer_load_dword a173, v5, s[8:11], s41 offen offset:3200 sc1
buffer_load_dword a174, v5, s[8:11], s41 offen offset:3328 sc1
buffer_load_dword a175, v5, s[8:11], s41 offen offset:3456 sc1
ds_read_b64_tr_b16 a[0:1], v16 offset:0
ds_read_b64_tr_b16 a[2:3], v16 offset:1024
ds_read_b64_tr_b16 a[4:5], v17 offset:0
ds_read_b64_tr_b16 a[6:7], v17 offset:1024
ds_read_b64_tr_b16 a[8:9], v17 offset:2304
ds_read_b64_tr_b16 a[10:11], v17 offset:3328
ds_read_b64_tr_b16 a[12:13], v16 offset:2304
ds_read_b64_tr_b16 a[14:15], v16 offset:3328
ds_read_b64_tr_b16 a[16:17], v16 offset:4608
ds_read_b64_tr_b16 a[18:19], v16 offset:5632
ds_read_b64_tr_b16 a[20:21], v17 offset:4608
ds_read_b64_tr_b16 a[22:23], v17 offset:5632
ds_read_b64_tr_b16 a[24:25], v17 offset:6912
ds_read_b64_tr_b16 a[26:27], v17 offset:7936
s_waitcnt vmcnt(46)
s_waitcnt lgkmcnt(6)
v_mfma_f32_32x32x16_bf16 v[32:47], a[0:3], a[32:35], 0
ds_read_b64_tr_b16 a[28:29], v16 offset:6912
ds_read_b64_tr_b16 a[30:31], v16 offset:7936
v_mfma_f32_32x32x16_bf16 v[48:63], a[4:7], a[32:35], 0
ds_read_b64_tr_b16 a[0:1], v16 offset:9216
ds_read_b64_tr_b16 a[2:3], v16 offset:10240
v_mfma_f32_32x32x16_bf16 v[32:47], a[8:11], a[36:39], v[32:47]
ds_read_b64_tr_b16 a[4:5], v17 offset:9216
ds_read_b64_tr_b16 a[6:7], v17 offset:10240
v_mfma_f32_32x32x16_bf16 v[48:63], a[12:15], a[36:39], v[48:63]
ds_read_b64_tr_b16 a[8:9], v17 offset:11520
ds_read_b64_tr_b16 a[10:11], v17 offset:12544
s_waitcnt vmcnt(44)
s_waitcnt lgkmcnt(6)
v_mfma_f32_32x32x16_bf16 v[32:47], a[16:19], a[40:43], v[32:47]
ds_read_b64_tr_b16 a[12:13], v16 offset:11520
ds_read_b64_tr_b16 a[14:15], v16 offset:12544
v_mfma_f32_32x32x16_bf16 v[48:63], a[20:23], a[40:43], v[48:63]
ds_read_b64_tr_b16 a[16:17], v16 offset:13824
ds_read_b64_tr_b16 a[18:19], v16 offset:14848
v_mfma_f32_32x32x16_bf16 v[32:47], a[24:27], a[44:47], v[32:47]
ds_read_b64_tr_b16 a[20:21], v17 offset:13824
ds_read_b64_tr_b16 a[22:23], v17 offset:14848
v_mfma_f32_32x32x16_bf16 v[48:63], a[28:31], a[44:47], v[48:63]
ds_read_b64_tr_b16 a[24:25], v17 offset:16128
ds_read_b64_tr_b16 a[26:27], v17 offset:17152
s_waitcnt vmcnt(42)
s_waitcnt lgkmcnt(6)
v_mfma_f32_32x32x16_bf16 v[32:47], a[0:3], a[48:51], v[32:47]
ds_read_b64_tr_b16 a[28:29], v16 offset:16128
ds_read_b64_tr_b16 a[30:31], v16 offset:17152
v_mfma_f32_32x32x16_bf16 v[48:63], a[4:7], a[48:51], v[48:63]
ds_read_b64_tr_b16 a[0:1], v16 offset:18432
ds_read_b64_tr_b16 a[2:3], v16 offset:19456
v_mfma_f32_32x32x16_bf16 v[32:47], a[8:11], a[52:55], v[32:47]
ds_read_b64_tr_b16 a[4:5], v17 offset:18432
ds_read_b64_tr_b16 a[6:7], v17 offset:19456
v_mfma_f32_32x32x16_bf16 v[48:63], a[12:15], a[52:55], v[48:63]
ds_read_b64_tr_b16 a[8:9], v17 offset:20736
ds_read_b64_tr_b16 a[10:11], v17 offset:21760
s_waitcnt vmcnt(40)
s_waitcnt lgkmcnt(6)
v_mfma_f32_32x32x16_bf16 v[32:47], a[16:19], a[56:59], v[32:47]
ds_read_b64_tr_b16 a[12:13], v16 offset:20736
ds_read_b64_tr_b16 a[14:15], v16 offset:21760
v_mfma_f32_32x32x16_bf16 v[48:63], a[20:23], a[56:59], v[48:63]
ds_read_b64_tr_b16 a[16:17], v16 offset:23040
ds_read_b64_tr_b16 a[18:19], v16 offset:24064
v_mfma_f32_32x32x16_bf16 v[32:47], a[24:27], a[60:63], v[32:47]
ds_read_b64_tr_b16 a[20:21], v17 offset:23040
ds_read_b64_tr_b16 a[22:23], v17 offset:24064
v_mfma_f32_32x32x16_bf16 v[48:63], a[28:31], a[60:63], v[48:63]
ds_read_b64_tr_b16 a[24:25], v17 offset:25344
ds_read_b64_tr_b16 a[26:27], v17 offset:26368
s_waitcnt vmcnt(38)
s_waitcnt lgkmcnt(6)
v_mfma_f32_32x32x16_bf16 v[32:47], a[0:3], a[64:67], v[32:47]
ds_read_b64_tr_b16 a[28:29], v16 offset:25344
ds_read_b64_tr_b16 a[30:31], v16 offset:26368
v_mfma_f32_32x32x16_bf16 v[48:63], a[4:7], a[64:67], v[48:63]
ds_read_b64_tr_b16 a[0:1], v16 offset:27648
ds_read_b64_tr_b16 a[2:3], v16 offset:28672
v_mfma_f32_32x32x16_bf16 v[32:47], a[8:11], a[68:71], v[32:47]
ds_read_b64_tr_b16 a[4:5], v17 offset:27648
ds_read_b64_tr_b16 a[6:7], v17 offset:28672
v_mfma_f32_32x32x16_bf16 v[48:63], a[12:15], a[68:71], v[48:63]
ds_read_b64_tr_b16 a[8:9], v17 offset:29952
ds_read_b64_tr_b16 a[10:11], v17 offset:30976
s_waitcnt vmcnt(36)
s_waitcnt lgkmcnt(6)
v_mfma_f32_32x32x16_bf16 v[32:47], a[16:19], a[72:75], v[32:47]
ds_read_b64_tr_b16 a[12:13], v16 offset:29952
ds_read_b64_tr_b16 a[14:15], v16 offset:30976
v_mfma_f32_32x32x16_bf16 v[48:63], a[20:23], a[72:75], v[48:63]
ds_read_b64_tr_b16 a[16:17], v16 offset:32256
ds_read_b64_tr_b16 a[18:19], v16 offset:33280
v_mfma_f32_32x32x16_bf16 v[32:47], a[24:27], a[76:79], v[32:47]
ds_read_b64_tr_b16 a[20:21], v17 offset:32256
ds_read_b64_tr_b16 a[22:23], v17 offset:33280
v_mfma_f32_32x32x16_bf16 v[48:63], a[28:31], a[76:79], v[48:63]
ds_read_b64_tr_b16 a[24:25], v17 offset:34560
ds_read_b64_tr_b16 a[26:27], v17 offset:35584
s_waitcnt vmcnt(34)
s_waitcnt lgkmcnt(6)
v_mfma_f32_32x32x16_bf16 v[32:47], a[0:3], a[80:83], v[32:47]
ds_read_b64_tr_b16 a[28:29], v16 offset:34560
ds_read_b64_tr_b16 a[30:31], v16 offset:35584
v_mfma_f32_32x32x16_bf16 v[48:63], a[4:7], a[80:83], v[48:63]
ds_read_b64_tr_b16 a[0:1], v18 offset:0
ds_read_b64_tr_b16 a[2:3], v18 offset:1024
v_mfma_f32_32x32x16_bf16 v[32:47], a[8:11], a[84:87], v[32:47]
ds_read_b64_tr_b16 a[4:5], v19 offset:0
ds_read_b64_tr_b16 a[6:7], v19 offset:1024
v_mfma_f32_32x32x16_bf16 v[48:63], a[12:15], a[84:87], v[48:63]
ds_read_b64_tr_b16 a[8:9], v19 offset:2304
ds_read_b64_tr_b16 a[10:11], v19 offset:3328
s_waitcnt vmcnt(32)
s_waitcnt lgkmcnt(6)
v_mfma_f32_32x32x16_bf16 v[32:47], a[16:19], a[88:91], v[32:47]
ds_read_b64_tr_b16 a[12:13], v18 offset:2304
ds_read_b64_tr_b16 a[14:15], v18 offset:3328
v_mfma_f32_32x32x16_bf16 v[48:63], a[20:23], a[88:91], v[48:63]
ds_read_b64_tr_b16 a[16:17], v18 offset:4608
ds_read_b64_tr_b16 a[18:19], v18 offset:5632
v_mfma_f32_32x32x16_bf16 v[32:47], a[24:27], a[92:95], v[32:47]
ds_read_b64_tr_b16 a[20:21], v19 offset:4608
ds_read_b64_tr_b16 a[22:23], v19 offset:5632
v_mfma_f32_32x32x16_bf16 v[48:63], a[28:31], a[92:95], v[48:63]
ds_read_b64_tr_b16 a[24:25], v19 offset:6912
ds_read_b64_tr_b16 a[26:27], v19 offset:7936
s_waitcnt vmcnt(30)
s_waitcnt lgkmcnt(6)
v_mfma_f32_32x32x16_bf16 v[32:47], a[0:3], a[96:99], v[32:47]
ds_read_b64_tr_b16 a[28:29], v18 offset:6912
ds_read_b64_tr_b16 a[30:31], v18 offset:7936
v_mfma_f32_32x32x16_bf16 v[48:63], a[4:7], a[96:99], v[48:63]
ds_read_b64_tr_b16 a[0:1], v18 offset:9216
ds_read_b64_tr_b16 a[2:3], v18 offset:10240
v_mfma_f32_32x32x16_bf16 v[32:47], a[8:11], a[100:103], v[32:47]
ds_read_b64_tr_b16 a[4:5], v19 offset:9216
ds_read_b64_tr_b16 a[6:7], v19 offset:10240
v_mfma_f32_32x32x16_bf16 v[48:63], a[12:15], a[100:103], v[48:63]
ds_read_b64_tr_b16 a[8:9], v19 offset:11520
ds_read_b64_tr_b16 a[10:11], v19 offset:12544
s_waitcnt vmcnt(28)
s_waitcnt lgkmcnt(6)
v_mfma_f32_32x32x16_bf16 v[32:47], a[16:19], a[104:107], v[32:47]
ds_read_b64_tr_b16 a[12:13], v18 offset:11520
ds_read_b64_tr_b16 a[14:15], v18 offset:12544
v_mfma_f32_32x32x16_bf16 v[48:63], a[20:23], a[104:107], v[48:63]
ds_read_b64_tr_b16 a[16:17], v18 offset:13824
ds_read_b64_tr_b16 a[18:19], v18 offset:14848
v_mfma_f32_32x32x16_bf16 v[32:47], a[24:27], a[108:111], v[32:47]
ds_read_b64_tr_b16 a[20:21], v19 offset:13824
ds_read_b64_tr_b16 a[22:23], v19 offset:14848
v_mfma_f32_32x32x16_bf16 v[48:63], a[28:31], a[108:111], v[48:63]
ds_read_b64_tr_b16 a[24:25], v19 offset:16128
ds_read_b64_tr_b16 a[26:27], v19 offset:17152
s_waitcnt vmcnt(26)
s_waitcnt lgkmcnt(6)
v_mfma_f32_32x32x16_bf16 v[32:47], a[0:3], a[112:115], v[32:47]
ds_read_b64_tr_b16 a[28:29], v18 offset:16128
ds_read_b64_tr_b16 a[30:31], v18 offset:17152
v_mfma_f32_32x32x16_bf16 v[48:63], a[4:7], a[112:115], v[48:63]
ds_read_b64_tr_b16 a[0:1], v18 offset:18432
ds_read_b64_tr_b16 a[2:3], v18 offset:19456
v_mfma_f32_32x32x16_bf16 v[32:47], a[8:11], a[116:119], v[32:47]
ds_read_b64_tr_b16 a[4:5], v19 offset:18432
ds_read_b64_tr_b16 a[6:7], v19 offset:19456
v_mfma_f32_32x32x16_bf16 v[48:63], a[12:15], a[116:119], v[48:63]
ds_read_b64_tr_b16 a[8:9], v19 offset:20736
ds_read_b64_tr_b16 a[10:11], v19 offset:21760
s_waitcnt vmcnt(24)
s_waitcnt lgkmcnt(6)
v_mfma_f32_32x32x16_bf16 v[32:47], a[16:19], a[120:123], v[32:47]
ds_read_b64_tr_b16 a[12:13], v18 offset:20736
ds_read_b64_tr_b16 a[14:15], v18 offset:21760
v_mfma_f32_32x32x16_bf16 v[48:63], a[20:23], a[120:123], v[48:63]
ds_read_b64_tr_b16 a[16:17], v18 offset:23040
ds_read_b64_tr_b16 a[18:19], v18 offset:24064
v_mfma_f32_32x32x16_bf16 v[32:47], a[24:27], a[124:127], v[32:47]
ds_read_b64_tr_b16 a[20:21], v19 offset:23040
ds_read_b64_tr_b16 a[22:23], v19 offset:24064
v_mfma_f32_32x32x16_bf16 v[48:63], a[28:31], a[124:127], v[48:63]
ds_read_b64_tr_b16 a[24:25], v19 offset:25344
ds_read_b64_tr_b16 a[26:27], v19 offset:26368
s_waitcnt vmcnt(22)
s_waitcnt lgkmcnt(6)
v_mfma_f32_32x32x16_bf16 v[32:47], a[0:3], a[128:131], v[32:47]
ds_read_b64_tr_b16 a[28:29], v18 offset:25344
ds_read_b64_tr_b16 a[30:31], v18 offset:26368
v_mfma_f32_32x32x16_bf16 v[48:63], a[4:7], a[128:131], v[48:63]
ds_read_b64_tr_b16 a[0:1], v18 offset:27648
ds_read_b64_tr_b16 a[2:3], v18 offset:28672
v_mfma_f32_32x32x16_bf16 v[32:47], a[8:11], a[132:135], v[32:47]
ds_read_b64_tr_b16 a[4:5], v19 offset:27648
ds_read_b64_tr_b16 a[6:7], v19 offset:28672
v_mfma_f32_32x32x16_bf16 v[48:63], a[12:15], a[132:135], v[48:63]
ds_read_b64_tr_b16 a[8:9], v19 offset:29952
ds_read_b64_tr_b16 a[10:11], v19 offset:30976
s_waitcnt vmcnt(20)
s_waitcnt lgkmcnt(6)
v_mfma_f32_32x32x16_bf16 v[32:47], a[16:19], a[136:139], v[32:47]
ds_read_b64_tr_b16 a[12:13], v18 offset:29952
ds_read_b64_tr_b16 a[14:15], v18 offset:30976
v_mfma_f32_32x32x16_bf16 v[48:63], a[20:23], a[136:139], v[48:63]
ds_read_b64_tr_b16 a[16:17], v18 offset:32256
ds_read_b64_tr_b16 a[18:19], v18 offset:33280
v_mfma_f32_32x32x16_bf16 v[32:47], a[24:27], a[140:143], v[32:47]
ds_read_b64_tr_b16 a[20:21], v19 offset:32256
ds_read_b64_tr_b16 a[22:23], v19 offset:33280
v_mfma_f32_32x32x16_bf16 v[48:63], a[28:31], a[140:143], v[48:63]
ds_read_b64_tr_b16 a[24:25], v19 offset:34560
ds_read_b64_tr_b16 a[26:27], v19 offset:35584
s_waitcnt vmcnt(18)
s_waitcnt lgkmcnt(6)
v_mfma_f32_32x32x16_bf16 v[32:47], a[0:3], a[144:147], v[32:47]
ds_read_b64_tr_b16 a[28:29], v18 offset:34560
ds_read_b64_tr_b16 a[30:31], v18 offset:35584
v_mfma_f32_32x32x16_bf16 v[48:63], a[4:7], a[144:147], v[48:63]
ds_read_b64_tr_b16 a[0:1], v20 offset:0
ds_read_b64_tr_b16 a[2:3], v20 offset:4608
v_mfma_f32_32x32x16_bf16 v[32:47], a[8:11], a[148:151], v[32:47]
ds_read_b64_tr_b16 a[4:5], v21 offset:0
ds_read_b64_tr_b16 a[6:7], v21 offset:4608
v_mfma_f32_32x32x16_bf16 v[48:63], a[12:15], a[148:151], v[48:63]
ds_read_b64_tr_b16 a[8:9], v20 offset:18432
ds_read_b64_tr_b16 a[10:11], v20 offset:23040
s_waitcnt vmcnt(16)
s_waitcnt lgkmcnt(6)
v_mfma_f32_32x32x16_bf16 v[32:47], a[16:19], a[152:155], v[32:47]
ds_read_b64_tr_b16 a[12:13], v21 offset:18432
ds_read_b64_tr_b16 a[14:15], v21 offset:23040
v_mfma_f32_32x32x16_bf16 v[48:63], a[20:23], a[152:155], v[48:63]
ds_read_b64_tr_b16 a[16:17], v20 offset:36864
ds_read_b64_tr_b16 a[18:19], v20 offset:41472
v_mfma_f32_32x32x16_bf16 v[32:47], a[24:27], a[156:159], v[32:47]
ds_read_b64_tr_b16 a[20:21], v21 offset:36864
ds_read_b64_tr_b16 a[22:23], v21 offset:41472
v_mfma_f32_32x32x16_bf16 v[48:63], a[28:31], a[156:159], v[48:63]
ds_read_b64_tr_b16 a[24:25], v20 offset:55296
ds_read_b64_tr_b16 a[26:27], v20 offset:59904
s_waitcnt vmcnt(8)
s_waitcnt lgkmcnt(6)
v_mfma_f32_32x32x16_bf16 v[32:47], a[0:3], a[160:163], v[32:47]
ds_read_b64_tr_b16 a[28:29], v21 offset:55296
ds_read_b64_tr_b16 a[30:31], v21 offset:59904
v_mfma_f32_32x32x16_bf16 v[48:63], a[4:7], a[160:163], v[48:63]
v_mfma_f32_32x32x16_bf16 v[32:47], a[8:11], a[164:167], v[32:47]
v_mfma_f32_32x32x16_bf16 v[48:63], a[12:15], a[164:167], v[48:63]
s_waitcnt vmcnt(0)
s_waitcnt lgkmcnt(0)
v_mfma_f32_32x32x16_bf16 v[32:47], a[16:19], a[168:171], v[32:47]
v_mfma_f32_32x32x16_bf16 v[48:63], a[20:23], a[168:171], v[48:63]
v_mfma_f32_32x32x16_bf16 v[32:47], a[24:27], a[172:175], v[32:47]
v_mfma_f32_32x32x16_bf16 v[48:63], a[28:31], a[172:175], v[48:63]
s_cmp_lg_u32 s24, 0
s_cbranch_scc1 L_fin_pa_ok
s_mov_b32 s59, 0x40000
L_fin_pa:
buffer_load_dword v11, v15, s[60:63], 0 offen offset:1024 sc1
s_waitcnt vmcnt(0)
v_cmp_ne_u32 vcc, 0, v11
s_sub_u32 s59, s59, 1
s_cmp_eq_u32 s59, 0
s_cbranch_scc1 L_fin_pa_ok
s_cmp_eq_u64 vcc, -1
s_cbranch_scc1 L_fin_pa_ok
s_sleep 4
s_branch L_fin_pa
L_fin_pa_ok:
s_barrier
buffer_load_dwordx4 v[112:115], v2, s[12:15], s40 offen offset:0 sc1
buffer_load_dwordx4 v[116:119], v2, s[12:15], s40 offen offset:1024 sc1
buffer_load_dwordx4 v[120:123], v2, s[12:15], s40 offen offset:2048 sc1
buffer_load_dwordx4 v[124:127], v2, s[12:15], s40 offen offset:3072 sc1
s_add_u32 s32, s40, 0x0
buffer_load_dwordx4 v[128:131], v2, s[20:23], s32 offen offset:0 sc1
buffer_load_dwordx4 v[132:135], v2, s[20:23], s32 offen offset:1024 sc1
buffer_load_dwordx4 v[136:139], v2, s[20:23], s32 offen offset:2048 sc1
buffer_load_dwordx4 v[140:143], v2, s[20:23], s32 offen offset:3072 sc1
s_add_u32 s32, s40, 0x240000
buffer_load_dwordx4 v[144:147], v2, s[20:23], s32 offen offset:0 sc1
buffer_load_dwordx4 v[148:151], v2, s[20:23], s32 offen offset:1024 sc1
buffer_load_dwordx4 v[152:155], v2, s[20:23], s32 offen offset:2048 sc1
buffer_load_dwordx4 v[156:159], v2, s[20:23], s32 offen offset:3072 sc1
s_add_u32 s32, s40, 0x480000
buffer_load_dwordx4 v[160:163], v2, s[20:23], s32 offen offset:0 sc1
buffer_load_dwordx4 v[164:167], v2, s[20:23], s32 offen offset:1024 sc1
buffer_load_dwordx4 v[168:171], v2, s[20:23], s32 offen offset:2048 sc1
buffer_load_dwordx4 v[172:175], v2, s[20:23], s32 offen offset:3072 sc1
s_add_u32 s32, s40, 0x6c0000
buffer_load_dwordx4 v[176:179], v2, s[20:23], s32 offen offset:0 sc1
buffer_load_dwordx4 v[180:183], v2, s[20:23], s32 offen offset:1024 sc1
buffer_load_dwordx4 v[184:187], v2, s[20:23], s32 offen offset:2048 sc1
buffer_load_dwordx4 v[188:191], v2, s[20:23], s32 offen offset:3072 sc1
s_add_u32 s32, s40, 0x900000
buffer_load_dwordx4 v[192:195], v2, s[20:23], s32 offen offset:0 sc1
buffer_load_dwordx4 v[196:199], v2, s[20:23], s32 offen offset:1024 sc1
buffer_load_dwordx4 v[200:203], v2, s[20:23], s32 offen offset:2048 sc1
buffer_load_dwordx4 v[204:207], v2, s[20:23], s32 offen offset:3072 sc1
s_add_u32 s32, s40, 0xb40000
buffer_load_dwordx4 v[208:211], v2, s[20:23], s32 offen offset:0 sc1
buffer_load_dwordx4 v[212:215], v2, s[20:23], s32 offen offset:1024 sc1
buffer_load_dwordx4 v[216:219], v2, s[20:23], s32 offen offset:2048 sc1
buffer_load_dwordx4 v[220:223], v2, s[20:23], s32 offen offset:3072 sc1
s_add_u32 s32, s40, 0xd80000
buffer_load_dwordx4 v[224:227], v2, s[20:23], s32 offen offset:0 sc1
buffer_load_dwordx4 v[228:231], v2, s[20:23], s32 offen offset:1024 sc1
buffer_load_dwordx4 v[232:235], v2, s[20:23], s32 offen offset:2048 sc1
buffer_load_dwordx4 v[236:239], v2, s[20:23], s32 offen offset:3072 sc1
s_add_u32 s32, s40, 0xfc0000
buffer_load_dwordx4 v[240:243], v2, s[20:23], s32 offen offset:0 sc1
buffer_load_dwordx4 v[244:247], v2, s[20:23], s32 offen offset:1024 sc1
buffer_load_dwordx4 v[248:251], v2, s[20:23], s32 offen offset:2048 sc1
buffer_load_dwordx4 v[252:255], v2, s[20:23], s32 offen offset:3072 sc1
v_xor_b32 v16, 0, v6
v_xor_b32 v17, 16, v6
v_xor_b32 v18, 32, v6
v_xor_b32 v19, 48, v6
v_xor_b32 v20, 64, v6
v_xor_b32 v21, 80, v6
v_xor_b32 v22, 96, v6
v_xor_b32 v23, 112, v6
s_waitcnt vmcnt(32)
v_mfma_f32_32x32x16_bf16 v[80:95], a[176:179], v[112:115], 0
v_mfma_f32_32x32x16_bf16 v[80:95], a[180:183], v[116:119], v[80:95]
v_mfma_f32_32x32x16_bf16 v[96:111], a[176:179], v[120:123], 0
v_mfma_f32_32x32x16_bf16 v[96:111], a[180:183], v[124:127], v[96:111]
s_waitcnt vmcnt(28)
v_mfma_f32_32x32x16_bf16 v[80:95], a[176:179], v[128:131], v[80:95]
v_mfma_f32_32x32x16_bf16 v[80:95], a[180:183], v[132:135], v[80:95]
v_mfma_f32_32x32x16_bf16 v[96:111], a[176:179], v[136:139], v[96:111]
v_mfma_f32_32x32x16_bf16 v[96:111], a[180:183], v[140:143], v[96:111]
ds_read_b64 v[112:113], v16
ds_read_b64 v[114:115], v17
ds_read_b64 v[116:117], v18
ds_read_b64 v[118:119], v19
ds_read_b64 v[120:121], v20
ds_read_b64 v[122:123], v21
ds_read_b64 v[124:125], v22
ds_read_b64 v[126:127], v23
s_waitcnt vmcnt(24)
v_mfma_f32_32x32x16_bf16 v[80:95], a[176:179], v[144:147], v[80:95]
v_mfma_f32_32x32x16_bf16 v[80:95], a[180:183], v[148:151], v[80:95]
v_mfma_f32_32x32x16_bf16 v[96:111], a[176:179], v[152:155], v[96:111]
v_mfma_f32_32x32x16_bf16 v[96:111], a[180:183], v[156:159], v[96:111]
s_waitcnt vmcnt(20)
v_mfma_f32_32x32x16_bf16 v[80:95], a[176:179], v[160:163], v[80:95]
v_mfma_f32_32x32x16_bf16 v[80:95], a[180:183], v[164:167], v[80:95]
v_mfma_f32_32x32x16_bf16 v[96:111], a[176:179], v[168:171], v[96:111]
v_mfma_f32_32x32x16_bf16 v[96:111], a[180:183], v[172:175], v[96:111]
s_waitcnt vmcnt(16)
v_mfma_f32_32x32x16_bf16 v[80:95], a[176:179], v[176:179], v[80:95]
v_mfma_f32_32x32x16_bf16 v[80:95], a[180:183], v[180:183], v[80:95]
v_mfma_f32_32x32x16_bf16 v[96:111], a[176:179], v[184:187], v[96:111]
v_mfma_f32_32x32x16_bf16 v[96:111], a[180:183], v[188:191], v[96:111]
s_waitcnt vmcnt(12)
v_mfma_f32_32x32x16_bf16 v[80:95], a[176:179], v[192:195], v[80:95]
v_mfma_f32_32x32x16_bf16 v[80:95], a[180:183], v[196:199], v[80:95]
v_mfma_f32_32x32x16_bf16 v[96:111], a[176:179], v[200:203], v[96:111]
v_mfma_f32_32x32x16_bf16 v[96:111], a[180:183], v[204:207], v[96:111]
s_waitcnt vmcnt(8)
v_mfma_f32_32x32x16_bf16 v[80:95], a[176:179], v[208:211], v[80:95]
v_mfma_f32_32x32x16_bf16 v[80:95], a[180:183], v[212:215], v[80:95]
v_mfma_f32_32x32x16_bf16 v[96:111], a[176:179], v[216:219], v[96:111]
v_mfma_f32_32x32x16_bf16 v[96:111], a[180:183], v[220:223], v[96:111]
s_waitcnt vmcnt(4)
v_mfma_f32_32x32x16_bf16 v[80:95], a[176:179], v[224:227], v[80:95]
v_mfma_f32_32x32x16_bf16 v[80:95], a[180:183], v[228:231], v[80:95]
v_mfma_f32_32x32x16_bf16 v[96:111], a[176:179], v[232:235], v[96:111]
v_mfma_f32_32x32x16_bf16 v[96:111], a[180:183], v[236:239], v[96:111]
s_waitcnt vmcnt(0)
v_mfma_f32_32x32x16_bf16 v[80:95], a[176:179], v[240:243], v[80:95]
v_mfma_f32_32x32x16_bf16 v[80:95], a[180:183], v[244:247], v[80:95]
v_mfma_f32_32x32x16_bf16 v[96:111], a[176:179], v[248:251], v[96:111]
v_mfma_f32_32x32x16_bf16 v[96:111], a[180:183], v[252:255], v[96:111]
s_waitcnt lgkmcnt(0)
s_nop 8
v_mul_f32 v128, s42, v80
v_mul_f32 v129, s42, v81
v_mul_f32 v130, s42, v82
v_mul_f32 v131, s42, v83
v_lshlrev_b32 v132, 16, v112
v_and_b32 v133, 0xffff0000, v112
v_lshlrev_b32 v134, 16, v113
v_and_b32 v135, 0xffff0000, v113
v_exp_f32 v128, v128
v_exp_f32 v129, v129
v_exp_f32 v130, v130
v_exp_f32 v131, v131
v_mul_f32 v80, v80, v32
v_mul_f32 v81, v81, v33
v_mul_f32 v82, v82, v34
v_mul_f32 v83, v83, v35
v_add_f32 v128, 1.0, v128
v_add_f32 v129, 1.0, v129
v_add_f32 v130, 1.0, v130
v_add_f32 v131, 1.0, v131
v_rcp_f32 v128, v128
v_rcp_f32 v129, v129
v_rcp_f32 v130, v130
v_rcp_f32 v131, v131
v_fmac_f32 v132, v80, v128
v_fmac_f32 v133, v81, v129
v_fmac_f32 v134, v82, v130
v_fmac_f32 v135, v83, v131
v_cvt_pk_bf16_f32 v80, v132, v133
v_cvt_pk_bf16_f32 v81, v134, v135
ds_write_b64 v16, v[80:81]
v_mul_f32 v136, s42, v84
v_mul_f32 v137, s42, v85
v_mul_f32 v138, s42, v86
v_mul_f32 v139, s42, v87
v_lshlrev_b32 v140, 16, v114
v_and_b32 v141, 0xffff0000, v114
v_lshlrev_b32 v142, 16, v115
v_and_b32 v143, 0xffff0000, v115
v_exp_f32 v136, v136
v_exp_f32 v137, v137
v_exp_f32 v138, v138
v_exp_f32 v139, v139
v_mul_f32 v84, v84, v36
v_mul_f32 v85, v85, v37
v_mul_f32 v86, v86, v38
v_mul_f32 v87, v87, v39
v_add_f32 v136, 1.0, v136
v_add_f32 v137, 1.0, v137
v_add_f32 v138, 1.0, v138
v_add_f32 v139, 1.0, v139
v_rcp_f32 v136, v136
v_rcp_f32 v137, v137
v_rcp_f32 v138, v138
v_rcp_f32 v139, v139
v_fmac_f32 v140, v84, v136
v_fmac_f32 v141, v85, v137
v_fmac_f32 v142, v86, v138
v_fmac_f32 v143, v87, v139
v_cvt_pk_bf16_f32 v84, v140, v141
v_cvt_pk_bf16_f32 v85, v142, v143
ds_write_b64 v17, v[84:85]
v_mul_f32 v128, s42, v88
v_mul_f32 v129, s42, v89
v_mul_f32 v130, s42, v90
v_mul_f32 v131, s42, v91
v_lshlrev_b32 v132, 16, v116
v_and_b32 v133, 0xffff0000, v116
v_lshlrev_b32 v134, 16, v117
v_and_b32 v135, 0xffff0000, v117
v_exp_f32 v128, v128
v_exp_f32 v129, v129
v_exp_f32 v130, v130
v_exp_f32 v131, v131
v_mul_f32 v88, v88, v40
v_mul_f32 v89, v89, v41
v_mul_f32 v90, v90, v42
v_mul_f32 v91, v91, v43
v_add_f32 v128, 1.0, v128
v_add_f32 v129, 1.0, v129
v_add_f32 v130, 1.0, v130
v_add_f32 v131, 1.0, v131
v_rcp_f32 v128, v128
v_rcp_f32 v129, v129
v_rcp_f32 v130, v130
v_rcp_f32 v131, v131
v_fmac_f32 v132, v88, v128
v_fmac_f32 v133, v89, v129
v_fmac_f32 v134, v90, v130
v_fmac_f32 v135, v91, v131
v_cvt_pk_bf16_f32 v88, v132, v133
v_cvt_pk_bf16_f32 v89, v134, v135
ds_write_b64 v18, v[88:89]
v_mul_f32 v136, s42, v92
v_mul_f32 v137, s42, v93
v_mul_f32 v138, s42, v94
v_mul_f32 v139, s42, v95
v_lshlrev_b32 v140, 16, v118
v_and_b32 v141, 0xffff0000, v118
v_lshlrev_b32 v142, 16, v119
v_and_b32 v143, 0xffff0000, v119
v_exp_f32 v136, v136
v_exp_f32 v137, v137
v_exp_f32 v138, v138
v_exp_f32 v139, v139
v_mul_f32 v92, v92, v44
v_mul_f32 v93, v93, v45
v_mul_f32 v94, v94, v46
v_mul_f32 v95, v95, v47
v_add_f32 v136, 1.0, v136
v_add_f32 v137, 1.0, v137
v_add_f32 v138, 1.0, v138
v_add_f32 v139, 1.0, v139
v_rcp_f32 v136, v136
v_rcp_f32 v137, v137
v_rcp_f32 v138, v138
v_rcp_f32 v139, v139
v_fmac_f32 v140, v92, v136
v_fmac_f32 v141, v93, v137
v_fmac_f32 v142, v94, v138
v_fmac_f32 v143, v95, v139
v_cvt_pk_bf16_f32 v92, v140, v141
v_cvt_pk_bf16_f32 v93, v142, v143
ds_write_b64 v19, v[92:93]
v_mul_f32 v128, s42, v96
v_mul_f32 v129, s42, v97
v_mul_f32 v130, s42, v98
v_mul_f32 v131, s42, v99
v_lshlrev_b32 v132, 16, v120
v_and_b32 v133, 0xffff0000, v120
v_lshlrev_b32 v134, 16, v121
v_and_b32 v135, 0xffff0000, v121
v_exp_f32 v128, v128
v_exp_f32 v129, v129
v_exp_f32 v130, v130
v_exp_f32 v131, v131
v_mul_f32 v96, v96, v48
v_mul_f32 v97, v97, v49
v_mul_f32 v98, v98, v50
v_mul_f32 v99, v99, v51
v_add_f32 v128, 1.0, v128
v_add_f32 v129, 1.0, v129
v_add_f32 v130, 1.0, v130
v_add_f32 v131, 1.0, v131
v_rcp_f32 v128, v128
v_rcp_f32 v129, v129
v_rcp_f32 v130, v130
v_rcp_f32 v131, v131
v_fmac_f32 v132, v96, v128
v_fmac_f32 v133, v97, v129
v_fmac_f32 v134, v98, v130
v_fmac_f32 v135, v99, v131
v_cvt_pk_bf16_f32 v96, v132, v133
v_cvt_pk_bf16_f32 v97, v134, v135
ds_write_b64 v20, v[96:97]
v_mul_f32 v136, s42, v100
v_mul_f32 v137, s42, v101
v_mul_f32 v138, s42, v102
v_mul_f32 v139, s42, v103
v_lshlrev_b32 v140, 16, v122
v_and_b32 v141, 0xffff0000, v122
v_lshlrev_b32 v142, 16, v123
v_and_b32 v143, 0xffff0000, v123
v_exp_f32 v136, v136
v_exp_f32 v137, v137
v_exp_f32 v138, v138
v_exp_f32 v139, v139
v_mul_f32 v100, v100, v52
v_mul_f32 v101, v101, v53
v_mul_f32 v102, v102, v54
v_mul_f32 v103, v103, v55
v_add_f32 v136, 1.0, v136
v_add_f32 v137, 1.0, v137
v_add_f32 v138, 1.0, v138
v_add_f32 v139, 1.0, v139
v_rcp_f32 v136, v136
v_rcp_f32 v137, v137
v_rcp_f32 v138, v138
v_rcp_f32 v139, v139
v_fmac_f32 v140, v100, v136
v_fmac_f32 v141, v101, v137
v_fmac_f32 v142, v102, v138
v_fmac_f32 v143, v103, v139
v_cvt_pk_bf16_f32 v100, v140, v141
v_cvt_pk_bf16_f32 v101, v142, v143
ds_write_b64 v21, v[100:101]
v_mul_f32 v128, s42, v104
v_mul_f32 v129, s42, v105
v_mul_f32 v130, s42, v106
v_mul_f32 v131, s42, v107
v_lshlrev_b32 v132, 16, v124
v_and_b32 v133, 0xffff0000, v124
v_lshlrev_b32 v134, 16, v125
v_and_b32 v135, 0xffff0000, v125
v_exp_f32 v128, v128
v_exp_f32 v129, v129
v_exp_f32 v130, v130
v_exp_f32 v131, v131
v_mul_f32 v104, v104, v56
v_mul_f32 v105, v105, v57
v_mul_f32 v106, v106, v58
v_mul_f32 v107, v107, v59
v_add_f32 v128, 1.0, v128
v_add_f32 v129, 1.0, v129
v_add_f32 v130, 1.0, v130
v_add_f32 v131, 1.0, v131
v_rcp_f32 v128, v128
v_rcp_f32 v129, v129
v_rcp_f32 v130, v130
v_rcp_f32 v131, v131
v_fmac_f32 v132, v104, v128
v_fmac_f32 v133, v105, v129
v_fmac_f32 v134, v106, v130
v_fmac_f32 v135, v107, v131
v_cvt_pk_bf16_f32 v104, v132, v133
v_cvt_pk_bf16_f32 v105, v134, v135
ds_write_b64 v22, v[104:105]
v_mul_f32 v136, s42, v108
v_mul_f32 v137, s42, v109
v_mul_f32 v138, s42, v110
v_mul_f32 v139, s42, v111
v_lshlrev_b32 v140, 16, v126
v_and_b32 v141, 0xffff0000, v126
v_lshlrev_b32 v142, 16, v127
v_and_b32 v143, 0xffff0000, v127
v_exp_f32 v136, v136
v_exp_f32 v137, v137
v_exp_f32 v138, v138
v_exp_f32 v139, v139
v_mul_f32 v108, v108, v60
v_mul_f32 v109, v109, v61
v_mul_f32 v110, v110, v62
v_mul_f32 v111, v111, v63
v_add_f32 v136, 1.0, v136
v_add_f32 v137, 1.0, v137
v_add_f32 v138, 1.0, v138
v_add_f32 v139, 1.0, v139
v_rcp_f32 v136, v136
v_rcp_f32 v137, v137
v_rcp_f32 v138, v138
v_rcp_f32 v139, v139
v_fmac_f32 v140, v108, v136
v_fmac_f32 v141, v109, v137
v_fmac_f32 v142, v110, v138
v_fmac_f32 v143, v111, v139
v_cvt_pk_bf16_f32 v108, v140, v141
v_cvt_pk_bf16_f32 v109, v142, v143
ds_write_b64 v23, v[108:109]
s_waitcnt lgkmcnt(0)
ds_read_b128 v[144:147], v7 offset:0
ds_read_b128 v[148:151], v7 offset:1024
ds_read_b128 v[152:155], v7 offset:2048
ds_read_b128 v[156:159], v7 offset:3072
s_waitcnt lgkmcnt(3)
s_add_u32 s32, s53, 0
buffer_store_dwordx4 v[144:147], v12, s[72:75], s32 offen sc1
s_waitcnt lgkmcnt(2)
s_add_u32 s32, s53, 9216
buffer_store_dwordx4 v[148:151], v13, s[72:75], s32 offen sc1
s_waitcnt lgkmcnt(1)
s_add_u32 s32, s53, 18432
buffer_store_dwordx4 v[152:155], v12, s[72:75], s32 offen sc1
s_waitcnt lgkmcnt(0)
s_add_u32 s32, s53, 27648
buffer_store_dwordx4 v[156:159], v13, s[72:75], s32 offen sc1
s_branch L_fin_end
L_fin_g1:
s_lshl_b32 s32, s48, 7
s_add_u32 s53, s52, s32
s_lshl_b32 s32, s48, 12
s_add_u32 s40, s52, s32
s_lshl_b32 s32, s43, 5
s_add_u32 s40, s40, s32
v_xor_b32 v6, s43, v6
v_mov_b32 v8, 0x80000000
v_and_b32 v9, 64, v12
v_cmp_eq_u32 vcc, s43, v9
s_nop 1
v_cndmask_b32 v28, v8, v12, vcc
v_cndmask_b32 v29, v13, v8, vcc
s_cmp_lg_u32 s24, 0
s_cbranch_scc1 L_fin_po1_ok
s_mov_b32 s59, 0x40000
L_fin_po1:
buffer_load_dword v11, v14, s[60:63], 0 offen offset:0 sc1
s_waitcnt vmcnt(0)
v_cmp_ne_u32 vcc, 0, v11
s_sub_u32 s59, s59, 1
s_cmp_eq_u32 s59, 0
s_cbranch_scc1 L_fin_po1_ok
s_cmp_eq_u64 vcc, -1
s_cbranch_scc1 L_fin_po1_ok
s_sleep 2
s_branch L_fin_po1
L_fin_po1_ok:
s_barrier
s_add_u32 s32, s52, 0
buffer_load_dwordx4 a[32:35], v2, s[16:19], s32 offen offset:0 sc1
buffer_load_dwordx4 a[36:39], v2, s[16:19], s32 offen offset:1024 sc1
buffer_load_dwordx4 a[40:43], v2, s[16:19], s32 offen offset:2048 sc1
buffer_load_dwordx4 a[44:47], v2, s[16:19], s32 offen offset:3072 sc1
s_add_u32 s32, s52, 4096
buffer_load_dwordx4 a[48:51], v2, s[16:19], s32 offen offset:0 sc1
buffer_load_dwordx4 a[52:55], v2, s[16:19], s32 offen offset:1024 sc1
buffer_load_dwordx4 a[56:59], v2, s[16:19], s32 offen offset:2048 sc1
buffer_load_dwordx4 a[60:63], v2, s[16:19], s32 offen offset:3072 sc1
s_add_u32 s32, s52, 8192
buffer_load_dwordx4 a[64:67], v2, s[16:19], s32 offen offset:0 sc1
buffer_load_dwordx4 a[68:71], v2, s[16:19], s32 offen offset:1024 sc1
buffer_load_dwordx4 a[72:75], v2, s[16:19], s32 offen offset:2048 sc1
buffer_load_dwordx4 a[76:79], v2, s[16:19], s32 offen offset:3072 sc1
s_add_u32 s32, s52, 12288
buffer_load_dwordx4 a[80:83], v2, s[16:19], s32 offen offset:0 sc1
buffer_load_dwordx4 a[84:87], v2, s[16:19], s32 offen offset:1024 sc1
buffer_load_dwordx4 a[88:91], v2, s[16:19], s32 offen offset:2048 sc1
buffer_load_dwordx4 a[92:95], v2, s[16:19], s32 offen offset:3072 sc1
s_add_u32 s32, s52, 16384
buffer_load_dwordx4 a[96:99], v2, s[16:19], s32 offen offset:0 sc1
buffer_load_dwordx4 a[100:103], v2, s[16:19], s32 offen offset:1024 sc1
buffer_load_dwordx4 a[104:107], v2, s[16:19], s32 offen offset:2048 sc1
buffer_load_dwordx4 a[108:111], v2, s[16:19], s32 offen offset:3072 sc1
s_add_u32 s32, s52, 20480
buffer_load_dwordx4 a[112:115], v2, s[16:19], s32 offen offset:0 sc1
buffer_load_dwordx4 a[116:119], v2, s[16:19], s32 offen offset:1024 sc1
buffer_load_dwordx4 a[120:123], v2, s[16:19], s32 offen offset:2048 sc1
buffer_load_dwordx4 a[124:127], v2, s[16:19], s32 offen offset:3072 sc1
s_add_u32 s32, s52, 24576
buffer_load_dwordx4 a[128:131], v2, s[16:19], s32 offen offset:0 sc1
buffer_load_dwordx4 a[132:135], v2, s[16:19], s32 offen offset:1024 sc1
buffer_load_dwordx4 a[136:139], v2, s[16:19], s32 offen offset:2048 sc1
buffer_load_dwordx4 a[140:143], v2, s[16:19], s32 offen offset:3072 sc1
s_add_u32 s32, s52, 28672
buffer_load_dwordx4 a[144:147], v2, s[16:19], s32 offen offset:0 sc1
buffer_load_dwordx4 a[148:151], v2, s[16:19], s32 offen offset:1024 sc1
buffer_load_dwordx4 a[152:155], v2, s[16:19], s32 offen offset:2048 sc1
buffer_load_dwordx4 a[156:159], v2, s[16:19], s32 offen offset:3072 sc1
buffer_load_dword a160, v5, s[8:11], s41 offen offset:0 sc1
buffer_load_dword a161, v5, s[8:11], s41 offen offset:128 sc1
buffer_load_dword a162, v5, s[8:11], s41 offen offset:256 sc1
buffer_load_dword a163, v5, s[8:11], s41 offen offset:384 sc1
buffer_load_dword a164, v5, s[8:11], s41 offen offset:1024 sc1
buffer_load_dword a165, v5, s[8:11], s41 offen offset:1152 sc1
buffer_load_dword a166, v5, s[8:11], s41 offen offset:1280 sc1
buffer_load_dword a167, v5, s[8:11], s41 offen offset:1408 sc1
buffer_load_dword a168, v5, s[8:11], s41 offen offset:2048 sc1
buffer_load_dword a169, v5, s[8:11], s41 offen offset:2176 sc1
buffer_load_dword a170, v5, s[8:11], s41 offen offset:2304 sc1
buffer_load_dword a171, v5, s[8:11], s41 offen offset:2432 sc1
buffer_load_dword a172, v5, s[8:11], s41 offen offset:3072 sc1
buffer_load_dword a173, v5, s[8:11], s41 offen offset:3200 sc1
buffer_load_dword a174, v5, s[8:11], s41 offen offset:3328 sc1
buffer_load_dword a175, v5, s[8:11], s41 offen offset:3456 sc1
ds_read_b64_tr_b16 a[0:1], v22 offset:0
ds_read_b64_tr_b16 a[2:3], v22 offset:1024
ds_read_b64_tr_b16 a[4:5], v23 offset:2304
ds_read_b64_tr_b16 a[6:7], v23 offset:3328
ds_read_b64_tr_b16 a[8:9], v22 offset:4608
ds_read_b64_tr_b16 a[10:11], v22 offset:5632
ds_read_b64_tr_b16 a[12:13], v23 offset:6912
ds_read_b64_tr_b16 a[14:15], v23 offset:7936
ds_read_b64_tr_b16 a[16:17], v22 offset:9216
ds_read_b64_tr_b16 a[18:19], v22 offset:10240
ds_read_b64_tr_b16 a[20:21], v23 offset:11520
ds_read_b64_tr_b16 a[22:23], v23 offset:12544
ds_read_b64_tr_b16 a[24:25], v22 offset:13824
ds_read_b64_tr_b16 a[26:27], v22 offset:14848
s_waitcnt vmcnt(46)
s_waitcnt lgkmcnt(6)
v_mfma_f32_32x32x16_bf16 v[64:79], a[0:3], a[32:35], 0
ds_read_b64_tr_b16 a[28:29], v23 offset:16128
ds_read_b64_tr_b16 a[30:31], v23 offset:17152
v_mfma_f32_32x32x16_bf16 v[64:79], a[4:7], a[36:39], v[64:79]
ds_read_b64_tr_b16 a[0:1], v22 offset:18432
ds_read_b64_tr_b16 a[2:3], v22 offset:19456
s_waitcnt vmcnt(44)
v_mfma_f32_32x32x16_bf16 v[64:79], a[8:11], a[40:43], v[64:79]
ds_read_b64_tr_b16 a[4:5], v23 offset:20736
ds_read_b64_tr_b16 a[6:7], v23 offset:21760
v_mfma_f32_32x32x16_bf16 v[64:79], a[12:15], a[44:47], v[64:79]
ds_read_b64_tr_b16 a[8:9], v22 offset:23040
ds_read_b64_tr_b16 a[10:11], v22 offset:24064
s_waitcnt vmcnt(42)
s_waitcnt lgkmcnt(6)
v_mfma_f32_32x32x16_bf16 v[64:79], a[16:19], a[48:51], v[64:79]
ds_read_b64_tr_b16 a[12:13], v23 offset:25344
ds_read_b64_tr_b16 a[14:15], v23 offset:26368
v_mfma_f32_32x32x16_bf16 v[64:79], a[20:23], a[52:55], v[64:79]
ds_read_b64_tr_b16 a[16:17], v22 offset:27648
ds_read_b64_tr_b16 a[18:19], v22 offset:28672
s_waitcnt vmcnt(40)
v_mfma_f32_32x32x16_bf16 v[64:79], a[24:27], a[56:59], v[64:79]
ds_read_b64_tr_b16 a[20:21], v23 offset:29952
ds_read_b64_tr_b16 a[22:23], v23 offset:30976
v_mfma_f32_32x32x16_bf16 v[64:79], a[28:31], a[60:63], v[64:79]
ds_read_b64_tr_b16 a[24:25], v22 offset:32256
ds_read_b64_tr_b16 a[26:27], v22 offset:33280
s_waitcnt vmcnt(38)
s_waitcnt lgkmcnt(6)
v_mfma_f32_32x32x16_bf16 v[64:79], a[0:3], a[64:67], v[64:79]
ds_read_b64_tr_b16 a[28:29], v23 offset:34560
ds_read_b64_tr_b16 a[30:31], v23 offset:35584
v_mfma_f32_32x32x16_bf16 v[64:79], a[4:7], a[68:71], v[64:79]
ds_read_b64_tr_b16 a[0:1], v24 offset:0
ds_read_b64_tr_b16 a[2:3], v24 offset:1024
s_waitcnt vmcnt(36)
v_mfma_f32_32x32x16_bf16 v[64:79], a[8:11], a[72:75], v[64:79]
ds_read_b64_tr_b16 a[4:5], v25 offset:2304
ds_read_b64_tr_b16 a[6:7], v25 offset:3328
v_mfma_f32_32x32x16_bf16 v[64:79], a[12:15], a[76:79], v[64:79]
ds_read_b64_tr_b16 a[8:9], v24 offset:4608
ds_read_b64_tr_b16 a[10:11], v24 offset:5632
s_waitcnt vmcnt(34)
s_waitcnt lgkmcnt(6)
v_mfma_f32_32x32x16_bf16 v[64:79], a[16:19], a[80:83], v[64:79]
ds_read_b64_tr_b16 a[12:13], v25 offset:6912
ds_read_b64_tr_b16 a[14:15], v25 offset:7936
v_mfma_f32_32x32x16_bf16 v[64:79], a[20:23], a[84:87], v[64:79]
ds_read_b64_tr_b16 a[16:17], v24 offset:9216
ds_read_b64_tr_b16 a[18:19], v24 offset:10240
s_waitcnt vmcnt(32)
v_mfma_f32_32x32x16_bf16 v[64:79], a[24:27], a[88:91], v[64:79]
ds_read_b64_tr_b16 a[20:21], v25 offset:11520
ds_read_b64_tr_b16 a[22:23], v25 offset:12544
v_mfma_f32_32x32x16_bf16 v[64:79], a[28:31], a[92:95], v[64:79]
ds_read_b64_tr_b16 a[24:25], v24 offset:13824
ds_read_b64_tr_b16 a[26:27], v24 offset:14848
s_waitcnt vmcnt(30)
s_waitcnt lgkmcnt(6)
v_mfma_f32_32x32x16_bf16 v[64:79], a[0:3], a[96:99], v[64:79]
ds_read_b64_tr_b16 a[28:29], v25 offset:16128
ds_read_b64_tr_b16 a[30:31], v25 offset:17152
v_mfma_f32_32x32x16_bf16 v[64:79], a[4:7], a[100:103], v[64:79]
ds_read_b64_tr_b16 a[0:1], v24 offset:18432
ds_read_b64_tr_b16 a[2:3], v24 offset:19456
s_waitcnt vmcnt(28)
v_mfma_f32_32x32x16_bf16 v[64:79], a[8:11], a[104:107], v[64:79]
ds_read_b64_tr_b16 a[4:5], v25 offset:20736
ds_read_b64_tr_b16 a[6:7], v25 offset:21760
v_mfma_f32_32x32x16_bf16 v[64:79], a[12:15], a[108:111], v[64:79]
ds_read_b64_tr_b16 a[8:9], v24 offset:23040
ds_read_b64_tr_b16 a[10:11], v24 offset:24064
s_waitcnt vmcnt(26)
s_waitcnt lgkmcnt(6)
v_mfma_f32_32x32x16_bf16 v[64:79], a[16:19], a[112:115], v[64:79]
ds_read_b64_tr_b16 a[12:13], v25 offset:25344
ds_read_b64_tr_b16 a[14:15], v25 offset:26368
v_mfma_f32_32x32x16_bf16 v[64:79], a[20:23], a[116:119], v[64:79]
ds_read_b64_tr_b16 a[16:17], v24 offset:27648
ds_read_b64_tr_b16 a[18:19], v24 offset:28672
s_waitcnt vmcnt(24)
v_mfma_f32_32x32x16_bf16 v[64:79], a[24:27], a[120:123], v[64:79]
ds_read_b64_tr_b16 a[20:21], v25 offset:29952
ds_read_b64_tr_b16 a[22:23], v25 offset:30976
v_mfma_f32_32x32x16_bf16 v[64:79], a[28:31], a[124:127], v[64:79]
ds_read_b64_tr_b16 a[24:25], v24 offset:32256
ds_read_b64_tr_b16 a[26:27], v24 offset:33280
s_waitcnt vmcnt(22)
s_waitcnt lgkmcnt(6)
v_mfma_f32_32x32x16_bf16 v[64:79], a[0:3], a[128:131], v[64:79]
ds_read_b64_tr_b16 a[28:29], v25 offset:34560
ds_read_b64_tr_b16 a[30:31], v25 offset:35584
v_mfma_f32_32x32x16_bf16 v[64:79], a[4:7], a[132:135], v[64:79]
ds_read_b64_tr_b16 a[0:1], v26 offset:0
ds_read_b64_tr_b16 a[2:3], v26 offset:4608
s_waitcnt vmcnt(20)
v_mfma_f32_32x32x16_bf16 v[64:79], a[8:11], a[136:139], v[64:79]
ds_read_b64_tr_b16 a[4:5], v26 offset:18432
ds_read_b64_tr_b16 a[6:7], v26 offset:23040
v_mfma_f32_32x32x16_bf16 v[64:79], a[12:15], a[140:143], v[64:79]
ds_read_b64_tr_b16 a[8:9], v26 offset:36864
ds_read_b64_tr_b16 a[10:11], v26 offset:41472
s_waitcnt vmcnt(18)
s_waitcnt lgkmcnt(6)
v_mfma_f32_32x32x16_bf16 v[64:79], a[16:19], a[144:147], v[64:79]
ds_read_b64_tr_b16 a[12:13], v26 offset:55296
ds_read_b64_tr_b16 a[14:15], v26 offset:59904
v_mfma_f32_32x32x16_bf16 v[64:79], a[20:23], a[148:151], v[64:79]
s_waitcnt vmcnt(16)
v_mfma_f32_32x32x16_bf16 v[64:79], a[24:27], a[152:155], v[64:79]
v_mfma_f32_32x32x16_bf16 v[64:79], a[28:31], a[156:159], v[64:79]
s_waitcnt vmcnt(8)
s_waitcnt lgkmcnt(0)
v_mfma_f32_32x32x16_bf16 v[64:79], a[0:3], a[160:163], v[64:79]
v_mfma_f32_32x32x16_bf16 v[64:79], a[4:7], a[164:167], v[64:79]
s_waitcnt vmcnt(0)
v_mfma_f32_32x32x16_bf16 v[64:79], a[8:11], a[168:171], v[64:79]
v_mfma_f32_32x32x16_bf16 v[64:79], a[12:15], a[172:175], v[64:79]
s_cmp_lg_u32 s24, 0
s_cbranch_scc1 L_fin_pa1_ok
s_mov_b32 s59, 0x40000
L_fin_pa1:
buffer_load_dword v11, v27, s[60:63], 0 offen offset:1024 sc1
s_waitcnt vmcnt(0)
v_cmp_ne_u32 vcc, 0, v11
s_sub_u32 s59, s59, 1
s_cmp_eq_u32 s59, 0
s_cbranch_scc1 L_fin_pa1_ok
s_cmp_eq_u64 vcc, -1
s_cbranch_scc1 L_fin_pa1_ok
s_sleep 4
s_branch L_fin_pa1
L_fin_pa1_ok:
s_barrier
buffer_load_dwordx4 v[112:115], v2, s[12:15], s40 offen offset:0 sc1
buffer_load_dwordx4 v[116:119], v2, s[12:15], s40 offen offset:1024 sc1
s_add_u32 s32, s40, 0x0
buffer_load_dwordx4 v[120:123], v2, s[20:23], s32 offen offset:0 sc1
buffer_load_dwordx4 v[124:127], v2, s[20:23], s32 offen offset:1024 sc1
s_add_u32 s32, s40, 0x240000
buffer_load_dwordx4 v[128:131], v2, s[20:23], s32 offen offset:0 sc1
buffer_load_dwordx4 v[132:135], v2, s[20:23], s32 offen offset:1024 sc1
s_add_u32 s32, s40, 0x480000
buffer_load_dwordx4 v[136:139], v2, s[20:23], s32 offen offset:0 sc1
buffer_load_dwordx4 v[140:143], v2, s[20:23], s32 offen offset:1024 sc1
s_add_u32 s32, s40, 0x6c0000
buffer_load_dwordx4 v[144:147], v2, s[20:23], s32 offen offset:0 sc1
buffer_load_dwordx4 v[148:151], v2, s[20:23], s32 offen offset:1024 sc1
s_add_u32 s32, s40, 0x900000
buffer_load_dwordx4 v[152:155], v2, s[20:23], s32 offen offset:0 sc1
buffer_load_dwordx4 v[156:159], v2, s[20:23], s32 offen offset:1024 sc1
s_add_u32 s32, s40, 0xb40000
buffer_load_dwordx4 v[160:163], v2, s[20:23], s32 offen offset:0 sc1
buffer_load_dwordx4 v[164:167], v2, s[20:23], s32 offen offset:1024 sc1
s_add_u32 s32, s40, 0xd80000
buffer_load_dwordx4 v[168:171], v2, s[20:23], s32 offen offset:0 sc1
buffer_load_dwordx4 v[172:175], v2, s[20:23], s32 offen offset:1024 sc1
s_add_u32 s32, s40, 0xfc0000
buffer_load_dwordx4 v[176:179], v2, s[20:23], s32 offen offset:0 sc1
buffer_load_dwordx4 v[180:183], v2, s[20:23], s32 offen offset:1024 sc1
v_xor_b32 v16, 0, v6
v_xor_b32 v17, 16, v6
v_xor_b32 v18, 32, v6
v_xor_b32 v19, 48, v6
s_waitcnt vmcnt(16)
v_mfma_f32_32x32x16_bf16 v[80:95], a[176:179], v[112:115], 0
v_mfma_f32_32x32x16_bf16 v[80:95], a[180:183], v[116:119], v[80:95]
s_waitcnt vmcnt(14)
v_mfma_f32_32x32x16_bf16 v[80:95], a[176:179], v[120:123], v[80:95]
v_mfma_f32_32x32x16_bf16 v[80:95], a[180:183], v[124:127], v[80:95]
ds_read_b64 v[112:113], v16
ds_read_b64 v[114:115], v17
ds_read_b64 v[116:117], v18
ds_read_b64 v[118:119], v19
s_waitcnt vmcnt(12)
v_mfma_f32_32x32x16_bf16 v[80:95], a[176:179], v[128:131], v[80:95]
v_mfma_f32_32x32x16_bf16 v[80:95], a[180:183], v[132:135], v[80:95]
s_waitcnt vmcnt(10)
v_mfma_f32_32x32x16_bf16 v[80:95], a[176:179], v[136:139], v[80:95]
v_mfma_f32_32x32x16_bf16 v[80:95], a[180:183], v[140:143], v[80:95]
s_waitcnt vmcnt(8)
v_mfma_f32_32x32x16_bf16 v[80:95], a[176:179], v[144:147], v[80:95]
v_mfma_f32_32x32x16_bf16 v[80:95], a[180:183], v[148:151], v[80:95]
s_waitcnt vmcnt(6)
v_mfma_f32_32x32x16_bf16 v[80:95], a[176:179], v[152:155], v[80:95]
v_mfma_f32_32x32x16_bf16 v[80:95], a[180:183], v[156:159], v[80:95]
s_waitcnt vmcnt(4)
v_mfma_f32_32x32x16_bf16 v[80:95], a[176:179], v[160:163], v[80:95]
v_mfma_f32_32x32x16_bf16 v[80:95], a[180:183], v[164:167], v[80:95]
s_waitcnt vmcnt(2)
v_mfma_f32_32x32x16_bf16 v[80:95], a[176:179], v[168:171], v[80:95]
v_mfma_f32_32x32x16_bf16 v[80:95], a[180:183], v[172:175], v[80:95]
s_waitcnt vmcnt(0)
v_mfma_f32_32x32x16_bf16 v[80:95], a[176:179], v[176:179], v[80:95]
v_mfma_f32_32x32x16_bf16 v[80:95], a[180:183], v[180:183], v[80:95]
s_waitcnt lgkmcnt(0)
s_nop 10
v_mul_f32 v128, s42, v80
v_mul_f32 v129, s42, v81
v_mul_f32 v130, s42, v82
v_mul_f32 v131, s42, v83
v_lshlrev_b32 v132, 16, v112
v_and_b32 v133, 0xffff0000, v112
v_lshlrev_b32 v134, 16, v113
v_and_b32 v135, 0xffff0000, v113
v_exp_f32 v128, v128
v_exp_f32 v129, v129
v_exp_f32 v130, v130
v_exp_f32 v131, v131
v_mul_f32 v80, v80, v64
v_mul_f32 v81, v81, v65
v_mul_f32 v82, v82, v66
v_mul_f32 v83, v83, v67
v_add_f32 v128, 1.0, v128
v_add_f32 v129, 1.0, v129
v_add_f32 v130, 1.0, v130
v_add_f32 v131, 1.0, v131
v_rcp_f32 v128, v128
v_rcp_f32 v129, v129
v_rcp_f32 v130, v130
v_rcp_f32 v131, v131
v_fmac_f32 v132, v80, v128
v_fmac_f32 v133, v81, v129
v_fmac_f32 v134, v82, v130
v_fmac_f32 v135, v83, v131
v_cvt_pk_bf16_f32 v80, v132, v133
v_cvt_pk_bf16_f32 v81, v134, v135
ds_write_b64 v16, v[80:81]
v_mul_f32 v136, s42, v84
v_mul_f32 v137, s42, v85
v_mul_f32 v138, s42, v86
v_mul_f32 v139, s42, v87
v_lshlrev_b32 v140, 16, v114
v_and_b32 v141, 0xffff0000, v114
v_lshlrev_b32 v142, 16, v115
v_and_b32 v143, 0xffff0000, v115
v_exp_f32 v136, v136
v_exp_f32 v137, v137
v_exp_f32 v138, v138
v_exp_f32 v139, v139
v_mul_f32 v84, v84, v68
v_mul_f32 v85, v85, v69
v_mul_f32 v86, v86, v70
v_mul_f32 v87, v87, v71
v_add_f32 v136, 1.0, v136
v_add_f32 v137, 1.0, v137
v_add_f32 v138, 1.0, v138
v_add_f32 v139, 1.0, v139
v_rcp_f32 v136, v136
v_rcp_f32 v137, v137
v_rcp_f32 v138, v138
v_rcp_f32 v139, v139
v_fmac_f32 v140, v84, v136
v_fmac_f32 v141, v85, v137
v_fmac_f32 v142, v86, v138
v_fmac_f32 v143, v87, v139
v_cvt_pk_bf16_f32 v84, v140, v141
v_cvt_pk_bf16_f32 v85, v142, v143
ds_write_b64 v17, v[84:85]
v_mul_f32 v128, s42, v88
v_mul_f32 v129, s42, v89
v_mul_f32 v130, s42, v90
v_mul_f32 v131, s42, v91
v_lshlrev_b32 v132, 16, v116
v_and_b32 v133, 0xffff0000, v116
v_lshlrev_b32 v134, 16, v117
v_and_b32 v135, 0xffff0000, v117
v_exp_f32 v128, v128
v_exp_f32 v129, v129
v_exp_f32 v130, v130
v_exp_f32 v131, v131
v_mul_f32 v88, v88, v72
v_mul_f32 v89, v89, v73
v_mul_f32 v90, v90, v74
v_mul_f32 v91, v91, v75
v_add_f32 v128, 1.0, v128
v_add_f32 v129, 1.0, v129
v_add_f32 v130, 1.0, v130
v_add_f32 v131, 1.0, v131
v_rcp_f32 v128, v128
v_rcp_f32 v129, v129
v_rcp_f32 v130, v130
v_rcp_f32 v131, v131
v_fmac_f32 v132, v88, v128
v_fmac_f32 v133, v89, v129
v_fmac_f32 v134, v90, v130
v_fmac_f32 v135, v91, v131
v_cvt_pk_bf16_f32 v88, v132, v133
v_cvt_pk_bf16_f32 v89, v134, v135
ds_write_b64 v18, v[88:89]
v_mul_f32 v136, s42, v92
v_mul_f32 v137, s42, v93
v_mul_f32 v138, s42, v94
v_mul_f32 v139, s42, v95
v_lshlrev_b32 v140, 16, v118
v_and_b32 v141, 0xffff0000, v118
v_lshlrev_b32 v142, 16, v119
v_and_b32 v143, 0xffff0000, v119
v_exp_f32 v136, v136
v_exp_f32 v137, v137
v_exp_f32 v138, v138
v_exp_f32 v139, v139
v_mul_f32 v92, v92, v76
v_mul_f32 v93, v93, v77
v_mul_f32 v94, v94, v78
v_mul_f32 v95, v95, v79
v_add_f32 v136, 1.0, v136
v_add_f32 v137, 1.0, v137
v_add_f32 v138, 1.0, v138
v_add_f32 v139, 1.0, v139
v_rcp_f32 v136, v136
v_rcp_f32 v137, v137
v_rcp_f32 v138, v138
v_rcp_f32 v139, v139
v_fmac_f32 v140, v92, v136
v_fmac_f32 v141, v93, v137
v_fmac_f32 v142, v94, v138
v_fmac_f32 v143, v95, v139
v_cvt_pk_bf16_f32 v92, v140, v141
v_cvt_pk_bf16_f32 v93, v142, v143
ds_write_b64 v19, v[92:93]
s_waitcnt lgkmcnt(0)
ds_read_b128 v[144:147], v7 offset:0
ds_read_b128 v[148:151], v7 offset:1024
ds_read_b128 v[152:155], v7 offset:2048
ds_read_b128 v[156:159], v7 offset:3072
s_waitcnt lgkmcnt(3)
s_add_u32 s32, s53, 0
buffer_store_dwordx4 v[144:147], v28, s[72:75], s32 offen sc1
s_waitcnt lgkmcnt(2)
s_add_u32 s32, s53, 9216
buffer_store_dwordx4 v[148:151], v29, s[72:75], s32 offen sc1
s_waitcnt lgkmcnt(1)
s_add_u32 s32, s53, 18432
buffer_store_dwordx4 v[152:155], v28, s[72:75], s32 offen sc1
s_waitcnt lgkmcnt(0)
s_add_u32 s32, s53, 27648
buffer_store_dwordx4 v[156:159], v29, s[72:75], s32 offen sc1
s_branch L_fin_end
L_fin_g3:
v_cmp_ne_u32 vcc, 0, v30
s_mov_b32 s59, 0x40000
s_cmp_eq_u64 vcc, -1
s_cbranch_scc1 L_fin_pa3_ok
L_fin_pa3:
s_sleep 4
buffer_load_dword v30, v15, s[60:63], 0 offen offset:1024 sc1
s_waitcnt vmcnt(0)
v_cmp_ne_u32 vcc, 0, v30
s_sub_u32 s59, s59, 1
s_cmp_eq_u32 s59, 0
s_cbranch_scc1 L_fin_pa3_ok
s_cmp_eq_u64 vcc, -1
s_cbranch_scc0 L_fin_pa3
L_fin_pa3_ok:
s_cmp_eq_u32 s24, 0
s_cbranch_scc1 L_fin_w0a
buffer_load_dwordx4 v[112:115], v2, s[12:15], s40 offen offset:0 sc1
buffer_load_dwordx4 v[116:119], v2, s[12:15], s40 offen offset:1024 sc1
buffer_load_dwordx4 v[120:123], v2, s[12:15], s40 offen offset:2048 sc1
buffer_load_dwordx4 v[124:127], v2, s[12:15], s40 offen offset:3072 sc1
s_add_u32 s32, s40, 0x0
buffer_load_dwordx4 v[128:131], v2, s[20:23], s32 offen offset:0 sc1
buffer_load_dwordx4 v[132:135], v2, s[20:23], s32 offen offset:1024 sc1
buffer_load_dwordx4 v[136:139], v2, s[20:23], s32 offen offset:2048 sc1
buffer_load_dwordx4 v[140:143], v2, s[20:23], s32 offen offset:3072 sc1
s_add_u32 s32, s40, 0x240000
buffer_load_dwordx4 v[144:147], v2, s[20:23], s32 offen offset:0 sc1
buffer_load_dwordx4 v[148:151], v2, s[20:23], s32 offen offset:1024 sc1
buffer_load_dwordx4 v[152:155], v2, s[20:23], s32 offen offset:2048 sc1
buffer_load_dwordx4 v[156:159], v2, s[20:23], s32 offen offset:3072 sc1
s_add_u32 s32, s40, 0x480000
buffer_load_dwordx4 v[160:163], v2, s[20:23], s32 offen offset:0 sc1
buffer_load_dwordx4 v[164:167], v2, s[20:23], s32 offen offset:1024 sc1
buffer_load_dwordx4 v[168:171], v2, s[20:23], s32 offen offset:2048 sc1
buffer_load_dwordx4 v[172:175], v2, s[20:23], s32 offen offset:3072 sc1
s_add_u32 s32, s40, 0x6c0000
buffer_load_dwordx4 v[176:179], v2, s[20:23], s32 offen offset:0 sc1
buffer_load_dwordx4 v[180:183], v2, s[20:23], s32 offen offset:1024 sc1
buffer_load_dwordx4 v[184:187], v2, s[20:23], s32 offen offset:2048 sc1
buffer_load_dwordx4 v[188:191], v2, s[20:23], s32 offen offset:3072 sc1
s_add_u32 s32, s40, 0x900000
buffer_load_dwordx4 v[192:195], v2, s[20:23], s32 offen offset:0 sc1
buffer_load_dwordx4 v[196:199], v2, s[20:23], s32 offen offset:1024 sc1
buffer_load_dwordx4 v[200:203], v2, s[20:23], s32 offen offset:2048 sc1
buffer_load_dwordx4 v[204:207], v2, s[20:23], s32 offen offset:3072 sc1
s_add_u32 s32, s40, 0xb40000
buffer_load_dwordx4 v[208:211], v2, s[20:23], s32 offen offset:0 sc1
buffer_load_dwordx4 v[212:215], v2, s[20:23], s32 offen offset:1024 sc1
buffer_load_dwordx4 v[216:219], v2, s[20:23], s32 offen offset:2048 sc1
buffer_load_dwordx4 v[220:223], v2, s[20:23], s32 offen offset:3072 sc1
s_add_u32 s32, s40, 0xd80000
buffer_load_dwordx4 v[224:227], v2, s[20:23], s32 offen offset:0 sc1
buffer_load_dwordx4 v[228:231], v2, s[20:23], s32 offen offset:1024 sc1
buffer_load_dwordx4 v[232:235], v2, s[20:23], s32 offen offset:2048 sc1
buffer_load_dwordx4 v[236:239], v2, s[20:23], s32 offen offset:3072 sc1
s_add_u32 s32, s40, 0xfc0000
buffer_load_dwordx4 v[240:243], v2, s[20:23], s32 offen offset:0 sc1
buffer_load_dwordx4 v[244:247], v2, s[20:23], s32 offen offset:1024 sc1
buffer_load_dwordx4 v[248:251], v2, s[20:23], s32 offen offset:2048 sc1
buffer_load_dwordx4 v[252:255], v2, s[20:23], s32 offen offset:3072 sc1
L_fin_w0a:
s_cmp_lg_u32 s24, 0
s_cbranch_scc1 L_fin_po3_ok
s_mov_b32 s59, 0x40000
L_fin_po3:
buffer_load_dword v11, v14, s[60:63], 0 offen offset:0 sc1
s_waitcnt vmcnt(0)
v_cmp_ne_u32 vcc, 0, v11
s_sub_u32 s59, s59, 1
s_cmp_eq_u32 s59, 0
s_cbranch_scc1 L_fin_po3_ok
s_cmp_eq_u64 vcc, -1
s_cbranch_scc1 L_fin_po3_ok
s_sleep 2
s_branch L_fin_po3
L_fin_po3_ok:
s_barrier
s_add_u32 s32, s52, 0
buffer_load_dwordx4 a[32:35], v2, s[16:19], s32 offen offset:0 sc1
buffer_load_dwordx4 a[36:39], v2, s[16:19], s32 offen offset:1024 sc1
buffer_load_dwordx4 a[40:43], v2, s[16:19], s32 offen offset:2048 sc1
buffer_load_dwordx4 a[44:47], v2, s[16:19], s32 offen offset:3072 sc1
s_add_u32 s32, s52, 4096
buffer_load_dwordx4 a[48:51], v2, s[16:19], s32 offen offset:0 sc1
buffer_load_dwordx4 a[52:55], v2, s[16:19], s32 offen offset:1024 sc1
buffer_load_dwordx4 a[56:59], v2, s[16:19], s32 offen offset:2048 sc1
buffer_load_dwordx4 a[60:63], v2, s[16:19], s32 offen offset:3072 sc1
s_add_u32 s32, s52, 8192
buffer_load_dwordx4 a[64:67], v2, s[16:19], s32 offen offset:0 sc1
buffer_load_dwordx4 a[68:71], v2, s[16:19], s32 offen offset:1024 sc1
buffer_load_dwordx4 a[72:75], v2, s[16:19], s32 offen offset:2048 sc1
buffer_load_dwordx4 a[76:79], v2, s[16:19], s32 offen offset:3072 sc1
s_add_u32 s32, s52, 12288
buffer_load_dwordx4 a[80:83], v2, s[16:19], s32 offen offset:0 sc1
buffer_load_dwordx4 a[84:87], v2, s[16:19], s32 offen offset:1024 sc1
buffer_load_dwordx4 a[88:91], v2, s[16:19], s32 offen offset:2048 sc1
buffer_load_dwordx4 a[92:95], v2, s[16:19], s32 offen offset:3072 sc1
s_add_u32 s32, s52, 16384
buffer_load_dwordx4 a[96:99], v2, s[16:19], s32 offen offset:0 sc1
buffer_load_dwordx4 a[100:103], v2, s[16:19], s32 offen offset:1024 sc1
buffer_load_dwordx4 a[104:107], v2, s[16:19], s32 offen offset:2048 sc1
buffer_load_dwordx4 a[108:111], v2, s[16:19], s32 offen offset:3072 sc1
s_add_u32 s32, s52, 20480
buffer_load_dwordx4 a[112:115], v2, s[16:19], s32 offen offset:0 sc1
buffer_load_dwordx4 a[116:119], v2, s[16:19], s32 offen offset:1024 sc1
buffer_load_dwordx4 a[120:123], v2, s[16:19], s32 offen offset:2048 sc1
buffer_load_dwordx4 a[124:127], v2, s[16:19], s32 offen offset:3072 sc1
s_add_u32 s32, s52, 24576
buffer_load_dwordx4 a[128:131], v2, s[16:19], s32 offen offset:0 sc1
buffer_load_dwordx4 a[132:135], v2, s[16:19], s32 offen offset:1024 sc1
buffer_load_dwordx4 a[136:139], v2, s[16:19], s32 offen offset:2048 sc1
buffer_load_dwordx4 a[140:143], v2, s[16:19], s32 offen offset:3072 sc1
s_add_u32 s32, s52, 28672
buffer_load_dwordx4 a[144:147], v2, s[16:19], s32 offen offset:0 sc1
buffer_load_dwordx4 a[148:151], v2, s[16:19], s32 offen offset:1024 sc1
buffer_load_dwordx4 a[152:155], v2, s[16:19], s32 offen offset:2048 sc1
buffer_load_dwordx4 a[156:159], v2, s[16:19], s32 offen offset:3072 sc1
buffer_load_dword a160, v5, s[8:11], s41 offen offset:0 sc1
buffer_load_dword a161, v5, s[8:11], s41 offen offset:128 sc1
buffer_load_dword a162, v5, s[8:11], s41 offen offset:256 sc1
buffer_load_dword a163, v5, s[8:11], s41 offen offset:384 sc1
buffer_load_dword a164, v5, s[8:11], s41 offen offset:1024 sc1
buffer_load_dword a165, v5, s[8:11], s41 offen offset:1152 sc1
buffer_load_dword a166, v5, s[8:11], s41 offen offset:1280 sc1
buffer_load_dword a167, v5, s[8:11], s41 offen offset:1408 sc1
buffer_load_dword a168, v5, s[8:11], s41 offen offset:2048 sc1
buffer_load_dword a169, v5, s[8:11], s41 offen offset:2176 sc1
buffer_load_dword a170, v5, s[8:11], s41 offen offset:2304 sc1
buffer_load_dword a171, v5, s[8:11], s41 offen offset:2432 sc1
buffer_load_dword a172, v5, s[8:11], s41 offen offset:3072 sc1
buffer_load_dword a173, v5, s[8:11], s41 offen offset:3200 sc1
buffer_load_dword a174, v5, s[8:11], s41 offen offset:3328 sc1
buffer_load_dword a175, v5, s[8:11], s41 offen offset:3456 sc1
s_cmp_lg_u32 s24, 0
s_cbranch_scc1 L_fin_w0b
buffer_load_dwordx4 v[112:115], v2, s[12:15], s40 offen offset:0 sc1
buffer_load_dwordx4 v[116:119], v2, s[12:15], s40 offen offset:1024 sc1
buffer_load_dwordx4 v[120:123], v2, s[12:15], s40 offen offset:2048 sc1
buffer_load_dwordx4 v[124:127], v2, s[12:15], s40 offen offset:3072 sc1
s_add_u32 s32, s40, 0x0
buffer_load_dwordx4 v[128:131], v2, s[20:23], s32 offen offset:0 sc1
buffer_load_dwordx4 v[132:135], v2, s[20:23], s32 offen offset:1024 sc1
buffer_load_dwordx4 v[136:139], v2, s[20:23], s32 offen offset:2048 sc1
buffer_load_dwordx4 v[140:143], v2, s[20:23], s32 offen offset:3072 sc1
s_add_u32 s32, s40, 0x240000
buffer_load_dwordx4 v[144:147], v2, s[20:23], s32 offen offset:0 sc1
buffer_load_dwordx4 v[148:151], v2, s[20:23], s32 offen offset:1024 sc1
buffer_load_dwordx4 v[152:155], v2, s[20:23], s32 offen offset:2048 sc1
buffer_load_dwordx4 v[156:159], v2, s[20:23], s32 offen offset:3072 sc1
s_add_u32 s32, s40, 0x480000
buffer_load_dwordx4 v[160:163], v2, s[20:23], s32 offen offset:0 sc1
buffer_load_dwordx4 v[164:167], v2, s[20:23], s32 offen offset:1024 sc1
buffer_load_dwordx4 v[168:171], v2, s[20:23], s32 offen offset:2048 sc1
buffer_load_dwordx4 v[172:175], v2, s[20:23], s32 offen offset:3072 sc1
s_add_u32 s32, s40, 0x6c0000
buffer_load_dwordx4 v[176:179], v2, s[20:23], s32 offen offset:0 sc1
buffer_load_dwordx4 v[180:183], v2, s[20:23], s32 offen offset:1024 sc1
buffer_load_dwordx4 v[184:187], v2, s[20:23], s32 offen offset:2048 sc1
buffer_load_dwordx4 v[188:191], v2, s[20:23], s32 offen offset:3072 sc1
s_add_u32 s32, s40, 0x900000
buffer_load_dwordx4 v[192:195], v2, s[20:23], s32 offen offset:0 sc1
buffer_load_dwordx4 v[196:199], v2, s[20:23], s32 offen offset:1024 sc1
buffer_load_dwordx4 v[200:203], v2, s[20:23], s32 offen offset:2048 sc1
buffer_load_dwordx4 v[204:207], v2, s[20:23], s32 offen offset:3072 sc1
s_add_u32 s32, s40, 0xb40000
buffer_load_dwordx4 v[208:211], v2, s[20:23], s32 offen offset:0 sc1
buffer_load_dwordx4 v[212:215], v2, s[20:23], s32 offen offset:1024 sc1
buffer_load_dwordx4 v[216:219], v2, s[20:23], s32 offen offset:2048 sc1
buffer_load_dwordx4 v[220:223], v2, s[20:23], s32 offen offset:3072 sc1
s_add_u32 s32, s40, 0xd80000
buffer_load_dwordx4 v[224:227], v2, s[20:23], s32 offen offset:0 sc1
buffer_load_dwordx4 v[228:231], v2, s[20:23], s32 offen offset:1024 sc1
buffer_load_dwordx4 v[232:235], v2, s[20:23], s32 offen offset:2048 sc1
buffer_load_dwordx4 v[236:239], v2, s[20:23], s32 offen offset:3072 sc1
s_add_u32 s32, s40, 0xfc0000
buffer_load_dwordx4 v[240:243], v2, s[20:23], s32 offen offset:0 sc1
buffer_load_dwordx4 v[244:247], v2, s[20:23], s32 offen offset:1024 sc1
buffer_load_dwordx4 v[248:251], v2, s[20:23], s32 offen offset:2048 sc1
buffer_load_dwordx4 v[252:255], v2, s[20:23], s32 offen offset:3072 sc1
L_fin_w0b:
ds_read_b64_tr_b16 a[0:1], v16 offset:0
ds_read_b64_tr_b16 a[2:3], v16 offset:1024
ds_read_b64_tr_b16 a[4:5], v17 offset:0
ds_read_b64_tr_b16 a[6:7], v17 offset:1024
ds_read_b64_tr_b16 a[8:9], v22 offset:0
ds_read_b64_tr_b16 a[10:11], v22 offset:1024
ds_read_b64_tr_b16 a[12:13], v17 offset:2304
ds_read_b64_tr_b16 a[14:15], v17 offset:3328
ds_read_b64_tr_b16 a[16:17], v16 offset:2304
ds_read_b64_tr_b16 a[18:19], v16 offset:3328
ds_read_b64_tr_b16 a[20:21], v23 offset:2304
ds_read_b64_tr_b16 a[22:23], v23 offset:3328
ds_read_b64_tr_b16 a[24:25], v16 offset:4608
ds_read_b64_tr_b16 a[26:27], v16 offset:5632
s_waitcnt vmcnt(46)
s_waitcnt lgkmcnt(6)
v_mfma_f32_32x32x16_bf16 v[32:47], a[0:3], a[32:35], 0
ds_read_b64_tr_b16 a[28:29], v17 offset:4608
ds_read_b64_tr_b16 a[30:31], v17 offset:5632
v_mfma_f32_32x32x16_bf16 v[48:63], a[4:7], a[32:35], 0
ds_read_b64_tr_b16 a[0:1], v22 offset:4608
ds_read_b64_tr_b16 a[2:3], v22 offset:5632
v_mfma_f32_32x32x16_bf16 v[64:79], a[8:11], a[32:35], 0
ds_read_b64_tr_b16 a[4:5], v17 offset:6912
ds_read_b64_tr_b16 a[6:7], v17 offset:7936
v_mfma_f32_32x32x16_bf16 v[32:47], a[12:15], a[36:39], v[32:47]
ds_read_b64_tr_b16 a[8:9], v16 offset:6912
ds_read_b64_tr_b16 a[10:11], v16 offset:7936
s_waitcnt lgkmcnt(6)
v_mfma_f32_32x32x16_bf16 v[48:63], a[16:19], a[36:39], v[48:63]
ds_read_b64_tr_b16 a[12:13], v23 offset:6912
ds_read_b64_tr_b16 a[14:15], v23 offset:7936
v_mfma_f32_32x32x16_bf16 v[64:79], a[20:23], a[36:39], v[64:79]
ds_read_b64_tr_b16 a[16:17], v16 offset:9216
ds_read_b64_tr_b16 a[18:19], v16 offset:10240
s_waitcnt vmcnt(44)
v_mfma_f32_32x32x16_bf16 v[32:47], a[24:27], a[40:43], v[32:47]
ds_read_b64_tr_b16 a[20:21], v17 offset:9216
ds_read_b64_tr_b16 a[22:23], v17 offset:10240
v_mfma_f32_32x32x16_bf16 v[48:63], a[28:31], a[40:43], v[48:63]
ds_read_b64_tr_b16 a[24:25], v22 offset:9216
ds_read_b64_tr_b16 a[26:27], v22 offset:10240
s_waitcnt lgkmcnt(6)
v_mfma_f32_32x32x16_bf16 v[64:79], a[0:3], a[40:43], v[64:79]
ds_read_b64_tr_b16 a[28:29], v17 offset:11520
ds_read_b64_tr_b16 a[30:31], v17 offset:12544
v_mfma_f32_32x32x16_bf16 v[32:47], a[4:7], a[44:47], v[32:47]
ds_read_b64_tr_b16 a[0:1], v16 offset:11520
ds_read_b64_tr_b16 a[2:3], v16 offset:12544
v_mfma_f32_32x32x16_bf16 v[48:63], a[8:11], a[44:47], v[48:63]
ds_read_b64_tr_b16 a[4:5], v23 offset:11520
ds_read_b64_tr_b16 a[6:7], v23 offset:12544
v_mfma_f32_32x32x16_bf16 v[64:79], a[12:15], a[44:47], v[64:79]
ds_read_b64_tr_b16 a[8:9], v16 offset:13824
ds_read_b64_tr_b16 a[10:11], v16 offset:14848
s_waitcnt vmcnt(42)
s_waitcnt lgkmcnt(6)
v_mfma_f32_32x32x16_bf16 v[32:47], a[16:19], a[48:51], v[32:47]
ds_read_b64_tr_b16 a[12:13], v17 offset:13824
ds_read_b64_tr_b16 a[14:15], v17 offset:14848
v_mfma_f32_32x32x16_bf16 v[48:63], a[20:23], a[48:51], v[48:63]
ds_read_b64_tr_b16 a[16:17], v22 offset:13824
ds_read_b64_tr_b16 a[18:19], v22 offset:14848
v_mfma_f32_32x32x16_bf16 v[64:79], a[24:27], a[48:51], v[64:79]
ds_read_b64_tr_b16 a[20:21], v17 offset:16128
ds_read_b64_tr_b16 a[22:23], v17 offset:17152
v_mfma_f32_32x32x16_bf16 v[32:47], a[28:31], a[52:55], v[32:47]
ds_read_b64_tr_b16 a[24:25], v16 offset:16128
ds_read_b64_tr_b16 a[26:27], v16 offset:17152
s_waitcnt lgkmcnt(6)
v_mfma_f32_32x32x16_bf16 v[48:63], a[0:3], a[52:55], v[48:63]
ds_read_b64_tr_b16 a[28:29], v23 offset:16128
ds_read_b64_tr_b16 a[30:31], v23 offset:17152
v_mfma_f32_32x32x16_bf16 v[64:79], a[4:7], a[52:55], v[64:79]
ds_read_b64_tr_b16 a[0:1], v16 offset:18432
ds_read_b64_tr_b16 a[2:3], v16 offset:19456
s_waitcnt vmcnt(40)
v_mfma_f32_32x32x16_bf16 v[32:47], a[8:11], a[56:59], v[32:47]
ds_read_b64_tr_b16 a[4:5], v17 offset:18432
ds_read_b64_tr_b16 a[6:7], v17 offset:19456
v_mfma_f32_32x32x16_bf16 v[48:63], a[12:15], a[56:59], v[48:63]
ds_read_b64_tr_b16 a[8:9], v22 offset:18432
ds_read_b64_tr_b16 a[10:11], v22 offset:19456
s_waitcnt lgkmcnt(6)
v_mfma_f32_32x32x16_bf16 v[64:79], a[16:19], a[56:59], v[64:79]
ds_read_b64_tr_b16 a[12:13], v17 offset:20736
ds_read_b64_tr_b16 a[14:15], v17 offset:21760
v_mfma_f32_32x32x16_bf16 v[32:47], a[20:23], a[60:63], v[32:47]
ds_read_b64_tr_b16 a[16:17], v16 offset:20736
ds_read_b64_tr_b16 a[18:19], v16 offset:21760
v_mfma_f32_32x32x16_bf16 v[48:63], a[24:27], a[60:63], v[48:63]
ds_read_b64_tr_b16 a[20:21], v23 offset:20736
ds_read_b64_tr_b16 a[22:23], v23 offset:21760
v_mfma_f32_32x32x16_bf16 v[64:79], a[28:31], a[60:63], v[64:79]
ds_read_b64_tr_b16 a[24:25], v16 offset:23040
ds_read_b64_tr_b16 a[26:27], v16 offset:24064
s_waitcnt vmcnt(38)
s_waitcnt lgkmcnt(6)
v_mfma_f32_32x32x16_bf16 v[32:47], a[0:3], a[64:67], v[32:47]
ds_read_b64_tr_b16 a[28:29], v17 offset:23040
ds_read_b64_tr_b16 a[30:31], v17 offset:24064
v_mfma_f32_32x32x16_bf16 v[48:63], a[4:7], a[64:67], v[48:63]
ds_read_b64_tr_b16 a[0:1], v22 offset:23040
ds_read_b64_tr_b16 a[2:3], v22 offset:24064
v_mfma_f32_32x32x16_bf16 v[64:79], a[8:11], a[64:67], v[64:79]
ds_read_b64_tr_b16 a[4:5], v17 offset:25344
ds_read_b64_tr_b16 a[6:7], v17 offset:26368
v_mfma_f32_32x32x16_bf16 v[32:47], a[12:15], a[68:71], v[32:47]
ds_read_b64_tr_b16 a[8:9], v16 offset:25344
ds_read_b64_tr_b16 a[10:11], v16 offset:26368
s_waitcnt lgkmcnt(6)
v_mfma_f32_32x32x16_bf16 v[48:63], a[16:19], a[68:71], v[48:63]
ds_read_b64_tr_b16 a[12:13], v23 offset:25344
ds_read_b64_tr_b16 a[14:15], v23 offset:26368
v_mfma_f32_32x32x16_bf16 v[64:79], a[20:23], a[68:71], v[64:79]
ds_read_b64_tr_b16 a[16:17], v16 offset:27648
ds_read_b64_tr_b16 a[18:19], v16 offset:28672
s_waitcnt vmcnt(36)
v_mfma_f32_32x32x16_bf16 v[32:47], a[24:27], a[72:75], v[32:47]
ds_read_b64_tr_b16 a[20:21], v17 offset:27648
ds_read_b64_tr_b16 a[22:23], v17 offset:28672
v_mfma_f32_32x32x16_bf16 v[48:63], a[28:31], a[72:75], v[48:63]
ds_read_b64_tr_b16 a[24:25], v22 offset:27648
ds_read_b64_tr_b16 a[26:27], v22 offset:28672
s_waitcnt lgkmcnt(6)
v_mfma_f32_32x32x16_bf16 v[64:79], a[0:3], a[72:75], v[64:79]
ds_read_b64_tr_b16 a[28:29], v17 offset:29952
ds_read_b64_tr_b16 a[30:31], v17 offset:30976
v_mfma_f32_32x32x16_bf16 v[32:47], a[4:7], a[76:79], v[32:47]
ds_read_b64_tr_b16 a[0:1], v16 offset:29952
ds_read_b64_tr_b16 a[2:3], v16 offset:30976
v_mfma_f32_32x32x16_bf16 v[48:63], a[8:11], a[76:79], v[48:63]
ds_read_b64_tr_b16 a[4:5], v23 offset:29952
ds_read_b64_tr_b16 a[6:7], v23 offset:30976
v_mfma_f32_32x32x16_bf16 v[64:79], a[12:15], a[76:79], v[64:79]
ds_read_b64_tr_b16 a[8:9], v16 offset:32256
ds_read_b64_tr_b16 a[10:11], v16 offset:33280
s_waitcnt vmcnt(34)
s_waitcnt lgkmcnt(6)
v_mfma_f32_32x32x16_bf16 v[32:47], a[16:19], a[80:83], v[32:47]
ds_read_b64_tr_b16 a[12:13], v17 offset:32256
ds_read_b64_tr_b16 a[14:15], v17 offset:33280
v_mfma_f32_32x32x16_bf16 v[48:63], a[20:23], a[80:83], v[48:63]
ds_read_b64_tr_b16 a[16:17], v22 offset:32256
ds_read_b64_tr_b16 a[18:19], v22 offset:33280
v_mfma_f32_32x32x16_bf16 v[64:79], a[24:27], a[80:83], v[64:79]
ds_read_b64_tr_b16 a[20:21], v17 offset:34560
ds_read_b64_tr_b16 a[22:23], v17 offset:35584
v_mfma_f32_32x32x16_bf16 v[32:47], a[28:31], a[84:87], v[32:47]
ds_read_b64_tr_b16 a[24:25], v16 offset:34560
ds_read_b64_tr_b16 a[26:27], v16 offset:35584
s_waitcnt lgkmcnt(6)
v_mfma_f32_32x32x16_bf16 v[48:63], a[0:3], a[84:87], v[48:63]
ds_read_b64_tr_b16 a[28:29], v23 offset:34560
ds_read_b64_tr_b16 a[30:31], v23 offset:35584
v_mfma_f32_32x32x16_bf16 v[64:79], a[4:7], a[84:87], v[64:79]
ds_read_b64_tr_b16 a[0:1], v18 offset:0
ds_read_b64_tr_b16 a[2:3], v18 offset:1024
s_waitcnt vmcnt(32)
v_mfma_f32_32x32x16_bf16 v[32:47], a[8:11], a[88:91], v[32:47]
ds_read_b64_tr_b16 a[4:5], v19 offset:0
ds_read_b64_tr_b16 a[6:7], v19 offset:1024
v_mfma_f32_32x32x16_bf16 v[48:63], a[12:15], a[88:91], v[48:63]
ds_read_b64_tr_b16 a[8:9], v24 offset:0
ds_read_b64_tr_b16 a[10:11], v24 offset:1024
s_waitcnt lgkmcnt(6)
v_mfma_f32_32x32x16_bf16 v[64:79], a[16:19], a[88:91], v[64:79]
ds_read_b64_tr_b16 a[12:13], v19 offset:2304
ds_read_b64_tr_b16 a[14:15], v19 offset:3328
v_mfma_f32_32x32x16_bf16 v[32:47], a[20:23], a[92:95], v[32:47]
ds_read_b64_tr_b16 a[16:17], v18 offset:2304
ds_read_b64_tr_b16 a[18:19], v18 offset:3328
v_mfma_f32_32x32x16_bf16 v[48:63], a[24:27], a[92:95], v[48:63]
ds_read_b64_tr_b16 a[20:21], v25 offset:2304
ds_read_b64_tr_b16 a[22:23], v25 offset:3328
v_mfma_f32_32x32x16_bf16 v[64:79], a[28:31], a[92:95], v[64:79]
ds_read_b64_tr_b16 a[24:25], v18 offset:4608
ds_read_b64_tr_b16 a[26:27], v18 offset:5632
s_waitcnt vmcnt(30)
s_waitcnt lgkmcnt(6)
v_mfma_f32_32x32x16_bf16 v[32:47], a[0:3], a[96:99], v[32:47]
ds_read_b64_tr_b16 a[28:29], v19 offset:4608
ds_read_b64_tr_b16 a[30:31], v19 offset:5632
v_mfma_f32_32x32x16_bf16 v[48:63], a[4:7], a[96:99], v[48:63]
ds_read_b64_tr_b16 a[0:1], v24 offset:4608
ds_read_b64_tr_b16 a[2:3], v24 offset:5632
v_mfma_f32_32x32x16_bf16 v[64:79], a[8:11], a[96:99], v[64:79]
ds_read_b64_tr_b16 a[4:5], v19 offset:6912
ds_read_b64_tr_b16 a[6:7], v19 offset:7936
v_mfma_f32_32x32x16_bf16 v[32:47], a[12:15], a[100:103], v[32:47]
ds_read_b64_tr_b16 a[8:9], v18 offset:6912
ds_read_b64_tr_b16 a[10:11], v18 offset:7936
s_waitcnt lgkmcnt(6)
v_mfma_f32_32x32x16_bf16 v[48:63], a[16:19], a[100:103], v[48:63]
ds_read_b64_tr_b16 a[12:13], v25 offset:6912
ds_read_b64_tr_b16 a[14:15], v25 offset:7936
v_mfma_f32_32x32x16_bf16 v[64:79], a[20:23], a[100:103], v[64:79]
ds_read_b64_tr_b16 a[16:17], v18 offset:9216
ds_read_b64_tr_b16 a[18:19], v18 offset:10240
s_waitcnt vmcnt(28)
v_mfma_f32_32x32x16_bf16 v[32:47], a[24:27], a[104:107], v[32:47]
ds_read_b64_tr_b16 a[20:21], v19 offset:9216
ds_read_b64_tr_b16 a[22:23], v19 offset:10240
v_mfma_f32_32x32x16_bf16 v[48:63], a[28:31], a[104:107], v[48:63]
ds_read_b64_tr_b16 a[24:25], v24 offset:9216
ds_read_b64_tr_b16 a[26:27], v24 offset:10240
s_waitcnt lgkmcnt(6)
v_mfma_f32_32x32x16_bf16 v[64:79], a[0:3], a[104:107], v[64:79]
ds_read_b64_tr_b16 a[28:29], v19 offset:11520
ds_read_b64_tr_b16 a[30:31], v19 offset:12544
v_mfma_f32_32x32x16_bf16 v[32:47], a[4:7], a[108:111], v[32:47]
ds_read_b64_tr_b16 a[0:1], v18 offset:11520
ds_read_b64_tr_b16 a[2:3], v18 offset:12544
v_mfma_f32_32x32x16_bf16 v[48:63], a[8:11], a[108:111], v[48:63]
ds_read_b64_tr_b16 a[4:5], v25 offset:11520
ds_read_b64_tr_b16 a[6:7], v25 offset:12544
v_mfma_f32_32x32x16_bf16 v[64:79], a[12:15], a[108:111], v[64:79]
ds_read_b64_tr_b16 a[8:9], v18 offset:13824
ds_read_b64_tr_b16 a[10:11], v18 offset:14848
s_waitcnt vmcnt(26)
s_waitcnt lgkmcnt(6)
v_mfma_f32_32x32x16_bf16 v[32:47], a[16:19], a[112:115], v[32:47]
ds_read_b64_tr_b16 a[12:13], v19 offset:13824
ds_read_b64_tr_b16 a[14:15], v19 offset:14848
v_mfma_f32_32x32x16_bf16 v[48:63], a[20:23], a[112:115], v[48:63]
ds_read_b64_tr_b16 a[16:17], v24 offset:13824
ds_read_b64_tr_b16 a[18:19], v24 offset:14848
v_mfma_f32_32x32x16_bf16 v[64:79], a[24:27], a[112:115], v[64:79]
ds_read_b64_tr_b16 a[20:21], v19 offset:16128
ds_read_b64_tr_b16 a[22:23], v19 offset:17152
v_mfma_f32_32x32x16_bf16 v[32:47], a[28:31], a[116:119], v[32:47]
ds_read_b64_tr_b16 a[24:25], v18 offset:16128
ds_read_b64_tr_b16 a[26:27], v18 offset:17152
s_waitcnt lgkmcnt(6)
v_mfma_f32_32x32x16_bf16 v[48:63], a[0:3], a[116:119], v[48:63]
ds_read_b64_tr_b16 a[28:29], v25 offset:16128
ds_read_b64_tr_b16 a[30:31], v25 offset:17152
v_mfma_f32_32x32x16_bf16 v[64:79], a[4:7], a[116:119], v[64:79]
ds_read_b64_tr_b16 a[0:1], v18 offset:18432
ds_read_b64_tr_b16 a[2:3], v18 offset:19456
s_waitcnt vmcnt(24)
v_mfma_f32_32x32x16_bf16 v[32:47], a[8:11], a[120:123], v[32:47]
ds_read_b64_tr_b16 a[4:5], v19 offset:18432
ds_read_b64_tr_b16 a[6:7], v19 offset:19456
v_mfma_f32_32x32x16_bf16 v[48:63], a[12:15], a[120:123], v[48:63]
ds_read_b64_tr_b16 a[8:9], v24 offset:18432
ds_read_b64_tr_b16 a[10:11], v24 offset:19456
s_waitcnt lgkmcnt(6)
v_mfma_f32_32x32x16_bf16 v[64:79], a[16:19], a[120:123], v[64:79]
ds_read_b64_tr_b16 a[12:13], v19 offset:20736
ds_read_b64_tr_b16 a[14:15], v19 offset:21760
v_mfma_f32_32x32x16_bf16 v[32:47], a[20:23], a[124:127], v[32:47]
ds_read_b64_tr_b16 a[16:17], v18 offset:20736
ds_read_b64_tr_b16 a[18:19], v18 offset:21760
v_mfma_f32_32x32x16_bf16 v[48:63], a[24:27], a[124:127], v[48:63]
ds_read_b64_tr_b16 a[20:21], v25 offset:20736
ds_read_b64_tr_b16 a[22:23], v25 offset:21760
v_mfma_f32_32x32x16_bf16 v[64:79], a[28:31], a[124:127], v[64:79]
ds_read_b64_tr_b16 a[24:25], v18 offset:23040
ds_read_b64_tr_b16 a[26:27], v18 offset:24064
s_waitcnt vmcnt(22)
s_waitcnt lgkmcnt(6)
v_mfma_f32_32x32x16_bf16 v[32:47], a[0:3], a[128:131], v[32:47]
ds_read_b64_tr_b16 a[28:29], v19 offset:23040
ds_read_b64_tr_b16 a[30:31], v19 offset:24064
v_mfma_f32_32x32x16_bf16 v[48:63], a[4:7], a[128:131], v[48:63]
ds_read_b64_tr_b16 a[0:1], v24 offset:23040
ds_read_b64_tr_b16 a[2:3], v24 offset:24064
v_mfma_f32_32x32x16_bf16 v[64:79], a[8:11], a[128:131], v[64:79]
ds_read_b64_tr_b16 a[4:5], v19 offset:25344
ds_read_b64_tr_b16 a[6:7], v19 offset:26368
v_mfma_f32_32x32x16_bf16 v[32:47], a[12:15], a[132:135], v[32:47]
ds_read_b64_tr_b16 a[8:9], v18 offset:25344
ds_read_b64_tr_b16 a[10:11], v18 offset:26368
s_waitcnt lgkmcnt(6)
v_mfma_f32_32x32x16_bf16 v[48:63], a[16:19], a[132:135], v[48:63]
ds_read_b64_tr_b16 a[12:13], v25 offset:25344
ds_read_b64_tr_b16 a[14:15], v25 offset:26368
v_mfma_f32_32x32x16_bf16 v[64:79], a[20:23], a[132:135], v[64:79]
ds_read_b64_tr_b16 a[16:17], v18 offset:27648
ds_read_b64_tr_b16 a[18:19], v18 offset:28672
s_waitcnt vmcnt(20)
v_mfma_f32_32x32x16_bf16 v[32:47], a[24:27], a[136:139], v[32:47]
ds_read_b64_tr_b16 a[20:21], v19 offset:27648
ds_read_b64_tr_b16 a[22:23], v19 offset:28672
v_mfma_f32_32x32x16_bf16 v[48:63], a[28:31], a[136:139], v[48:63]
ds_read_b64_tr_b16 a[24:25], v24 offset:27648
ds_read_b64_tr_b16 a[26:27], v24 offset:28672
s_waitcnt lgkmcnt(6)
v_mfma_f32_32x32x16_bf16 v[64:79], a[0:3], a[136:139], v[64:79]
ds_read_b64_tr_b16 a[28:29], v19 offset:29952
ds_read_b64_tr_b16 a[30:31], v19 offset:30976
v_mfma_f32_32x32x16_bf16 v[32:47], a[4:7], a[140:143], v[32:47]
ds_read_b64_tr_b16 a[0:1], v18 offset:29952
ds_read_b64_tr_b16 a[2:3], v18 offset:30976
v_mfma_f32_32x32x16_bf16 v[48:63], a[8:11], a[140:143], v[48:63]
ds_read_b64_tr_b16 a[4:5], v25 offset:29952
ds_read_b64_tr_b16 a[6:7], v25 offset:30976
v_mfma_f32_32x32x16_bf16 v[64:79], a[12:15], a[140:143], v[64:79]
ds_read_b64_tr_b16 a[8:9], v18 offset:32256
ds_read_b64_tr_b16 a[10:11], v18 offset:33280
s_waitcnt vmcnt(18)
s_waitcnt lgkmcnt(6)
v_mfma_f32_32x32x16_bf16 v[32:47], a[16:19], a[144:147], v[32:47]
ds_read_b64_tr_b16 a[12:13], v19 offset:32256
ds_read_b64_tr_b16 a[14:15], v19 offset:33280
v_mfma_f32_32x32x16_bf16 v[48:63], a[20:23], a[144:147], v[48:63]
ds_read_b64_tr_b16 a[16:17], v24 offset:32256
ds_read_b64_tr_b16 a[18:19], v24 offset:33280
v_mfma_f32_32x32x16_bf16 v[64:79], a[24:27], a[144:147], v[64:79]
ds_read_b64_tr_b16 a[20:21], v19 offset:34560
ds_read_b64_tr_b16 a[22:23], v19 offset:35584
v_mfma_f32_32x32x16_bf16 v[32:47], a[28:31], a[148:151], v[32:47]
ds_read_b64_tr_b16 a[24:25], v18 offset:34560
ds_read_b64_tr_b16 a[26:27], v18 offset:35584
s_waitcnt lgkmcnt(6)
v_mfma_f32_32x32x16_bf16 v[48:63], a[0:3], a[148:151], v[48:63]
ds_read_b64_tr_b16 a[28:29], v25 offset:34560
ds_read_b64_tr_b16 a[30:31], v25 offset:35584
v_mfma_f32_32x32x16_bf16 v[64:79], a[4:7], a[148:151], v[64:79]
ds_read_b64_tr_b16 a[0:1], v20 offset:0
ds_read_b64_tr_b16 a[2:3], v20 offset:4608
s_waitcnt vmcnt(16)
v_mfma_f32_32x32x16_bf16 v[32:47], a[8:11], a[152:155], v[32:47]
ds_read_b64_tr_b16 a[4:5], v21 offset:0
ds_read_b64_tr_b16 a[6:7], v21 offset:4608
v_mfma_f32_32x32x16_bf16 v[48:63], a[12:15], a[152:155], v[48:63]
ds_read_b64_tr_b16 a[8:9], v26 offset:0
ds_read_b64_tr_b16 a[10:11], v26 offset:4608
s_waitcnt lgkmcnt(6)
v_mfma_f32_32x32x16_bf16 v[64:79], a[16:19], a[152:155], v[64:79]
ds_read_b64_tr_b16 a[12:13], v20 offset:18432
ds_read_b64_tr_b16 a[14:15], v20 offset:23040
v_mfma_f32_32x32x16_bf16 v[32:47], a[20:23], a[156:159], v[32:47]
ds_read_b64_tr_b16 a[16:17], v21 offset:18432
ds_read_b64_tr_b16 a[18:19], v21 offset:23040
v_mfma_f32_32x32x16_bf16 v[48:63], a[24:27], a[156:159], v[48:63]
ds_read_b64_tr_b16 a[20:21], v26 offset:18432
ds_read_b64_tr_b16 a[22:23], v26 offset:23040
v_mfma_f32_32x32x16_bf16 v[64:79], a[28:31], a[156:159], v[64:79]
ds_read_b64_tr_b16 a[24:25], v20 offset:36864
ds_read_b64_tr_b16 a[26:27], v20 offset:41472
s_waitcnt vmcnt(8)
s_waitcnt lgkmcnt(6)
v_mfma_f32_32x32x16_bf16 v[32:47], a[0:3], a[160:163], v[32:47]
ds_read_b64_tr_b16 a[28:29], v21 offset:36864
ds_read_b64_tr_b16 a[30:31], v21 offset:41472
v_mfma_f32_32x32x16_bf16 v[48:63], a[4:7], a[160:163], v[48:63]
ds_read_b64_tr_b16 a[0:1], v26 offset:36864
ds_read_b64_tr_b16 a[2:3], v26 offset:41472
v_mfma_f32_32x32x16_bf16 v[64:79], a[8:11], a[160:163], v[64:79]
ds_read_b64_tr_b16 a[4:5], v20 offset:55296
ds_read_b64_tr_b16 a[6:7], v20 offset:59904
v_mfma_f32_32x32x16_bf16 v[32:47], a[12:15], a[164:167], v[32:47]
ds_read_b64_tr_b16 a[8:9], v21 offset:55296
ds_read_b64_tr_b16 a[10:11], v21 offset:59904
s_waitcnt lgkmcnt(6)
v_mfma_f32_32x32x16_bf16 v[48:63], a[16:19], a[164:167], v[48:63]
ds_read_b64_tr_b16 a[12:13], v26 offset:55296
ds_read_b64_tr_b16 a[14:15], v26 offset:59904
v_mfma_f32_32x32x16_bf16 v[64:79], a[20:23], a[164:167], v[64:79]
s_waitcnt vmcnt(0)
v_mfma_f32_32x32x16_bf16 v[32:47], a[24:27], a[168:171], v[32:47]
v_mfma_f32_32x32x16_bf16 v[48:63], a[28:31], a[168:171], v[48:63]
s_waitcnt lgkmcnt(0)
v_mfma_f32_32x32x16_bf16 v[64:79], a[0:3], a[168:171], v[64:79]
v_mfma_f32_32x32x16_bf16 v[32:47], a[4:7], a[172:175], v[32:47]
v_mfma_f32_32x32x16_bf16 v[48:63], a[8:11], a[172:175], v[48:63]
v_mfma_f32_32x32x16_bf16 v[64:79], a[12:15], a[172:175], v[64:79]
s_waitcnt vmcnt(0)
buffer_load_dword v30, v27, s[60:63], 0 offen offset:1024 sc1
v_xor_b32 v16, 0, v6
v_xor_b32 v17, 16, v6
v_xor_b32 v18, 32, v6
v_xor_b32 v19, 48, v6
v_xor_b32 v20, 64, v6
v_xor_b32 v21, 80, v6
v_xor_b32 v22, 96, v6
v_xor_b32 v23, 112, v6
v_mfma_f32_32x32x16_bf16 v[80:95], a[176:179], v[112:115], 0
v_mfma_f32_32x32x16_bf16 v[80:95], a[180:183], v[116:119], v[80:95]
v_mfma_f32_32x32x16_bf16 v[96:111], a[176:179], v[120:123], 0
v_mfma_f32_32x32x16_bf16 v[96:111], a[180:183], v[124:127], v[96:111]
v_mfma_f32_32x32x16_bf16 v[80:95], a[176:179], v[128:131], v[80:95]
v_mfma_f32_32x32x16_bf16 v[80:95], a[180:183], v[132:135], v[80:95]
v_mfma_f32_32x32x16_bf16 v[96:111], a[176:179], v[136:139], v[96:111]
v_mfma_f32_32x32x16_bf16 v[96:111], a[180:183], v[140:143], v[96:111]
ds_read_b64 v[112:113], v16
ds_read_b64 v[114:115], v17
ds_read_b64 v[116:117], v18
ds_read_b64 v[118:119], v19
ds_read_b64 v[120:121], v20
ds_read_b64 v[122:123], v21
ds_read_b64 v[124:125], v22
ds_read_b64 v[126:127], v23
v_mfma_f32_32x32x16_bf16 v[80:95], a[176:179], v[144:147], v[80:95]
v_mfma_f32_32x32x16_bf16 v[80:95], a[180:183], v[148:151], v[80:95]
v_mfma_f32_32x32x16_bf16 v[96:111], a[176:179], v[152:155], v[96:111]
v_mfma_f32_32x32x16_bf16 v[96:111], a[180:183], v[156:159], v[96:111]
v_mfma_f32_32x32x16_bf16 v[80:95], a[176:179], v[160:163], v[80:95]
v_mfma_f32_32x32x16_bf16 v[80:95], a[180:183], v[164:167], v[80:95]
v_mfma_f32_32x32x16_bf16 v[96:111], a[176:179], v[168:171], v[96:111]
v_mfma_f32_32x32x16_bf16 v[96:111], a[180:183], v[172:175], v[96:111]
v_mfma_f32_32x32x16_bf16 v[80:95], a[176:179], v[176:179], v[80:95]
v_mfma_f32_32x32x16_bf16 v[80:95], a[180:183], v[180:183], v[80:95]
v_mfma_f32_32x32x16_bf16 v[96:111], a[176:179], v[184:187], v[96:111]
v_mfma_f32_32x32x16_bf16 v[96:111], a[180:183], v[188:191], v[96:111]
v_mfma_f32_32x32x16_bf16 v[80:95], a[176:179], v[192:195], v[80:95]
v_mfma_f32_32x32x16_bf16 v[80:95], a[180:183], v[196:199], v[80:95]
v_mfma_f32_32x32x16_bf16 v[96:111], a[176:179], v[200:203], v[96:111]
v_mfma_f32_32x32x16_bf16 v[96:111], a[180:183], v[204:207], v[96:111]
v_mfma_f32_32x32x16_bf16 v[80:95], a[176:179], v[208:211], v[80:95]
v_mfma_f32_32x32x16_bf16 v[80:95], a[180:183], v[212:215], v[80:95]
v_mfma_f32_32x32x16_bf16 v[96:111], a[176:179], v[216:219], v[96:111]
v_mfma_f32_32x32x16_bf16 v[96:111], a[180:183], v[220:223], v[96:111]
v_mfma_f32_32x32x16_bf16 v[80:95], a[176:179], v[224:227], v[80:95]
v_mfma_f32_32x32x16_bf16 v[80:95], a[180:183], v[228:231], v[80:95]
v_mfma_f32_32x32x16_bf16 v[96:111], a[176:179], v[232:235], v[96:111]
v_mfma_f32_32x32x16_bf16 v[96:111], a[180:183], v[236:239], v[96:111]
v_mfma_f32_32x32x16_bf16 v[80:95], a[176:179], v[240:243], v[80:95]
v_mfma_f32_32x32x16_bf16 v[80:95], a[180:183], v[244:247], v[80:95]
v_mfma_f32_32x32x16_bf16 v[96:111], a[176:179], v[248:251], v[96:111]
v_mfma_f32_32x32x16_bf16 v[96:111], a[180:183], v[252:255], v[96:111]
s_waitcnt lgkmcnt(0)
s_nop 8
v_mul_f32 v128, s42, v80
v_mul_f32 v129, s42, v81
v_mul_f32 v130, s42, v82
v_mul_f32 v131, s42, v83
v_lshlrev_b32 v132, 16, v112
v_and_b32 v133, 0xffff0000, v112
v_lshlrev_b32 v134, 16, v113
v_and_b32 v135, 0xffff0000, v113
v_exp_f32 v128, v128
v_exp_f32 v129, v129
v_exp_f32 v130, v130
v_exp_f32 v131, v131
v_mul_f32 v80, v80, v32
v_mul_f32 v81, v81, v33
v_mul_f32 v82, v82, v34
v_mul_f32 v83, v83, v35
v_add_f32 v128, 1.0, v128
v_add_f32 v129, 1.0, v129
v_add_f32 v130, 1.0, v130
v_add_f32 v131, 1.0, v131
v_rcp_f32 v128, v128
v_rcp_f32 v129, v129
v_rcp_f32 v130, v130
v_rcp_f32 v131, v131
v_fmac_f32 v132, v80, v128
v_fmac_f32 v133, v81, v129
v_fmac_f32 v134, v82, v130
v_fmac_f32 v135, v83, v131
v_cvt_pk_bf16_f32 v80, v132, v133
v_cvt_pk_bf16_f32 v81, v134, v135
ds_write_b64 v16, v[80:81]
v_mul_f32 v136, s42, v84
v_mul_f32 v137, s42, v85
v_mul_f32 v138, s42, v86
v_mul_f32 v139, s42, v87
v_lshlrev_b32 v140, 16, v114
v_and_b32 v141, 0xffff0000, v114
v_lshlrev_b32 v142, 16, v115
v_and_b32 v143, 0xffff0000, v115
v_exp_f32 v136, v136
v_exp_f32 v137, v137
v_exp_f32 v138, v138
v_exp_f32 v139, v139
v_mul_f32 v84, v84, v36
v_mul_f32 v85, v85, v37
v_mul_f32 v86, v86, v38
v_mul_f32 v87, v87, v39
v_add_f32 v136, 1.0, v136
v_add_f32 v137, 1.0, v137
v_add_f32 v138, 1.0, v138
v_add_f32 v139, 1.0, v139
v_rcp_f32 v136, v136
v_rcp_f32 v137, v137
v_rcp_f32 v138, v138
v_rcp_f32 v139, v139
v_fmac_f32 v140, v84, v136
v_fmac_f32 v141, v85, v137
v_fmac_f32 v142, v86, v138
v_fmac_f32 v143, v87, v139
v_cvt_pk_bf16_f32 v84, v140, v141
v_cvt_pk_bf16_f32 v85, v142, v143
ds_write_b64 v17, v[84:85]
v_mul_f32 v128, s42, v88
v_mul_f32 v129, s42, v89
v_mul_f32 v130, s42, v90
v_mul_f32 v131, s42, v91
v_lshlrev_b32 v132, 16, v116
v_and_b32 v133, 0xffff0000, v116
v_lshlrev_b32 v134, 16, v117
v_and_b32 v135, 0xffff0000, v117
v_exp_f32 v128, v128
v_exp_f32 v129, v129
v_exp_f32 v130, v130
v_exp_f32 v131, v131
v_mul_f32 v88, v88, v40
v_mul_f32 v89, v89, v41
v_mul_f32 v90, v90, v42
v_mul_f32 v91, v91, v43
v_add_f32 v128, 1.0, v128
v_add_f32 v129, 1.0, v129
v_add_f32 v130, 1.0, v130
v_add_f32 v131, 1.0, v131
v_rcp_f32 v128, v128
v_rcp_f32 v129, v129
v_rcp_f32 v130, v130
v_rcp_f32 v131, v131
v_fmac_f32 v132, v88, v128
v_fmac_f32 v133, v89, v129
v_fmac_f32 v134, v90, v130
v_fmac_f32 v135, v91, v131
v_cvt_pk_bf16_f32 v88, v132, v133
v_cvt_pk_bf16_f32 v89, v134, v135
ds_write_b64 v18, v[88:89]
v_mul_f32 v136, s42, v92
v_mul_f32 v137, s42, v93
v_mul_f32 v138, s42, v94
v_mul_f32 v139, s42, v95
v_lshlrev_b32 v140, 16, v118
v_and_b32 v141, 0xffff0000, v118
v_lshlrev_b32 v142, 16, v119
v_and_b32 v143, 0xffff0000, v119
v_exp_f32 v136, v136
v_exp_f32 v137, v137
v_exp_f32 v138, v138
v_exp_f32 v139, v139
v_mul_f32 v92, v92, v44
v_mul_f32 v93, v93, v45
v_mul_f32 v94, v94, v46
v_mul_f32 v95, v95, v47
v_add_f32 v136, 1.0, v136
v_add_f32 v137, 1.0, v137
v_add_f32 v138, 1.0, v138
v_add_f32 v139, 1.0, v139
v_rcp_f32 v136, v136
v_rcp_f32 v137, v137
v_rcp_f32 v138, v138
v_rcp_f32 v139, v139
v_fmac_f32 v140, v92, v136
v_fmac_f32 v141, v93, v137
v_fmac_f32 v142, v94, v138
v_fmac_f32 v143, v95, v139
v_cvt_pk_bf16_f32 v92, v140, v141
v_cvt_pk_bf16_f32 v93, v142, v143
ds_write_b64 v19, v[92:93]
v_mul_f32 v128, s42, v96
v_mul_f32 v129, s42, v97
v_mul_f32 v130, s42, v98
v_mul_f32 v131, s42, v99
v_lshlrev_b32 v132, 16, v120
v_and_b32 v133, 0xffff0000, v120
v_lshlrev_b32 v134, 16, v121
v_and_b32 v135, 0xffff0000, v121
v_exp_f32 v128, v128
v_exp_f32 v129, v129
v_exp_f32 v130, v130
v_exp_f32 v131, v131
v_mul_f32 v96, v96, v48
v_mul_f32 v97, v97, v49
v_mul_f32 v98, v98, v50
v_mul_f32 v99, v99, v51
v_add_f32 v128, 1.0, v128
v_add_f32 v129, 1.0, v129
v_add_f32 v130, 1.0, v130
v_add_f32 v131, 1.0, v131
v_rcp_f32 v128, v128
v_rcp_f32 v129, v129
v_rcp_f32 v130, v130
v_rcp_f32 v131, v131
v_fmac_f32 v132, v96, v128
v_fmac_f32 v133, v97, v129
v_fmac_f32 v134, v98, v130
v_fmac_f32 v135, v99, v131
v_cvt_pk_bf16_f32 v96, v132, v133
v_cvt_pk_bf16_f32 v97, v134, v135
ds_write_b64 v20, v[96:97]
v_mul_f32 v136, s42, v100
v_mul_f32 v137, s42, v101
v_mul_f32 v138, s42, v102
v_mul_f32 v139, s42, v103
v_lshlrev_b32 v140, 16, v122
v_and_b32 v141, 0xffff0000, v122
v_lshlrev_b32 v142, 16, v123
v_and_b32 v143, 0xffff0000, v123
v_exp_f32 v136, v136
v_exp_f32 v137, v137
v_exp_f32 v138, v138
v_exp_f32 v139, v139
v_mul_f32 v100, v100, v52
v_mul_f32 v101, v101, v53
v_mul_f32 v102, v102, v54
v_mul_f32 v103, v103, v55
v_add_f32 v136, 1.0, v136
v_add_f32 v137, 1.0, v137
v_add_f32 v138, 1.0, v138
v_add_f32 v139, 1.0, v139
v_rcp_f32 v136, v136
v_rcp_f32 v137, v137
v_rcp_f32 v138, v138
v_rcp_f32 v139, v139
v_fmac_f32 v140, v100, v136
v_fmac_f32 v141, v101, v137
v_fmac_f32 v142, v102, v138
v_fmac_f32 v143, v103, v139
v_cvt_pk_bf16_f32 v100, v140, v141
v_cvt_pk_bf16_f32 v101, v142, v143
ds_write_b64 v21, v[100:101]
v_mul_f32 v128, s42, v104
v_mul_f32 v129, s42, v105
v_mul_f32 v130, s42, v106
v_mul_f32 v131, s42, v107
v_lshlrev_b32 v132, 16, v124
v_and_b32 v133, 0xffff0000, v124
v_lshlrev_b32 v134, 16, v125
v_and_b32 v135, 0xffff0000, v125
v_exp_f32 v128, v128
v_exp_f32 v129, v129
v_exp_f32 v130, v130
v_exp_f32 v131, v131
v_mul_f32 v104, v104, v56
v_mul_f32 v105, v105, v57
v_mul_f32 v106, v106, v58
v_mul_f32 v107, v107, v59
v_add_f32 v128, 1.0, v128
v_add_f32 v129, 1.0, v129
v_add_f32 v130, 1.0, v130
v_add_f32 v131, 1.0, v131
v_rcp_f32 v128, v128
v_rcp_f32 v129, v129
v_rcp_f32 v130, v130
v_rcp_f32 v131, v131
v_fmac_f32 v132, v104, v128
v_fmac_f32 v133, v105, v129
v_fmac_f32 v134, v106, v130
v_fmac_f32 v135, v107, v131
v_cvt_pk_bf16_f32 v104, v132, v133
v_cvt_pk_bf16_f32 v105, v134, v135
ds_write_b64 v22, v[104:105]
v_mul_f32 v136, s42, v108
v_mul_f32 v137, s42, v109
v_mul_f32 v138, s42, v110
v_mul_f32 v139, s42, v111
v_lshlrev_b32 v140, 16, v126
v_and_b32 v141, 0xffff0000, v126
v_lshlrev_b32 v142, 16, v127
v_and_b32 v143, 0xffff0000, v127
v_exp_f32 v136, v136
v_exp_f32 v137, v137
v_exp_f32 v138, v138
v_exp_f32 v139, v139
v_mul_f32 v108, v108, v60
v_mul_f32 v109, v109, v61
v_mul_f32 v110, v110, v62
v_mul_f32 v111, v111, v63
v_add_f32 v136, 1.0, v136
v_add_f32 v137, 1.0, v137
v_add_f32 v138, 1.0, v138
v_add_f32 v139, 1.0, v139
v_rcp_f32 v136, v136
v_rcp_f32 v137, v137
v_rcp_f32 v138, v138
v_rcp_f32 v139, v139
v_fmac_f32 v140, v108, v136
v_fmac_f32 v141, v109, v137
v_fmac_f32 v142, v110, v138
v_fmac_f32 v143, v111, v139
v_cvt_pk_bf16_f32 v108, v140, v141
v_cvt_pk_bf16_f32 v109, v142, v143
ds_write_b64 v23, v[108:109]
s_waitcnt lgkmcnt(0)
ds_read_b128 v[144:147], v7 offset:0
ds_read_b128 v[148:151], v7 offset:1024
ds_read_b128 v[152:155], v7 offset:2048
ds_read_b128 v[156:159], v7 offset:3072
s_waitcnt lgkmcnt(3)
s_add_u32 s32, s53, 0
buffer_store_dwordx4 v[144:147], v12, s[72:75], s32 offen sc1
s_waitcnt lgkmcnt(2)
s_add_u32 s32, s53, 9216
buffer_store_dwordx4 v[148:151], v13, s[72:75], s32 offen sc1
s_waitcnt lgkmcnt(1)
s_add_u32 s32, s53, 18432
buffer_store_dwordx4 v[152:155], v12, s[72:75], s32 offen sc1
s_waitcnt lgkmcnt(0)
s_add_u32 s32, s53, 27648
buffer_store_dwordx4 v[156:159], v13, s[72:75], s32 offen sc1
s_lshl_b32 s32, s48, 7
s_add_u32 s53, s52, s32
s_lshl_b32 s32, s48, 12
s_add_u32 s40, s52, s32
s_lshl_b32 s32, s43, 5
s_add_u32 s40, s40, s32
v_xor_b32 v6, s43, v6
v_mov_b32 v8, 0x80000000
v_and_b32 v9, 64, v12
v_cmp_eq_u32 vcc, s43, v9
s_nop 1
v_cndmask_b32 v28, v8, v12, vcc
v_cndmask_b32 v29, v13, v8, vcc
s_add_u32 m0, s54, 0
s_add_u32 s32, s53, 0
buffer_load_dwordx4 v12, s[68:71], s32 offen lds
s_add_u32 m0, s54, 1024
s_add_u32 s32, s53, 9216
buffer_load_dwordx4 v13, s[68:71], s32 offen lds
s_add_u32 m0, s54, 2048
s_add_u32 s32, s53, 18432
buffer_load_dwordx4 v12, s[68:71], s32 offen lds
s_add_u32 m0, s54, 3072
s_add_u32 s32, s53, 27648
buffer_load_dwordx4 v13, s[68:71], s32 offen lds
s_waitcnt vmcnt(8)
v_cmp_ne_u32 vcc, 0, v30
s_mov_b32 s59, 0x40000
s_cmp_eq_u64 vcc, -1
s_cbranch_scc1 L_fin_pb_ok
L_fin_pb:
s_sleep 2
buffer_load_dword v30, v27, s[60:63], 0 offen offset:1024 sc1
s_waitcnt vmcnt(0)
v_cmp_ne_u32 vcc, 0, v30
s_sub_u32 s59, s59, 1
s_cmp_eq_u32 s59, 0
s_cbranch_scc1 L_fin_pb_ok
s_cmp_eq_u64 vcc, -1
s_cbranch_scc0 L_fin_pb
L_fin_pb_ok:
buffer_load_dwordx4 v[112:115], v2, s[12:15], s40 offen offset:0 sc1
buffer_load_dwordx4 v[116:119], v2, s[12:15], s40 offen offset:1024 sc1
s_add_u32 s32, s40, 0x0
buffer_load_dwordx4 v[120:123], v2, s[20:23], s32 offen offset:0 sc1
buffer_load_dwordx4 v[124:127], v2, s[20:23], s32 offen offset:1024 sc1
s_add_u32 s32, s40, 0x240000
buffer_load_dwordx4 v[128:131], v2, s[20:23], s32 offen offset:0 sc1
buffer_load_dwordx4 v[132:135], v2, s[20:23], s32 offen offset:1024 sc1
s_add_u32 s32, s40, 0x480000
buffer_load_dwordx4 v[136:139], v2, s[20:23], s32 offen offset:0 sc1
buffer_load_dwordx4 v[140:143], v2, s[20:23], s32 offen offset:1024 sc1
s_add_u32 s32, s40, 0x6c0000
buffer_load_dwordx4 v[144:147], v2, s[20:23], s32 offen offset:0 sc1
buffer_load_dwordx4 v[148:151], v2, s[20:23], s32 offen offset:1024 sc1
s_add_u32 s32, s40, 0x900000
buffer_load_dwordx4 v[152:155], v2, s[20:23], s32 offen offset:0 sc1
buffer_load_dwordx4 v[156:159], v2, s[20:23], s32 offen offset:1024 sc1
s_add_u32 s32, s40, 0xb40000
buffer_load_dwordx4 v[160:163], v2, s[20:23], s32 offen offset:0 sc1
buffer_load_dwordx4 v[164:167], v2, s[20:23], s32 offen offset:1024 sc1
s_add_u32 s32, s40, 0xd80000
buffer_load_dwordx4 v[168:171], v2, s[20:23], s32 offen offset:0 sc1
buffer_load_dwordx4 v[172:175], v2, s[20:23], s32 offen offset:1024 sc1
s_add_u32 s32, s40, 0xfc0000
buffer_load_dwordx4 v[176:179], v2, s[20:23], s32 offen offset:0 sc1
buffer_load_dwordx4 v[180:183], v2, s[20:23], s32 offen offset:1024 sc1
v_xor_b32 v16, 0, v6
v_xor_b32 v17, 16, v6
v_xor_b32 v18, 32, v6
v_xor_b32 v19, 48, v6
s_waitcnt vmcnt(16)
v_mfma_f32_32x32x16_bf16 v[80:95], a[176:179], v[112:115], 0
v_mfma_f32_32x32x16_bf16 v[80:95], a[180:183], v[116:119], v[80:95]
s_waitcnt vmcnt(14)
v_mfma_f32_32x32x16_bf16 v[80:95], a[176:179], v[120:123], v[80:95]
v_mfma_f32_32x32x16_bf16 v[80:95], a[180:183], v[124:127], v[80:95]
ds_read_b64 v[112:113], v16
ds_read_b64 v[114:115], v17
ds_read_b64 v[116:117], v18
ds_read_b64 v[118:119], v19
s_waitcnt vmcnt(12)
v_mfma_f32_32x32x16_bf16 v[80:95], a[176:179], v[128:131], v[80:95]
v_mfma_f32_32x32x16_bf16 v[80:95], a[180:183], v[132:135], v[80:95]
s_waitcnt vmcnt(10)
v_mfma_f32_32x32x16_bf16 v[80:95], a[176:179], v[136:139], v[80:95]
v_mfma_f32_32x32x16_bf16 v[80:95], a[180:183], v[140:143], v[80:95]
s_waitcnt vmcnt(8)
v_mfma_f32_32x32x16_bf16 v[80:95], a[176:179], v[144:147], v[80:95]
v_mfma_f32_32x32x16_bf16 v[80:95], a[180:183], v[148:151], v[80:95]
s_waitcnt vmcnt(6)
v_mfma_f32_32x32x16_bf16 v[80:95], a[176:179], v[152:155], v[80:95]
v_mfma_f32_32x32x16_bf16 v[80:95], a[180:183], v[156:159], v[80:95]
s_waitcnt vmcnt(4)
v_mfma_f32_32x32x16_bf16 v[80:95], a[176:179], v[160:163], v[80:95]
v_mfma_f32_32x32x16_bf16 v[80:95], a[180:183], v[164:167], v[80:95]
s_waitcnt vmcnt(2)
v_mfma_f32_32x32x16_bf16 v[80:95], a[176:179], v[168:171], v[80:95]
v_mfma_f32_32x32x16_bf16 v[80:95], a[180:183], v[172:175], v[80:95]
s_waitcnt vmcnt(0)
v_mfma_f32_32x32x16_bf16 v[80:95], a[176:179], v[176:179], v[80:95]
v_mfma_f32_32x32x16_bf16 v[80:95], a[180:183], v[180:183], v[80:95]
s_waitcnt lgkmcnt(0)
s_nop 10
v_mul_f32 v128, s42, v80
v_mul_f32 v129, s42, v81
v_mul_f32 v130, s42, v82
v_mul_f32 v131, s42, v83
v_lshlrev_b32 v132, 16, v112
v_and_b32 v133, 0xffff0000, v112
v_lshlrev_b32 v134, 16, v113
v_and_b32 v135, 0xffff0000, v113
v_exp_f32 v128, v128
v_exp_f32 v129, v129
v_exp_f32 v130, v130
v_exp_f32 v131, v131
v_mul_f32 v80, v80, v64
v_mul_f32 v81, v81, v65
v_mul_f32 v82, v82, v66
v_mul_f32 v83, v83, v67
v_add_f32 v128, 1.0, v128
v_add_f32 v129, 1.0, v129
v_add_f32 v130, 1.0, v130
v_add_f32 v131, 1.0, v131
v_rcp_f32 v128, v128
v_rcp_f32 v129, v129
v_rcp_f32 v130, v130
v_rcp_f32 v131, v131
v_fmac_f32 v132, v80, v128
v_fmac_f32 v133, v81, v129
v_fmac_f32 v134, v82, v130
v_fmac_f32 v135, v83, v131
v_cvt_pk_bf16_f32 v80, v132, v133
v_cvt_pk_bf16_f32 v81, v134, v135
ds_write_b64 v16, v[80:81]
v_mul_f32 v136, s42, v84
v_mul_f32 v137, s42, v85
v_mul_f32 v138, s42, v86
v_mul_f32 v139, s42, v87
v_lshlrev_b32 v140, 16, v114
v_and_b32 v141, 0xffff0000, v114
v_lshlrev_b32 v142, 16, v115
v_and_b32 v143, 0xffff0000, v115
v_exp_f32 v136, v136
v_exp_f32 v137, v137
v_exp_f32 v138, v138
v_exp_f32 v139, v139
v_mul_f32 v84, v84, v68
v_mul_f32 v85, v85, v69
v_mul_f32 v86, v86, v70
v_mul_f32 v87, v87, v71
v_add_f32 v136, 1.0, v136
v_add_f32 v137, 1.0, v137
v_add_f32 v138, 1.0, v138
v_add_f32 v139, 1.0, v139
v_rcp_f32 v136, v136
v_rcp_f32 v137, v137
v_rcp_f32 v138, v138
v_rcp_f32 v139, v139
v_fmac_f32 v140, v84, v136
v_fmac_f32 v141, v85, v137
v_fmac_f32 v142, v86, v138
v_fmac_f32 v143, v87, v139
v_cvt_pk_bf16_f32 v84, v140, v141
v_cvt_pk_bf16_f32 v85, v142, v143
ds_write_b64 v17, v[84:85]
v_mul_f32 v128, s42, v88
v_mul_f32 v129, s42, v89
v_mul_f32 v130, s42, v90
v_mul_f32 v131, s42, v91
v_lshlrev_b32 v132, 16, v116
v_and_b32 v133, 0xffff0000, v116
v_lshlrev_b32 v134, 16, v117
v_and_b32 v135, 0xffff0000, v117
v_exp_f32 v128, v128
v_exp_f32 v129, v129
v_exp_f32 v130, v130
v_exp_f32 v131, v131
v_mul_f32 v88, v88, v72
v_mul_f32 v89, v89, v73
v_mul_f32 v90, v90, v74
v_mul_f32 v91, v91, v75
v_add_f32 v128, 1.0, v128
v_add_f32 v129, 1.0, v129
v_add_f32 v130, 1.0, v130
v_add_f32 v131, 1.0, v131
v_rcp_f32 v128, v128
v_rcp_f32 v129, v129
v_rcp_f32 v130, v130
v_rcp_f32 v131, v131
v_fmac_f32 v132, v88, v128
v_fmac_f32 v133, v89, v129
v_fmac_f32 v134, v90, v130
v_fmac_f32 v135, v91, v131
v_cvt_pk_bf16_f32 v88, v132, v133
v_cvt_pk_bf16_f32 v89, v134, v135
ds_write_b64 v18, v[88:89]
v_mul_f32 v136, s42, v92
v_mul_f32 v137, s42, v93
v_mul_f32 v138, s42, v94
v_mul_f32 v139, s42, v95
v_lshlrev_b32 v140, 16, v118
v_and_b32 v141, 0xffff0000, v118
v_lshlrev_b32 v142, 16, v119
v_and_b32 v143, 0xffff0000, v119
v_exp_f32 v136, v136
v_exp_f32 v137, v137
v_exp_f32 v138, v138
v_exp_f32 v139, v139
v_mul_f32 v92, v92, v76
v_mul_f32 v93, v93, v77
v_mul_f32 v94, v94, v78
v_mul_f32 v95, v95, v79
v_add_f32 v136, 1.0, v136
v_add_f32 v137, 1.0, v137
v_add_f32 v138, 1.0, v138
v_add_f32 v139, 1.0, v139
v_rcp_f32 v136, v136
v_rcp_f32 v137, v137
v_rcp_f32 v138, v138
v_rcp_f32 v139, v139
v_fmac_f32 v140, v92, v136
v_fmac_f32 v141, v93, v137
v_fmac_f32 v142, v94, v138
v_fmac_f32 v143, v95, v139
v_cvt_pk_bf16_f32 v92, v140, v141
v_cvt_pk_bf16_f32 v93, v142, v143
ds_write_b64 v19, v[92:93]
s_waitcnt lgkmcnt(0)
ds_read_b128 v[144:147], v7 offset:0
ds_read_b128 v[148:151], v7 offset:1024
ds_read_b128 v[152:155], v7 offset:2048
ds_read_b128 v[156:159], v7 offset:3072
s_waitcnt lgkmcnt(3)
s_add_u32 s32, s53, 0
buffer_store_dwordx4 v[144:147], v28, s[72:75], s32 offen sc1
s_waitcnt lgkmcnt(2)
s_add_u32 s32, s53, 9216
buffer_store_dwordx4 v[148:151], v29, s[72:75], s32 offen sc1
s_waitcnt lgkmcnt(1)
s_add_u32 s32, s53, 18432
buffer_store_dwordx4 v[152:155], v28, s[72:75], s32 offen sc1
s_waitcnt lgkmcnt(0)
s_add_u32 s32, s53, 27648
buffer_store_dwordx4 v[156:159], v29, s[72:75], s32 offen sc1
L_fin_end:
s_endpgm
L_kc_mlp:
s_load_dwordx2 s[4:5], s[0:1], 40
s_load_dwordx2 s[36:37], s[0:1], 56
s_lshr_b32 s32, s25, 1
s_lshl_b32 s32, s32, 2
s_and_b32 s25, s25, 1
s_lshl_b32 s25, s25, 2
s_and_b32 s33, s26, 3
s_add_u32 s25, s25, s33
s_lshr_b32 s26, s26, 2
s_add_u32 s26, s26, s32
s_lshl_b32 s35, s26, 2
s_add_u32 s35, s35, s24
s_mul_i32 s41, s35, 36864
v_lshlrev_b32 v2, 4, v1
s_mul_i32 s38, s25, 663552
s_mul_i32 s32, s24, 55296
s_add_u32 s38, s38, s32
s_lshl_b32 s30, s25, 7
s_add_u32 s30, s30, s32
s_add_u32 s31, s30, 27648
s_add_u32 s39, s32, 1024
s_add_u32 s48, s39, 27648
s_mul_i32 s34, s24, 6144
v_add_u32 v3, 4096, v2
v_add_u32 v4, 49152, v2
v_add_u32 v5, 98304, v2
v_lshrrev_b32 v15, 3, v1
v_and_b32 v6, 7, v1
v_bfe_u32 v7, v1, 4, 1
v_lshlrev_b32 v7, 2, v7
v_xor_b32 v6, v6, v7
v_lshlrev_b32 v6, 4, v6
v_mul_u32_u24 v15, 1152, v15
v_add_u32 v6, v6, v15
v_add_u32 v7, 8192, v6
v_add_u32 v8, 16384, v6
v_and_b32 v20, 31, v1
v_lshrrev_b32 v21, 5, v1
v_lshlrev_b32 v245, 2, v20
v_add_u32 v245, 147456, v245
s_lshl_b32 s32, s35, 5
v_add_u32 v20, s32, v20
v_mov_b32 v22, 0x80000000
v_add_u32 v23, -1, v20
v_lshrrev_b32 v16, 5, v23
v_mul_u32_u24 v16, 36864, v16
v_and_b32 v24, 31, v23
v_lshl_add_u32 v24, v21, 5, v24
v_lshl_add_u32 v16, v24, 4, v16
v_cmp_gt_u32 vcc, 2048, v23
s_nop 1
v_cndmask_b32 v16, v22, v16, vcc
v_add_u32 v23, 1, v20
v_lshrrev_b32 v17, 5, v23
v_mul_u32_u24 v17, 36864, v17
v_and_b32 v24, 31, v23
v_lshl_add_u32 v24, v21, 5, v24
v_lshl_add_u32 v17, v24, 4, v17
v_cmp_gt_u32 vcc, 2048, v23
s_nop 1
v_cndmask_b32 v17, v22, v17, vcc
v_add_u32 v23, -2, v20
v_lshrrev_b32 v18, 5, v23
v_mul_u32_u24 v18, 36864, v18
v_and_b32 v24, 31, v23
v_lshl_add_u32 v24, v21, 5, v24
v_lshl_add_u32 v18, v24, 4, v18
v_cmp_gt_u32 vcc, 2048, v23
s_nop 1
v_cndmask_b32 v18, v22, v18, vcc
v_add_u32 v23, 2, v20
v_lshrrev_b32 v19, 5, v23
v_mul_u32_u24 v19, 36864, v19
v_and_b32 v24, 31, v23
v_lshl_add_u32 v24, v21, 5, v24
v_lshl_add_u32 v19, v24, 4, v19
v_cmp_gt_u32 vcc, 2048, v23
s_nop 1
v_cndmask_b32 v19, v22, v19, vcc
s_add_u32 s44, s6, 0x7e0000
s_addc_u32 s45, s7, 0
s_mov_b32 s46, 0x240000
s_mov_b32 s47, 0x00020000
s_add_u32 s20, s6, 0xa20000
s_addc_u32 s21, s7, 0
s_mov_b32 s22, 0x240000
s_mov_b32 s23, 0x00020000
s_add_u32 s64, s6, 0xea0000
s_addc_u32 s65, s7, 0
s_mov_b32 s66, 0x240000
s_mov_b32 s67, 0x00020000
s_mov_b32 s68, s6
s_mov_b32 s69, s7
s_mov_b32 s70, 0x70000
s_mov_b32 s71, 0x00020000
s_mov_b32 s50, 0
s_mov_b32 s51, 4096
s_mov_b32 s52, 8192
s_mov_b32 s53, 12288
s_mov_b32 s54, 16384
s_mov_b32 s55, 20480
s_mov_b32 s56, 24576
s_mov_b32 s57, 28672
s_mov_b32 s58, 32768
s_waitcnt lgkmcnt(0)
s_mov_b32 s8, s4
s_mov_b32 s9, s5
s_mov_b32 s10, 0xa2000
s_mov_b32 s11, 0x00020000
s_mov_b32 s12, s36
s_mov_b32 s13, s37
s_mov_b32 s14, 0x510000
s_mov_b32 s15, 0x00020000
s_add_u32 s16, s6, 0x1320000
s_addc_u32 s17, s7, 0
s_mov_b32 s18, 0x1200000
s_mov_b32 s19, 0x00020000
s_add_u32 s60, s6, 0xc0000
s_addc_u32 s61, s7, 0
s_mov_b32 s62, 0x30000
s_mov_b32 s63, 0x00020000
s_lshl_b32 s32, s25, 12
s_add_u32 s42, s41, s32
s_lshl_b32 s32, s25, 11
s_add_u32 s43, s41, s32
s_add_u32 s43, s43, 32768
v_bfe_u32 v22, v1, 2, 2
v_lshrrev_b32 v23, 5, v1
v_lshl_add_u32 v23, v23, 2, v22
v_lshlrev_b32 v9, 7, v23
v_bfe_u32 v23, v1, 4, 1
v_lshl_add_u32 v9, v23, 5, v9
v_and_b32 v23, 3, v1
v_lshl_add_u32 v9, v23, 3, v9
v_lshrrev_b32 v22, 1, v22
v_lshlrev_b32 v22, 6, v22
v_add_u32 v9, v9, v22
v_xor_b32 v10, 64, v9
v_add_u32 v11, 49152, v9
v_add_u32 v12, 49152, v10
v_add_u32 v13, 98304, v9
v_add_u32 v14, 98304, v10
s_lshl_b32 s32, s25, 6
v_xor_b32 v20, s32, v11
v_xor_b32 v21, s32, v13
s_mov_b32 s49, 0x40088e99
v_mov_b32 v240, 0
v_mov_b32 v241, 0
v_lshlrev_b32 v15, 2, v0
s_mul_i32 s32, s25, 2304
s_add_u32 s28, s32, 0xc000
s_add_u32 s33, s28, 18432
s_add_u32 s40, s33, 18432
s_add_u32 s29, s40, 18432
v_add_u32 v23, 0x20000, v15
s_cmp_lt_u32 s25, 2
s_cbranch_scc1 L_mlp_three
s_add_u32 m0, s34, 0
s_nop 0
buffer_load_dwordx4 v6, s[8:11], s30 offen lds
buffer_load_dwordx4 v7, s[8:11], s30 offen offset:1024 lds
buffer_load_dwordx4 v8, s[8:11], s30 offen offset:2048 lds
s_add_u32 m0, s34, 3072
s_nop 0
buffer_load_dwordx4 v6, s[8:11], s31 offen lds
buffer_load_dwordx4 v7, s[8:11], s31 offen offset:1024 lds
buffer_load_dwordx4 v8, s[8:11], s31 offen offset:2048 lds
s_add_u32 s30, s30, 221184
s_add_u32 s31, s31, 221184
buffer_load_dwordx4 a[32:35], v16, s[44:47], s50 offen offset:0
buffer_load_dwordx4 a[36:39], v16, s[44:47], s50 offen offset:1024
buffer_load_dwordx4 a[40:43], v16, s[44:47], s50 offen offset:2048
buffer_load_dwordx4 a[44:47], v16, s[44:47], s50 offen offset:3072
buffer_load_dwordx4 a[48:51], v16, s[44:47], s51 offen offset:0
buffer_load_dwordx4 a[52:55], v16, s[44:47], s51 offen offset:1024
buffer_load_dwordx4 a[56:59], v16, s[44:47], s51 offen offset:2048
buffer_load_dwordx4 a[60:63], v16, s[44:47], s51 offen offset:3072
buffer_load_dwordx4 a[64:67], v16, s[44:47], s52 offen offset:0
buffer_load_dwordx4 a[68:71], v17, s[44:47], s52 offen offset:1024
buffer_load_dwordx4 a[72:75], v17, s[44:47], s52 offen offset:2048
buffer_load_dwordx4 a[76:79], v17, s[44:47], s52 offen offset:3072
s_add_u32 m0, s34, 24576
s_nop 0
buffer_load_dwordx4 v6, s[8:11], s30 offen lds
buffer_load_dwordx4 v7, s[8:11], s30 offen offset:1024 lds
buffer_load_dwordx4 v8, s[8:11], s30 offen offset:2048 lds
s_add_u32 m0, s34, 27648
s_nop 0
buffer_load_dwordx4 v6, s[8:11], s31 offen lds
buffer_load_dwordx4 v7, s[8:11], s31 offen offset:1024 lds
buffer_load_dwordx4 v8, s[8:11], s31 offen offset:2048 lds
s_add_u32 s30, s30, 221184
s_add_u32 s31, s31, 221184
buffer_load_dwordx4 a[80:83], v17, s[44:47], s53 offen offset:0
buffer_load_dwordx4 a[84:87], v17, s[44:47], s53 offen offset:1024
buffer_load_dwordx4 a[88:91], v17, s[44:47], s53 offen offset:2048
buffer_load_dwordx4 a[92:95], v17, s[44:47], s53 offen offset:3072
s_waitcnt vmcnt(22)
s_barrier
ds_read_b64_tr_b16 a[0:1], v9 offset:0
ds_read_b64_tr_b16 a[2:3], v9 offset:1024
ds_read_b64_tr_b16 a[4:5], v10 offset:0
ds_read_b64_tr_b16 a[6:7], v10 offset:1024
ds_read_b64_tr_b16 a[8:9], v9 offset:2048
ds_read_b64_tr_b16 a[10:11], v9 offset:3072
ds_read_b64_tr_b16 a[12:13], v10 offset:2048
ds_read_b64_tr_b16 a[14:15], v10 offset:3072
ds_read_b64_tr_b16 a[16:17], v9 offset:4096
ds_read_b64_tr_b16 a[18:19], v9 offset:5120
ds_read_b64_tr_b16 a[20:21], v10 offset:4096
ds_read_b64_tr_b16 a[22:23], v10 offset:5120
ds_read_b64_tr_b16 a[24:25], v9 offset:6144
ds_read_b64_tr_b16 a[26:27], v9 offset:7168
s_waitcnt vmcnt(18)
s_waitcnt lgkmcnt(6)
v_mfma_f32_32x32x16_bf16 v[32:47], a[0:3], a[32:35], 0
ds_read_b64_tr_b16 a[28:29], v10 offset:6144
ds_read_b64_tr_b16 a[30:31], v10 offset:7168
buffer_load_dwordx4 a[96:99], v17, s[44:47], s54 offen offset:0
v_mfma_f32_32x32x16_bf16 v[48:63], a[4:7], a[32:35], 0
ds_read_b64_tr_b16 a[0:1], v9 offset:8192
ds_read_b64_tr_b16 a[2:3], v9 offset:9216
buffer_load_dwordx4 a[100:103], v17, s[44:47], s54 offen offset:1024
v_mfma_f32_32x32x16_bf16 v[32:47], a[8:11], a[36:39], v[32:47]
ds_read_b64_tr_b16 a[4:5], v10 offset:8192
ds_read_b64_tr_b16 a[6:7], v10 offset:9216
buffer_load_dwordx4 a[104:107], v18, s[44:47], s54 offen offset:2048
v_mfma_f32_32x32x16_bf16 v[48:63], a[12:15], a[36:39], v[48:63]
ds_read_b64_tr_b16 a[8:9], v9 offset:10240
ds_read_b64_tr_b16 a[10:11], v9 offset:11264
buffer_load_dwordx4 a[108:111], v18, s[44:47], s54 offen offset:3072
s_waitcnt lgkmcnt(6)
v_mfma_f32_32x32x16_bf16 v[32:47], a[16:19], a[40:43], v[32:47]
ds_read_b64_tr_b16 a[12:13], v10 offset:10240
ds_read_b64_tr_b16 a[14:15], v10 offset:11264
buffer_load_dwordx4 a[112:115], v18, s[44:47], s55 offen offset:0
v_mfma_f32_32x32x16_bf16 v[48:63], a[20:23], a[40:43], v[48:63]
ds_read_b64_tr_b16 a[16:17], v9 offset:12288
ds_read_b64_tr_b16 a[18:19], v9 offset:13312
buffer_load_dwordx4 a[116:119], v18, s[44:47], s55 offen offset:1024
v_mfma_f32_32x32x16_bf16 v[32:47], a[24:27], a[44:47], v[32:47]
ds_read_b64_tr_b16 a[20:21], v10 offset:12288
ds_read_b64_tr_b16 a[22:23], v10 offset:13312
buffer_load_dwordx4 a[120:123], v18, s[44:47], s55 offen offset:2048
v_mfma_f32_32x32x16_bf16 v[48:63], a[28:31], a[44:47], v[48:63]
ds_read_b64_tr_b16 a[24:25], v9 offset:14336
ds_read_b64_tr_b16 a[26:27], v9 offset:15360
buffer_load_dwordx4 a[124:127], v18, s[44:47], s55 offen offset:3072
s_waitcnt vmcnt(22)
s_waitcnt lgkmcnt(6)
v_mfma_f32_32x32x16_bf16 v[32:47], a[0:3], a[48:51], v[32:47]
ds_read_b64_tr_b16 a[28:29], v10 offset:14336
ds_read_b64_tr_b16 a[30:31], v10 offset:15360
s_add_u32 m0, s34, 49152
s_nop 0
buffer_load_dwordx4 v6, s[8:11], s30 offen lds
v_mfma_f32_32x32x16_bf16 v[48:63], a[4:7], a[48:51], v[48:63]
ds_read_b64_tr_b16 a[0:1], v9 offset:16384
ds_read_b64_tr_b16 a[2:3], v9 offset:17408
buffer_load_dwordx4 v7, s[8:11], s30 offen offset:1024 lds
v_mfma_f32_32x32x16_bf16 v[32:47], a[8:11], a[52:55], v[32:47]
ds_read_b64_tr_b16 a[4:5], v10 offset:16384
ds_read_b64_tr_b16 a[6:7], v10 offset:17408
buffer_load_dwordx4 v8, s[8:11], s30 offen offset:2048 lds
v_mfma_f32_32x32x16_bf16 v[48:63], a[12:15], a[52:55], v[48:63]
ds_read_b64_tr_b16 a[8:9], v9 offset:18432
ds_read_b64_tr_b16 a[10:11], v9 offset:19456
s_add_u32 m0, s34, 52224
s_nop 0
buffer_load_dwordx4 v6, s[8:11], s31 offen lds
s_waitcnt lgkmcnt(6)
v_mfma_f32_32x32x16_bf16 v[32:47], a[16:19], a[56:59], v[32:47]
ds_read_b64_tr_b16 a[12:13], v10 offset:18432
ds_read_b64_tr_b16 a[14:15], v10 offset:19456
buffer_load_dwordx4 v7, s[8:11], s31 offen offset:1024 lds
v_mfma_f32_32x32x16_bf16 v[48:63], a[20:23], a[56:59], v[48:63]
ds_read_b64_tr_b16 a[16:17], v9 offset:20480
ds_read_b64_tr_b16 a[18:19], v9 offset:21504
buffer_load_dwordx4 v8, s[8:11], s31 offen offset:2048 lds
v_mfma_f32_32x32x16_bf16 v[32:47], a[24:27], a[60:63], v[32:47]
ds_read_b64_tr_b16 a[20:21], v10 offset:20480
ds_read_b64_tr_b16 a[22:23], v10 offset:21504
buffer_load_dwordx4 a[128:131], v18, s[44:47], s56 offen offset:0
v_mfma_f32_32x32x16_bf16 v[48:63], a[28:31], a[60:63], v[48:63]
ds_read_b64_tr_b16 a[24:25], v9 offset:22528
ds_read_b64_tr_b16 a[26:27], v9 offset:23552
buffer_load_dwordx4 a[132:135], v18, s[44:47], s56 offen offset:1024
s_waitcnt vmcnt(26)
s_waitcnt lgkmcnt(6)
v_mfma_f32_32x32x16_bf16 v[32:47], a[0:3], a[64:67], v[32:47]
ds_read_b64_tr_b16 a[28:29], v10 offset:22528
ds_read_b64_tr_b16 a[30:31], v10 offset:23552
s_waitcnt vmcnt(20)
s_barrier
buffer_load_dwordx4 a[136:139], v18, s[44:47], s56 offen offset:2048
v_mfma_f32_32x32x16_bf16 v[48:63], a[4:7], a[64:67], v[48:63]
ds_read_b64_tr_b16 a[0:1], v9 offset:24576
ds_read_b64_tr_b16 a[2:3], v9 offset:25600
buffer_load_dwordx4 a[140:143], v19, s[44:47], s56 offen offset:3072
v_mfma_f32_32x32x16_bf16 v[32:47], a[8:11], a[68:71], v[32:47]
ds_read_b64_tr_b16 a[4:5], v10 offset:24576
ds_read_b64_tr_b16 a[6:7], v10 offset:25600
buffer_load_dwordx4 a[144:147], v19, s[44:47], s57 offen offset:0
v_mfma_f32_32x32x16_bf16 v[48:63], a[12:15], a[68:71], v[48:63]
ds_read_b64_tr_b16 a[8:9], v9 offset:26624
ds_read_b64_tr_b16 a[10:11], v9 offset:27648
buffer_load_dwordx4 a[148:151], v19, s[44:47], s57 offen offset:1024
s_waitcnt lgkmcnt(6)
v_mfma_f32_32x32x16_bf16 v[32:47], a[16:19], a[72:75], v[32:47]
ds_read_b64_tr_b16 a[12:13], v10 offset:26624
ds_read_b64_tr_b16 a[14:15], v10 offset:27648
buffer_load_dwordx4 a[152:155], v19, s[44:47], s57 offen offset:2048
v_mfma_f32_32x32x16_bf16 v[48:63], a[20:23], a[72:75], v[48:63]
ds_read_b64_tr_b16 a[16:17], v9 offset:28672
ds_read_b64_tr_b16 a[18:19], v9 offset:29696
buffer_load_dwordx4 a[156:159], v19, s[44:47], s57 offen offset:3072
v_mfma_f32_32x32x16_bf16 v[32:47], a[24:27], a[76:79], v[32:47]
ds_read_b64_tr_b16 a[20:21], v10 offset:28672
ds_read_b64_tr_b16 a[22:23], v10 offset:29696
buffer_load_dwordx4 a[160:163], v19, s[44:47], s58 offen offset:0
v_mfma_f32_32x32x16_bf16 v[48:63], a[28:31], a[76:79], v[48:63]
ds_read_b64_tr_b16 a[24:25], v9 offset:30720
ds_read_b64_tr_b16 a[26:27], v9 offset:31744
buffer_load_dwordx4 a[164:167], v19, s[44:47], s58 offen offset:1024
s_waitcnt vmcnt(24)
s_waitcnt lgkmcnt(6)
v_mfma_f32_32x32x16_bf16 v[32:47], a[0:3], a[80:83], v[32:47]
ds_read_b64_tr_b16 a[28:29], v10 offset:30720
ds_read_b64_tr_b16 a[30:31], v10 offset:31744
buffer_load_dwordx4 a[168:171], v19, s[44:47], s58 offen offset:2048
v_mfma_f32_32x32x16_bf16 v[48:63], a[4:7], a[80:83], v[48:63]
ds_read_b64_tr_b16 a[0:1], v9 offset:32768
ds_read_b64_tr_b16 a[2:3], v9 offset:33792
buffer_load_dwordx4 a[172:175], v19, s[44:47], s58 offen offset:3072
v_mfma_f32_32x32x16_bf16 v[32:47], a[8:11], a[84:87], v[32:47]
ds_read_b64_tr_b16 a[4:5], v10 offset:32768
ds_read_b64_tr_b16 a[6:7], v10 offset:33792
buffer_load_dwordx4 v[96:99], v2, s[64:67], s42 offen offset:0
v_mfma_f32_32x32x16_bf16 v[48:63], a[12:15], a[84:87], v[48:63]
ds_read_b64_tr_b16 a[8:9], v9 offset:34816
ds_read_b64_tr_b16 a[10:11], v9 offset:35840
buffer_load_dwordx4 v[100:103], v2, s[64:67], s42 offen offset:1024
s_waitcnt lgkmcnt(6)
v_mfma_f32_32x32x16_bf16 v[32:47], a[16:19], a[88:91], v[32:47]
ds_read_b64_tr_b16 a[12:13], v10 offset:34816
ds_read_b64_tr_b16 a[14:15], v10 offset:35840
buffer_load_dwordx4 v[104:107], v2, s[64:67], s42 offen offset:2048
v_mfma_f32_32x32x16_bf16 v[48:63], a[20:23], a[88:91], v[48:63]
ds_read_b64_tr_b16 a[16:17], v9 offset:36864
ds_read_b64_tr_b16 a[18:19], v9 offset:37888
buffer_load_dwordx4 v[108:111], v2, s[64:67], s42 offen offset:3072
v_mfma_f32_32x32x16_bf16 v[32:47], a[24:27], a[92:95], v[32:47]
ds_read_b64_tr_b16 a[20:21], v10 offset:36864
ds_read_b64_tr_b16 a[22:23], v10 offset:37888
buffer_load_dword v128, v15, s[68:71], s28 offen offset:0
v_mfma_f32_32x32x16_bf16 v[48:63], a[28:31], a[92:95], v[48:63]
ds_read_b64_tr_b16 a[24:25], v9 offset:38912
ds_read_b64_tr_b16 a[26:27], v9 offset:39936
buffer_load_dword v129, v15, s[68:71], s33 offen offset:0
s_waitcnt vmcnt(28)
s_waitcnt lgkmcnt(6)
v_mfma_f32_32x32x16_bf16 v[32:47], a[0:3], a[96:99], v[32:47]
ds_read_b64_tr_b16 a[28:29], v10 offset:38912
ds_read_b64_tr_b16 a[30:31], v10 offset:39936
buffer_load_dword v130, v15, s[68:71], s40 offen offset:0
v_mfma_f32_32x32x16_bf16 v[48:63], a[4:7], a[96:99], v[48:63]
ds_read_b64_tr_b16 a[0:1], v9 offset:40960
ds_read_b64_tr_b16 a[2:3], v9 offset:41984
buffer_load_dword v131, v15, s[68:71], s29 offen offset:0
v_mfma_f32_32x32x16_bf16 v[32:47], a[8:11], a[100:103], v[32:47]
ds_read_b64_tr_b16 a[4:5], v10 offset:40960
ds_read_b64_tr_b16 a[6:7], v10 offset:41984
buffer_load_dword v132, v15, s[68:71], s28 offen offset:1024
v_mfma_f32_32x32x16_bf16 v[48:63], a[12:15], a[100:103], v[48:63]
ds_read_b64_tr_b16 a[8:9], v9 offset:43008
ds_read_b64_tr_b16 a[10:11], v9 offset:44032
buffer_load_dword v133, v15, s[68:71], s33 offen offset:1024
s_waitcnt lgkmcnt(6)
v_mfma_f32_32x32x16_bf16 v[32:47], a[16:19], a[104:107], v[32:47]
ds_read_b64_tr_b16 a[12:13], v10 offset:43008
ds_read_b64_tr_b16 a[14:15], v10 offset:44032
buffer_load_dword v134, v15, s[68:71], s40 offen offset:1024
v_mfma_f32_32x32x16_bf16 v[48:63], a[20:23], a[104:107], v[48:63]
ds_read_b64_tr_b16 a[16:17], v9 offset:45056
ds_read_b64_tr_b16 a[18:19], v9 offset:46080
buffer_load_dword v135, v15, s[68:71], s29 offen offset:1024
v_mfma_f32_32x32x16_bf16 v[32:47], a[24:27], a[108:111], v[32:47]
ds_read_b64_tr_b16 a[20:21], v10 offset:45056
ds_read_b64_tr_b16 a[22:23], v10 offset:46080
buffer_load_dword v136, v15, s[68:71], s28 offen offset:2048
v_mfma_f32_32x32x16_bf16 v[48:63], a[28:31], a[108:111], v[48:63]
ds_read_b64_tr_b16 a[24:25], v9 offset:47104
ds_read_b64_tr_b16 a[26:27], v9 offset:48128
buffer_load_dword v137, v15, s[68:71], s33 offen offset:2048
s_waitcnt vmcnt(32)
s_waitcnt lgkmcnt(6)
v_mfma_f32_32x32x16_bf16 v[32:47], a[0:3], a[112:115], v[32:47]
ds_read_b64_tr_b16 a[28:29], v10 offset:47104
ds_read_b64_tr_b16 a[30:31], v10 offset:48128
s_waitcnt vmcnt(26)
s_barrier
buffer_load_dword v138, v15, s[68:71], s40 offen offset:2048
v_mfma_f32_32x32x16_bf16 v[48:63], a[4:7], a[112:115], v[48:63]
ds_read_b64_tr_b16 a[0:1], v11 offset:0
ds_read_b64_tr_b16 a[2:3], v11 offset:1024
buffer_load_dword v139, v15, s[68:71], s29 offen offset:2048
v_mfma_f32_32x32x16_bf16 v[32:47], a[8:11], a[116:119], v[32:47]
ds_read_b64_tr_b16 a[4:5], v12 offset:0
ds_read_b64_tr_b16 a[6:7], v12 offset:1024
v_mfma_f32_32x32x16_bf16 v[48:63], a[12:15], a[116:119], v[48:63]
ds_read_b64_tr_b16 a[8:9], v11 offset:2048
ds_read_b64_tr_b16 a[10:11], v11 offset:3072
s_waitcnt lgkmcnt(6)
v_mfma_f32_32x32x16_bf16 v[32:47], a[16:19], a[120:123], v[32:47]
ds_read_b64_tr_b16 a[12:13], v12 offset:2048
ds_read_b64_tr_b16 a[14:15], v12 offset:3072
v_mfma_f32_32x32x16_bf16 v[48:63], a[20:23], a[120:123], v[48:63]
ds_read_b64_tr_b16 a[16:17], v11 offset:4096
ds_read_b64_tr_b16 a[18:19], v11 offset:5120
v_mfma_f32_32x32x16_bf16 v[32:47], a[24:27], a[124:127], v[32:47]
ds_read_b64_tr_b16 a[20:21], v12 offset:4096
ds_read_b64_tr_b16 a[22:23], v12 offset:5120
v_mfma_f32_32x32x16_bf16 v[48:63], a[28:31], a[124:127], v[48:63]
ds_read_b64_tr_b16 a[24:25], v11 offset:6144
ds_read_b64_tr_b16 a[26:27], v11 offset:7168
s_waitcnt vmcnt(24)
s_waitcnt lgkmcnt(6)
v_mfma_f32_32x32x16_bf16 v[32:47], a[0:3], a[128:131], v[32:47]
ds_read_b64_tr_b16 a[28:29], v12 offset:6144
ds_read_b64_tr_b16 a[30:31], v12 offset:7168
v_mfma_f32_32x32x16_bf16 v[48:63], a[4:7], a[128:131], v[48:63]
ds_read_b64_tr_b16 a[0:1], v11 offset:8192
ds_read_b64_tr_b16 a[2:3], v11 offset:9216
v_mfma_f32_32x32x16_bf16 v[32:47], a[8:11], a[132:135], v[32:47]
ds_read_b64_tr_b16 a[4:5], v12 offset:8192
ds_read_b64_tr_b16 a[6:7], v12 offset:9216
v_mfma_f32_32x32x16_bf16 v[48:63], a[12:15], a[132:135], v[48:63]
ds_read_b64_tr_b16 a[8:9], v11 offset:10240
ds_read_b64_tr_b16 a[10:11], v11 offset:11264
s_waitcnt lgkmcnt(6)
v_mfma_f32_32x32x16_bf16 v[32:47], a[16:19], a[136:139], v[32:47]
ds_read_b64_tr_b16 a[12:13], v12 offset:10240
ds_read_b64_tr_b16 a[14:15], v12 offset:11264
v_mfma_f32_32x32x16_bf16 v[48:63], a[20:23], a[136:139], v[48:63]
ds_read_b64_tr_b16 a[16:17], v11 offset:12288
ds_read_b64_tr_b16 a[18:19], v11 offset:13312
v_mfma_f32_32x32x16_bf16 v[32:47], a[24:27], a[140:143], v[32:47]
ds_read_b64_tr_b16 a[20:21], v12 offset:12288
ds_read_b64_tr_b16 a[22:23], v12 offset:13312
v_mfma_f32_32x32x16_bf16 v[48:63], a[28:31], a[140:143], v[48:63]
ds_read_b64_tr_b16 a[24:25], v11 offset:14336
ds_read_b64_tr_b16 a[26:27], v11 offset:15360
s_waitcnt vmcnt(20)
s_waitcnt lgkmcnt(6)
v_mfma_f32_32x32x16_bf16 v[32:47], a[0:3], a[144:147], v[32:47]
ds_read_b64_tr_b16 a[28:29], v12 offset:14336
ds_read_b64_tr_b16 a[30:31], v12 offset:15360
v_mfma_f32_32x32x16_bf16 v[48:63], a[4:7], a[144:147], v[48:63]
ds_read_b64_tr_b16 a[0:1], v11 offset:16384
ds_read_b64_tr_b16 a[2:3], v11 offset:17408
v_mfma_f32_32x32x16_bf16 v[32:47], a[8:11], a[148:151], v[32:47]
ds_read_b64_tr_b16 a[4:5], v12 offset:16384
ds_read_b64_tr_b16 a[6:7], v12 offset:17408
v_mfma_f32_32x32x16_bf16 v[48:63], a[12:15], a[148:151], v[48:63]
ds_read_b64_tr_b16 a[8:9], v11 offset:18432
ds_read_b64_tr_b16 a[10:11], v11 offset:19456
s_waitcnt lgkmcnt(6)
v_mfma_f32_32x32x16_bf16 v[32:47], a[16:19], a[152:155], v[32:47]
ds_read_b64_tr_b16 a[12:13], v12 offset:18432
ds_read_b64_tr_b16 a[14:15], v12 offset:19456
v_mfma_f32_32x32x16_bf16 v[48:63], a[20:23], a[152:155], v[48:63]
ds_read_b64_tr_b16 a[16:17], v11 offset:20480
ds_read_b64_tr_b16 a[18:19], v11 offset:21504
v_mfma_f32_32x32x16_bf16 v[32:47], a[24:27], a[156:159], v[32:47]
ds_read_b64_tr_b16 a[20:21], v12 offset:20480
ds_read_b64_tr_b16 a[22:23], v12 offset:21504
v_mfma_f32_32x32x16_bf16 v[48:63], a[28:31], a[156:159], v[48:63]
ds_read_b64_tr_b16 a[24:25], v11 offset:22528
ds_read_b64_tr_b16 a[26:27], v11 offset:23552
s_waitcnt vmcnt(16)
s_waitcnt lgkmcnt(6)
v_mfma_f32_32x32x16_bf16 v[32:47], a[0:3], a[160:163], v[32:47]
ds_read_b64_tr_b16 a[28:29], v12 offset:22528
ds_read_b64_tr_b16 a[30:31], v12 offset:23552
v_mfma_f32_32x32x16_bf16 v[48:63], a[4:7], a[160:163], v[48:63]
v_mfma_f32_32x32x16_bf16 v[32:47], a[8:11], a[164:167], v[32:47]
v_mfma_f32_32x32x16_bf16 v[48:63], a[12:15], a[164:167], v[48:63]
s_waitcnt lgkmcnt(0)
v_mfma_f32_32x32x16_bf16 v[32:47], a[16:19], a[168:171], v[32:47]
v_mfma_f32_32x32x16_bf16 v[48:63], a[20:23], a[168:171], v[48:63]
v_mfma_f32_32x32x16_bf16 v[32:47], a[24:27], a[172:175], v[32:47]
v_mfma_f32_32x32x16_bf16 v[48:63], a[28:31], a[172:175], v[48:63]
s_waitcnt vmcnt(0)
v_add_f32 v128, v128, v129
v_add_f32 v130, v130, v131
v_add_f32 v128, v128, v130
v_cvt_pk_bf16_f32 v129, v128, v128
v_and_b32 v129, 0xffff0000, v129
v_sub_f32 v128, v128, v129
v_cvt_pk_bf16_f32 v128, v128, v129
ds_write_b32 v23, v128 offset:16384
v_add_f32 v132, v132, v133
v_add_f32 v134, v134, v135
v_add_f32 v132, v132, v134
v_cvt_pk_bf16_f32 v133, v132, v132
v_and_b32 v133, 0xffff0000, v133
v_sub_f32 v132, v132, v133
v_cvt_pk_bf16_f32 v132, v132, v133
ds_write_b32 v23, v132 offset:17408
v_add_f32 v136, v136, v137
v_add_f32 v138, v138, v139
v_add_f32 v136, v136, v138
v_cvt_pk_bf16_f32 v137, v136, v136
v_and_b32 v137, 0xffff0000, v137
v_sub_f32 v136, v136, v137
v_cvt_pk_bf16_f32 v136, v136, v137
ds_write_b32 v23, v136 offset:18432
v_lshlrev_b32 v24, 16, v96
v_and_b32 v25, 0xffff0000, v96
v_fmac_f32 v24, s49, v32
v_fmac_f32 v25, s49, v33
v_cvt_pk_bf16_f32 v96, v24, v25
v_add_f32 v240, v240, v24
v_fmac_f32 v241, v24, v24
v_add_f32 v240, v240, v25
v_fmac_f32 v241, v25, v25
v_lshlrev_b32 v26, 16, v97
v_and_b32 v27, 0xffff0000, v97
v_fmac_f32 v26, s49, v34
v_fmac_f32 v27, s49, v35
v_cvt_pk_bf16_f32 v97, v26, v27
v_add_f32 v240, v240, v26
v_fmac_f32 v241, v26, v26
v_add_f32 v240, v240, v27
v_fmac_f32 v241, v27, v27
v_lshlrev_b32 v28, 16, v98
v_and_b32 v29, 0xffff0000, v98
v_fmac_f32 v28, s49, v36
v_fmac_f32 v29, s49, v37
v_cvt_pk_bf16_f32 v98, v28, v29
v_add_f32 v240, v240, v28
v_fmac_f32 v241, v28, v28
v_add_f32 v240, v240, v29
v_fmac_f32 v241, v29, v29
v_lshlrev_b32 v30, 16, v99
v_and_b32 v31, 0xffff0000, v99
v_fmac_f32 v30, s49, v38
v_fmac_f32 v31, s49, v39
v_cvt_pk_bf16_f32 v99, v30, v31
v_add_f32 v240, v240, v30
v_fmac_f32 v241, v30, v30
v_add_f32 v240, v240, v31
v_fmac_f32 v241, v31, v31
buffer_store_dwordx4 v[96:99], v2, s[20:23], s42 offen offset:0 sc1
v_lshlrev_b32 v24, 16, v100
v_and_b32 v25, 0xffff0000, v100
v_fmac_f32 v24, s49, v40
v_fmac_f32 v25, s49, v41
v_cvt_pk_bf16_f32 v100, v24, v25
v_add_f32 v240, v240, v24
v_fmac_f32 v241, v24, v24
v_add_f32 v240, v240, v25
v_fmac_f32 v241, v25, v25
v_lshlrev_b32 v26, 16, v101
v_and_b32 v27, 0xffff0000, v101
v_fmac_f32 v26, s49, v42
v_fmac_f32 v27, s49, v43
v_cvt_pk_bf16_f32 v101, v26, v27
v_add_f32 v240, v240, v26
v_fmac_f32 v241, v26, v26
v_add_f32 v240, v240, v27
v_fmac_f32 v241, v27, v27
v_lshlrev_b32 v28, 16, v102
v_and_b32 v29, 0xffff0000, v102
v_fmac_f32 v28, s49, v44
v_fmac_f32 v29, s49, v45
v_cvt_pk_bf16_f32 v102, v28, v29
v_add_f32 v240, v240, v28
v_fmac_f32 v241, v28, v28
v_add_f32 v240, v240, v29
v_fmac_f32 v241, v29, v29
v_lshlrev_b32 v30, 16, v103
v_and_b32 v31, 0xffff0000, v103
v_fmac_f32 v30, s49, v46
v_fmac_f32 v31, s49, v47
v_cvt_pk_bf16_f32 v103, v30, v31
v_add_f32 v240, v240, v30
v_fmac_f32 v241, v30, v30
v_add_f32 v240, v240, v31
v_fmac_f32 v241, v31, v31
buffer_store_dwordx4 v[100:103], v2, s[20:23], s42 offen offset:1024 sc1
v_lshlrev_b32 v24, 16, v104
v_and_b32 v25, 0xffff0000, v104
v_fmac_f32 v24, s49, v48
v_fmac_f32 v25, s49, v49
v_cvt_pk_bf16_f32 v104, v24, v25
v_add_f32 v240, v240, v24
v_fmac_f32 v241, v24, v24
v_add_f32 v240, v240, v25
v_fmac_f32 v241, v25, v25
v_lshlrev_b32 v26, 16, v105
v_and_b32 v27, 0xffff0000, v105
v_fmac_f32 v26, s49, v50
v_fmac_f32 v27, s49, v51
v_cvt_pk_bf16_f32 v105, v26, v27
v_add_f32 v240, v240, v26
v_fmac_f32 v241, v26, v26
v_add_f32 v240, v240, v27
v_fmac_f32 v241, v27, v27
v_lshlrev_b32 v28, 16, v106
v_and_b32 v29, 0xffff0000, v106
v_fmac_f32 v28, s49, v52
v_fmac_f32 v29, s49, v53
v_cvt_pk_bf16_f32 v106, v28, v29
v_add_f32 v240, v240, v28
v_fmac_f32 v241, v28, v28
v_add_f32 v240, v240, v29
v_fmac_f32 v241, v29, v29
v_lshlrev_b32 v30, 16, v107
v_and_b32 v31, 0xffff0000, v107
v_fmac_f32 v30, s49, v54
v_fmac_f32 v31, s49, v55
v_cvt_pk_bf16_f32 v107, v30, v31
v_add_f32 v240, v240, v30
v_fmac_f32 v241, v30, v30
v_add_f32 v240, v240, v31
v_fmac_f32 v241, v31, v31
buffer_store_dwordx4 v[104:107], v2, s[20:23], s42 offen offset:2048 sc1
v_lshlrev_b32 v24, 16, v108
v_and_b32 v25, 0xffff0000, v108
v_fmac_f32 v24, s49, v56
v_fmac_f32 v25, s49, v57
v_cvt_pk_bf16_f32 v108, v24, v25
v_add_f32 v240, v240, v24
v_fmac_f32 v241, v24, v24
v_add_f32 v240, v240, v25
v_fmac_f32 v241, v25, v25
v_lshlrev_b32 v26, 16, v109
v_and_b32 v27, 0xffff0000, v109
v_fmac_f32 v26, s49, v58
v_fmac_f32 v27, s49, v59
v_cvt_pk_bf16_f32 v109, v26, v27
v_add_f32 v240, v240, v26
v_fmac_f32 v241, v26, v26
v_add_f32 v240, v240, v27
v_fmac_f32 v241, v27, v27
v_lshlrev_b32 v28, 16, v110
v_and_b32 v29, 0xffff0000, v110
v_fmac_f32 v28, s49, v60
v_fmac_f32 v29, s49, v61
v_cvt_pk_bf16_f32 v110, v28, v29
v_add_f32 v240, v240, v28
v_fmac_f32 v241, v28, v28
v_add_f32 v240, v240, v29
v_fmac_f32 v241, v29, v29
v_lshlrev_b32 v30, 16, v111
v_and_b32 v31, 0xffff0000, v111
v_fmac_f32 v30, s49, v62
v_fmac_f32 v31, s49, v63
v_cvt_pk_bf16_f32 v111, v30, v31
v_add_f32 v240, v240, v30
v_fmac_f32 v241, v30, v30
v_add_f32 v240, v240, v31
v_fmac_f32 v241, v31, v31
buffer_store_dwordx4 v[108:111], v2, s[20:23], s42 offen offset:3072 sc1
s_mul_i32 s33, s35, 5120
s_add_u32 s33, s33, 0x20000
s_lshl_b32 s32, s25, 9
s_add_u32 s42, s32, s33
v_lshlrev_b32 v15, 3, v1
buffer_store_dwordx2 v[240:241], v15, s[68:71], s42 offen sc1
s_mul_i32 s32, s26, 11264
v_and_b32 v22, 7, v1
v_lshl_add_u32 v242, v22, 7, s32
v_and_b32 v22, 1, v1
v_lshl_add_u32 v243, v22, 7, s32
v_add_u32 v243, 10240, v243
s_lshl_b32 s59, s25, 7
s_add_u32 s32, s32, s59
v_mov_b32 v254, s32
v_mov_b32 v255, 1
v_mov_b32 v22, 0x80000000
v_cmp_eq_u32 vcc, 0, v0
s_nop 1
v_cndmask_b32 v254, v22, v254, vcc
s_waitcnt vmcnt(0) lgkmcnt(0)
s_barrier
v_mov_b32 v240, 0
v_mov_b32 v241, 0
buffer_store_dword v255, v254, s[60:63], 0 offen sc1
s_add_u32 s8, s6, 0x2600000
s_addc_u32 s9, s7, 0
s_mov_b32 s10, 0xa20000
s_mov_b32 s11, 0x00020000
s_mul_i32 s32, s25, 663552
s_add_u32 s30, s34, s32
s_add_u32 m0, s34, 0
s_nop 0
buffer_load_dwordx4 v2, s[8:11], s30 offen lds
buffer_load_dwordx4 v2, s[8:11], s30 offen offset:1024 lds
buffer_load_dwordx4 v2, s[8:11], s30 offen offset:2048 lds
buffer_load_dwordx4 v2, s[8:11], s30 offen offset:3072 lds
s_add_u32 m0, s34, 4096
s_nop 0
buffer_load_dwordx4 v3, s[8:11], s30 offen lds
buffer_load_dwordx4 v3, s[8:11], s30 offen offset:1024 lds
s_add_u32 s30, s30, 24576
s_add_u32 m0, s34, 24576
s_nop 0
buffer_load_dwordx4 v2, s[8:11], s30 offen lds
buffer_load_dwordx4 v2, s[8:11], s30 offen offset:1024 lds
buffer_load_dwordx4 v2, s[8:11], s30 offen offset:2048 lds
buffer_load_dwordx4 v2, s[8:11], s30 offen offset:3072 lds
s_add_u32 m0, s34, 28672
s_nop 0
buffer_load_dwordx4 v3, s[8:11], s30 offen lds
buffer_load_dwordx4 v3, s[8:11], s30 offen offset:1024 lds
s_add_u32 s30, s30, 24576
L_mlp_pub:
s_mul_i32 s32, s25, 2359296
s_add_u32 s40, s41, s32
s_mov_b32 s49, 0xc09d30fc
v_mov_b32 v249, 0
v_mov_b32 v251, 0
v_mov_b32 v247, 0
s_add_u32 s50, s41, s50
s_add_u32 s51, s41, s51
s_add_u32 s52, s41, s52
s_add_u32 s53, s41, s53
s_add_u32 s54, s41, s54
s_add_u32 s55, s41, s55
s_add_u32 s56, s41, s56
s_add_u32 s57, s41, s57
s_add_u32 s58, s41, s58
s_cmp_lg_u32 s24, 0
s_cbranch_scc1 L_mlp_poll_ok
s_mov_b32 s59, 0x40000
L_mlp_poll:
buffer_load_dword v21, v242, s[60:63], 0 offen offset:0 sc1
s_waitcnt vmcnt(0)
v_cmp_ne_u32 vcc, 0, v21
s_sub_u32 s59, s59, 1
s_cmp_eq_u32 s59, 0
s_cbranch_scc1 L_mlp_poll_ok
s_cmp_eq_u64 vcc, -1
s_cbranch_scc1 L_mlp_poll_ok
s_sleep 2
s_branch L_mlp_poll
L_mlp_poll_ok:
s_barrier
s_add_u32 s42, s33, 4096
buffer_load_dwordx4 a[32:35], v2, s[20:23], s50 offen offset:0 sc1
buffer_load_dwordx4 a[36:39], v2, s[20:23], s50 offen offset:1024 sc1
buffer_load_dwordx4 a[40:43], v2, s[20:23], s50 offen offset:2048 sc1
buffer_load_dwordx4 a[44:47], v2, s[20:23], s50 offen offset:3072 sc1
buffer_load_dwordx4 a[48:51], v2, s[20:23], s51 offen offset:0 sc1
buffer_load_dwordx4 a[52:55], v2, s[20:23], s51 offen offset:1024 sc1
buffer_load_dwordx4 a[56:59], v2, s[20:23], s51 offen offset:2048 sc1
buffer_load_dwordx4 a[60:63], v2, s[20:23], s51 offen offset:3072 sc1
buffer_load_dwordx4 a[64:67], v2, s[20:23], s52 offen offset:0 sc1
buffer_load_dwordx4 a[68:71], v2, s[20:23], s52 offen offset:1024 sc1
buffer_load_dwordx4 a[72:75], v2, s[20:23], s52 offen offset:2048 sc1
buffer_load_dwordx4 a[76:79], v2, s[20:23], s52 offen offset:3072 sc1
buffer_load_dwordx4 a[80:83], v2, s[20:23], s53 offen offset:0 sc1
buffer_load_dwordx4 a[84:87], v2, s[20:23], s53 offen offset:1024 sc1
buffer_load_dwordx4 a[88:91], v2, s[20:23], s53 offen offset:2048 sc1
buffer_load_dwordx4 a[92:95], v2, s[20:23], s53 offen offset:3072 sc1
s_mul_i32 s43, s25, 663552
s_mul_i32 s32, s35, 10368
s_add_u32 s43, s43, s32
s_mov_b32 s48, 0x40088e99
s_mov_b32 s39, 0x80000000
s_waitcnt vmcnt(22)
s_barrier
ds_read_b128 a[0:3], v2 offset:0
ds_read_b128 a[4:7], v2 offset:1024
ds_read_b128 a[8:11], v2 offset:2048
ds_read_b128 a[12:15], v2 offset:3072
ds_read_b128 a[16:19], v2 offset:4096
ds_read_b128 a[20:23], v2 offset:5120
ds_read_b128 a[24:27], v2 offset:6144
s_waitcnt vmcnt(14)
s_waitcnt lgkmcnt(3)
v_mfma_f32_32x32x16_bf16 v[32:47], a[0:3], a[32:35], 0
ds_read_b128 a[28:31], v2 offset:7168
buffer_load_dwordx4 a[96:99], v2, s[20:23], s54 offen offset:0 sc1
s_add_u32 m0, s34, 49152
s_nop 0
buffer_load_dwordx4 v2, s[8:11], s30 offen lds
buffer_load_dwordx4 v2, s[8:11], s30 offen offset:1024 lds
v_mfma_f32_32x32x16_bf16 v[48:63], a[4:7], a[32:35], 0
ds_read_b128 a[0:3], v2 offset:8192
buffer_load_dwordx4 a[100:103], v2, s[20:23], s54 offen offset:1024 sc1
buffer_load_dwordx4 v2, s[8:11], s30 offen offset:2048 lds
v_mfma_f32_32x32x16_bf16 v[32:47], a[8:11], a[36:39], v[32:47]
ds_read_b128 a[4:7], v2 offset:9216
buffer_load_dwordx4 a[104:107], v2, s[20:23], s54 offen offset:2048 sc1
buffer_load_dwordx4 v2, s[8:11], s30 offen offset:3072 lds
v_mfma_f32_32x32x16_bf16 v[48:63], a[12:15], a[36:39], v[48:63]
ds_read_b128 a[8:11], v2 offset:10240
buffer_load_dwordx4 a[108:111], v2, s[20:23], s54 offen offset:3072 sc1
s_add_u32 m0, s34, 53248
s_nop 0
buffer_load_dwordx4 v3, s[8:11], s30 offen lds
s_waitcnt vmcnt(21)
s_waitcnt lgkmcnt(3)
v_mfma_f32_32x32x16_bf16 v[32:47], a[16:19], a[40:43], v[32:47]
ds_read_b128 a[12:15], v2 offset:11264
buffer_load_dwordx4 a[112:115], v2, s[20:23], s55 offen offset:0 sc1
buffer_load_dwordx4 v3, s[8:11], s30 offen offset:1024 lds
s_add_u32 s30, s30, 24576
v_mfma_f32_32x32x16_bf16 v[48:63], a[20:23], a[40:43], v[48:63]
ds_read_b128 a[16:19], v2 offset:12288
buffer_load_dwordx4 a[116:119], v2, s[20:23], s55 offen offset:1024 sc1
s_add_u32 m0, s34, 73728
s_nop 0
buffer_load_dwordx4 v2, s[8:11], s30 offen lds
v_mfma_f32_32x32x16_bf16 v[32:47], a[24:27], a[44:47], v[32:47]
ds_read_b128 a[20:23], v2 offset:13312
buffer_load_dwordx4 a[120:123], v2, s[20:23], s55 offen offset:2048 sc1
buffer_load_dwordx4 v2, s[8:11], s30 offen offset:1024 lds
v_mfma_f32_32x32x16_bf16 v[48:63], a[28:31], a[44:47], v[48:63]
ds_read_b128 a[24:27], v2 offset:14336
buffer_load_dwordx4 a[124:127], v2, s[20:23], s55 offen offset:3072 sc1
buffer_load_dwordx4 v2, s[8:11], s30 offen offset:2048 lds
s_waitcnt vmcnt(27)
s_waitcnt lgkmcnt(3)
v_mfma_f32_32x32x16_bf16 v[32:47], a[0:3], a[48:51], v[32:47]
ds_read_b128 a[28:31], v2 offset:15360
buffer_load_dwordx4 a[128:131], v2, s[20:23], s56 offen offset:0 sc1
buffer_load_dwordx4 v2, s[8:11], s30 offen offset:3072 lds
s_add_u32 m0, s34, 77824
s_nop 0
buffer_load_dwordx4 v3, s[8:11], s30 offen lds
buffer_load_dword v21, v243, s[60:63], 0 offen sc1
v_mfma_f32_32x32x16_bf16 v[48:63], a[4:7], a[48:51], v[48:63]
ds_read_b128 a[0:3], v2 offset:16384
buffer_load_dwordx4 a[132:135], v2, s[20:23], s56 offen offset:1024 sc1
buffer_load_dwordx4 v3, s[8:11], s30 offen offset:1024 lds
s_add_u32 s30, s30, 24576
v_mfma_f32_32x32x16_bf16 v[32:47], a[8:11], a[52:55], v[32:47]
ds_read_b128 a[4:7], v2 offset:17408
buffer_load_dwordx4 a[136:139], v2, s[20:23], s56 offen offset:2048 sc1
s_add_u32 m0, s34, 98304
s_nop 0
buffer_load_dwordx4 v2, s[8:11], s30 offen lds
v_mfma_f32_32x32x16_bf16 v[48:63], a[12:15], a[52:55], v[48:63]
ds_read_b128 a[8:11], v2 offset:18432
buffer_load_dwordx4 a[140:143], v2, s[20:23], s56 offen offset:3072 sc1
buffer_load_dwordx4 v2, s[8:11], s30 offen offset:1024 lds
s_waitcnt vmcnt(35)
s_waitcnt lgkmcnt(3)
v_mfma_f32_32x32x16_bf16 v[32:47], a[16:19], a[56:59], v[32:47]
ds_read_b128 a[12:15], v2 offset:19456
buffer_load_dwordx4 a[144:147], v2, s[20:23], s57 offen offset:0 sc1
buffer_load_dwordx4 v2, s[8:11], s30 offen offset:2048 lds
v_mfma_f32_32x32x16_bf16 v[48:63], a[20:23], a[56:59], v[48:63]
ds_read_b128 a[16:19], v2 offset:20480
buffer_load_dwordx4 a[148:151], v2, s[20:23], s57 offen offset:1024 sc1
buffer_load_dwordx4 v2, s[8:11], s30 offen offset:3072 lds
v_mfma_f32_32x32x16_bf16 v[32:47], a[24:27], a[60:63], v[32:47]
ds_read_b128 a[20:23], v2 offset:21504
buffer_load_dwordx4 a[152:155], v2, s[20:23], s57 offen offset:2048 sc1
s_add_u32 m0, s34, 102400
s_nop 0
buffer_load_dwordx4 v3, s[8:11], s30 offen lds
v_mfma_f32_32x32x16_bf16 v[48:63], a[28:31], a[60:63], v[48:63]
ds_read_b128 a[24:27], v2 offset:22528
buffer_load_dwordx4 a[156:159], v2, s[20:23], s57 offen offset:3072 sc1
buffer_load_dwordx4 v3, s[8:11], s30 offen offset:1024 lds
s_add_u32 s30, s30, 24576
s_waitcnt vmcnt(41)
s_waitcnt lgkmcnt(3)
v_mfma_f32_32x32x16_bf16 v[32:47], a[0:3], a[64:67], v[32:47]
ds_read_b128 a[28:31], v2 offset:23552
s_barrier
v_mfma_f32_32x32x16_bf16 v[48:63], a[4:7], a[64:67], v[48:63]
ds_read_b128 a[0:3], v2 offset:24576
s_add_u32 m0, s34, 122880
buffer_load_dwordx2 v[96:97], v15, s[68:71], s33 offen offset:0 sc1
v_mfma_f32_32x32x16_bf16 v[32:47], a[8:11], a[68:71], v[32:47]
ds_read_b128 a[4:7], v2 offset:25600
buffer_load_dwordx2 v[98:99], v15, s[68:71], s33 offen offset:512 sc1
v_mfma_f32_32x32x16_bf16 v[48:63], a[12:15], a[68:71], v[48:63]
ds_read_b128 a[8:11], v2 offset:26624
buffer_load_dwordx4 v2, s[8:11], s30 offen lds
buffer_load_dwordx2 v[100:101], v15, s[68:71], s33 offen offset:1024 sc1
s_waitcnt vmcnt(43)
s_waitcnt lgkmcnt(3)
v_mfma_f32_32x32x16_bf16 v[32:47], a[16:19], a[72:75], v[32:47]
ds_read_b128 a[12:15], v2 offset:27648
buffer_load_dwordx2 v[102:103], v15, s[68:71], s33 offen offset:1536 sc1
s_waitcnt vmcnt(19)
v_cmp_ne_u32 vcc, 0, v21
s_mov_b32 s59, 0x40000
s_cmp_eq_u64 vcc, -1
s_cbranch_scc1 L_mlp_p2_ok
L_mlp_p2:
s_sleep 2
buffer_load_dword v21, v243, s[60:63], 0 offen offset:0 sc1
s_waitcnt vmcnt(0)
v_cmp_ne_u32 vcc, 0, v21
s_sub_u32 s59, s59, 1
s_cmp_eq_u32 s59, 0
s_cbranch_scc1 L_mlp_p2_ok
s_cmp_eq_u64 vcc, -1
s_cbranch_scc0 L_mlp_p2
L_mlp_p2_ok:
buffer_load_dwordx2 v[112:113], v15, s[68:71], s42 offen offset:0 sc1
v_mfma_f32_32x32x16_bf16 v[48:63], a[20:23], a[72:75], v[48:63]
ds_read_b128 a[16:19], v2 offset:28672
buffer_load_dwordx4 v2, s[8:11], s30 offen offset:1024 lds
buffer_load_dwordx2 v[104:105], v15, s[68:71], s33 offen offset:2048 sc1
buffer_load_dwordx2 v[114:115], v15, s[68:71], s42 offen offset:512 sc1
v_mfma_f32_32x32x16_bf16 v[32:47], a[24:27], a[76:79], v[32:47]
ds_read_b128 a[20:23], v2 offset:29696
buffer_load_dwordx2 v[106:107], v15, s[68:71], s33 offen offset:2560 sc1
buffer_load_dwordx4 a[160:163], v2, s[20:23], s58 offen offset:0 sc1
v_mfma_f32_32x32x16_bf16 v[48:63], a[28:31], a[76:79], v[48:63]
ds_read_b128 a[24:27], v2 offset:30720
buffer_load_dwordx4 v2, s[8:11], s30 offen offset:2048 lds
buffer_load_dwordx2 v[108:109], v15, s[68:71], s33 offen offset:3072 sc1
buffer_load_dwordx4 a[164:167], v2, s[20:23], s58 offen offset:1024 sc1
s_waitcnt vmcnt(51)
s_waitcnt lgkmcnt(3)
v_mfma_f32_32x32x16_bf16 v[32:47], a[0:3], a[80:83], v[32:47]
ds_read_b128 a[28:31], v2 offset:31744
buffer_load_dwordx2 v[110:111], v15, s[68:71], s33 offen offset:3584 sc1
buffer_load_dwordx4 a[168:171], v2, s[20:23], s58 offen offset:2048 sc1
v_mfma_f32_32x32x16_bf16 v[48:63], a[4:7], a[80:83], v[48:63]
ds_read_b128 a[0:3], v2 offset:32768
buffer_load_dwordx4 v2, s[8:11], s30 offen offset:3072 lds
buffer_load_dwordx4 a[172:175], v2, s[20:23], s58 offen offset:3072 sc1
v_mfma_f32_32x32x16_bf16 v[32:47], a[8:11], a[84:87], v[32:47]
ds_read_b128 a[4:7], v2 offset:33792
v_mfma_f32_32x32x16_bf16 v[48:63], a[12:15], a[84:87], v[48:63]
ds_read_b128 a[8:11], v2 offset:34816
s_add_u32 m0, s34, 126976
s_waitcnt vmcnt(53)
s_waitcnt lgkmcnt(3)
v_mfma_f32_32x32x16_bf16 v[32:47], a[16:19], a[88:91], v[32:47]
ds_read_b128 a[12:15], v2 offset:35840
v_mfma_f32_32x32x16_bf16 v[48:63], a[20:23], a[88:91], v[48:63]
ds_read_b128 a[16:19], v2 offset:36864
buffer_load_dwordx4 v3, s[8:11], s30 offen lds
v_mfma_f32_32x32x16_bf16 v[32:47], a[24:27], a[92:95], v[32:47]
ds_read_b128 a[20:23], v2 offset:37888
v_mfma_f32_32x32x16_bf16 v[48:63], a[28:31], a[92:95], v[48:63]
ds_read_b128 a[24:27], v2 offset:38912
buffer_load_dwordx4 v3, s[8:11], s30 offen offset:1024 lds
s_waitcnt vmcnt(51)
s_waitcnt lgkmcnt(3)
v_mfma_f32_32x32x16_bf16 v[32:47], a[0:3], a[96:99], v[32:47]
ds_read_b128 a[28:31], v2 offset:39936
v_mfma_f32_32x32x16_bf16 v[48:63], a[4:7], a[96:99], v[48:63]
ds_read_b128 a[0:3], v2 offset:40960
s_add_u32 s30, s30, 24576
v_mfma_f32_32x32x16_bf16 v[32:47], a[8:11], a[100:103], v[32:47]
ds_read_b128 a[4:7], v2 offset:41984
v_mfma_f32_32x32x16_bf16 v[48:63], a[12:15], a[100:103], v[48:63]
ds_read_b128 a[8:11], v2 offset:43008
s_waitcnt vmcnt(47)
s_waitcnt lgkmcnt(3)
v_mfma_f32_32x32x16_bf16 v[32:47], a[16:19], a[104:107], v[32:47]
ds_read_b128 a[12:15], v2 offset:44032
v_mfma_f32_32x32x16_bf16 v[48:63], a[20:23], a[104:107], v[48:63]
ds_read_b128 a[16:19], v2 offset:45056
v_mfma_f32_32x32x16_bf16 v[32:47], a[24:27], a[108:111], v[32:47]
ds_read_b128 a[20:23], v2 offset:46080
v_mfma_f32_32x32x16_bf16 v[48:63], a[28:31], a[108:111], v[48:63]
ds_read_b128 a[24:27], v2 offset:47104
s_waitcnt vmcnt(43)
s_waitcnt lgkmcnt(3)
v_mfma_f32_32x32x16_bf16 v[32:47], a[0:3], a[112:115], v[32:47]
ds_read_b128 a[28:31], v2 offset:48128
s_barrier
v_mfma_f32_32x32x16_bf16 v[48:63], a[4:7], a[112:115], v[48:63]
ds_read_b128 a[0:3], v4 offset:0
s_add_u32 m0, s34, 0
v_mfma_f32_32x32x16_bf16 v[32:47], a[8:11], a[116:119], v[32:47]
ds_read_b128 a[4:7], v4 offset:1024
v_mfma_f32_32x32x16_bf16 v[48:63], a[12:15], a[116:119], v[48:63]
ds_read_b128 a[8:11], v4 offset:2048
buffer_load_dwordx4 v2, s[8:11], s30 offen lds
s_waitcnt vmcnt(40)
s_waitcnt lgkmcnt(3)
v_mfma_f32_32x32x16_bf16 v[32:47], a[16:19], a[120:123], v[32:47]
ds_read_b128 a[12:15], v4 offset:3072
v_mfma_f32_32x32x16_bf16 v[48:63], a[20:23], a[120:123], v[48:63]
ds_read_b128 a[16:19], v4 offset:4096
buffer_load_dwordx4 v2, s[8:11], s30 offen offset:1024 lds
v_mfma_f32_32x32x16_bf16 v[32:47], a[24:27], a[124:127], v[32:47]
ds_read_b128 a[20:23], v4 offset:5120
v_mfma_f32_32x32x16_bf16 v[48:63], a[28:31], a[124:127], v[48:63]
ds_read_b128 a[24:27], v4 offset:6144
buffer_load_dwordx4 v2, s[8:11], s30 offen offset:2048 lds
s_waitcnt vmcnt(36)
s_waitcnt lgkmcnt(3)
v_mfma_f32_32x32x16_bf16 v[32:47], a[0:3], a[128:131], v[32:47]
ds_read_b128 a[28:31], v4 offset:7168
v_mfma_f32_32x32x16_bf16 v[48:63], a[4:7], a[128:131], v[48:63]
ds_read_b128 a[0:3], v4 offset:8192
buffer_load_dwordx4 v2, s[8:11], s30 offen offset:3072 lds
v_mfma_f32_32x32x16_bf16 v[32:47], a[8:11], a[132:135], v[32:47]
ds_read_b128 a[4:7], v4 offset:9216
s_waitcnt vmcnt(9)
v_add_f32 v16, v96, v98
v_add_f32 v20, v97, v99
v_mfma_f32_32x32x16_bf16 v[48:63], a[12:15], a[132:135], v[48:63]
ds_read_b128 a[8:11], v4 offset:10240
s_add_u32 m0, s34, 4096
v_add_f32 v17, v100, v102
v_add_f32 v21, v101, v103
v_add_f32 v18, v104, v106
s_waitcnt lgkmcnt(3)
v_mfma_f32_32x32x16_bf16 v[32:47], a[16:19], a[136:139], v[32:47]
ds_read_b128 a[12:15], v4 offset:11264
v_add_f32 v22, v105, v107
v_add_f32 v19, v108, v110
v_add_f32 v23, v109, v111
v_mfma_f32_32x32x16_bf16 v[48:63], a[20:23], a[136:139], v[48:63]
ds_read_b128 a[16:19], v4 offset:12288
buffer_load_dwordx4 v3, s[8:11], s30 offen lds
v_add_f32 v16, v16, v17
v_add_f32 v18, v18, v19
v_add_f32 v20, v20, v21
v_mfma_f32_32x32x16_bf16 v[32:47], a[24:27], a[140:143], v[32:47]
ds_read_b128 a[20:23], v4 offset:13312
v_add_f32 v22, v22, v23
v_add_f32 v17, v112, v114
v_add_f32 v21, v113, v115
v_mfma_f32_32x32x16_bf16 v[48:63], a[28:31], a[140:143], v[48:63]
ds_read_b128 a[24:27], v4 offset:14336
buffer_load_dwordx4 v3, s[8:11], s30 offen offset:1024 lds
v_add_f32 v16, v16, v18
v_add_f32 v20, v20, v22
v_add_f32 v16, v16, v17
s_waitcnt lgkmcnt(3)
v_mfma_f32_32x32x16_bf16 v[32:47], a[0:3], a[144:147], v[32:47]
ds_read_b128 a[28:31], v4 offset:15360
v_add_f32 v20, v20, v21
v_mov_b32 v17, v16
v_mov_b32 v21, v20
v_mfma_f32_32x32x16_bf16 v[48:63], a[4:7], a[144:147], v[48:63]
ds_read_b128 a[0:3], v4 offset:16384
s_add_u32 s30, s30, 24576
v_permlane32_swap_b32 v16, v17
v_permlane32_swap_b32 v20, v21
v_add_f32 v16, v16, v17
v_mfma_f32_32x32x16_bf16 v[32:47], a[8:11], a[148:151], v[32:47]
ds_read_b128 a[4:7], v4 offset:17408
v_add_f32 v20, v20, v21
v_mul_f32 v16, 0x3ae38e39, v16
v_mul_f32 v20, 0x3ae38e39, v20
v_mfma_f32_32x32x16_bf16 v[48:63], a[12:15], a[148:151], v[48:63]
ds_read_b128 a[8:11], v4 offset:18432
v_fma_f32 v18, -v16, v16, v20
v_max_f32 v18, 0, v18
v_cvt_pk_bf16_f32 v17, v16, v16
s_waitcnt lgkmcnt(3)
v_mfma_f32_32x32x16_bf16 v[32:47], a[16:19], a[152:155], v[32:47]
ds_read_b128 a[12:15], v4 offset:19456
v_and_b32 v17, 0xffff0000, v17
v_cvt_pk_bf16_f32 v19, v18, v18
v_and_b32 v19, 0xffff0000, v19
ds_read_b32 v248, v245 offset:0
v_mfma_f32_32x32x16_bf16 v[48:63], a[20:23], a[152:155], v[48:63]
ds_read_b128 a[16:19], v4 offset:20480
v_add_f32 v19, 0x3727c5ac, v19
v_cvt_pk_bf16_f32 v19, v19, v19
v_and_b32 v19, 0xffff0000, v19
ds_read_b32 v250, v245 offset:128
v_mfma_f32_32x32x16_bf16 v[32:47], a[24:27], a[156:159], v[32:47]
ds_read_b128 a[20:23], v4 offset:21504
v_sqrt_f32 v19, v19
s_nop 0
v_cvt_pk_bf16_f32 v19, v19, v19
v_and_b32 v19, 0xffff0000, v19
v_mfma_f32_32x32x16_bf16 v[48:63], a[28:31], a[156:159], v[48:63]
ds_read_b128 a[24:27], v4 offset:22528
v_rcp_f32 v19, v19
s_nop 0
v_mul_f32 v244, 0x3eeff558, v19
v_sub_f32 v17, 0, v17
s_waitcnt lgkmcnt(5)
v_mfma_f32_32x32x16_bf16 v[32:47], a[0:3], a[160:163], v[32:47]
ds_read_b128 a[28:31], v4 offset:23552
s_barrier
v_cvt_pk_bf16_f32 v246, v17, v17
v_cmp_gt_u32 vcc, 32, v1
s_nop 1
v_cndmask_b32 v246, 0, v246, vcc
v_mfma_f32_32x32x16_bf16 v[48:63], a[4:7], a[160:163], v[48:63]
ds_read_b128 a[0:3], v4 offset:24576
s_add_u32 m0, s34, 24576
v_mfma_f32_32x32x16_bf16 v[32:47], a[8:11], a[164:167], v[32:47]
ds_read_b128 a[4:7], v4 offset:25600
v_mfma_f32_32x32x16_bf16 v[48:63], a[12:15], a[164:167], v[48:63]
ds_read_b128 a[8:11], v4 offset:26624
buffer_load_dwordx4 v2, s[8:11], s30 offen lds
s_waitcnt vmcnt(9)
s_waitcnt lgkmcnt(3)
v_mfma_f32_32x32x16_bf16 v[32:47], a[16:19], a[168:171], v[32:47]
ds_read_b128 a[12:15], v4 offset:27648
v_mfma_f32_32x32x16_bf16 v[48:63], a[20:23], a[168:171], v[48:63]
ds_read_b128 a[16:19], v4 offset:28672
buffer_load_dwordx4 v2, s[8:11], s30 offen offset:1024 lds
v_mfma_f32_32x32x16_bf16 v[32:47], a[24:27], a[172:175], v[32:47]
ds_read_b128 a[20:23], v4 offset:29696
v_mfma_f32_32x32x8bf16_1k v[32:47], v[248:249], v[246:247], v[32:47]
v_mfma_f32_32x32x16_bf16 v[48:63], a[28:31], a[172:175], v[48:63]
ds_read_b128 a[24:27], v4 offset:30720
buffer_load_dwordx4 v2, s[8:11], s30 offen offset:2048 lds
v_mfma_f32_32x32x8bf16_1k v[48:63], v[250:251], v[246:247], v[48:63]
s_waitcnt lgkmcnt(3)
v_mfma_f32_32x32x16_bf16 v[64:79], a[0:3], a[32:35], 0
ds_read_b128 a[28:31], v4 offset:31744
v_mfma_f32_32x32x16_bf16 v[80:95], a[4:7], a[32:35], 0
ds_read_b128 a[0:3], v4 offset:32768
buffer_load_dwordx4 v2, s[8:11], s30 offen offset:3072 lds
v_mfma_f32_32x32x16_bf16 v[64:79], a[8:11], a[36:39], v[64:79]
ds_read_b128 a[4:7], v4 offset:33792
v_mfma_f32_32x32x16_bf16 v[80:95], a[12:15], a[36:39], v[80:95]
ds_read_b128 a[8:11], v4 offset:34816
s_add_u32 m0, s34, 28672
v_mul_f32 v32, v244, v32
v_mul_f32 v36, v244, v36
v_mul_f32 v33, v244, v33
v_mul_f32 v37, v244, v37
s_waitcnt lgkmcnt(3)
v_mfma_f32_32x32x16_bf16 v[64:79], a[16:19], a[40:43], v[64:79]
ds_read_b128 a[12:15], v4 offset:35840
v_mul_f32 v34, v244, v34
v_mul_f32 v38, v244, v38
v_mul_f32 v35, v244, v35
v_mul_f32 v39, v244, v39
v_fma_f32 v16, -v32, v32, s49
v_fma_f32 v20, -v36, v36, s49
v_mfma_f32_32x32x16_bf16 v[80:95], a[20:23], a[40:43], v[80:95]
ds_read_b128 a[16:19], v4 offset:36864
buffer_load_dwordx4 v3, s[8:11], s30 offen lds
v_fma_f32 v17, -v33, v33, s49
v_fma_f32 v21, -v37, v37, s49
v_fma_f32 v18, -v34, v34, s49
v_mfma_f32_32x32x16_bf16 v[64:79], a[24:27], a[44:47], v[64:79]
ds_read_b128 a[20:23], v4 offset:37888
v_fma_f32 v22, -v38, v38, s49
v_fma_f32 v19, -v35, v35, s49
v_fma_f32 v23, -v39, v39, s49
v_mul_f32 v16, v16, v32
v_mul_f32 v20, v20, v36
v_mul_f32 v17, v17, v33
v_mfma_f32_32x32x16_bf16 v[80:95], a[28:31], a[44:47], v[80:95]
ds_read_b128 a[24:27], v4 offset:38912
buffer_load_dwordx4 v3, s[8:11], s30 offen offset:1024 lds
v_mul_f32 v21, v21, v37
v_mul_f32 v18, v18, v34
s_waitcnt lgkmcnt(3)
v_mfma_f32_32x32x16_bf16 v[64:79], a[0:3], a[48:51], v[64:79]
ds_read_b128 a[28:31], v4 offset:39936
v_mul_f32 v22, v22, v38
v_mul_f32 v19, v19, v35
v_mul_f32 v23, v23, v39
v_exp_f32 v16, v16
v_mfma_f32_32x32x16_bf16 v[80:95], a[4:7], a[48:51], v[80:95]
ds_read_b128 a[0:3], v4 offset:40960
s_add_u32 s30, s30, 24576
v_exp_f32 v20, v20
v_exp_f32 v17, v17
v_mfma_f32_32x32x16_bf16 v[64:79], a[8:11], a[52:55], v[64:79]
ds_read_b128 a[4:7], v4 offset:41984
v_exp_f32 v21, v21
v_exp_f32 v18, v18
v_exp_f32 v22, v22
v_mfma_f32_32x32x16_bf16 v[80:95], a[12:15], a[52:55], v[80:95]
ds_read_b128 a[8:11], v4 offset:43008
v_exp_f32 v19, v19
v_exp_f32 v23, v23
s_waitcnt lgkmcnt(3)
v_mfma_f32_32x32x16_bf16 v[64:79], a[16:19], a[56:59], v[64:79]
ds_read_b128 a[12:15], v4 offset:44032
v_add_f32 v16, 1.0, v16
v_add_f32 v20, 1.0, v20
v_add_f32 v17, 1.0, v17
v_add_f32 v21, 1.0, v21
v_add_f32 v18, 1.0, v18
v_add_f32 v22, 1.0, v22
v_mfma_f32_32x32x16_bf16 v[80:95], a[20:23], a[56:59], v[80:95]
ds_read_b128 a[16:19], v4 offset:45056
v_add_f32 v19, 1.0, v19
v_add_f32 v23, 1.0, v23
v_rcp_f32 v16, v16
v_mfma_f32_32x32x16_bf16 v[64:79], a[24:27], a[60:63], v[64:79]
ds_read_b128 a[20:23], v4 offset:46080
v_rcp_f32 v20, v20
v_rcp_f32 v17, v17
v_rcp_f32 v21, v21
v_mfma_f32_32x32x16_bf16 v[80:95], a[28:31], a[60:63], v[80:95]
ds_read_b128 a[24:27], v4 offset:47104
v_rcp_f32 v18, v18
v_rcp_f32 v22, v22
s_waitcnt lgkmcnt(3)
v_mfma_f32_32x32x16_bf16 v[64:79], a[0:3], a[64:67], v[64:79]
ds_read_b128 a[28:31], v4 offset:48128
s_barrier
v_rcp_f32 v19, v19
v_mul_f32 v16, v16, v32
v_mfma_f32_32x32x16_bf16 v[80:95], a[4:7], a[64:67], v[80:95]
ds_read_b128 a[0:3], v5 offset:0
s_add_u32 m0, s34, 49152
v_rcp_f32 v23, v23
v_mul_f32 v20, v20, v36
v_mul_f32 v17, v17, v33
v_mul_f32 v21, v21, v37
v_mfma_f32_32x32x16_bf16 v[64:79], a[8:11], a[68:71], v[64:79]
ds_read_b128 a[4:7], v5 offset:1024
v_mul_f32 v18, v18, v34
v_mul_f32 v22, v22, v38
v_mul_f32 v19, v19, v35
v_mul_f32 v23, v23, v39
v_cvt_pk_bf16_f32 v96, v16, v17
v_mfma_f32_32x32x16_bf16 v[80:95], a[12:15], a[68:71], v[80:95]
ds_read_b128 a[8:11], v5 offset:2048
buffer_load_dwordx4 v2, s[8:11], s30 offen lds
v_cvt_pk_bf16_f32 v98, v20, v21
v_cvt_pk_bf16_f32 v97, v18, v19
v_cvt_pk_bf16_f32 v99, v22, v23
s_waitcnt lgkmcnt(3)
v_mfma_f32_32x32x16_bf16 v[64:79], a[16:19], a[72:75], v[64:79]
ds_read_b128 a[12:15], v5 offset:3072
v_mul_f32 v40, v244, v40
v_mul_f32 v44, v244, v44
v_mul_f32 v41, v244, v41
v_mul_f32 v45, v244, v45
v_mul_f32 v42, v244, v42
v_mfma_f32_32x32x16_bf16 v[80:95], a[20:23], a[72:75], v[80:95]
ds_read_b128 a[16:19], v5 offset:4096
buffer_load_dwordx4 v2, s[8:11], s30 offen offset:1024 lds
v_mul_f32 v46, v244, v46
v_mul_f32 v43, v244, v43
v_mul_f32 v47, v244, v47
v_fma_f32 v16, -v40, v40, s49
v_mfma_f32_32x32x16_bf16 v[64:79], a[24:27], a[76:79], v[64:79]
ds_read_b128 a[20:23], v5 offset:5120
v_fma_f32 v20, -v44, v44, s49
v_fma_f32 v17, -v41, v41, s49
v_fma_f32 v21, -v45, v45, s49
v_fma_f32 v18, -v42, v42, s49
v_fma_f32 v22, -v46, v46, s49
v_mfma_f32_32x32x16_bf16 v[80:95], a[28:31], a[76:79], v[80:95]
ds_read_b128 a[24:27], v5 offset:6144
buffer_load_dwordx4 v2, s[8:11], s30 offen offset:2048 lds
v_fma_f32 v19, -v43, v43, s49
v_fma_f32 v23, -v47, v47, s49
v_mul_f32 v16, v16, v40
s_waitcnt lgkmcnt(3)
v_mfma_f32_32x32x16_bf16 v[64:79], a[0:3], a[80:83], v[64:79]
ds_read_b128 a[28:31], v5 offset:7168
v_mul_f32 v20, v20, v44
v_mul_f32 v17, v17, v41
v_mul_f32 v21, v21, v45
v_mul_f32 v18, v18, v42
v_mul_f32 v22, v22, v46
v_mfma_f32_32x32x16_bf16 v[80:95], a[4:7], a[80:83], v[80:95]
ds_read_b128 a[0:3], v5 offset:8192
buffer_load_dwordx4 v2, s[8:11], s30 offen offset:3072 lds
v_mul_f32 v19, v19, v43
v_mul_f32 v23, v23, v47
v_exp_f32 v16, v16
v_mfma_f32_32x32x16_bf16 v[64:79], a[8:11], a[84:87], v[64:79]
ds_read_b128 a[4:7], v5 offset:9216
v_exp_f32 v20, v20
v_exp_f32 v17, v17
v_exp_f32 v21, v21
v_mfma_f32_32x32x16_bf16 v[80:95], a[12:15], a[84:87], v[80:95]
ds_read_b128 a[8:11], v5 offset:10240
s_add_u32 m0, s34, 53248
v_exp_f32 v18, v18
s_waitcnt lgkmcnt(3)
v_mfma_f32_32x32x16_bf16 v[64:79], a[16:19], a[88:91], v[64:79]
ds_read_b128 a[12:15], v5 offset:11264
v_exp_f32 v22, v22
v_exp_f32 v19, v19
v_exp_f32 v23, v23
v_mfma_f32_32x32x16_bf16 v[80:95], a[20:23], a[88:91], v[80:95]
ds_read_b128 a[16:19], v5 offset:12288
buffer_load_dwordx4 v3, s[8:11], s30 offen lds
v_add_f32 v16, 1.0, v16
v_add_f32 v20, 1.0, v20
v_add_f32 v17, 1.0, v17
v_mfma_f32_32x32x16_bf16 v[64:79], a[24:27], a[92:95], v[64:79]
ds_read_b128 a[20:23], v5 offset:13312
v_add_f32 v21, 1.0, v21
v_add_f32 v18, 1.0, v18
v_add_f32 v22, 1.0, v22
v_add_f32 v19, 1.0, v19
v_add_f32 v23, 1.0, v23
v_mfma_f32_32x32x16_bf16 v[80:95], a[28:31], a[92:95], v[80:95]
ds_read_b128 a[24:27], v5 offset:14336
buffer_load_dwordx4 v3, s[8:11], s30 offen offset:1024 lds
v_rcp_f32 v16, v16
s_waitcnt lgkmcnt(3)
v_mfma_f32_32x32x16_bf16 v[64:79], a[0:3], a[96:99], v[64:79]
ds_read_b128 a[28:31], v5 offset:15360
v_rcp_f32 v20, v20
v_rcp_f32 v17, v17
v_rcp_f32 v21, v21
v_mfma_f32_32x32x16_bf16 v[80:95], a[4:7], a[96:99], v[80:95]
ds_read_b128 a[0:3], v5 offset:16384
s_add_u32 s30, s30, 24576
v_rcp_f32 v18, v18
v_rcp_f32 v22, v22
v_mfma_f32_32x32x16_bf16 v[64:79], a[8:11], a[100:103], v[64:79]
ds_read_b128 a[4:7], v5 offset:17408
v_rcp_f32 v19, v19
v_rcp_f32 v23, v23
v_mul_f32 v16, v16, v40
v_mul_f32 v20, v20, v44
v_mfma_f32_32x32x16_bf16 v[80:95], a[12:15], a[100:103], v[80:95]
ds_read_b128 a[8:11], v5 offset:18432
v_mul_f32 v17, v17, v41
v_mul_f32 v21, v21, v45
v_mul_f32 v18, v18, v42
v_mul_f32 v22, v22, v46
s_waitcnt lgkmcnt(3)
v_mfma_f32_32x32x16_bf16 v[64:79], a[16:19], a[104:107], v[64:79]
ds_read_b128 a[12:15], v5 offset:19456
v_mul_f32 v19, v19, v43
v_mul_f32 v23, v23, v47
v_cvt_pk_bf16_f32 v100, v16, v17
v_cvt_pk_bf16_f32 v102, v20, v21
v_cvt_pk_bf16_f32 v101, v18, v19
v_cvt_pk_bf16_f32 v103, v22, v23
v_mfma_f32_32x32x16_bf16 v[80:95], a[20:23], a[104:107], v[80:95]
ds_read_b128 a[16:19], v5 offset:20480
v_mul_f32 v48, v244, v48
v_mul_f32 v52, v244, v52
v_mul_f32 v49, v244, v49
v_mul_f32 v53, v244, v53
v_mul_f32 v50, v244, v50
v_mul_f32 v54, v244, v54
v_mfma_f32_32x32x16_bf16 v[64:79], a[24:27], a[108:111], v[64:79]
ds_read_b128 a[20:23], v5 offset:21504
v_mul_f32 v51, v244, v51
v_mul_f32 v55, v244, v55
v_fma_f32 v16, -v48, v48, s49
v_fma_f32 v20, -v52, v52, s49
v_fma_f32 v17, -v49, v49, s49
v_mfma_f32_32x32x16_bf16 v[80:95], a[28:31], a[108:111], v[80:95]
ds_read_b128 a[24:27], v5 offset:22528
v_fma_f32 v21, -v53, v53, s49
v_fma_f32 v18, -v50, v50, s49
v_fma_f32 v22, -v54, v54, s49
v_fma_f32 v19, -v51, v51, s49
v_fma_f32 v23, -v55, v55, s49
s_waitcnt lgkmcnt(3)
v_mfma_f32_32x32x16_bf16 v[64:79], a[0:3], a[112:115], v[64:79]
ds_read_b128 a[28:31], v5 offset:23552
s_waitcnt vmcnt(18)
s_barrier
v_mul_f32 v16, v16, v48
v_mul_f32 v20, v20, v52
v_mul_f32 v17, v17, v49
v_mfma_f32_32x32x16_bf16 v[80:95], a[4:7], a[112:115], v[80:95]
ds_read_b128 a[0:3], v5 offset:24576
s_add_u32 m0, s34, 73728
v_mul_f32 v21, v21, v53
v_mul_f32 v18, v18, v50
v_mul_f32 v22, v22, v54
v_mul_f32 v19, v19, v51
v_mul_f32 v23, v23, v55
v_mfma_f32_32x32x16_bf16 v[64:79], a[8:11], a[116:119], v[64:79]
ds_read_b128 a[4:7], v5 offset:25600
v_exp_f32 v16, v16
v_exp_f32 v20, v20
v_mfma_f32_32x32x16_bf16 v[80:95], a[12:15], a[116:119], v[80:95]
ds_read_b128 a[8:11], v5 offset:26624
buffer_load_dwordx4 v2, s[8:11], s30 offen lds
v_exp_f32 v17, v17
s_waitcnt lgkmcnt(3)
v_mfma_f32_32x32x16_bf16 v[64:79], a[16:19], a[120:123], v[64:79]
ds_read_b128 a[12:15], v5 offset:27648
v_exp_f32 v21, v21
v_exp_f32 v18, v18
v_mfma_f32_32x32x16_bf16 v[80:95], a[20:23], a[120:123], v[80:95]
ds_read_b128 a[16:19], v5 offset:28672
buffer_load_dwordx4 v2, s[8:11], s30 offen offset:1024 lds
v_exp_f32 v22, v22
v_exp_f32 v19, v19
v_mfma_f32_32x32x16_bf16 v[64:79], a[24:27], a[124:127], v[64:79]
ds_read_b128 a[20:23], v5 offset:29696
v_exp_f32 v23, v23
v_add_f32 v16, 1.0, v16
v_add_f32 v20, 1.0, v20
v_add_f32 v17, 1.0, v17
v_mfma_f32_32x32x16_bf16 v[80:95], a[28:31], a[124:127], v[80:95]
ds_read_b128 a[24:27], v5 offset:30720
buffer_load_dwordx4 v2, s[8:11], s30 offen offset:2048 lds
v_add_f32 v21, 1.0, v21
v_add_f32 v18, 1.0, v18
v_add_f32 v22, 1.0, v22
s_waitcnt lgkmcnt(3)
v_mfma_f32_32x32x16_bf16 v[64:79], a[0:3], a[128:131], v[64:79]
ds_read_b128 a[28:31], v5 offset:31744
v_add_f32 v19, 1.0, v19
v_add_f32 v23, 1.0, v23
v_rcp_f32 v16, v16
v_rcp_f32 v20, v20
v_mfma_f32_32x32x16_bf16 v[80:95], a[4:7], a[128:131], v[80:95]
ds_read_b128 a[0:3], v5 offset:32768
buffer_load_dwordx4 v2, s[8:11], s30 offen offset:3072 lds
v_rcp_f32 v17, v17
v_mfma_f32_32x32x16_bf16 v[64:79], a[8:11], a[132:135], v[64:79]
ds_read_b128 a[4:7], v5 offset:33792
v_rcp_f32 v21, v21
v_rcp_f32 v18, v18
v_rcp_f32 v22, v22
v_mfma_f32_32x32x16_bf16 v[80:95], a[12:15], a[132:135], v[80:95]
ds_read_b128 a[8:11], v5 offset:34816
s_add_u32 m0, s34, 77824
v_rcp_f32 v19, v19
v_mul_f32 v16, v16, v48
s_waitcnt lgkmcnt(3)
v_mfma_f32_32x32x16_bf16 v[64:79], a[16:19], a[136:139], v[64:79]
ds_read_b128 a[12:15], v5 offset:35840
v_rcp_f32 v23, v23
v_mul_f32 v20, v20, v52
v_mul_f32 v17, v17, v49
v_mul_f32 v21, v21, v53
v_mul_f32 v18, v18, v50
v_mfma_f32_32x32x16_bf16 v[80:95], a[20:23], a[136:139], v[80:95]
ds_read_b128 a[16:19], v5 offset:36864
buffer_load_dwordx4 v3, s[8:11], s30 offen lds
v_mul_f32 v22, v22, v54
v_mul_f32 v19, v19, v51
v_mul_f32 v23, v23, v55
v_mfma_f32_32x32x16_bf16 v[64:79], a[24:27], a[140:143], v[64:79]
ds_read_b128 a[20:23], v5 offset:37888
v_cvt_pk_bf16_f32 v104, v16, v17
v_cvt_pk_bf16_f32 v106, v20, v21
v_cvt_pk_bf16_f32 v105, v18, v19
v_cvt_pk_bf16_f32 v107, v22, v23
v_mul_f32 v56, v244, v56
v_mul_f32 v60, v244, v60
v_mfma_f32_32x32x16_bf16 v[80:95], a[28:31], a[140:143], v[80:95]
ds_read_b128 a[24:27], v5 offset:38912
buffer_load_dwordx4 v3, s[8:11], s30 offen offset:1024 lds
v_mul_f32 v57, v244, v57
v_mul_f32 v61, v244, v61
s_waitcnt lgkmcnt(3)
v_mfma_f32_32x32x16_bf16 v[64:79], a[0:3], a[144:147], v[64:79]
ds_read_b128 a[28:31], v5 offset:39936
v_mul_f32 v58, v244, v58
v_mul_f32 v62, v244, v62
v_mul_f32 v59, v244, v59
v_mul_f32 v63, v244, v63
v_fma_f32 v16, -v56, v56, s49
v_fma_f32 v20, -v60, v60, s49
v_mfma_f32_32x32x16_bf16 v[80:95], a[4:7], a[144:147], v[80:95]
ds_read_b128 a[0:3], v5 offset:40960
s_add_u32 s30, s30, 24576
v_fma_f32 v17, -v57, v57, s49
v_fma_f32 v21, -v61, v61, s49
v_fma_f32 v18, -v58, v58, s49
v_fma_f32 v22, -v62, v62, s49
v_mfma_f32_32x32x16_bf16 v[64:79], a[8:11], a[148:151], v[64:79]
ds_read_b128 a[4:7], v5 offset:41984
v_fma_f32 v19, -v59, v59, s49
v_fma_f32 v23, -v63, v63, s49
v_mul_f32 v16, v16, v56
v_mul_f32 v20, v20, v60
v_mul_f32 v17, v17, v57
v_mul_f32 v21, v21, v61
v_mfma_f32_32x32x16_bf16 v[80:95], a[12:15], a[148:151], v[80:95]
ds_read_b128 a[8:11], v5 offset:43008
v_mul_f32 v18, v18, v58
v_mul_f32 v22, v22, v62
v_mul_f32 v19, v19, v59
v_mul_f32 v23, v23, v63
s_waitcnt lgkmcnt(3)
v_mfma_f32_32x32x16_bf16 v[64:79], a[16:19], a[152:155], v[64:79]
ds_read_b128 a[12:15], v5 offset:44032
ds_read_b32 v248, v245 offset:256
v_exp_f32 v16, v16
v_exp_f32 v20, v20
v_mfma_f32_32x32x16_bf16 v[80:95], a[20:23], a[152:155], v[80:95]
ds_read_b128 a[16:19], v5 offset:45056
ds_read_b32 v250, v245 offset:384
v_exp_f32 v17, v17
v_exp_f32 v21, v21
v_mfma_f32_32x32x16_bf16 v[64:79], a[24:27], a[156:159], v[64:79]
ds_read_b128 a[20:23], v5 offset:46080
v_exp_f32 v18, v18
v_exp_f32 v22, v22
v_mfma_f32_32x32x16_bf16 v[80:95], a[28:31], a[156:159], v[80:95]
ds_read_b128 a[24:27], v5 offset:47104
v_exp_f32 v19, v19
v_exp_f32 v23, v23
v_add_f32 v16, 1.0, v16
s_waitcnt lgkmcnt(5)
v_mfma_f32_32x32x16_bf16 v[64:79], a[0:3], a[160:163], v[64:79]
ds_read_b128 a[28:31], v5 offset:48128
s_waitcnt vmcnt(18)
s_barrier
v_add_f32 v20, 1.0, v20
v_add_f32 v17, 1.0, v17
v_add_f32 v21, 1.0, v21
v_mfma_f32_32x32x16_bf16 v[80:95], a[4:7], a[160:163], v[80:95]
ds_read_b128 a[0:3], v2 offset:0
s_add_u32 m0, s34, 98304
v_add_f32 v18, 1.0, v18
v_add_f32 v22, 1.0, v22
v_add_f32 v19, 1.0, v19
v_add_f32 v23, 1.0, v23
v_mfma_f32_32x32x16_bf16 v[64:79], a[8:11], a[164:167], v[64:79]
ds_read_b128 a[4:7], v2 offset:1024
v_rcp_f32 v16, v16
v_rcp_f32 v20, v20
v_mfma_f32_32x32x16_bf16 v[80:95], a[12:15], a[164:167], v[80:95]
ds_read_b128 a[8:11], v2 offset:2048
buffer_load_dwordx4 v2, s[8:11], s30 offen lds
v_rcp_f32 v17, v17
s_waitcnt lgkmcnt(3)
v_mfma_f32_32x32x16_bf16 v[64:79], a[16:19], a[168:171], v[64:79]
ds_read_b128 a[12:15], v2 offset:3072
v_rcp_f32 v21, v21
v_rcp_f32 v18, v18
v_mfma_f32_32x32x16_bf16 v[80:95], a[20:23], a[168:171], v[80:95]
ds_read_b128 a[16:19], v2 offset:4096
buffer_load_dwordx4 v2, s[8:11], s30 offen offset:1024 lds
v_rcp_f32 v22, v22
v_rcp_f32 v19, v19
v_mfma_f32_32x32x16_bf16 v[64:79], a[24:27], a[172:175], v[64:79]
ds_read_b128 a[20:23], v2 offset:5120
v_mfma_f32_32x32x8bf16_1k v[64:79], v[248:249], v[246:247], v[64:79]
v_rcp_f32 v23, v23
v_mul_f32 v16, v16, v56
v_mul_f32 v20, v20, v60
v_mul_f32 v17, v17, v57
v_mul_f32 v21, v21, v61
v_mul_f32 v18, v18, v58
v_mul_f32 v22, v22, v62
v_mul_f32 v19, v19, v59
v_mul_f32 v23, v23, v63
v_cvt_pk_bf16_f32 v108, v16, v17
v_cvt_pk_bf16_f32 v110, v20, v21
v_cvt_pk_bf16_f32 v109, v18, v19
v_cvt_pk_bf16_f32 v111, v22, v23
v_mfma_f32_32x32x16_bf16 v[80:95], a[28:31], a[172:175], v[80:95]
ds_read_b128 a[24:27], v2 offset:6144
buffer_load_dwordx4 v2, s[8:11], s30 offen offset:2048 lds
v_mfma_f32_32x32x8bf16_1k v[80:95], v[250:251], v[246:247], v[80:95]
s_waitcnt lgkmcnt(3)
v_mfma_f32_32x32x16_bf16 v[32:47], a[0:3], a[32:35], 0
ds_read_b128 a[28:31], v2 offset:7168
v_mfma_f32_32x32x16_bf16 v[48:63], a[4:7], a[32:35], 0
ds_read_b128 a[0:3], v2 offset:8192
buffer_load_dwordx4 v2, s[8:11], s30 offen offset:3072 lds
v_lshlrev_b32 v242, 6, v1
v_mfma_f32_32x32x16_bf16 v[32:47], a[8:11], a[36:39], v[32:47]
ds_read_b128 a[4:7], v2 offset:9216
v_mfma_f32_32x32x16_bf16 v[48:63], a[12:15], a[36:39], v[48:63]
ds_read_b128 a[8:11], v2 offset:10240
s_add_u32 m0, s34, 102400
v_mul_f32 v64, v244, v64
v_mul_f32 v68, v244, v68
v_mul_f32 v65, v244, v65
v_mul_f32 v69, v244, v69
s_waitcnt lgkmcnt(3)
v_mfma_f32_32x32x16_bf16 v[32:47], a[16:19], a[40:43], v[32:47]
ds_read_b128 a[12:15], v2 offset:11264
v_mul_f32 v66, v244, v66
v_mul_f32 v70, v244, v70
v_mul_f32 v67, v244, v67
v_mul_f32 v71, v244, v71
v_fma_f32 v16, -v64, v64, s49
v_fma_f32 v20, -v68, v68, s49
v_mfma_f32_32x32x16_bf16 v[48:63], a[20:23], a[40:43], v[48:63]
ds_read_b128 a[16:19], v2 offset:12288
buffer_load_dwordx4 v3, s[8:11], s30 offen lds
v_fma_f32 v17, -v65, v65, s49
v_fma_f32 v21, -v69, v69, s49
v_fma_f32 v18, -v66, v66, s49
v_mfma_f32_32x32x16_bf16 v[32:47], a[24:27], a[44:47], v[32:47]
ds_read_b128 a[20:23], v2 offset:13312
v_fma_f32 v22, -v70, v70, s49
v_fma_f32 v19, -v67, v67, s49
v_fma_f32 v23, -v71, v71, s49
v_mul_f32 v16, v16, v64
v_mul_f32 v20, v20, v68
v_mul_f32 v17, v17, v65
v_mfma_f32_32x32x16_bf16 v[48:63], a[28:31], a[44:47], v[48:63]
ds_read_b128 a[24:27], v2 offset:14336
buffer_load_dwordx4 v3, s[8:11], s30 offen offset:1024 lds
v_mul_f32 v21, v21, v69
v_mul_f32 v18, v18, v66
s_waitcnt lgkmcnt(3)
v_mfma_f32_32x32x16_bf16 v[32:47], a[0:3], a[48:51], v[32:47]
ds_read_b128 a[28:31], v2 offset:15360
v_mul_f32 v22, v22, v70
v_mul_f32 v19, v19, v67
v_mul_f32 v23, v23, v71
v_exp_f32 v16, v16
v_mfma_f32_32x32x16_bf16 v[48:63], a[4:7], a[48:51], v[48:63]
ds_read_b128 a[0:3], v2 offset:16384
s_add_u32 s30, s30, 24576
v_exp_f32 v20, v20
v_exp_f32 v17, v17
v_mfma_f32_32x32x16_bf16 v[32:47], a[8:11], a[52:55], v[32:47]
ds_read_b128 a[4:7], v2 offset:17408
v_exp_f32 v21, v21
v_exp_f32 v18, v18
v_mfma_f32_32x32x16_bf16 v[48:63], a[12:15], a[52:55], v[48:63]
ds_read_b128 a[8:11], v2 offset:18432
v_exp_f32 v22, v22
v_exp_f32 v19, v19
v_add_f32 v16, 1.0, v16
s_waitcnt lgkmcnt(3)
v_mfma_f32_32x32x16_bf16 v[32:47], a[16:19], a[56:59], v[32:47]
ds_read_b128 a[12:15], v2 offset:19456
v_exp_f32 v23, v23
v_add_f32 v20, 1.0, v20
v_add_f32 v17, 1.0, v17
v_add_f32 v21, 1.0, v21
v_mfma_f32_32x32x16_bf16 v[48:63], a[20:23], a[56:59], v[48:63]
ds_read_b128 a[16:19], v2 offset:20480
v_add_f32 v18, 1.0, v18
v_add_f32 v22, 1.0, v22
v_add_f32 v19, 1.0, v19
v_add_f32 v23, 1.0, v23
v_rcp_f32 v16, v16
v_mfma_f32_32x32x16_bf16 v[32:47], a[24:27], a[60:63], v[32:47]
ds_read_b128 a[20:23], v2 offset:21504
v_rcp_f32 v20, v20
v_rcp_f32 v17, v17
v_rcp_f32 v21, v21
v_mfma_f32_32x32x16_bf16 v[48:63], a[28:31], a[60:63], v[48:63]
ds_read_b128 a[24:27], v2 offset:22528
v_rcp_f32 v18, v18
v_rcp_f32 v22, v22
s_waitcnt lgkmcnt(3)
v_mfma_f32_32x32x16_bf16 v[32:47], a[0:3], a[64:67], v[32:47]
ds_read_b128 a[28:31], v2 offset:23552
s_waitcnt vmcnt(18)
s_barrier
v_rcp_f32 v19, v19
v_rcp_f32 v23, v23
v_mfma_f32_32x32x16_bf16 v[48:63], a[4:7], a[64:67], v[48:63]
ds_read_b128 a[0:3], v2 offset:24576
s_add_u32 m0, s34, 122880
v_mul_f32 v16, v16, v64
v_mul_f32 v20, v20, v68
v_mul_f32 v17, v17, v65
v_mul_f32 v21, v21, v69
v_mfma_f32_32x32x16_bf16 v[32:47], a[8:11], a[68:71], v[32:47]
ds_read_b128 a[4:7], v2 offset:25600
v_mul_f32 v18, v18, v66
v_mul_f32 v22, v22, v70
v_mul_f32 v19, v19, v67
v_mul_f32 v23, v23, v71
v_cvt_pk_bf16_f32 v112, v16, v17
v_cvt_pk_bf16_f32 v114, v20, v21
v_mfma_f32_32x32x16_bf16 v[48:63], a[12:15], a[68:71], v[48:63]
ds_read_b128 a[8:11], v2 offset:26624
buffer_load_dwordx4 v2, s[8:11], s30 offen lds
v_cvt_pk_bf16_f32 v113, v18, v19
v_cvt_pk_bf16_f32 v115, v22, v23
s_waitcnt lgkmcnt(3)
v_mfma_f32_32x32x16_bf16 v[32:47], a[16:19], a[72:75], v[32:47]
ds_read_b128 a[12:15], v2 offset:27648
v_mul_f32 v72, v244, v72
v_mul_f32 v76, v244, v76
v_mul_f32 v73, v244, v73
v_mul_f32 v77, v244, v77
v_mul_f32 v74, v244, v74
v_mul_f32 v78, v244, v78
v_mfma_f32_32x32x16_bf16 v[48:63], a[20:23], a[72:75], v[48:63]
ds_read_b128 a[16:19], v2 offset:28672
buffer_load_dwordx4 v2, s[8:11], s30 offen offset:1024 lds
v_mul_f32 v75, v244, v75
v_mul_f32 v79, v244, v79
v_fma_f32 v16, -v72, v72, s49
v_fma_f32 v20, -v76, v76, s49
v_mfma_f32_32x32x16_bf16 v[32:47], a[24:27], a[76:79], v[32:47]
ds_read_b128 a[20:23], v2 offset:29696
v_fma_f32 v17, -v73, v73, s49
v_fma_f32 v21, -v77, v77, s49
v_fma_f32 v18, -v74, v74, s49
v_fma_f32 v22, -v78, v78, s49
v_fma_f32 v19, -v75, v75, s49
v_mfma_f32_32x32x16_bf16 v[48:63], a[28:31], a[76:79], v[48:63]
ds_read_b128 a[24:27], v2 offset:30720
buffer_load_dwordx4 v2, s[8:11], s30 offen offset:2048 lds
v_fma_f32 v23, -v79, v79, s49
v_mul_f32 v16, v16, v72
v_mul_f32 v20, v20, v76
s_waitcnt lgkmcnt(3)
v_mfma_f32_32x32x16_bf16 v[32:47], a[0:3], a[80:83], v[32:47]
ds_read_b128 a[28:31], v2 offset:31744
v_mul_f32 v17, v17, v73
v_mul_f32 v21, v21, v77
v_mul_f32 v18, v18, v74
v_mul_f32 v22, v22, v78
v_mul_f32 v19, v19, v75
v_mfma_f32_32x32x16_bf16 v[48:63], a[4:7], a[80:83], v[48:63]
ds_read_b128 a[0:3], v2 offset:32768
buffer_load_dwordx4 v2, s[8:11], s30 offen offset:3072 lds
v_mul_f32 v23, v23, v79
v_exp_f32 v16, v16
v_mfma_f32_32x32x16_bf16 v[32:47], a[8:11], a[84:87], v[32:47]
ds_read_b128 a[4:7], v2 offset:33792
v_exp_f32 v20, v20
v_exp_f32 v17, v17
v_exp_f32 v21, v21
v_mfma_f32_32x32x16_bf16 v[48:63], a[12:15], a[84:87], v[48:63]
ds_read_b128 a[8:11], v2 offset:34816
s_add_u32 m0, s34, 126976
v_exp_f32 v18, v18
s_waitcnt lgkmcnt(3)
v_mfma_f32_32x32x16_bf16 v[32:47], a[16:19], a[88:91], v[32:47]
ds_read_b128 a[12:15], v2 offset:35840
v_exp_f32 v22, v22
v_exp_f32 v19, v19
v_exp_f32 v23, v23
v_mfma_f32_32x32x16_bf16 v[48:63], a[20:23], a[88:91], v[48:63]
ds_read_b128 a[16:19], v2 offset:36864
buffer_load_dwordx4 v3, s[8:11], s30 offen lds
v_add_f32 v16, 1.0, v16
v_add_f32 v20, 1.0, v20
v_add_f32 v17, 1.0, v17
v_mfma_f32_32x32x16_bf16 v[32:47], a[24:27], a[92:95], v[32:47]
ds_read_b128 a[20:23], v2 offset:37888
v_add_f32 v21, 1.0, v21
v_add_f32 v18, 1.0, v18
v_add_f32 v22, 1.0, v22
v_add_f32 v19, 1.0, v19
v_add_f32 v23, 1.0, v23
v_mfma_f32_32x32x16_bf16 v[48:63], a[28:31], a[92:95], v[48:63]
ds_read_b128 a[24:27], v2 offset:38912
buffer_load_dwordx4 v3, s[8:11], s30 offen offset:1024 lds
v_rcp_f32 v16, v16
s_waitcnt lgkmcnt(3)
v_mfma_f32_32x32x16_bf16 v[32:47], a[0:3], a[96:99], v[32:47]
ds_read_b128 a[28:31], v2 offset:39936
v_rcp_f32 v20, v20
v_rcp_f32 v17, v17
v_mfma_f32_32x32x16_bf16 v[48:63], a[4:7], a[96:99], v[48:63]
ds_read_b128 a[0:3], v2 offset:40960
s_add_u32 s30, s30, 24576
v_rcp_f32 v21, v21
v_rcp_f32 v18, v18
v_mfma_f32_32x32x16_bf16 v[32:47], a[8:11], a[100:103], v[32:47]
ds_read_b128 a[4:7], v2 offset:41984
v_rcp_f32 v22, v22
v_rcp_f32 v19, v19
v_mul_f32 v16, v16, v72
v_mfma_f32_32x32x16_bf16 v[48:63], a[12:15], a[100:103], v[48:63]
ds_read_b128 a[8:11], v2 offset:43008
v_rcp_f32 v23, v23
v_mul_f32 v20, v20, v76
v_mul_f32 v17, v17, v73
v_mul_f32 v21, v21, v77
s_waitcnt lgkmcnt(3)
v_mfma_f32_32x32x16_bf16 v[32:47], a[16:19], a[104:107], v[32:47]
ds_read_b128 a[12:15], v2 offset:44032
v_mul_f32 v18, v18, v74
v_mul_f32 v22, v22, v78
v_mul_f32 v19, v19, v75
v_mul_f32 v23, v23, v79
v_cvt_pk_bf16_f32 v116, v16, v17
v_mfma_f32_32x32x16_bf16 v[48:63], a[20:23], a[104:107], v[48:63]
ds_read_b128 a[16:19], v2 offset:45056
buffer_load_dword v240, v242, s[12:15], s43 offen
s_add_u32 s43, s43, 3456
v_cvt_pk_bf16_f32 v118, v20, v21
v_cvt_pk_bf16_f32 v117, v18, v19
v_cvt_pk_bf16_f32 v119, v22, v23
v_mfma_f32_32x32x16_bf16 v[32:47], a[24:27], a[108:111], v[32:47]
ds_read_b128 a[20:23], v2 offset:46080
v_mul_f32 v80, v244, v80
v_mul_f32 v84, v244, v84
v_mul_f32 v81, v244, v81
v_mul_f32 v85, v244, v85
v_mul_f32 v82, v244, v82
v_mul_f32 v86, v244, v86
v_mfma_f32_32x32x16_bf16 v[48:63], a[28:31], a[108:111], v[48:63]
ds_read_b128 a[24:27], v2 offset:47104
v_mul_f32 v83, v244, v83
v_mul_f32 v87, v244, v87
v_fma_f32 v16, -v80, v80, s49
v_fma_f32 v20, -v84, v84, s49
s_waitcnt lgkmcnt(3)
v_mfma_f32_32x32x16_bf16 v[32:47], a[0:3], a[112:115], v[32:47]
ds_read_b128 a[28:31], v2 offset:48128
s_waitcnt vmcnt(19)
s_barrier
v_fma_f32 v17, -v81, v81, s49
v_fma_f32 v21, -v85, v85, s49
v_fma_f32 v18, -v82, v82, s49
v_fma_f32 v22, -v86, v86, s49
v_mfma_f32_32x32x16_bf16 v[48:63], a[4:7], a[112:115], v[48:63]
ds_read_b128 a[0:3], v4 offset:0
s_add_u32 m0, s34, 0
v_fma_f32 v19, -v83, v83, s49
v_fma_f32 v23, -v87, v87, s49
v_mul_f32 v16, v16, v80
v_mul_f32 v20, v20, v84
v_mfma_f32_32x32x16_bf16 v[32:47], a[8:11], a[116:119], v[32:47]
ds_read_b128 a[4:7], v4 offset:1024
v_mul_f32 v17, v17, v81
v_mul_f32 v21, v21, v85
v_mul_f32 v18, v18, v82
v_mul_f32 v22, v22, v86
v_mul_f32 v19, v19, v83
v_mul_f32 v23, v23, v87
v_mfma_f32_32x32x16_bf16 v[48:63], a[12:15], a[116:119], v[48:63]
ds_read_b128 a[8:11], v4 offset:2048
buffer_load_dwordx4 v2, s[8:11], s30 offen lds
v_exp_f32 v16, v16
s_waitcnt lgkmcnt(3)
v_mfma_f32_32x32x16_bf16 v[32:47], a[16:19], a[120:123], v[32:47]
ds_read_b128 a[12:15], v4 offset:3072
v_exp_f32 v20, v20
v_exp_f32 v17, v17
v_mfma_f32_32x32x16_bf16 v[48:63], a[20:23], a[120:123], v[48:63]
ds_read_b128 a[16:19], v4 offset:4096
buffer_load_dwordx4 v2, s[8:11], s30 offen offset:1024 lds
v_exp_f32 v21, v21
v_exp_f32 v18, v18
v_mfma_f32_32x32x16_bf16 v[32:47], a[24:27], a[124:127], v[32:47]
ds_read_b128 a[20:23], v4 offset:5120
v_exp_f32 v22, v22
v_exp_f32 v19, v19
v_add_f32 v16, 1.0, v16
v_mfma_f32_32x32x16_bf16 v[48:63], a[28:31], a[124:127], v[48:63]
ds_read_b128 a[24:27], v4 offset:6144
buffer_load_dwordx4 v2, s[8:11], s30 offen offset:2048 lds
v_exp_f32 v23, v23
v_add_f32 v20, 1.0, v20
s_waitcnt lgkmcnt(3)
v_mfma_f32_32x32x16_bf16 v[32:47], a[0:3], a[128:131], v[32:47]
ds_read_b128 a[28:31], v4 offset:7168
v_add_f32 v17, 1.0, v17
v_add_f32 v21, 1.0, v21
v_add_f32 v18, 1.0, v18
v_add_f32 v22, 1.0, v22
v_add_f32 v19, 1.0, v19
v_add_f32 v23, 1.0, v23
v_mfma_f32_32x32x16_bf16 v[48:63], a[4:7], a[128:131], v[48:63]
ds_read_b128 a[0:3], v4 offset:8192
buffer_load_dwordx4 v2, s[8:11], s30 offen offset:3072 lds
v_rcp_f32 v16, v16
v_mfma_f32_32x32x16_bf16 v[32:47], a[8:11], a[132:135], v[32:47]
ds_read_b128 a[4:7], v4 offset:9216
v_rcp_f32 v20, v20
v_rcp_f32 v17, v17
v_rcp_f32 v21, v21
v_mfma_f32_32x32x16_bf16 v[48:63], a[12:15], a[132:135], v[48:63]
ds_read_b128 a[8:11], v4 offset:10240
s_add_u32 m0, s34, 4096
v_rcp_f32 v18, v18
s_waitcnt lgkmcnt(3)
v_mfma_f32_32x32x16_bf16 v[32:47], a[16:19], a[136:139], v[32:47]
ds_read_b128 a[12:15], v4 offset:11264
v_rcp_f32 v22, v22
v_rcp_f32 v19, v19
v_rcp_f32 v23, v23
v_mfma_f32_32x32x16_bf16 v[48:63], a[20:23], a[136:139], v[48:63]
ds_read_b128 a[16:19], v4 offset:12288
buffer_load_dwordx4 v3, s[8:11], s30 offen lds
v_mul_f32 v16, v16, v80
v_mul_f32 v20, v20, v84
v_mul_f32 v17, v17, v81
v_mfma_f32_32x32x16_bf16 v[32:47], a[24:27], a[140:143], v[32:47]
ds_read_b128 a[20:23], v4 offset:13312
v_mul_f32 v21, v21, v85
v_mul_f32 v18, v18, v82
v_mul_f32 v22, v22, v86
v_mul_f32 v19, v19, v83
v_mul_f32 v23, v23, v87
v_cvt_pk_bf16_f32 v120, v16, v17
v_mfma_f32_32x32x16_bf16 v[48:63], a[28:31], a[140:143], v[48:63]
ds_read_b128 a[24:27], v4 offset:14336
buffer_load_dwordx4 v3, s[8:11], s30 offen offset:1024 lds
v_cvt_pk_bf16_f32 v122, v20, v21
v_cvt_pk_bf16_f32 v121, v18, v19
v_cvt_pk_bf16_f32 v123, v22, v23
s_waitcnt lgkmcnt(3)
v_mfma_f32_32x32x16_bf16 v[32:47], a[0:3], a[144:147], v[32:47]
ds_read_b128 a[28:31], v4 offset:15360
v_mul_f32 v88, v244, v88
v_mul_f32 v92, v244, v92
v_mul_f32 v89, v244, v89
v_mul_f32 v93, v244, v93
v_mul_f32 v90, v244, v90
v_mfma_f32_32x32x16_bf16 v[48:63], a[4:7], a[144:147], v[48:63]
ds_read_b128 a[0:3], v4 offset:16384
s_add_u32 s30, s30, 24576
v_mul_f32 v94, v244, v94
v_mul_f32 v91, v244, v91
v_mul_f32 v95, v244, v95
v_fma_f32 v16, -v88, v88, s49
v_fma_f32 v20, -v92, v92, s49
v_mfma_f32_32x32x16_bf16 v[32:47], a[8:11], a[148:151], v[32:47]
ds_read_b128 a[4:7], v4 offset:17408
v_fma_f32 v17, -v89, v89, s49
v_fma_f32 v21, -v93, v93, s49
v_fma_f32 v18, -v90, v90, s49
v_fma_f32 v22, -v94, v94, s49
v_fma_f32 v19, -v91, v91, s49
v_mfma_f32_32x32x16_bf16 v[48:63], a[12:15], a[148:151], v[48:63]
ds_read_b128 a[8:11], v4 offset:18432
v_fma_f32 v23, -v95, v95, s49
v_mul_f32 v16, v16, v88
v_mul_f32 v20, v20, v92
v_mul_f32 v17, v17, v89
v_mul_f32 v21, v21, v93
s_waitcnt lgkmcnt(3)
v_mfma_f32_32x32x16_bf16 v[32:47], a[16:19], a[152:155], v[32:47]
ds_read_b128 a[12:15], v4 offset:19456
ds_read_b32 v248, v245 offset:512
v_mul_f32 v18, v18, v90
v_mul_f32 v22, v22, v94
v_mul_f32 v19, v19, v91
v_mul_f32 v23, v23, v95
v_mfma_f32_32x32x16_bf16 v[48:63], a[20:23], a[152:155], v[48:63]
ds_read_b128 a[16:19], v4 offset:20480
ds_read_b32 v250, v245 offset:640
v_exp_f32 v16, v16
v_exp_f32 v20, v20
v_mfma_f32_32x32x16_bf16 v[32:47], a[24:27], a[156:159], v[32:47]
ds_read_b128 a[20:23], v4 offset:21504
v_exp_f32 v17, v17
v_exp_f32 v21, v21
v_exp_f32 v18, v18
v_mfma_f32_32x32x16_bf16 v[48:63], a[28:31], a[156:159], v[48:63]
ds_read_b128 a[24:27], v4 offset:22528
v_exp_f32 v22, v22
v_exp_f32 v19, v19
s_waitcnt lgkmcnt(5)
v_mfma_f32_32x32x16_bf16 v[32:47], a[0:3], a[160:163], v[32:47]
ds_read_b128 a[28:31], v4 offset:23552
s_waitcnt vmcnt(19)
s_barrier
v_exp_f32 v23, v23
v_add_f32 v16, 1.0, v16
v_add_f32 v20, 1.0, v20
v_mfma_f32_32x32x16_bf16 v[48:63], a[4:7], a[160:163], v[48:63]
ds_read_b128 a[0:3], v4 offset:24576
s_add_u32 m0, s34, 24576
v_add_f32 v17, 1.0, v17
v_add_f32 v21, 1.0, v21
v_add_f32 v18, 1.0, v18
v_add_f32 v22, 1.0, v22
v_add_f32 v19, 1.0, v19
v_mfma_f32_32x32x16_bf16 v[32:47], a[8:11], a[164:167], v[32:47]
ds_read_b128 a[4:7], v4 offset:25600
v_add_f32 v23, 1.0, v23
v_rcp_f32 v16, v16
v_rcp_f32 v20, v20
v_mfma_f32_32x32x16_bf16 v[48:63], a[12:15], a[164:167], v[48:63]
ds_read_b128 a[8:11], v4 offset:26624
buffer_load_dwordx4 v2, s[8:11], s30 offen lds
v_rcp_f32 v17, v17
s_waitcnt lgkmcnt(3)
v_mfma_f32_32x32x16_bf16 v[32:47], a[16:19], a[168:171], v[32:47]
ds_read_b128 a[12:15], v4 offset:27648
v_rcp_f32 v21, v21
v_rcp_f32 v18, v18
v_mfma_f32_32x32x16_bf16 v[48:63], a[20:23], a[168:171], v[48:63]
ds_read_b128 a[16:19], v4 offset:28672
buffer_load_dwordx4 v2, s[8:11], s30 offen offset:1024 lds
v_rcp_f32 v22, v22
v_rcp_f32 v19, v19
v_mfma_f32_32x32x16_bf16 v[32:47], a[24:27], a[172:175], v[32:47]
ds_read_b128 a[20:23], v4 offset:29696
v_mfma_f32_32x32x8bf16_1k v[32:47], v[248:249], v[246:247], v[32:47]
v_rcp_f32 v23, v23
v_mul_f32 v16, v16, v88
v_mul_f32 v20, v20, v92
v_mul_f32 v17, v17, v89
v_mul_f32 v21, v21, v93
v_mul_f32 v18, v18, v90
v_mul_f32 v22, v22, v94
v_mul_f32 v19, v19, v91
v_mul_f32 v23, v23, v95
v_cvt_pk_bf16_f32 v124, v16, v17
v_cvt_pk_bf16_f32 v126, v20, v21
v_cvt_pk_bf16_f32 v125, v18, v19
v_cvt_pk_bf16_f32 v127, v22, v23
v_mfma_f32_32x32x16_bf16 v[48:63], a[28:31], a[172:175], v[48:63]
ds_read_b128 a[24:27], v4 offset:30720
buffer_load_dwordx4 v2, s[8:11], s30 offen offset:2048 lds
v_mfma_f32_32x32x8bf16_1k v[48:63], v[250:251], v[246:247], v[48:63]
s_waitcnt lgkmcnt(3)
v_mfma_f32_32x32x16_bf16 v[64:79], a[0:3], a[32:35], 0
ds_read_b128 a[28:31], v4 offset:31744
v_mfma_f32_32x32x16_bf16 v[80:95], a[4:7], a[32:35], 0
ds_read_b128 a[0:3], v4 offset:32768
buffer_load_dwordx4 v2, s[8:11], s30 offen offset:3072 lds
v_mfma_f32_32x32x16_bf16 v[64:79], a[8:11], a[36:39], v[64:79]
ds_read_b128 a[4:7], v4 offset:33792
v_mfma_f32_32x32x16_bf16 v[80:95], a[12:15], a[36:39], v[80:95]
ds_read_b128 a[8:11], v4 offset:34816
s_add_u32 m0, s34, 28672
v_mul_f32 v32, v244, v32
v_mul_f32 v36, v244, v36
v_mul_f32 v33, v244, v33
v_mul_f32 v37, v244, v37
s_waitcnt lgkmcnt(3)
v_mfma_f32_32x32x16_bf16 v[64:79], a[16:19], a[40:43], v[64:79]
ds_read_b128 a[12:15], v4 offset:35840
v_mul_f32 v34, v244, v34
v_mul_f32 v38, v244, v38
v_mul_f32 v35, v244, v35
v_mul_f32 v39, v244, v39
v_fma_f32 v16, -v32, v32, s49
v_fma_f32 v20, -v36, v36, s49
v_mfma_f32_32x32x16_bf16 v[80:95], a[20:23], a[40:43], v[80:95]
ds_read_b128 a[16:19], v4 offset:36864
buffer_load_dwordx4 v3, s[8:11], s30 offen lds
v_fma_f32 v17, -v33, v33, s49
v_fma_f32 v21, -v37, v37, s49
v_fma_f32 v18, -v34, v34, s49
v_mfma_f32_32x32x16_bf16 v[64:79], a[24:27], a[44:47], v[64:79]
ds_read_b128 a[20:23], v4 offset:37888
v_fma_f32 v22, -v38, v38, s49
v_fma_f32 v19, -v35, v35, s49
v_fma_f32 v23, -v39, v39, s49
v_mul_f32 v16, v16, v32
v_mul_f32 v20, v20, v36
v_mul_f32 v17, v17, v33
v_mfma_f32_32x32x16_bf16 v[80:95], a[28:31], a[44:47], v[80:95]
ds_read_b128 a[24:27], v4 offset:38912
buffer_load_dwordx4 v3, s[8:11], s30 offen offset:1024 lds
v_mul_f32 v21, v21, v37
v_mul_f32 v18, v18, v34
s_waitcnt lgkmcnt(3)
v_mfma_f32_32x32x16_bf16 v[64:79], a[0:3], a[48:51], v[64:79]
ds_read_b128 a[28:31], v4 offset:39936
v_mul_f32 v22, v22, v38
v_mul_f32 v19, v19, v35
v_mul_f32 v23, v23, v39
v_exp_f32 v16, v16
v_mfma_f32_32x32x16_bf16 v[80:95], a[4:7], a[48:51], v[80:95]
ds_read_b128 a[0:3], v4 offset:40960
s_add_u32 s30, s30, 24576
v_exp_f32 v20, v20
v_exp_f32 v17, v17
v_mfma_f32_32x32x16_bf16 v[64:79], a[8:11], a[52:55], v[64:79]
ds_read_b128 a[4:7], v4 offset:41984
v_exp_f32 v21, v21
v_exp_f32 v18, v18
v_mfma_f32_32x32x16_bf16 v[80:95], a[12:15], a[52:55], v[80:95]
ds_read_b128 a[8:11], v4 offset:43008
v_exp_f32 v22, v22
v_exp_f32 v19, v19
v_add_f32 v16, 1.0, v16
s_waitcnt lgkmcnt(3)
v_mfma_f32_32x32x16_bf16 v[64:79], a[16:19], a[56:59], v[64:79]
ds_read_b128 a[12:15], v4 offset:44032
v_exp_f32 v23, v23
v_add_f32 v20, 1.0, v20
v_add_f32 v17, 1.0, v17
v_add_f32 v21, 1.0, v21
v_mfma_f32_32x32x16_bf16 v[80:95], a[20:23], a[56:59], v[80:95]
ds_read_b128 a[16:19], v4 offset:45056
v_add_f32 v18, 1.0, v18
v_add_f32 v22, 1.0, v22
v_add_f32 v19, 1.0, v19
v_add_f32 v23, 1.0, v23
v_rcp_f32 v16, v16
v_mfma_f32_32x32x16_bf16 v[64:79], a[24:27], a[60:63], v[64:79]
ds_read_b128 a[20:23], v4 offset:46080
v_rcp_f32 v20, v20
v_rcp_f32 v17, v17
v_rcp_f32 v21, v21
v_mfma_f32_32x32x16_bf16 v[80:95], a[28:31], a[60:63], v[80:95]
ds_read_b128 a[24:27], v4 offset:47104
v_rcp_f32 v18, v18
v_rcp_f32 v22, v22
s_waitcnt lgkmcnt(3)
v_mfma_f32_32x32x16_bf16 v[64:79], a[0:3], a[64:67], v[64:79]
ds_read_b128 a[28:31], v4 offset:48128
s_waitcnt vmcnt(19)
s_barrier
v_rcp_f32 v19, v19
v_rcp_f32 v23, v23
v_mfma_f32_32x32x16_bf16 v[80:95], a[4:7], a[64:67], v[80:95]
ds_read_b128 a[0:3], v5 offset:0
s_add_u32 m0, s34, 49152
v_mul_f32 v16, v16, v32
v_mul_f32 v20, v20, v36
v_mul_f32 v17, v17, v33
v_mul_f32 v21, v21, v37
v_mfma_f32_32x32x16_bf16 v[64:79], a[8:11], a[68:71], v[64:79]
ds_read_b128 a[4:7], v5 offset:1024
v_mul_f32 v18, v18, v34
v_mul_f32 v22, v22, v38
v_mul_f32 v19, v19, v35
v_mul_f32 v23, v23, v39
v_cvt_pk_bf16_f32 v128, v16, v17
v_cvt_pk_bf16_f32 v130, v20, v21
v_mfma_f32_32x32x16_bf16 v[80:95], a[12:15], a[68:71], v[80:95]
ds_read_b128 a[8:11], v5 offset:2048
buffer_load_dwordx4 v2, s[8:11], s30 offen lds
v_cvt_pk_bf16_f32 v129, v18, v19
v_cvt_pk_bf16_f32 v131, v22, v23
s_waitcnt lgkmcnt(3)
v_mfma_f32_32x32x16_bf16 v[64:79], a[16:19], a[72:75], v[64:79]
ds_read_b128 a[12:15], v5 offset:3072
v_mul_f32 v40, v244, v40
v_mul_f32 v44, v244, v44
v_mul_f32 v41, v244, v41
v_mul_f32 v45, v244, v45
v_mul_f32 v42, v244, v42
v_mul_f32 v46, v244, v46
v_mfma_f32_32x32x16_bf16 v[80:95], a[20:23], a[72:75], v[80:95]
ds_read_b128 a[16:19], v5 offset:4096
buffer_load_dwordx4 v2, s[8:11], s30 offen offset:1024 lds
v_mul_f32 v43, v244, v43
v_mul_f32 v47, v244, v47
v_fma_f32 v16, -v40, v40, s49
v_fma_f32 v20, -v44, v44, s49
v_mfma_f32_32x32x16_bf16 v[64:79], a[24:27], a[76:79], v[64:79]
ds_read_b128 a[20:23], v5 offset:5120
v_fma_f32 v17, -v41, v41, s49
v_fma_f32 v21, -v45, v45, s49
v_fma_f32 v18, -v42, v42, s49
v_fma_f32 v22, -v46, v46, s49
v_fma_f32 v19, -v43, v43, s49
v_mfma_f32_32x32x16_bf16 v[80:95], a[28:31], a[76:79], v[80:95]
ds_read_b128 a[24:27], v5 offset:6144
buffer_load_dwordx4 v2, s[8:11], s30 offen offset:2048 lds
v_fma_f32 v23, -v47, v47, s49
v_mul_f32 v16, v16, v40
v_mul_f32 v20, v20, v44
s_waitcnt lgkmcnt(3)
v_mfma_f32_32x32x16_bf16 v[64:79], a[0:3], a[80:83], v[64:79]
ds_read_b128 a[28:31], v5 offset:7168
v_mul_f32 v17, v17, v41
v_mul_f32 v21, v21, v45
v_mul_f32 v18, v18, v42
v_mul_f32 v22, v22, v46
v_mul_f32 v19, v19, v43
v_mfma_f32_32x32x16_bf16 v[80:95], a[4:7], a[80:83], v[80:95]
ds_read_b128 a[0:3], v5 offset:8192
buffer_load_dwordx4 v2, s[8:11], s30 offen offset:3072 lds
v_mul_f32 v23, v23, v47
v_exp_f32 v16, v16
v_mfma_f32_32x32x16_bf16 v[64:79], a[8:11], a[84:87], v[64:79]
ds_read_b128 a[4:7], v5 offset:9216
v_exp_f32 v20, v20
v_exp_f32 v17, v17
v_exp_f32 v21, v21
v_mfma_f32_32x32x16_bf16 v[80:95], a[12:15], a[84:87], v[80:95]
ds_read_b128 a[8:11], v5 offset:10240
s_add_u32 m0, s34, 53248
v_exp_f32 v18, v18
s_waitcnt lgkmcnt(3)
v_mfma_f32_32x32x16_bf16 v[64:79], a[16:19], a[88:91], v[64:79]
ds_read_b128 a[12:15], v5 offset:11264
v_exp_f32 v22, v22
v_exp_f32 v19, v19
v_exp_f32 v23, v23
v_mfma_f32_32x32x16_bf16 v[80:95], a[20:23], a[88:91], v[80:95]
ds_read_b128 a[16:19], v5 offset:12288
buffer_load_dwordx4 v3, s[8:11], s30 offen lds
v_add_f32 v16, 1.0, v16
v_add_f32 v20, 1.0, v20
v_add_f32 v17, 1.0, v17
v_mfma_f32_32x32x16_bf16 v[64:79], a[24:27], a[92:95], v[64:79]
ds_read_b128 a[20:23], v5 offset:13312
v_add_f32 v21, 1.0, v21
v_add_f32 v18, 1.0, v18
v_add_f32 v22, 1.0, v22
v_add_f32 v19, 1.0, v19
v_add_f32 v23, 1.0, v23
v_mfma_f32_32x32x16_bf16 v[80:95], a[28:31], a[92:95], v[80:95]
ds_read_b128 a[24:27], v5 offset:14336
buffer_load_dwordx4 v3, s[8:11], s30 offen offset:1024 lds
v_rcp_f32 v16, v16
s_waitcnt lgkmcnt(3)
v_mfma_f32_32x32x16_bf16 v[64:79], a[0:3], a[96:99], v[64:79]
ds_read_b128 a[28:31], v5 offset:15360
v_rcp_f32 v20, v20
v_rcp_f32 v17, v17
v_mfma_f32_32x32x16_bf16 v[80:95], a[4:7], a[96:99], v[80:95]
ds_read_b128 a[0:3], v5 offset:16384
s_add_u32 s30, s30, 24576
v_rcp_f32 v21, v21
v_rcp_f32 v18, v18
v_mfma_f32_32x32x16_bf16 v[64:79], a[8:11], a[100:103], v[64:79]
ds_read_b128 a[4:7], v5 offset:17408
v_rcp_f32 v22, v22
v_rcp_f32 v19, v19
v_mul_f32 v16, v16, v40
v_mfma_f32_32x32x16_bf16 v[80:95], a[12:15], a[100:103], v[80:95]
ds_read_b128 a[8:11], v5 offset:18432
v_rcp_f32 v23, v23
v_mul_f32 v20, v20, v44
v_mul_f32 v17, v17, v41
v_mul_f32 v21, v21, v45
s_waitcnt lgkmcnt(3)
v_mfma_f32_32x32x16_bf16 v[64:79], a[16:19], a[104:107], v[64:79]
ds_read_b128 a[12:15], v5 offset:19456
v_mul_f32 v18, v18, v42
v_mul_f32 v22, v22, v46
v_mul_f32 v19, v19, v43
v_mul_f32 v23, v23, v47
v_cvt_pk_bf16_f32 v132, v16, v17
v_mfma_f32_32x32x16_bf16 v[80:95], a[20:23], a[104:107], v[80:95]
ds_read_b128 a[16:19], v5 offset:20480
buffer_load_dword v241, v242, s[12:15], s43 offen
s_add_u32 s43, s43, 3456
v_cvt_pk_bf16_f32 v134, v20, v21
v_cvt_pk_bf16_f32 v133, v18, v19
v_cvt_pk_bf16_f32 v135, v22, v23
v_mfma_f32_32x32x16_bf16 v[64:79], a[24:27], a[108:111], v[64:79]
ds_read_b128 a[20:23], v5 offset:21504
v_mul_f32 v48, v244, v48
v_mul_f32 v52, v244, v52
v_mul_f32 v49, v244, v49
v_mul_f32 v53, v244, v53
v_mul_f32 v50, v244, v50
v_mul_f32 v54, v244, v54
v_mfma_f32_32x32x16_bf16 v[80:95], a[28:31], a[108:111], v[80:95]
ds_read_b128 a[24:27], v5 offset:22528
v_mul_f32 v51, v244, v51
v_mul_f32 v55, v244, v55
v_fma_f32 v16, -v48, v48, s49
v_fma_f32 v20, -v52, v52, s49
s_waitcnt lgkmcnt(3)
v_mfma_f32_32x32x16_bf16 v[64:79], a[0:3], a[112:115], v[64:79]
ds_read_b128 a[28:31], v5 offset:23552
s_waitcnt vmcnt(20)
s_barrier
v_fma_f32 v17, -v49, v49, s49
v_fma_f32 v21, -v53, v53, s49
v_fma_f32 v18, -v50, v50, s49
v_fma_f32 v22, -v54, v54, s49
v_mfma_f32_32x32x16_bf16 v[80:95], a[4:7], a[112:115], v[80:95]
ds_read_b128 a[0:3], v5 offset:24576
s_add_u32 m0, s34, 73728
v_fma_f32 v19, -v51, v51, s49
v_fma_f32 v23, -v55, v55, s49
v_mul_f32 v16, v16, v48
v_mul_f32 v20, v20, v52
v_mfma_f32_32x32x16_bf16 v[64:79], a[8:11], a[116:119], v[64:79]
ds_read_b128 a[4:7], v5 offset:25600
v_mul_f32 v17, v17, v49
v_mul_f32 v21, v21, v53
v_mul_f32 v18, v18, v50
v_mul_f32 v22, v22, v54
v_mul_f32 v19, v19, v51
v_mul_f32 v23, v23, v55
v_mfma_f32_32x32x16_bf16 v[80:95], a[12:15], a[116:119], v[80:95]
ds_read_b128 a[8:11], v5 offset:26624
buffer_load_dwordx4 v2, s[8:11], s30 offen lds
v_exp_f32 v16, v16
s_waitcnt lgkmcnt(3)
v_mfma_f32_32x32x16_bf16 v[64:79], a[16:19], a[120:123], v[64:79]
ds_read_b128 a[12:15], v5 offset:27648
v_exp_f32 v20, v20
v_exp_f32 v17, v17
v_mfma_f32_32x32x16_bf16 v[80:95], a[20:23], a[120:123], v[80:95]
ds_read_b128 a[16:19], v5 offset:28672
buffer_load_dwordx4 v2, s[8:11], s30 offen offset:1024 lds
v_exp_f32 v21, v21
v_exp_f32 v18, v18
v_mfma_f32_32x32x16_bf16 v[64:79], a[24:27], a[124:127], v[64:79]
ds_read_b128 a[20:23], v5 offset:29696
v_exp_f32 v22, v22
v_exp_f32 v19, v19
v_add_f32 v16, 1.0, v16
v_mfma_f32_32x32x16_bf16 v[80:95], a[28:31], a[124:127], v[80:95]
ds_read_b128 a[24:27], v5 offset:30720
buffer_load_dwordx4 v2, s[8:11], s30 offen offset:2048 lds
v_exp_f32 v23, v23
v_add_f32 v20, 1.0, v20
s_waitcnt lgkmcnt(3)
v_mfma_f32_32x32x16_bf16 v[64:79], a[0:3], a[128:131], v[64:79]
ds_read_b128 a[28:31], v5 offset:31744
v_add_f32 v17, 1.0, v17
v_add_f32 v21, 1.0, v21
v_add_f32 v18, 1.0, v18
v_add_f32 v22, 1.0, v22
v_add_f32 v19, 1.0, v19
v_add_f32 v23, 1.0, v23
v_mfma_f32_32x32x16_bf16 v[80:95], a[4:7], a[128:131], v[80:95]
ds_read_b128 a[0:3], v5 offset:32768
buffer_load_dwordx4 v2, s[8:11], s30 offen offset:3072 lds
v_rcp_f32 v16, v16
v_mfma_f32_32x32x16_bf16 v[64:79], a[8:11], a[132:135], v[64:79]
ds_read_b128 a[4:7], v5 offset:33792
v_rcp_f32 v20, v20
v_rcp_f32 v17, v17
v_rcp_f32 v21, v21
v_mfma_f32_32x32x16_bf16 v[80:95], a[12:15], a[132:135], v[80:95]
ds_read_b128 a[8:11], v5 offset:34816
s_add_u32 m0, s34, 77824
v_rcp_f32 v18, v18
s_waitcnt lgkmcnt(3)
v_mfma_f32_32x32x16_bf16 v[64:79], a[16:19], a[136:139], v[64:79]
ds_read_b128 a[12:15], v5 offset:35840
v_rcp_f32 v22, v22
v_rcp_f32 v19, v19
v_rcp_f32 v23, v23
v_mfma_f32_32x32x16_bf16 v[80:95], a[20:23], a[136:139], v[80:95]
ds_read_b128 a[16:19], v5 offset:36864
buffer_load_dwordx4 v3, s[8:11], s30 offen lds
v_mul_f32 v16, v16, v48
v_mul_f32 v20, v20, v52
v_mul_f32 v17, v17, v49
v_mfma_f32_32x32x16_bf16 v[64:79], a[24:27], a[140:143], v[64:79]
ds_read_b128 a[20:23], v5 offset:37888
v_mul_f32 v21, v21, v53
v_mul_f32 v18, v18, v50
v_mul_f32 v22, v22, v54
v_mul_f32 v19, v19, v51
v_mul_f32 v23, v23, v55
v_cvt_pk_bf16_f32 v136, v16, v17
v_mfma_f32_32x32x16_bf16 v[80:95], a[28:31], a[140:143], v[80:95]
ds_read_b128 a[24:27], v5 offset:38912
buffer_load_dwordx4 v3, s[8:11], s30 offen offset:1024 lds
v_cvt_pk_bf16_f32 v138, v20, v21
v_cvt_pk_bf16_f32 v137, v18, v19
v_cvt_pk_bf16_f32 v139, v22, v23
s_waitcnt lgkmcnt(3)
v_mfma_f32_32x32x16_bf16 v[64:79], a[0:3], a[144:147], v[64:79]
ds_read_b128 a[28:31], v5 offset:39936
v_mul_f32 v56, v244, v56
v_mul_f32 v60, v244, v60
v_mul_f32 v57, v244, v57
v_mul_f32 v61, v244, v61
v_mul_f32 v58, v244, v58
v_mfma_f32_32x32x16_bf16 v[80:95], a[4:7], a[144:147], v[80:95]
ds_read_b128 a[0:3], v5 offset:40960
s_add_u32 s30, s30, 24576
v_mul_f32 v62, v244, v62
v_mul_f32 v59, v244, v59
v_mul_f32 v63, v244, v63
v_fma_f32 v16, -v56, v56, s49
v_fma_f32 v20, -v60, v60, s49
v_mfma_f32_32x32x16_bf16 v[64:79], a[8:11], a[148:151], v[64:79]
ds_read_b128 a[4:7], v5 offset:41984
v_fma_f32 v17, -v57, v57, s49
v_fma_f32 v21, -v61, v61, s49
v_fma_f32 v18, -v58, v58, s49
v_fma_f32 v22, -v62, v62, s49
v_fma_f32 v19, -v59, v59, s49
v_mfma_f32_32x32x16_bf16 v[80:95], a[12:15], a[148:151], v[80:95]
ds_read_b128 a[8:11], v5 offset:43008
v_fma_f32 v23, -v63, v63, s49
v_mul_f32 v16, v16, v56
v_mul_f32 v20, v20, v60
v_mul_f32 v17, v17, v57
v_mul_f32 v21, v21, v61
s_waitcnt lgkmcnt(3)
v_mfma_f32_32x32x16_bf16 v[64:79], a[16:19], a[152:155], v[64:79]
ds_read_b128 a[12:15], v5 offset:44032
ds_read_b32 v248, v245 offset:768
v_mul_f32 v18, v18, v58
v_mul_f32 v22, v22, v62
v_mul_f32 v19, v19, v59
v_mul_f32 v23, v23, v63
v_mfma_f32_32x32x16_bf16 v[80:95], a[20:23], a[152:155], v[80:95]
ds_read_b128 a[16:19], v5 offset:45056
ds_read_b32 v250, v245 offset:896
v_exp_f32 v16, v16
v_exp_f32 v20, v20
v_mfma_f32_32x32x16_bf16 v[64:79], a[24:27], a[156:159], v[64:79]
ds_read_b128 a[20:23], v5 offset:46080
v_exp_f32 v17, v17
v_exp_f32 v21, v21
v_exp_f32 v18, v18
v_mfma_f32_32x32x16_bf16 v[80:95], a[28:31], a[156:159], v[80:95]
ds_read_b128 a[24:27], v5 offset:47104
v_exp_f32 v22, v22
v_exp_f32 v19, v19
s_waitcnt lgkmcnt(5)
v_mfma_f32_32x32x16_bf16 v[64:79], a[0:3], a[160:163], v[64:79]
ds_read_b128 a[28:31], v5 offset:48128
s_waitcnt vmcnt(19)
s_barrier
v_exp_f32 v23, v23
v_add_f32 v16, 1.0, v16
v_add_f32 v20, 1.0, v20
v_mfma_f32_32x32x16_bf16 v[80:95], a[4:7], a[160:163], v[80:95]
ds_read_b128 a[0:3], v2 offset:0
s_add_u32 m0, s34, 98304
v_add_f32 v17, 1.0, v17
v_add_f32 v21, 1.0, v21
v_add_f32 v18, 1.0, v18
v_add_f32 v22, 1.0, v22
v_add_f32 v19, 1.0, v19
v_mfma_f32_32x32x16_bf16 v[64:79], a[8:11], a[164:167], v[64:79]
ds_read_b128 a[4:7], v2 offset:1024
v_add_f32 v23, 1.0, v23
v_rcp_f32 v16, v16
v_rcp_f32 v20, v20
v_mfma_f32_32x32x16_bf16 v[80:95], a[12:15], a[164:167], v[80:95]
ds_read_b128 a[8:11], v2 offset:2048
buffer_load_dwordx4 v2, s[8:11], s30 offen lds
v_rcp_f32 v17, v17
s_waitcnt lgkmcnt(3)
v_mfma_f32_32x32x16_bf16 v[64:79], a[16:19], a[168:171], v[64:79]
ds_read_b128 a[12:15], v2 offset:3072
v_rcp_f32 v21, v21
v_rcp_f32 v18, v18
v_mfma_f32_32x32x16_bf16 v[80:95], a[20:23], a[168:171], v[80:95]
ds_read_b128 a[16:19], v2 offset:4096
buffer_load_dwordx4 v2, s[8:11], s30 offen offset:1024 lds
v_rcp_f32 v22, v22
v_rcp_f32 v19, v19
v_mfma_f32_32x32x16_bf16 v[64:79], a[24:27], a[172:175], v[64:79]
ds_read_b128 a[20:23], v2 offset:5120
v_mfma_f32_32x32x8bf16_1k v[64:79], v[248:249], v[246:247], v[64:79]
v_rcp_f32 v23, v23
v_mul_f32 v16, v16, v56
v_mul_f32 v20, v20, v60
v_mul_f32 v17, v17, v57
v_mul_f32 v21, v21, v61
v_mul_f32 v18, v18, v58
v_mul_f32 v22, v22, v62
v_mul_f32 v19, v19, v59
v_mul_f32 v23, v23, v63
v_cvt_pk_bf16_f32 v140, v16, v17
v_cvt_pk_bf16_f32 v142, v20, v21
v_cvt_pk_bf16_f32 v141, v18, v19
v_cvt_pk_bf16_f32 v143, v22, v23
v_mfma_f32_32x32x16_bf16 v[80:95], a[28:31], a[172:175], v[80:95]
ds_read_b128 a[24:27], v2 offset:6144
buffer_load_dwordx4 v2, s[8:11], s30 offen offset:2048 lds
v_mfma_f32_32x32x8bf16_1k v[80:95], v[250:251], v[246:247], v[80:95]
s_waitcnt lgkmcnt(3)
v_mfma_f32_32x32x16_bf16 v[32:47], a[0:3], a[32:35], 0
ds_read_b128 a[28:31], v2 offset:7168
v_mfma_f32_32x32x16_bf16 v[48:63], a[4:7], a[32:35], 0
ds_read_b128 a[0:3], v2 offset:8192
buffer_load_dwordx4 v2, s[8:11], s30 offen offset:3072 lds
v_mfma_f32_32x32x16_bf16 v[32:47], a[8:11], a[36:39], v[32:47]
ds_read_b128 a[4:7], v2 offset:9216
v_mfma_f32_32x32x16_bf16 v[48:63], a[12:15], a[36:39], v[48:63]
ds_read_b128 a[8:11], v2 offset:10240
s_add_u32 m0, s34, 102400
v_mul_f32 v64, v244, v64
v_mul_f32 v68, v244, v68
v_mul_f32 v65, v244, v65
v_mul_f32 v69, v244, v69
s_waitcnt lgkmcnt(3)
v_mfma_f32_32x32x16_bf16 v[32:47], a[16:19], a[40:43], v[32:47]
ds_read_b128 a[12:15], v2 offset:11264
v_mul_f32 v66, v244, v66
v_mul_f32 v70, v244, v70
v_mul_f32 v67, v244, v67
v_mul_f32 v71, v244, v71
v_fma_f32 v16, -v64, v64, s49
v_fma_f32 v20, -v68, v68, s49
v_mfma_f32_32x32x16_bf16 v[48:63], a[20:23], a[40:43], v[48:63]
ds_read_b128 a[16:19], v2 offset:12288
buffer_load_dwordx4 v3, s[8:11], s30 offen lds
v_fma_f32 v17, -v65, v65, s49
v_fma_f32 v21, -v69, v69, s49
v_fma_f32 v18, -v66, v66, s49
v_mfma_f32_32x32x16_bf16 v[32:47], a[24:27], a[44:47], v[32:47]
ds_read_b128 a[20:23], v2 offset:13312
v_fma_f32 v22, -v70, v70, s49
v_fma_f32 v19, -v67, v67, s49
v_fma_f32 v23, -v71, v71, s49
v_mul_f32 v16, v16, v64
v_mul_f32 v20, v20, v68
v_mul_f32 v17, v17, v65
v_mfma_f32_32x32x16_bf16 v[48:63], a[28:31], a[44:47], v[48:63]
ds_read_b128 a[24:27], v2 offset:14336
buffer_load_dwordx4 v3, s[8:11], s30 offen offset:1024 lds
v_mul_f32 v21, v21, v69
v_mul_f32 v18, v18, v66
s_waitcnt lgkmcnt(3)
v_mfma_f32_32x32x16_bf16 v[32:47], a[0:3], a[48:51], v[32:47]
ds_read_b128 a[28:31], v2 offset:15360
v_mul_f32 v22, v22, v70
v_mul_f32 v19, v19, v67
v_mul_f32 v23, v23, v71
v_exp_f32 v16, v16
v_mfma_f32_32x32x16_bf16 v[48:63], a[4:7], a[48:51], v[48:63]
ds_read_b128 a[0:3], v2 offset:16384
s_add_u32 s30, s30, 24576
v_exp_f32 v20, v20
v_exp_f32 v17, v17
v_mfma_f32_32x32x16_bf16 v[32:47], a[8:11], a[52:55], v[32:47]
ds_read_b128 a[4:7], v2 offset:17408
v_exp_f32 v21, v21
v_exp_f32 v18, v18
v_mfma_f32_32x32x16_bf16 v[48:63], a[12:15], a[52:55], v[48:63]
ds_read_b128 a[8:11], v2 offset:18432
v_exp_f32 v22, v22
v_exp_f32 v19, v19
v_add_f32 v16, 1.0, v16
s_waitcnt lgkmcnt(3)
v_mfma_f32_32x32x16_bf16 v[32:47], a[16:19], a[56:59], v[32:47]
ds_read_b128 a[12:15], v2 offset:19456
v_exp_f32 v23, v23
v_add_f32 v20, 1.0, v20
v_add_f32 v17, 1.0, v17
v_add_f32 v21, 1.0, v21
v_mfma_f32_32x32x16_bf16 v[48:63], a[20:23], a[56:59], v[48:63]
ds_read_b128 a[16:19], v2 offset:20480
v_add_f32 v18, 1.0, v18
v_add_f32 v22, 1.0, v22
v_add_f32 v19, 1.0, v19
v_add_f32 v23, 1.0, v23
v_rcp_f32 v16, v16
v_mfma_f32_32x32x16_bf16 v[32:47], a[24:27], a[60:63], v[32:47]
ds_read_b128 a[20:23], v2 offset:21504
v_rcp_f32 v20, v20
v_rcp_f32 v17, v17
v_rcp_f32 v21, v21
v_mfma_f32_32x32x16_bf16 v[48:63], a[28:31], a[60:63], v[48:63]
ds_read_b128 a[24:27], v2 offset:22528
v_rcp_f32 v18, v18
v_rcp_f32 v22, v22
s_waitcnt lgkmcnt(3)
v_mfma_f32_32x32x16_bf16 v[32:47], a[0:3], a[64:67], v[32:47]
ds_read_b128 a[28:31], v2 offset:23552
s_waitcnt vmcnt(19)
s_barrier
v_rcp_f32 v19, v19
v_rcp_f32 v23, v23
v_mfma_f32_32x32x16_bf16 v[48:63], a[4:7], a[64:67], v[48:63]
ds_read_b128 a[0:3], v2 offset:24576
s_add_u32 m0, s34, 122880
v_mul_f32 v16, v16, v64
v_mul_f32 v20, v20, v68
v_mul_f32 v17, v17, v65
v_mul_f32 v21, v21, v69
v_mfma_f32_32x32x16_bf16 v[32:47], a[8:11], a[68:71], v[32:47]
ds_read_b128 a[4:7], v2 offset:25600
v_mul_f32 v18, v18, v66
v_mul_f32 v22, v22, v70
v_mul_f32 v19, v19, v67
v_mul_f32 v23, v23, v71
v_cvt_pk_bf16_f32 v144, v16, v17
v_cvt_pk_bf16_f32 v146, v20, v21
v_mfma_f32_32x32x16_bf16 v[48:63], a[12:15], a[68:71], v[48:63]
ds_read_b128 a[8:11], v2 offset:26624
buffer_load_dwordx4 v2, s[8:11], s30 offen lds
v_cvt_pk_bf16_f32 v145, v18, v19
v_cvt_pk_bf16_f32 v147, v22, v23
s_waitcnt lgkmcnt(3)
v_mfma_f32_32x32x16_bf16 v[32:47], a[16:19], a[72:75], v[32:47]
ds_read_b128 a[12:15], v2 offset:27648
v_mul_f32 v72, v244, v72
v_mul_f32 v76, v244, v76
v_mul_f32 v73, v244, v73
v_mul_f32 v77, v244, v77
v_mul_f32 v74, v244, v74
v_mul_f32 v78, v244, v78
v_mfma_f32_32x32x16_bf16 v[48:63], a[20:23], a[72:75], v[48:63]
ds_read_b128 a[16:19], v2 offset:28672
buffer_load_dwordx4 v2, s[8:11], s30 offen offset:1024 lds
v_mul_f32 v75, v244, v75
v_mul_f32 v79, v244, v79
v_fma_f32 v16, -v72, v72, s49
v_fma_f32 v20, -v76, v76, s49
v_mfma_f32_32x32x16_bf16 v[32:47], a[24:27], a[76:79], v[32:47]
ds_read_b128 a[20:23], v2 offset:29696
v_fma_f32 v17, -v73, v73, s49
v_fma_f32 v21, -v77, v77, s49
v_fma_f32 v18, -v74, v74, s49
v_fma_f32 v22, -v78, v78, s49
v_fma_f32 v19, -v75, v75, s49
v_mfma_f32_32x32x16_bf16 v[48:63], a[28:31], a[76:79], v[48:63]
ds_read_b128 a[24:27], v2 offset:30720
buffer_load_dwordx4 v2, s[8:11], s30 offen offset:2048 lds
v_fma_f32 v23, -v79, v79, s49
v_mul_f32 v16, v16, v72
v_mul_f32 v20, v20, v76
s_waitcnt lgkmcnt(3)
v_mfma_f32_32x32x16_bf16 v[32:47], a[0:3], a[80:83], v[32:47]
ds_read_b128 a[28:31], v2 offset:31744
v_mul_f32 v17, v17, v73
v_mul_f32 v21, v21, v77
v_mul_f32 v18, v18, v74
v_mul_f32 v22, v22, v78
v_mul_f32 v19, v19, v75
v_mfma_f32_32x32x16_bf16 v[48:63], a[4:7], a[80:83], v[48:63]
ds_read_b128 a[0:3], v2 offset:32768
buffer_load_dwordx4 v2, s[8:11], s30 offen offset:3072 lds
v_mul_f32 v23, v23, v79
v_exp_f32 v16, v16
v_mfma_f32_32x32x16_bf16 v[32:47], a[8:11], a[84:87], v[32:47]
ds_read_b128 a[4:7], v2 offset:33792
v_exp_f32 v20, v20
v_exp_f32 v17, v17
v_exp_f32 v21, v21
v_mfma_f32_32x32x16_bf16 v[48:63], a[12:15], a[84:87], v[48:63]
ds_read_b128 a[8:11], v2 offset:34816
s_add_u32 m0, s34, 126976
v_exp_f32 v18, v18
s_waitcnt lgkmcnt(3)
v_mfma_f32_32x32x16_bf16 v[32:47], a[16:19], a[88:91], v[32:47]
ds_read_b128 a[12:15], v2 offset:35840
v_exp_f32 v22, v22
v_exp_f32 v19, v19
v_exp_f32 v23, v23
v_mfma_f32_32x32x16_bf16 v[48:63], a[20:23], a[88:91], v[48:63]
ds_read_b128 a[16:19], v2 offset:36864
buffer_load_dwordx4 v3, s[8:11], s30 offen lds
v_add_f32 v16, 1.0, v16
v_add_f32 v20, 1.0, v20
v_add_f32 v17, 1.0, v17
v_mfma_f32_32x32x16_bf16 v[32:47], a[24:27], a[92:95], v[32:47]
ds_read_b128 a[20:23], v2 offset:37888
v_add_f32 v21, 1.0, v21
v_add_f32 v18, 1.0, v18
v_add_f32 v22, 1.0, v22
v_add_f32 v19, 1.0, v19
v_add_f32 v23, 1.0, v23
v_mfma_f32_32x32x16_bf16 v[48:63], a[28:31], a[92:95], v[48:63]
ds_read_b128 a[24:27], v2 offset:38912
buffer_load_dwordx4 v3, s[8:11], s30 offen offset:1024 lds
v_rcp_f32 v16, v16
s_waitcnt lgkmcnt(3)
v_mfma_f32_32x32x16_bf16 v[32:47], a[0:3], a[96:99], v[32:47]
ds_read_b128 a[28:31], v2 offset:39936
v_rcp_f32 v20, v20
v_rcp_f32 v17, v17
v_mfma_f32_32x32x16_bf16 v[48:63], a[4:7], a[96:99], v[48:63]
ds_read_b128 a[0:3], v2 offset:40960
s_add_u32 s30, s30, 24576
v_rcp_f32 v21, v21
v_rcp_f32 v18, v18
v_mfma_f32_32x32x16_bf16 v[32:47], a[8:11], a[100:103], v[32:47]
ds_read_b128 a[4:7], v2 offset:41984
v_rcp_f32 v22, v22
v_rcp_f32 v19, v19
v_mul_f32 v16, v16, v72
v_mfma_f32_32x32x16_bf16 v[48:63], a[12:15], a[100:103], v[48:63]
ds_read_b128 a[8:11], v2 offset:43008
v_rcp_f32 v23, v23
v_mul_f32 v20, v20, v76
v_mul_f32 v17, v17, v73
v_mul_f32 v21, v21, v77
s_waitcnt lgkmcnt(3)
v_mfma_f32_32x32x16_bf16 v[32:47], a[16:19], a[104:107], v[32:47]
ds_read_b128 a[12:15], v2 offset:44032
v_mul_f32 v18, v18, v74
v_mul_f32 v22, v22, v78
v_mul_f32 v19, v19, v75
v_mul_f32 v23, v23, v79
v_cvt_pk_bf16_f32 v148, v16, v17
v_mfma_f32_32x32x16_bf16 v[48:63], a[20:23], a[104:107], v[48:63]
ds_read_b128 a[16:19], v2 offset:45056
buffer_load_dword v240, v242, s[12:15], s43 offen
s_add_u32 s43, s43, 3456
v_cvt_pk_bf16_f32 v150, v20, v21
v_cvt_pk_bf16_f32 v149, v18, v19
v_cvt_pk_bf16_f32 v151, v22, v23
v_mfma_f32_32x32x16_bf16 v[32:47], a[24:27], a[108:111], v[32:47]
ds_read_b128 a[20:23], v2 offset:46080
v_mul_f32 v80, v244, v80
v_mul_f32 v84, v244, v84
v_mul_f32 v81, v244, v81
v_mul_f32 v85, v244, v85
v_mul_f32 v82, v244, v82
v_mul_f32 v86, v244, v86
v_mfma_f32_32x32x16_bf16 v[48:63], a[28:31], a[108:111], v[48:63]
ds_read_b128 a[24:27], v2 offset:47104
v_mul_f32 v83, v244, v83
v_mul_f32 v87, v244, v87
v_fma_f32 v16, -v80, v80, s49
v_fma_f32 v20, -v84, v84, s49
s_waitcnt lgkmcnt(3)
v_mfma_f32_32x32x16_bf16 v[32:47], a[0:3], a[112:115], v[32:47]
ds_read_b128 a[28:31], v2 offset:48128
s_waitcnt vmcnt(20)
s_barrier
v_fma_f32 v17, -v81, v81, s49
v_fma_f32 v21, -v85, v85, s49
v_fma_f32 v18, -v82, v82, s49
v_fma_f32 v22, -v86, v86, s49
v_mfma_f32_32x32x16_bf16 v[48:63], a[4:7], a[112:115], v[48:63]
ds_read_b128 a[0:3], v4 offset:0
s_add_u32 m0, s34, 0
v_fma_f32 v19, -v83, v83, s49
v_fma_f32 v23, -v87, v87, s49
v_mul_f32 v16, v16, v80
v_mul_f32 v20, v20, v84
v_mfma_f32_32x32x16_bf16 v[32:47], a[8:11], a[116:119], v[32:47]
ds_read_b128 a[4:7], v4 offset:1024
v_mul_f32 v17, v17, v81
v_mul_f32 v21, v21, v85
v_mul_f32 v18, v18, v82
v_mul_f32 v22, v22, v86
v_mul_f32 v19, v19, v83
v_mul_f32 v23, v23, v87
v_mfma_f32_32x32x16_bf16 v[48:63], a[12:15], a[116:119], v[48:63]
ds_read_b128 a[8:11], v4 offset:2048
buffer_load_dwordx4 v2, s[8:11], s30 offen lds
v_exp_f32 v16, v16
s_waitcnt lgkmcnt(3)
v_mfma_f32_32x32x16_bf16 v[32:47], a[16:19], a[120:123], v[32:47]
ds_read_b128 a[12:15], v4 offset:3072
v_exp_f32 v20, v20
v_exp_f32 v17, v17
v_mfma_f32_32x32x16_bf16 v[48:63], a[20:23], a[120:123], v[48:63]
ds_read_b128 a[16:19], v4 offset:4096
buffer_load_dwordx4 v2, s[8:11], s30 offen offset:1024 lds
v_exp_f32 v21, v21
v_exp_f32 v18, v18
v_mfma_f32_32x32x16_bf16 v[32:47], a[24:27], a[124:127], v[32:47]
ds_read_b128 a[20:23], v4 offset:5120
v_exp_f32 v22, v22
v_exp_f32 v19, v19
v_add_f32 v16, 1.0, v16
v_mfma_f32_32x32x16_bf16 v[48:63], a[28:31], a[124:127], v[48:63]
ds_read_b128 a[24:27], v4 offset:6144
buffer_load_dwordx4 v2, s[8:11], s30 offen offset:2048 lds
v_exp_f32 v23, v23
v_add_f32 v20, 1.0, v20
s_waitcnt lgkmcnt(3)
v_mfma_f32_32x32x16_bf16 v[32:47], a[0:3], a[128:131], v[32:47]
ds_read_b128 a[28:31], v4 offset:7168
v_add_f32 v17, 1.0, v17
v_add_f32 v21, 1.0, v21
v_add_f32 v18, 1.0, v18
v_add_f32 v22, 1.0, v22
v_add_f32 v19, 1.0, v19
v_add_f32 v23, 1.0, v23
v_mfma_f32_32x32x16_bf16 v[48:63], a[4:7], a[128:131], v[48:63]
ds_read_b128 a[0:3], v4 offset:8192
buffer_load_dwordx4 v2, s[8:11], s30 offen offset:3072 lds
v_rcp_f32 v16, v16
v_mfma_f32_32x32x16_bf16 v[32:47], a[8:11], a[132:135], v[32:47]
ds_read_b128 a[4:7], v4 offset:9216
v_rcp_f32 v20, v20
v_rcp_f32 v17, v17
v_rcp_f32 v21, v21
v_mfma_f32_32x32x16_bf16 v[48:63], a[12:15], a[132:135], v[48:63]
ds_read_b128 a[8:11], v4 offset:10240
s_add_u32 m0, s34, 4096
v_rcp_f32 v18, v18
s_waitcnt lgkmcnt(3)
v_mfma_f32_32x32x16_bf16 v[32:47], a[16:19], a[136:139], v[32:47]
ds_read_b128 a[12:15], v4 offset:11264
v_rcp_f32 v22, v22
v_rcp_f32 v19, v19
v_rcp_f32 v23, v23
v_mfma_f32_32x32x16_bf16 v[48:63], a[20:23], a[136:139], v[48:63]
ds_read_b128 a[16:19], v4 offset:12288
buffer_load_dwordx4 v3, s[8:11], s30 offen lds
v_mul_f32 v16, v16, v80
v_mul_f32 v20, v20, v84
v_mul_f32 v17, v17, v81
v_mfma_f32_32x32x16_bf16 v[32:47], a[24:27], a[140:143], v[32:47]
ds_read_b128 a[20:23], v4 offset:13312
v_mul_f32 v21, v21, v85
v_mul_f32 v18, v18, v82
v_mul_f32 v22, v22, v86
v_mul_f32 v19, v19, v83
v_mul_f32 v23, v23, v87
v_cvt_pk_bf16_f32 v152, v16, v17
v_mfma_f32_32x32x16_bf16 v[48:63], a[28:31], a[140:143], v[48:63]
ds_read_b128 a[24:27], v4 offset:14336
buffer_load_dwordx4 v3, s[8:11], s30 offen offset:1024 lds
v_cvt_pk_bf16_f32 v154, v20, v21
v_cvt_pk_bf16_f32 v153, v18, v19
v_cvt_pk_bf16_f32 v155, v22, v23
s_waitcnt lgkmcnt(3)
v_mfma_f32_32x32x16_bf16 v[32:47], a[0:3], a[144:147], v[32:47]
ds_read_b128 a[28:31], v4 offset:15360
v_mul_f32 v88, v244, v88
v_mul_f32 v92, v244, v92
v_mul_f32 v89, v244, v89
v_mul_f32 v93, v244, v93
v_mul_f32 v90, v244, v90
v_mfma_f32_32x32x16_bf16 v[48:63], a[4:7], a[144:147], v[48:63]
ds_read_b128 a[0:3], v4 offset:16384
s_add_u32 s30, s30, 24576
v_mul_f32 v94, v244, v94
v_mul_f32 v91, v244, v91
v_mul_f32 v95, v244, v95
v_fma_f32 v16, -v88, v88, s49
v_fma_f32 v20, -v92, v92, s49
v_mfma_f32_32x32x16_bf16 v[32:47], a[8:11], a[148:151], v[32:47]
ds_read_b128 a[4:7], v4 offset:17408
v_fma_f32 v17, -v89, v89, s49
v_fma_f32 v21, -v93, v93, s49
v_fma_f32 v18, -v90, v90, s49
v_fma_f32 v22, -v94, v94, s49
v_fma_f32 v19, -v91, v91, s49
v_mfma_f32_32x32x16_bf16 v[48:63], a[12:15], a[148:151], v[48:63]
ds_read_b128 a[8:11], v4 offset:18432
v_fma_f32 v23, -v95, v95, s49
v_mul_f32 v16, v16, v88
v_mul_f32 v20, v20, v92
v_mul_f32 v17, v17, v89
v_mul_f32 v21, v21, v93
s_waitcnt lgkmcnt(3)
v_mfma_f32_32x32x16_bf16 v[32:47], a[16:19], a[152:155], v[32:47]
ds_read_b128 a[12:15], v4 offset:19456
ds_read_b32 v248, v245 offset:1024
v_mul_f32 v18, v18, v90
v_mul_f32 v22, v22, v94
v_mul_f32 v19, v19, v91
v_mul_f32 v23, v23, v95
v_mfma_f32_32x32x16_bf16 v[48:63], a[20:23], a[152:155], v[48:63]
ds_read_b128 a[16:19], v4 offset:20480
ds_read_b32 v250, v245 offset:1152
v_exp_f32 v16, v16
v_exp_f32 v20, v20
v_mfma_f32_32x32x16_bf16 v[32:47], a[24:27], a[156:159], v[32:47]
ds_read_b128 a[20:23], v4 offset:21504
v_exp_f32 v17, v17
v_exp_f32 v21, v21
v_exp_f32 v18, v18
v_mfma_f32_32x32x16_bf16 v[48:63], a[28:31], a[156:159], v[48:63]
ds_read_b128 a[24:27], v4 offset:22528
v_exp_f32 v22, v22
v_exp_f32 v19, v19
s_waitcnt lgkmcnt(5)
v_mfma_f32_32x32x16_bf16 v[32:47], a[0:3], a[160:163], v[32:47]
ds_read_b128 a[28:31], v4 offset:23552
s_waitcnt vmcnt(19)
s_barrier
v_exp_f32 v23, v23
v_add_f32 v16, 1.0, v16
v_add_f32 v20, 1.0, v20
v_mfma_f32_32x32x16_bf16 v[48:63], a[4:7], a[160:163], v[48:63]
ds_read_b128 a[0:3], v4 offset:24576
s_add_u32 m0, s34, 24576
v_add_f32 v17, 1.0, v17
v_add_f32 v21, 1.0, v21
v_add_f32 v18, 1.0, v18
v_add_f32 v22, 1.0, v22
v_add_f32 v19, 1.0, v19
v_mfma_f32_32x32x16_bf16 v[32:47], a[8:11], a[164:167], v[32:47]
ds_read_b128 a[4:7], v4 offset:25600
v_add_f32 v23, 1.0, v23
v_rcp_f32 v16, v16
v_rcp_f32 v20, v20
v_mfma_f32_32x32x16_bf16 v[48:63], a[12:15], a[164:167], v[48:63]
ds_read_b128 a[8:11], v4 offset:26624
buffer_load_dwordx4 v2, s[8:11], s30 offen lds
v_rcp_f32 v17, v17
s_waitcnt lgkmcnt(3)
v_mfma_f32_32x32x16_bf16 v[32:47], a[16:19], a[168:171], v[32:47]
ds_read_b128 a[12:15], v4 offset:27648
v_rcp_f32 v21, v21
v_rcp_f32 v18, v18
v_mfma_f32_32x32x16_bf16 v[48:63], a[20:23], a[168:171], v[48:63]
ds_read_b128 a[16:19], v4 offset:28672
buffer_load_dwordx4 v2, s[8:11], s30 offen offset:1024 lds
v_rcp_f32 v22, v22
v_rcp_f32 v19, v19
v_mfma_f32_32x32x16_bf16 v[32:47], a[24:27], a[172:175], v[32:47]
ds_read_b128 a[20:23], v4 offset:29696
v_mfma_f32_32x32x8bf16_1k v[32:47], v[248:249], v[246:247], v[32:47]
v_rcp_f32 v23, v23
v_mul_f32 v16, v16, v88
v_mul_f32 v20, v20, v92
v_mul_f32 v17, v17, v89
v_mul_f32 v21, v21, v93
v_mul_f32 v18, v18, v90
v_mul_f32 v22, v22, v94
v_mul_f32 v19, v19, v91
v_mul_f32 v23, v23, v95
v_cvt_pk_bf16_f32 v156, v16, v17
v_cvt_pk_bf16_f32 v158, v20, v21
v_cvt_pk_bf16_f32 v157, v18, v19
v_cvt_pk_bf16_f32 v159, v22, v23
v_mfma_f32_32x32x16_bf16 v[48:63], a[28:31], a[172:175], v[48:63]
ds_read_b128 a[24:27], v4 offset:30720
buffer_load_dwordx4 v2, s[8:11], s30 offen offset:2048 lds
v_mfma_f32_32x32x8bf16_1k v[48:63], v[250:251], v[246:247], v[48:63]
s_waitcnt lgkmcnt(3)
v_mfma_f32_32x32x16_bf16 v[64:79], a[0:3], a[32:35], 0
ds_read_b128 a[28:31], v4 offset:31744
v_mfma_f32_32x32x16_bf16 v[80:95], a[4:7], a[32:35], 0
ds_read_b128 a[0:3], v4 offset:32768
buffer_load_dwordx4 v2, s[8:11], s30 offen offset:3072 lds
v_mfma_f32_32x32x16_bf16 v[64:79], a[8:11], a[36:39], v[64:79]
ds_read_b128 a[4:7], v4 offset:33792
v_mfma_f32_32x32x16_bf16 v[80:95], a[12:15], a[36:39], v[80:95]
ds_read_b128 a[8:11], v4 offset:34816
s_add_u32 m0, s34, 28672
v_mul_f32 v32, v244, v32
v_mul_f32 v36, v244, v36
v_mul_f32 v33, v244, v33
v_mul_f32 v37, v244, v37
s_waitcnt lgkmcnt(3)
v_mfma_f32_32x32x16_bf16 v[64:79], a[16:19], a[40:43], v[64:79]
ds_read_b128 a[12:15], v4 offset:35840
v_mul_f32 v34, v244, v34
v_mul_f32 v38, v244, v38
v_mul_f32 v35, v244, v35
v_mul_f32 v39, v244, v39
v_fma_f32 v16, -v32, v32, s49
v_fma_f32 v20, -v36, v36, s49
v_mfma_f32_32x32x16_bf16 v[80:95], a[20:23], a[40:43], v[80:95]
ds_read_b128 a[16:19], v4 offset:36864
buffer_load_dwordx4 v3, s[8:11], s30 offen lds
v_fma_f32 v17, -v33, v33, s49
v_fma_f32 v21, -v37, v37, s49
v_fma_f32 v18, -v34, v34, s49
v_mfma_f32_32x32x16_bf16 v[64:79], a[24:27], a[44:47], v[64:79]
ds_read_b128 a[20:23], v4 offset:37888
v_fma_f32 v22, -v38, v38, s49
v_fma_f32 v19, -v35, v35, s49
v_fma_f32 v23, -v39, v39, s49
v_mul_f32 v16, v16, v32
v_mul_f32 v20, v20, v36
v_mul_f32 v17, v17, v33
v_mfma_f32_32x32x16_bf16 v[80:95], a[28:31], a[44:47], v[80:95]
ds_read_b128 a[24:27], v4 offset:38912
buffer_load_dwordx4 v3, s[8:11], s30 offen offset:1024 lds
v_mul_f32 v21, v21, v37
v_mul_f32 v18, v18, v34
s_waitcnt lgkmcnt(3)
v_mfma_f32_32x32x16_bf16 v[64:79], a[0:3], a[48:51], v[64:79]
ds_read_b128 a[28:31], v4 offset:39936
v_mul_f32 v22, v22, v38
v_mul_f32 v19, v19, v35
v_mul_f32 v23, v23, v39
v_exp_f32 v16, v16
v_mfma_f32_32x32x16_bf16 v[80:95], a[4:7], a[48:51], v[80:95]
ds_read_b128 a[0:3], v4 offset:40960
s_add_u32 s30, s30, 24576
v_exp_f32 v20, v20
v_exp_f32 v17, v17
v_mfma_f32_32x32x16_bf16 v[64:79], a[8:11], a[52:55], v[64:79]
ds_read_b128 a[4:7], v4 offset:41984
v_exp_f32 v21, v21
v_exp_f32 v18, v18
v_exp_f32 v22, v22
v_mfma_f32_32x32x16_bf16 v[80:95], a[12:15], a[52:55], v[80:95]
ds_read_b128 a[8:11], v4 offset:43008
v_exp_f32 v19, v19
v_exp_f32 v23, v23
s_waitcnt lgkmcnt(3)
v_mfma_f32_32x32x16_bf16 v[64:79], a[16:19], a[56:59], v[64:79]
ds_read_b128 a[12:15], v4 offset:44032
v_add_f32 v16, 1.0, v16
v_add_f32 v20, 1.0, v20
v_add_f32 v17, 1.0, v17
v_add_f32 v21, 1.0, v21
v_add_f32 v18, 1.0, v18
v_add_f32 v22, 1.0, v22
v_mfma_f32_32x32x16_bf16 v[80:95], a[20:23], a[56:59], v[80:95]
ds_read_b128 a[16:19], v4 offset:45056
v_add_f32 v19, 1.0, v19
v_add_f32 v23, 1.0, v23
v_rcp_f32 v16, v16
v_mfma_f32_32x32x16_bf16 v[64:79], a[24:27], a[60:63], v[64:79]
ds_read_b128 a[20:23], v4 offset:46080
v_rcp_f32 v20, v20
v_rcp_f32 v17, v17
v_rcp_f32 v21, v21
v_mfma_f32_32x32x16_bf16 v[80:95], a[28:31], a[60:63], v[80:95]
ds_read_b128 a[24:27], v4 offset:47104
v_rcp_f32 v18, v18
v_rcp_f32 v22, v22
s_waitcnt lgkmcnt(3)
v_mfma_f32_32x32x16_bf16 v[64:79], a[0:3], a[64:67], v[64:79]
ds_read_b128 a[28:31], v4 offset:48128
s_waitcnt vmcnt(19)
s_barrier
v_rcp_f32 v19, v19
v_mul_f32 v16, v16, v32
v_mfma_f32_32x32x16_bf16 v[80:95], a[4:7], a[64:67], v[80:95]
ds_read_b128 a[0:3], v5 offset:0
s_add_u32 m0, s34, 49152
v_rcp_f32 v23, v23
v_mul_f32 v20, v20, v36
v_mul_f32 v17, v17, v33
v_mul_f32 v21, v21, v37
v_mfma_f32_32x32x16_bf16 v[64:79], a[8:11], a[68:71], v[64:79]
ds_read_b128 a[4:7], v5 offset:1024
v_mul_f32 v18, v18, v34
v_mul_f32 v22, v22, v38
v_mul_f32 v19, v19, v35
v_mul_f32 v23, v23, v39
v_cvt_pk_bf16_f32 v160, v16, v17
v_mfma_f32_32x32x16_bf16 v[80:95], a[12:15], a[68:71], v[80:95]
ds_read_b128 a[8:11], v5 offset:2048
buffer_load_dwordx4 v2, s[8:11], s30 offen lds
v_cvt_pk_bf16_f32 v162, v20, v21
v_cvt_pk_bf16_f32 v161, v18, v19
v_cvt_pk_bf16_f32 v163, v22, v23
s_waitcnt lgkmcnt(3)
v_mfma_f32_32x32x16_bf16 v[64:79], a[16:19], a[72:75], v[64:79]
ds_read_b128 a[12:15], v5 offset:3072
v_mul_f32 v40, v244, v40
v_mul_f32 v44, v244, v44
v_mul_f32 v41, v244, v41
v_mul_f32 v45, v244, v45
v_mul_f32 v42, v244, v42
v_mfma_f32_32x32x16_bf16 v[80:95], a[20:23], a[72:75], v[80:95]
ds_read_b128 a[16:19], v5 offset:4096
buffer_load_dwordx4 v2, s[8:11], s30 offen offset:1024 lds
v_mul_f32 v46, v244, v46
v_mul_f32 v43, v244, v43
v_mul_f32 v47, v244, v47
v_fma_f32 v16, -v40, v40, s49
v_mfma_f32_32x32x16_bf16 v[64:79], a[24:27], a[76:79], v[64:79]
ds_read_b128 a[20:23], v5 offset:5120
v_fma_f32 v20, -v44, v44, s49
v_fma_f32 v17, -v41, v41, s49
v_fma_f32 v21, -v45, v45, s49
v_fma_f32 v18, -v42, v42, s49
v_fma_f32 v22, -v46, v46, s49
v_mfma_f32_32x32x16_bf16 v[80:95], a[28:31], a[76:79], v[80:95]
ds_read_b128 a[24:27], v5 offset:6144
buffer_load_dwordx4 v2, s[8:11], s30 offen offset:2048 lds
v_fma_f32 v19, -v43, v43, s49
v_fma_f32 v23, -v47, v47, s49
v_mul_f32 v16, v16, v40
s_waitcnt lgkmcnt(3)
v_mfma_f32_32x32x16_bf16 v[64:79], a[0:3], a[80:83], v[64:79]
ds_read_b128 a[28:31], v5 offset:7168
v_mul_f32 v20, v20, v44
v_mul_f32 v17, v17, v41
v_mul_f32 v21, v21, v45
v_mul_f32 v18, v18, v42
v_mul_f32 v22, v22, v46
v_mfma_f32_32x32x16_bf16 v[80:95], a[4:7], a[80:83], v[80:95]
ds_read_b128 a[0:3], v5 offset:8192
buffer_load_dwordx4 v2, s[8:11], s30 offen offset:3072 lds
v_mul_f32 v19, v19, v43
v_mul_f32 v23, v23, v47
v_exp_f32 v16, v16
v_mfma_f32_32x32x16_bf16 v[64:79], a[8:11], a[84:87], v[64:79]
ds_read_b128 a[4:7], v5 offset:9216
v_exp_f32 v20, v20
v_exp_f32 v17, v17
v_exp_f32 v21, v21
v_mfma_f32_32x32x16_bf16 v[80:95], a[12:15], a[84:87], v[80:95]
ds_read_b128 a[8:11], v5 offset:10240
s_add_u32 m0, s34, 53248
v_exp_f32 v18, v18
s_waitcnt lgkmcnt(3)
v_mfma_f32_32x32x16_bf16 v[64:79], a[16:19], a[88:91], v[64:79]
ds_read_b128 a[12:15], v5 offset:11264
v_exp_f32 v22, v22
v_exp_f32 v19, v19
v_exp_f32 v23, v23
v_mfma_f32_32x32x16_bf16 v[80:95], a[20:23], a[88:91], v[80:95]
ds_read_b128 a[16:19], v5 offset:12288
buffer_load_dwordx4 v3, s[8:11], s30 offen lds
v_add_f32 v16, 1.0, v16
v_add_f32 v20, 1.0, v20
v_add_f32 v17, 1.0, v17
v_mfma_f32_32x32x16_bf16 v[64:79], a[24:27], a[92:95], v[64:79]
ds_read_b128 a[20:23], v5 offset:13312
v_add_f32 v21, 1.0, v21
v_add_f32 v18, 1.0, v18
v_add_f32 v22, 1.0, v22
v_add_f32 v19, 1.0, v19
v_add_f32 v23, 1.0, v23
v_mfma_f32_32x32x16_bf16 v[80:95], a[28:31], a[92:95], v[80:95]
ds_read_b128 a[24:27], v5 offset:14336
buffer_load_dwordx4 v3, s[8:11], s30 offen offset:1024 lds
v_rcp_f32 v16, v16
s_waitcnt lgkmcnt(3)
v_mfma_f32_32x32x16_bf16 v[64:79], a[0:3], a[96:99], v[64:79]
ds_read_b128 a[28:31], v5 offset:15360
v_rcp_f32 v20, v20
v_rcp_f32 v17, v17
v_rcp_f32 v21, v21
v_mfma_f32_32x32x16_bf16 v[80:95], a[4:7], a[96:99], v[80:95]
ds_read_b128 a[0:3], v5 offset:16384
s_add_u32 s30, s30, 24576
v_rcp_f32 v18, v18
v_rcp_f32 v22, v22
v_mfma_f32_32x32x16_bf16 v[64:79], a[8:11], a[100:103], v[64:79]
ds_read_b128 a[4:7], v5 offset:17408
v_rcp_f32 v19, v19
v_rcp_f32 v23, v23
v_mul_f32 v16, v16, v40
v_mul_f32 v20, v20, v44
v_mfma_f32_32x32x16_bf16 v[80:95], a[12:15], a[100:103], v[80:95]
ds_read_b128 a[8:11], v5 offset:18432
v_mul_f32 v17, v17, v41
v_mul_f32 v21, v21, v45
v_mul_f32 v18, v18, v42
v_mul_f32 v22, v22, v46
s_waitcnt lgkmcnt(3)
v_mfma_f32_32x32x16_bf16 v[64:79], a[16:19], a[104:107], v[64:79]
ds_read_b128 a[12:15], v5 offset:19456
v_mul_f32 v19, v19, v43
v_mul_f32 v23, v23, v47
v_cvt_pk_bf16_f32 v164, v16, v17
v_cvt_pk_bf16_f32 v166, v20, v21
v_cvt_pk_bf16_f32 v165, v18, v19
v_cvt_pk_bf16_f32 v167, v22, v23
v_mfma_f32_32x32x16_bf16 v[80:95], a[20:23], a[104:107], v[80:95]
ds_read_b128 a[16:19], v5 offset:20480
v_mul_f32 v48, v244, v48
v_mul_f32 v52, v244, v52
v_mul_f32 v49, v244, v49
v_mul_f32 v53, v244, v53
v_mul_f32 v50, v244, v50
v_mul_f32 v54, v244, v54
v_mfma_f32_32x32x16_bf16 v[64:79], a[24:27], a[108:111], v[64:79]
ds_read_b128 a[20:23], v5 offset:21504
v_mul_f32 v51, v244, v51
v_mul_f32 v55, v244, v55
v_fma_f32 v16, -v48, v48, s49
v_fma_f32 v20, -v52, v52, s49
v_fma_f32 v17, -v49, v49, s49
v_mfma_f32_32x32x16_bf16 v[80:95], a[28:31], a[108:111], v[80:95]
ds_read_b128 a[24:27], v5 offset:22528
v_fma_f32 v21, -v53, v53, s49
v_fma_f32 v18, -v50, v50, s49
v_fma_f32 v22, -v54, v54, s49
v_fma_f32 v19, -v51, v51, s49
v_fma_f32 v23, -v55, v55, s49
s_waitcnt lgkmcnt(3)
v_mfma_f32_32x32x16_bf16 v[64:79], a[0:3], a[112:115], v[64:79]
ds_read_b128 a[28:31], v5 offset:23552
s_waitcnt vmcnt(19)
s_barrier
v_mul_f32 v16, v16, v48
v_mul_f32 v20, v20, v52
v_mul_f32 v17, v17, v49
v_mfma_f32_32x32x16_bf16 v[80:95], a[4:7], a[112:115], v[80:95]
ds_read_b128 a[0:3], v5 offset:24576
s_add_u32 m0, s34, 73728
v_mul_f32 v21, v21, v53
v_mul_f32 v18, v18, v50
v_mul_f32 v22, v22, v54
v_mul_f32 v19, v19, v51
v_mul_f32 v23, v23, v55
v_mfma_f32_32x32x16_bf16 v[64:79], a[8:11], a[116:119], v[64:79]
ds_read_b128 a[4:7], v5 offset:25600
v_exp_f32 v16, v16
v_exp_f32 v20, v20
v_mfma_f32_32x32x16_bf16 v[80:95], a[12:15], a[116:119], v[80:95]
ds_read_b128 a[8:11], v5 offset:26624
buffer_load_dwordx4 v2, s[8:11], s30 offen lds
v_exp_f32 v17, v17
s_waitcnt lgkmcnt(3)
v_mfma_f32_32x32x16_bf16 v[64:79], a[16:19], a[120:123], v[64:79]
ds_read_b128 a[12:15], v5 offset:27648
v_exp_f32 v21, v21
v_exp_f32 v18, v18
v_mfma_f32_32x32x16_bf16 v[80:95], a[20:23], a[120:123], v[80:95]
ds_read_b128 a[16:19], v5 offset:28672
buffer_load_dwordx4 v2, s[8:11], s30 offen offset:1024 lds
v_exp_f32 v22, v22
v_exp_f32 v19, v19
v_mfma_f32_32x32x16_bf16 v[64:79], a[24:27], a[124:127], v[64:79]
ds_read_b128 a[20:23], v5 offset:29696
v_exp_f32 v23, v23
v_add_f32 v16, 1.0, v16
v_add_f32 v20, 1.0, v20
v_add_f32 v17, 1.0, v17
v_mfma_f32_32x32x16_bf16 v[80:95], a[28:31], a[124:127], v[80:95]
ds_read_b128 a[24:27], v5 offset:30720
buffer_load_dwordx4 v2, s[8:11], s30 offen offset:2048 lds
v_add_f32 v21, 1.0, v21
v_add_f32 v18, 1.0, v18
v_add_f32 v22, 1.0, v22
s_waitcnt lgkmcnt(3)
v_mfma_f32_32x32x16_bf16 v[64:79], a[0:3], a[128:131], v[64:79]
ds_read_b128 a[28:31], v5 offset:31744
v_add_f32 v19, 1.0, v19
v_add_f32 v23, 1.0, v23
v_rcp_f32 v16, v16
v_rcp_f32 v20, v20
v_mfma_f32_32x32x16_bf16 v[80:95], a[4:7], a[128:131], v[80:95]
ds_read_b128 a[0:3], v5 offset:32768
buffer_load_dwordx4 v2, s[8:11], s30 offen offset:3072 lds
v_rcp_f32 v17, v17
v_mfma_f32_32x32x16_bf16 v[64:79], a[8:11], a[132:135], v[64:79]
ds_read_b128 a[4:7], v5 offset:33792
v_rcp_f32 v21, v21
v_rcp_f32 v18, v18
v_rcp_f32 v22, v22
v_mfma_f32_32x32x16_bf16 v[80:95], a[12:15], a[132:135], v[80:95]
ds_read_b128 a[8:11], v5 offset:34816
s_add_u32 m0, s34, 77824
v_rcp_f32 v19, v19
v_mul_f32 v16, v16, v48
s_waitcnt lgkmcnt(3)
v_mfma_f32_32x32x16_bf16 v[64:79], a[16:19], a[136:139], v[64:79]
ds_read_b128 a[12:15], v5 offset:35840
v_rcp_f32 v23, v23
v_mul_f32 v20, v20, v52
v_mul_f32 v17, v17, v49
v_mul_f32 v21, v21, v53
v_mul_f32 v18, v18, v50
v_mfma_f32_32x32x16_bf16 v[80:95], a[20:23], a[136:139], v[80:95]
ds_read_b128 a[16:19], v5 offset:36864
buffer_load_dwordx4 v3, s[8:11], s30 offen lds
v_mul_f32 v22, v22, v54
v_mul_f32 v19, v19, v51
v_mul_f32 v23, v23, v55
v_mfma_f32_32x32x16_bf16 v[64:79], a[24:27], a[140:143], v[64:79]
ds_read_b128 a[20:23], v5 offset:37888
v_cvt_pk_bf16_f32 v168, v16, v17
v_cvt_pk_bf16_f32 v170, v20, v21
v_cvt_pk_bf16_f32 v169, v18, v19
v_cvt_pk_bf16_f32 v171, v22, v23
v_mul_f32 v56, v244, v56
v_mul_f32 v60, v244, v60
v_mfma_f32_32x32x16_bf16 v[80:95], a[28:31], a[140:143], v[80:95]
ds_read_b128 a[24:27], v5 offset:38912
buffer_load_dwordx4 v3, s[8:11], s30 offen offset:1024 lds
v_mul_f32 v57, v244, v57
v_mul_f32 v61, v244, v61
s_waitcnt lgkmcnt(3)
v_mfma_f32_32x32x16_bf16 v[64:79], a[0:3], a[144:147], v[64:79]
ds_read_b128 a[28:31], v5 offset:39936
v_mul_f32 v58, v244, v58
v_mul_f32 v62, v244, v62
v_mul_f32 v59, v244, v59
v_mul_f32 v63, v244, v63
v_fma_f32 v16, -v56, v56, s49
v_fma_f32 v20, -v60, v60, s49
v_mfma_f32_32x32x16_bf16 v[80:95], a[4:7], a[144:147], v[80:95]
ds_read_b128 a[0:3], v5 offset:40960
s_add_u32 s30, s30, 24576
v_fma_f32 v17, -v57, v57, s49
v_fma_f32 v21, -v61, v61, s49
v_fma_f32 v18, -v58, v58, s49
v_fma_f32 v22, -v62, v62, s49
v_mfma_f32_32x32x16_bf16 v[64:79], a[8:11], a[148:151], v[64:79]
ds_read_b128 a[4:7], v5 offset:41984
v_fma_f32 v19, -v59, v59, s49
v_fma_f32 v23, -v63, v63, s49
v_mul_f32 v16, v16, v56
v_mul_f32 v20, v20, v60
v_mul_f32 v17, v17, v57
v_mul_f32 v21, v21, v61
v_mfma_f32_32x32x16_bf16 v[80:95], a[12:15], a[148:151], v[80:95]
ds_read_b128 a[8:11], v5 offset:43008
v_mul_f32 v18, v18, v58
v_mul_f32 v22, v22, v62
v_mul_f32 v19, v19, v59
v_mul_f32 v23, v23, v63
s_waitcnt lgkmcnt(3)
v_mfma_f32_32x32x16_bf16 v[64:79], a[16:19], a[152:155], v[64:79]
ds_read_b128 a[12:15], v5 offset:44032
ds_read_b32 v248, v245 offset:1280
v_exp_f32 v16, v16
v_exp_f32 v20, v20
v_mfma_f32_32x32x16_bf16 v[80:95], a[20:23], a[152:155], v[80:95]
ds_read_b128 a[16:19], v5 offset:45056
ds_read_b32 v250, v245 offset:1408
v_exp_f32 v17, v17
v_exp_f32 v21, v21
v_mfma_f32_32x32x16_bf16 v[64:79], a[24:27], a[156:159], v[64:79]
ds_read_b128 a[20:23], v5 offset:46080
v_exp_f32 v18, v18
v_exp_f32 v22, v22
v_mfma_f32_32x32x16_bf16 v[80:95], a[28:31], a[156:159], v[80:95]
ds_read_b128 a[24:27], v5 offset:47104
v_exp_f32 v19, v19
v_exp_f32 v23, v23
v_add_f32 v16, 1.0, v16
s_waitcnt lgkmcnt(5)
v_mfma_f32_32x32x16_bf16 v[64:79], a[0:3], a[160:163], v[64:79]
ds_read_b128 a[28:31], v5 offset:48128
s_waitcnt vmcnt(18)
s_barrier
v_add_f32 v20, 1.0, v20
v_add_f32 v17, 1.0, v17
v_add_f32 v21, 1.0, v21
v_mfma_f32_32x32x16_bf16 v[80:95], a[4:7], a[160:163], v[80:95]
ds_read_b128 a[0:3], v2 offset:0
s_add_u32 m0, s34, 98304
v_add_f32 v18, 1.0, v18
v_add_f32 v22, 1.0, v22
v_add_f32 v19, 1.0, v19
v_add_f32 v23, 1.0, v23
v_mfma_f32_32x32x16_bf16 v[64:79], a[8:11], a[164:167], v[64:79]
ds_read_b128 a[4:7], v2 offset:1024
v_rcp_f32 v16, v16
v_rcp_f32 v20, v20
v_mfma_f32_32x32x16_bf16 v[80:95], a[12:15], a[164:167], v[80:95]
ds_read_b128 a[8:11], v2 offset:2048
buffer_load_dwordx4 v2, s[8:11], s30 offen lds
v_rcp_f32 v17, v17
s_waitcnt lgkmcnt(3)
v_mfma_f32_32x32x16_bf16 v[64:79], a[16:19], a[168:171], v[64:79]
ds_read_b128 a[12:15], v2 offset:3072
v_rcp_f32 v21, v21
v_rcp_f32 v18, v18
v_mfma_f32_32x32x16_bf16 v[80:95], a[20:23], a[168:171], v[80:95]
ds_read_b128 a[16:19], v2 offset:4096
buffer_load_dwordx4 v2, s[8:11], s30 offen offset:1024 lds
v_rcp_f32 v22, v22
v_rcp_f32 v19, v19
v_mfma_f32_32x32x16_bf16 v[64:79], a[24:27], a[172:175], v[64:79]
ds_read_b128 a[20:23], v2 offset:5120
v_mfma_f32_32x32x8bf16_1k v[64:79], v[248:249], v[246:247], v[64:79]
v_rcp_f32 v23, v23
v_mul_f32 v16, v16, v56
v_mul_f32 v20, v20, v60
v_mul_f32 v17, v17, v57
v_mul_f32 v21, v21, v61
v_mul_f32 v18, v18, v58
v_mul_f32 v22, v22, v62
v_mul_f32 v19, v19, v59
v_mul_f32 v23, v23, v63
v_cvt_pk_bf16_f32 v172, v16, v17
v_cvt_pk_bf16_f32 v174, v20, v21
v_cvt_pk_bf16_f32 v173, v18, v19
v_cvt_pk_bf16_f32 v175, v22, v23
v_mfma_f32_32x32x16_bf16 v[80:95], a[28:31], a[172:175], v[80:95]
ds_read_b128 a[24:27], v2 offset:6144
buffer_load_dwordx4 v2, s[8:11], s30 offen offset:2048 lds
v_mfma_f32_32x32x8bf16_1k v[80:95], v[250:251], v[246:247], v[80:95]
s_waitcnt lgkmcnt(3)
v_mfma_f32_32x32x16_bf16 v[32:47], a[0:3], a[32:35], 0
ds_read_b128 a[28:31], v2 offset:7168
v_mfma_f32_32x32x16_bf16 v[48:63], a[4:7], a[32:35], 0
ds_read_b128 a[0:3], v2 offset:8192
buffer_load_dwordx4 v2, s[8:11], s30 offen offset:3072 lds
v_mfma_f32_32x32x16_bf16 v[32:47], a[8:11], a[36:39], v[32:47]
ds_read_b128 a[4:7], v2 offset:9216
v_mfma_f32_32x32x16_bf16 v[48:63], a[12:15], a[36:39], v[48:63]
ds_read_b128 a[8:11], v2 offset:10240
s_add_u32 m0, s34, 102400
v_mul_f32 v64, v244, v64
v_mul_f32 v68, v244, v68
v_mul_f32 v65, v244, v65
v_mul_f32 v69, v244, v69
s_waitcnt lgkmcnt(3)
v_mfma_f32_32x32x16_bf16 v[32:47], a[16:19], a[40:43], v[32:47]
ds_read_b128 a[12:15], v2 offset:11264
v_mul_f32 v66, v244, v66
v_mul_f32 v70, v244, v70
v_mul_f32 v67, v244, v67
v_mul_f32 v71, v244, v71
v_fma_f32 v16, -v64, v64, s49
v_fma_f32 v20, -v68, v68, s49
v_mfma_f32_32x32x16_bf16 v[48:63], a[20:23], a[40:43], v[48:63]
ds_read_b128 a[16:19], v2 offset:12288
buffer_load_dwordx4 v3, s[8:11], s30 offen lds
v_fma_f32 v17, -v65, v65, s49
v_fma_f32 v21, -v69, v69, s49
v_fma_f32 v18, -v66, v66, s49
v_mfma_f32_32x32x16_bf16 v[32:47], a[24:27], a[44:47], v[32:47]
ds_read_b128 a[20:23], v2 offset:13312
v_fma_f32 v22, -v70, v70, s49
v_fma_f32 v19, -v67, v67, s49
v_fma_f32 v23, -v71, v71, s49
v_mul_f32 v16, v16, v64
v_mul_f32 v20, v20, v68
v_mul_f32 v17, v17, v65
v_mfma_f32_32x32x16_bf16 v[48:63], a[28:31], a[44:47], v[48:63]
ds_read_b128 a[24:27], v2 offset:14336
buffer_load_dwordx4 v3, s[8:11], s30 offen offset:1024 lds
v_mul_f32 v21, v21, v69
v_mul_f32 v18, v18, v66
s_waitcnt lgkmcnt(3)
v_mfma_f32_32x32x16_bf16 v[32:47], a[0:3], a[48:51], v[32:47]
ds_read_b128 a[28:31], v2 offset:15360
v_mul_f32 v22, v22, v70
v_mul_f32 v19, v19, v67
v_mul_f32 v23, v23, v71
v_exp_f32 v16, v16
v_mfma_f32_32x32x16_bf16 v[48:63], a[4:7], a[48:51], v[48:63]
ds_read_b128 a[0:3], v2 offset:16384
s_add_u32 s30, s30, 24576
v_exp_f32 v20, v20
v_exp_f32 v17, v17
v_mfma_f32_32x32x16_bf16 v[32:47], a[8:11], a[52:55], v[32:47]
ds_read_b128 a[4:7], v2 offset:17408
v_exp_f32 v21, v21
v_exp_f32 v18, v18
v_exp_f32 v22, v22
v_mfma_f32_32x32x16_bf16 v[48:63], a[12:15], a[52:55], v[48:63]
ds_read_b128 a[8:11], v2 offset:18432
v_exp_f32 v19, v19
v_exp_f32 v23, v23
s_waitcnt lgkmcnt(3)
v_mfma_f32_32x32x16_bf16 v[32:47], a[16:19], a[56:59], v[32:47]
ds_read_b128 a[12:15], v2 offset:19456
v_add_f32 v16, 1.0, v16
v_add_f32 v20, 1.0, v20
v_add_f32 v17, 1.0, v17
v_add_f32 v21, 1.0, v21
v_add_f32 v18, 1.0, v18
v_add_f32 v22, 1.0, v22
v_mfma_f32_32x32x16_bf16 v[48:63], a[20:23], a[56:59], v[48:63]
ds_read_b128 a[16:19], v2 offset:20480
v_add_f32 v19, 1.0, v19
v_add_f32 v23, 1.0, v23
v_rcp_f32 v16, v16
v_mfma_f32_32x32x16_bf16 v[32:47], a[24:27], a[60:63], v[32:47]
ds_read_b128 a[20:23], v2 offset:21504
v_rcp_f32 v20, v20
v_rcp_f32 v17, v17
v_rcp_f32 v21, v21
v_mfma_f32_32x32x16_bf16 v[48:63], a[28:31], a[60:63], v[48:63]
ds_read_b128 a[24:27], v2 offset:22528
v_rcp_f32 v18, v18
v_rcp_f32 v22, v22
s_waitcnt lgkmcnt(3)
v_mfma_f32_32x32x16_bf16 v[32:47], a[0:3], a[64:67], v[32:47]
ds_read_b128 a[28:31], v2 offset:23552
s_waitcnt vmcnt(18)
s_barrier
v_rcp_f32 v19, v19
v_mul_f32 v16, v16, v64
v_mfma_f32_32x32x16_bf16 v[48:63], a[4:7], a[64:67], v[48:63]
ds_read_b128 a[0:3], v2 offset:24576
s_add_u32 m0, s34, 122880
v_rcp_f32 v23, v23
v_mul_f32 v20, v20, v68
v_mul_f32 v17, v17, v65
v_mul_f32 v21, v21, v69
v_mfma_f32_32x32x16_bf16 v[32:47], a[8:11], a[68:71], v[32:47]
ds_read_b128 a[4:7], v2 offset:25600
v_mul_f32 v18, v18, v66
v_mul_f32 v22, v22, v70
v_mul_f32 v19, v19, v67
v_mul_f32 v23, v23, v71
v_cvt_pk_bf16_f32 v176, v16, v17
v_mfma_f32_32x32x16_bf16 v[48:63], a[12:15], a[68:71], v[48:63]
ds_read_b128 a[8:11], v2 offset:26624
buffer_load_dwordx4 v2, s[8:11], s30 offen lds
v_cvt_pk_bf16_f32 v178, v20, v21
v_cvt_pk_bf16_f32 v177, v18, v19
v_cvt_pk_bf16_f32 v179, v22, v23
s_waitcnt lgkmcnt(3)
v_mfma_f32_32x32x16_bf16 v[32:47], a[16:19], a[72:75], v[32:47]
ds_read_b128 a[12:15], v2 offset:27648
v_mul_f32 v72, v244, v72
v_mul_f32 v76, v244, v76
v_mul_f32 v73, v244, v73
v_mul_f32 v77, v244, v77
v_mul_f32 v74, v244, v74
v_mfma_f32_32x32x16_bf16 v[48:63], a[20:23], a[72:75], v[48:63]
ds_read_b128 a[16:19], v2 offset:28672
buffer_load_dwordx4 v2, s[8:11], s30 offen offset:1024 lds
v_mul_f32 v78, v244, v78
v_mul_f32 v75, v244, v75
v_mul_f32 v79, v244, v79
v_fma_f32 v16, -v72, v72, s49
v_mfma_f32_32x32x16_bf16 v[32:47], a[24:27], a[76:79], v[32:47]
ds_read_b128 a[20:23], v2 offset:29696
v_fma_f32 v20, -v76, v76, s49
v_fma_f32 v17, -v73, v73, s49
v_fma_f32 v21, -v77, v77, s49
v_fma_f32 v18, -v74, v74, s49
v_fma_f32 v22, -v78, v78, s49
v_mfma_f32_32x32x16_bf16 v[48:63], a[28:31], a[76:79], v[48:63]
ds_read_b128 a[24:27], v2 offset:30720
buffer_load_dwordx4 v2, s[8:11], s30 offen offset:2048 lds
v_fma_f32 v19, -v75, v75, s49
v_fma_f32 v23, -v79, v79, s49
v_mul_f32 v16, v16, v72
s_waitcnt lgkmcnt(3)
v_mfma_f32_32x32x16_bf16 v[32:47], a[0:3], a[80:83], v[32:47]
ds_read_b128 a[28:31], v2 offset:31744
v_mul_f32 v20, v20, v76
v_mul_f32 v17, v17, v73
v_mul_f32 v21, v21, v77
v_mul_f32 v18, v18, v74
v_mul_f32 v22, v22, v78
v_mfma_f32_32x32x16_bf16 v[48:63], a[4:7], a[80:83], v[48:63]
ds_read_b128 a[0:3], v2 offset:32768
buffer_load_dwordx4 v2, s[8:11], s30 offen offset:3072 lds
v_mul_f32 v19, v19, v75
v_mul_f32 v23, v23, v79
v_exp_f32 v16, v16
v_mfma_f32_32x32x16_bf16 v[32:47], a[8:11], a[84:87], v[32:47]
ds_read_b128 a[4:7], v2 offset:33792
v_exp_f32 v20, v20
v_exp_f32 v17, v17
v_exp_f32 v21, v21
v_mfma_f32_32x32x16_bf16 v[48:63], a[12:15], a[84:87], v[48:63]
ds_read_b128 a[8:11], v2 offset:34816
s_add_u32 m0, s34, 126976
v_exp_f32 v18, v18
s_waitcnt lgkmcnt(3)
v_mfma_f32_32x32x16_bf16 v[32:47], a[16:19], a[88:91], v[32:47]
ds_read_b128 a[12:15], v2 offset:35840
v_exp_f32 v22, v22
v_exp_f32 v19, v19
v_exp_f32 v23, v23
v_mfma_f32_32x32x16_bf16 v[48:63], a[20:23], a[88:91], v[48:63]
ds_read_b128 a[16:19], v2 offset:36864
buffer_load_dwordx4 v3, s[8:11], s30 offen lds
v_add_f32 v16, 1.0, v16
v_add_f32 v20, 1.0, v20
v_add_f32 v17, 1.0, v17
v_mfma_f32_32x32x16_bf16 v[32:47], a[24:27], a[92:95], v[32:47]
ds_read_b128 a[20:23], v2 offset:37888
v_add_f32 v21, 1.0, v21
v_add_f32 v18, 1.0, v18
v_add_f32 v22, 1.0, v22
v_add_f32 v19, 1.0, v19
v_add_f32 v23, 1.0, v23
v_mfma_f32_32x32x16_bf16 v[48:63], a[28:31], a[92:95], v[48:63]
ds_read_b128 a[24:27], v2 offset:38912
buffer_load_dwordx4 v3, s[8:11], s30 offen offset:1024 lds
v_rcp_f32 v16, v16
s_waitcnt lgkmcnt(3)
v_mfma_f32_32x32x16_bf16 v[32:47], a[0:3], a[96:99], v[32:47]
ds_read_b128 a[28:31], v2 offset:39936
v_rcp_f32 v20, v20
v_rcp_f32 v17, v17
v_rcp_f32 v21, v21
v_mfma_f32_32x32x16_bf16 v[48:63], a[4:7], a[96:99], v[48:63]
ds_read_b128 a[0:3], v2 offset:40960
s_add_u32 s30, s30, 24576
v_rcp_f32 v18, v18
v_rcp_f32 v22, v22
v_mfma_f32_32x32x16_bf16 v[32:47], a[8:11], a[100:103], v[32:47]
ds_read_b128 a[4:7], v2 offset:41984
v_rcp_f32 v19, v19
v_rcp_f32 v23, v23
v_mul_f32 v16, v16, v72
v_mul_f32 v20, v20, v76
v_mfma_f32_32x32x16_bf16 v[48:63], a[12:15], a[100:103], v[48:63]
ds_read_b128 a[8:11], v2 offset:43008
v_mul_f32 v17, v17, v73
v_mul_f32 v21, v21, v77
v_mul_f32 v18, v18, v74
v_mul_f32 v22, v22, v78
s_waitcnt lgkmcnt(3)
v_mfma_f32_32x32x16_bf16 v[32:47], a[16:19], a[104:107], v[32:47]
ds_read_b128 a[12:15], v2 offset:44032
v_mul_f32 v19, v19, v75
v_mul_f32 v23, v23, v79
v_cvt_pk_bf16_f32 v180, v16, v17
v_cvt_pk_bf16_f32 v182, v20, v21
v_cvt_pk_bf16_f32 v181, v18, v19
v_cvt_pk_bf16_f32 v183, v22, v23
v_mfma_f32_32x32x16_bf16 v[48:63], a[20:23], a[104:107], v[48:63]
ds_read_b128 a[16:19], v2 offset:45056
v_mul_f32 v80, v244, v80
v_mul_f32 v84, v244, v84
v_mul_f32 v81, v244, v81
v_mul_f32 v85, v244, v85
v_mul_f32 v82, v244, v82
v_mul_f32 v86, v244, v86
v_mfma_f32_32x32x16_bf16 v[32:47], a[24:27], a[108:111], v[32:47]
ds_read_b128 a[20:23], v2 offset:46080
v_mul_f32 v83, v244, v83
v_mul_f32 v87, v244, v87
v_fma_f32 v16, -v80, v80, s49
v_fma_f32 v20, -v84, v84, s49
v_fma_f32 v17, -v81, v81, s49
v_mfma_f32_32x32x16_bf16 v[48:63], a[28:31], a[108:111], v[48:63]
ds_read_b128 a[24:27], v2 offset:47104
v_fma_f32 v21, -v85, v85, s49
v_fma_f32 v18, -v82, v82, s49
v_fma_f32 v22, -v86, v86, s49
v_fma_f32 v19, -v83, v83, s49
v_fma_f32 v23, -v87, v87, s49
s_waitcnt lgkmcnt(3)
v_mfma_f32_32x32x16_bf16 v[32:47], a[0:3], a[112:115], v[32:47]
ds_read_b128 a[28:31], v2 offset:48128
s_waitcnt vmcnt(18)
s_barrier
v_mul_f32 v16, v16, v80
v_mul_f32 v20, v20, v84
v_mul_f32 v17, v17, v81
v_mfma_f32_32x32x16_bf16 v[48:63], a[4:7], a[112:115], v[48:63]
ds_read_b128 a[0:3], v4 offset:0
s_add_u32 m0, s34, 0
v_mul_f32 v21, v21, v85
v_mul_f32 v18, v18, v82
v_mul_f32 v22, v22, v86
v_mul_f32 v19, v19, v83
v_mul_f32 v23, v23, v87
v_mfma_f32_32x32x16_bf16 v[32:47], a[8:11], a[116:119], v[32:47]
ds_read_b128 a[4:7], v4 offset:1024
v_exp_f32 v16, v16
v_exp_f32 v20, v20
v_mfma_f32_32x32x16_bf16 v[48:63], a[12:15], a[116:119], v[48:63]
ds_read_b128 a[8:11], v4 offset:2048
buffer_load_dwordx4 v2, s[8:11], s30 offen lds
v_exp_f32 v17, v17
s_waitcnt lgkmcnt(3)
v_mfma_f32_32x32x16_bf16 v[32:47], a[16:19], a[120:123], v[32:47]
ds_read_b128 a[12:15], v4 offset:3072
v_exp_f32 v21, v21
v_exp_f32 v18, v18
v_mfma_f32_32x32x16_bf16 v[48:63], a[20:23], a[120:123], v[48:63]
ds_read_b128 a[16:19], v4 offset:4096
buffer_load_dwordx4 v2, s[8:11], s30 offen offset:1024 lds
v_exp_f32 v22, v22
v_exp_f32 v19, v19
v_mfma_f32_32x32x16_bf16 v[32:47], a[24:27], a[124:127], v[32:47]
ds_read_b128 a[20:23], v4 offset:5120
v_exp_f32 v23, v23
v_add_f32 v16, 1.0, v16
v_add_f32 v20, 1.0, v20
v_add_f32 v17, 1.0, v17
v_mfma_f32_32x32x16_bf16 v[48:63], a[28:31], a[124:127], v[48:63]
ds_read_b128 a[24:27], v4 offset:6144
buffer_load_dwordx4 v2, s[8:11], s30 offen offset:2048 lds
v_add_f32 v21, 1.0, v21
v_add_f32 v18, 1.0, v18
v_add_f32 v22, 1.0, v22
s_waitcnt lgkmcnt(3)
v_mfma_f32_32x32x16_bf16 v[32:47], a[0:3], a[128:131], v[32:47]
ds_read_b128 a[28:31], v4 offset:7168
v_add_f32 v19, 1.0, v19
v_add_f32 v23, 1.0, v23
v_rcp_f32 v16, v16
v_rcp_f32 v20, v20
v_mfma_f32_32x32x16_bf16 v[48:63], a[4:7], a[128:131], v[48:63]
ds_read_b128 a[0:3], v4 offset:8192
buffer_load_dwordx4 v2, s[8:11], s30 offen offset:3072 lds
v_rcp_f32 v17, v17
v_mfma_f32_32x32x16_bf16 v[32:47], a[8:11], a[132:135], v[32:47]
ds_read_b128 a[4:7], v4 offset:9216
v_rcp_f32 v21, v21
v_rcp_f32 v18, v18
v_rcp_f32 v22, v22
v_mfma_f32_32x32x16_bf16 v[48:63], a[12:15], a[132:135], v[48:63]
ds_read_b128 a[8:11], v4 offset:10240
s_add_u32 m0, s34, 4096
v_rcp_f32 v19, v19
v_mul_f32 v16, v16, v80
s_waitcnt lgkmcnt(3)
v_mfma_f32_32x32x16_bf16 v[32:47], a[16:19], a[136:139], v[32:47]
ds_read_b128 a[12:15], v4 offset:11264
v_rcp_f32 v23, v23
v_mul_f32 v20, v20, v84
v_mul_f32 v17, v17, v81
v_mul_f32 v21, v21, v85
v_mul_f32 v18, v18, v82
v_mfma_f32_32x32x16_bf16 v[48:63], a[20:23], a[136:139], v[48:63]
ds_read_b128 a[16:19], v4 offset:12288
buffer_load_dwordx4 v3, s[8:11], s30 offen lds
v_mul_f32 v22, v22, v86
v_mul_f32 v19, v19, v83
v_mul_f32 v23, v23, v87
v_mfma_f32_32x32x16_bf16 v[32:47], a[24:27], a[140:143], v[32:47]
ds_read_b128 a[20:23], v4 offset:13312
v_cvt_pk_bf16_f32 v184, v16, v17
v_cvt_pk_bf16_f32 v186, v20, v21
v_cvt_pk_bf16_f32 v185, v18, v19
v_cvt_pk_bf16_f32 v187, v22, v23
v_mul_f32 v88, v244, v88
v_mul_f32 v92, v244, v92
v_mfma_f32_32x32x16_bf16 v[48:63], a[28:31], a[140:143], v[48:63]
ds_read_b128 a[24:27], v4 offset:14336
buffer_load_dwordx4 v3, s[8:11], s30 offen offset:1024 lds
v_mul_f32 v89, v244, v89
v_mul_f32 v93, v244, v93
s_waitcnt lgkmcnt(3)
v_mfma_f32_32x32x16_bf16 v[32:47], a[0:3], a[144:147], v[32:47]
ds_read_b128 a[28:31], v4 offset:15360
v_mul_f32 v90, v244, v90
v_mul_f32 v94, v244, v94
v_mul_f32 v91, v244, v91
v_mul_f32 v95, v244, v95
v_fma_f32 v16, -v88, v88, s49
v_fma_f32 v20, -v92, v92, s49
v_mfma_f32_32x32x16_bf16 v[48:63], a[4:7], a[144:147], v[48:63]
ds_read_b128 a[0:3], v4 offset:16384
s_add_u32 s30, s30, 24576
v_fma_f32 v17, -v89, v89, s49
v_fma_f32 v21, -v93, v93, s49
v_fma_f32 v18, -v90, v90, s49
v_fma_f32 v22, -v94, v94, s49
v_mfma_f32_32x32x16_bf16 v[32:47], a[8:11], a[148:151], v[32:47]
ds_read_b128 a[4:7], v4 offset:17408
v_fma_f32 v19, -v91, v91, s49
v_fma_f32 v23, -v95, v95, s49
v_mul_f32 v16, v16, v88
v_mul_f32 v20, v20, v92
v_mul_f32 v17, v17, v89
v_mul_f32 v21, v21, v93
v_mfma_f32_32x32x16_bf16 v[48:63], a[12:15], a[148:151], v[48:63]
ds_read_b128 a[8:11], v4 offset:18432
v_mul_f32 v18, v18, v90
v_mul_f32 v22, v22, v94
v_mul_f32 v19, v19, v91
v_mul_f32 v23, v23, v95
s_waitcnt lgkmcnt(3)
v_mfma_f32_32x32x16_bf16 v[32:47], a[16:19], a[152:155], v[32:47]
ds_read_b128 a[12:15], v4 offset:19456
ds_read_b32 v248, v245 offset:1536
v_exp_f32 v16, v16
v_exp_f32 v20, v20
v_mfma_f32_32x32x16_bf16 v[48:63], a[20:23], a[152:155], v[48:63]
ds_read_b128 a[16:19], v4 offset:20480
ds_read_b32 v250, v245 offset:1664
v_exp_f32 v17, v17
v_exp_f32 v21, v21
v_mfma_f32_32x32x16_bf16 v[32:47], a[24:27], a[156:159], v[32:47]
ds_read_b128 a[20:23], v4 offset:21504
v_exp_f32 v18, v18
v_exp_f32 v22, v22
v_mfma_f32_32x32x16_bf16 v[48:63], a[28:31], a[156:159], v[48:63]
ds_read_b128 a[24:27], v4 offset:22528
v_exp_f32 v19, v19
v_exp_f32 v23, v23
v_add_f32 v16, 1.0, v16
s_waitcnt lgkmcnt(5)
v_mfma_f32_32x32x16_bf16 v[32:47], a[0:3], a[160:163], v[32:47]
ds_read_b128 a[28:31], v4 offset:23552
s_waitcnt vmcnt(18)
s_barrier
v_add_f32 v20, 1.0, v20
v_add_f32 v17, 1.0, v17
v_add_f32 v21, 1.0, v21
v_mfma_f32_32x32x16_bf16 v[48:63], a[4:7], a[160:163], v[48:63]
ds_read_b128 a[0:3], v4 offset:24576
s_add_u32 m0, s34, 24576
v_add_f32 v18, 1.0, v18
v_add_f32 v22, 1.0, v22
v_add_f32 v19, 1.0, v19
v_add_f32 v23, 1.0, v23
v_mfma_f32_32x32x16_bf16 v[32:47], a[8:11], a[164:167], v[32:47]
ds_read_b128 a[4:7], v4 offset:25600
v_rcp_f32 v16, v16
v_rcp_f32 v20, v20
v_mfma_f32_32x32x16_bf16 v[48:63], a[12:15], a[164:167], v[48:63]
ds_read_b128 a[8:11], v4 offset:26624
buffer_load_dwordx4 v2, s[8:11], s30 offen lds
v_rcp_f32 v17, v17
s_waitcnt lgkmcnt(3)
v_mfma_f32_32x32x16_bf16 v[32:47], a[16:19], a[168:171], v[32:47]
ds_read_b128 a[12:15], v4 offset:27648
v_rcp_f32 v21, v21
v_rcp_f32 v18, v18
v_mfma_f32_32x32x16_bf16 v[48:63], a[20:23], a[168:171], v[48:63]
ds_read_b128 a[16:19], v4 offset:28672
buffer_load_dwordx4 v2, s[8:11], s30 offen offset:1024 lds
v_rcp_f32 v22, v22
v_rcp_f32 v19, v19
v_mfma_f32_32x32x16_bf16 v[32:47], a[24:27], a[172:175], v[32:47]
ds_read_b128 a[20:23], v4 offset:29696
v_mfma_f32_32x32x8bf16_1k v[32:47], v[248:249], v[246:247], v[32:47]
v_rcp_f32 v23, v23
v_mul_f32 v16, v16, v88
v_mul_f32 v20, v20, v92
v_mul_f32 v17, v17, v89
v_mul_f32 v21, v21, v93
v_mul_f32 v18, v18, v90
v_mul_f32 v22, v22, v94
v_mul_f32 v19, v19, v91
v_mul_f32 v23, v23, v95
v_cvt_pk_bf16_f32 v188, v16, v17
v_cvt_pk_bf16_f32 v190, v20, v21
v_cvt_pk_bf16_f32 v189, v18, v19
v_cvt_pk_bf16_f32 v191, v22, v23
v_mfma_f32_32x32x16_bf16 v[48:63], a[28:31], a[172:175], v[48:63]
ds_read_b128 a[24:27], v4 offset:30720
buffer_load_dwordx4 v2, s[8:11], s30 offen offset:2048 lds
v_mfma_f32_32x32x8bf16_1k v[48:63], v[250:251], v[246:247], v[48:63]
s_waitcnt lgkmcnt(3)
v_mfma_f32_32x32x16_bf16 v[64:79], a[0:3], a[32:35], 0
ds_read_b128 a[28:31], v4 offset:31744
v_mfma_f32_32x32x16_bf16 v[80:95], a[4:7], a[32:35], 0
ds_read_b128 a[0:3], v4 offset:32768
buffer_load_dwordx4 v2, s[8:11], s30 offen offset:3072 lds
v_mfma_f32_32x32x16_bf16 v[64:79], a[8:11], a[36:39], v[64:79]
ds_read_b128 a[4:7], v4 offset:33792
v_mfma_f32_32x32x16_bf16 v[80:95], a[12:15], a[36:39], v[80:95]
ds_read_b128 a[8:11], v4 offset:34816
s_add_u32 m0, s34, 28672
v_mul_f32 v32, v244, v32
v_mul_f32 v36, v244, v36
v_mul_f32 v33, v244, v33
v_mul_f32 v37, v244, v37
s_waitcnt lgkmcnt(3)
v_mfma_f32_32x32x16_bf16 v[64:79], a[16:19], a[40:43], v[64:79]
ds_read_b128 a[12:15], v4 offset:35840
v_mul_f32 v34, v244, v34
v_mul_f32 v38, v244, v38
v_mul_f32 v35, v244, v35
v_mul_f32 v39, v244, v39
v_fma_f32 v16, -v32, v32, s49
v_fma_f32 v20, -v36, v36, s49
v_mfma_f32_32x32x16_bf16 v[80:95], a[20:23], a[40:43], v[80:95]
ds_read_b128 a[16:19], v4 offset:36864
buffer_load_dwordx4 v3, s[8:11], s30 offen lds
v_fma_f32 v17, -v33, v33, s49
v_fma_f32 v21, -v37, v37, s49
v_fma_f32 v18, -v34, v34, s49
v_mfma_f32_32x32x16_bf16 v[64:79], a[24:27], a[44:47], v[64:79]
ds_read_b128 a[20:23], v4 offset:37888
v_fma_f32 v22, -v38, v38, s49
v_fma_f32 v19, -v35, v35, s49
v_fma_f32 v23, -v39, v39, s49
v_mul_f32 v16, v16, v32
v_mul_f32 v20, v20, v36
v_mul_f32 v17, v17, v33
v_mfma_f32_32x32x16_bf16 v[80:95], a[28:31], a[44:47], v[80:95]
ds_read_b128 a[24:27], v4 offset:38912
buffer_load_dwordx4 v3, s[8:11], s30 offen offset:1024 lds
v_mul_f32 v21, v21, v37
v_mul_f32 v18, v18, v34
s_waitcnt lgkmcnt(3)
v_mfma_f32_32x32x16_bf16 v[64:79], a[0:3], a[48:51], v[64:79]
ds_read_b128 a[28:31], v4 offset:39936
v_mul_f32 v22, v22, v38
v_mul_f32 v19, v19, v35
v_mul_f32 v23, v23, v39
v_exp_f32 v16, v16
v_mfma_f32_32x32x16_bf16 v[80:95], a[4:7], a[48:51], v[80:95]
ds_read_b128 a[0:3], v4 offset:40960
s_add_u32 s30, s30, 24576
v_exp_f32 v20, v20
v_exp_f32 v17, v17
v_mfma_f32_32x32x16_bf16 v[64:79], a[8:11], a[52:55], v[64:79]
ds_read_b128 a[4:7], v4 offset:41984
v_exp_f32 v21, v21
v_exp_f32 v18, v18
v_mfma_f32_32x32x16_bf16 v[80:95], a[12:15], a[52:55], v[80:95]
ds_read_b128 a[8:11], v4 offset:43008
v_exp_f32 v22, v22
v_exp_f32 v19, v19
v_add_f32 v16, 1.0, v16
s_waitcnt lgkmcnt(3)
v_mfma_f32_32x32x16_bf16 v[64:79], a[16:19], a[56:59], v[64:79]
ds_read_b128 a[12:15], v4 offset:44032
v_exp_f32 v23, v23
v_add_f32 v20, 1.0, v20
v_add_f32 v17, 1.0, v17
v_add_f32 v21, 1.0, v21
v_mfma_f32_32x32x16_bf16 v[80:95], a[20:23], a[56:59], v[80:95]
ds_read_b128 a[16:19], v4 offset:45056
v_add_f32 v18, 1.0, v18
v_add_f32 v22, 1.0, v22
v_add_f32 v19, 1.0, v19
v_add_f32 v23, 1.0, v23
v_rcp_f32 v16, v16
v_mfma_f32_32x32x16_bf16 v[64:79], a[24:27], a[60:63], v[64:79]
ds_read_b128 a[20:23], v4 offset:46080
v_rcp_f32 v20, v20
v_rcp_f32 v17, v17
v_mfma_f32_32x32x16_bf16 v[80:95], a[28:31], a[60:63], v[80:95]
ds_read_b128 a[24:27], v4 offset:47104
v_rcp_f32 v21, v21
v_rcp_f32 v18, v18
s_waitcnt lgkmcnt(3)
v_mfma_f32_32x32x16_bf16 v[64:79], a[0:3], a[64:67], v[64:79]
ds_read_b128 a[28:31], v4 offset:48128
s_waitcnt vmcnt(18)
s_barrier
v_rcp_f32 v22, v22
v_rcp_f32 v19, v19
v_mfma_f32_32x32x16_bf16 v[80:95], a[4:7], a[64:67], v[80:95]
ds_read_b128 a[0:3], v5 offset:0
s_add_u32 m0, s34, 49152
v_rcp_f32 v23, v23
v_mul_f32 v16, v16, v32
v_mul_f32 v20, v20, v36
v_mfma_f32_32x32x16_bf16 v[64:79], a[8:11], a[68:71], v[64:79]
ds_read_b128 a[4:7], v5 offset:1024
v_mul_f32 v17, v17, v33
v_mul_f32 v21, v21, v37
v_mul_f32 v18, v18, v34
v_mul_f32 v22, v22, v38
v_mul_f32 v19, v19, v35
v_mul_f32 v23, v23, v39
v_mfma_f32_32x32x16_bf16 v[80:95], a[12:15], a[68:71], v[80:95]
ds_read_b128 a[8:11], v5 offset:2048
buffer_load_dwordx4 v2, s[8:11], s30 offen lds
v_cvt_pk_bf16_f32 v192, v16, v17
v_cvt_pk_bf16_f32 v194, v20, v21
s_waitcnt lgkmcnt(3)
v_mfma_f32_32x32x16_bf16 v[64:79], a[16:19], a[72:75], v[64:79]
ds_read_b128 a[12:15], v5 offset:3072
v_cvt_pk_bf16_f32 v193, v18, v19
v_cvt_pk_bf16_f32 v195, v22, v23
v_mul_f32 v40, v244, v40
v_mul_f32 v44, v244, v44
v_mul_f32 v41, v244, v41
v_mul_f32 v45, v244, v45
v_mfma_f32_32x32x16_bf16 v[80:95], a[20:23], a[72:75], v[80:95]
ds_read_b128 a[16:19], v5 offset:4096
buffer_load_dwordx4 v2, s[8:11], s30 offen offset:1024 lds
v_mul_f32 v42, v244, v42
v_mul_f32 v46, v244, v46
v_mul_f32 v43, v244, v43
v_mfma_f32_32x32x16_bf16 v[64:79], a[24:27], a[76:79], v[64:79]
ds_read_b128 a[20:23], v5 offset:5120
v_mul_f32 v47, v244, v47
v_fma_f32 v16, -v40, v40, s49
v_fma_f32 v20, -v44, v44, s49
v_fma_f32 v17, -v41, v41, s49
v_fma_f32 v21, -v45, v45, s49
v_fma_f32 v18, -v42, v42, s49
v_mfma_f32_32x32x16_bf16 v[80:95], a[28:31], a[76:79], v[80:95]
ds_read_b128 a[24:27], v5 offset:6144
buffer_load_dwordx4 v2, s[8:11], s30 offen offset:2048 lds
v_fma_f32 v22, -v46, v46, s49
v_fma_f32 v19, -v43, v43, s49
v_fma_f32 v23, -v47, v47, s49
s_waitcnt lgkmcnt(3)
v_mfma_f32_32x32x16_bf16 v[64:79], a[0:3], a[80:83], v[64:79]
ds_read_b128 a[28:31], v5 offset:7168
v_mul_f32 v16, v16, v40
v_mul_f32 v20, v20, v44
v_mul_f32 v17, v17, v41
v_mul_f32 v21, v21, v45
v_mul_f32 v18, v18, v42
v_mfma_f32_32x32x16_bf16 v[80:95], a[4:7], a[80:83], v[80:95]
ds_read_b128 a[0:3], v5 offset:8192
buffer_load_dwordx4 v2, s[8:11], s30 offen offset:3072 lds
v_mul_f32 v22, v22, v46
v_mul_f32 v19, v19, v43
v_mul_f32 v23, v23, v47
v_mfma_f32_32x32x16_bf16 v[64:79], a[8:11], a[84:87], v[64:79]
ds_read_b128 a[4:7], v5 offset:9216
v_exp_f32 v16, v16
v_exp_f32 v20, v20
v_mfma_f32_32x32x16_bf16 v[80:95], a[12:15], a[84:87], v[80:95]
ds_read_b128 a[8:11], v5 offset:10240
s_add_u32 m0, s34, 53248
v_exp_f32 v17, v17
v_exp_f32 v21, v21
s_waitcnt lgkmcnt(3)
v_mfma_f32_32x32x16_bf16 v[64:79], a[16:19], a[88:91], v[64:79]
ds_read_b128 a[12:15], v5 offset:11264
v_exp_f32 v18, v18
v_exp_f32 v22, v22
v_mfma_f32_32x32x16_bf16 v[80:95], a[20:23], a[88:91], v[80:95]
ds_read_b128 a[16:19], v5 offset:12288
buffer_load_dwordx4 v3, s[8:11], s30 offen lds
v_exp_f32 v19, v19
v_exp_f32 v23, v23
v_mfma_f32_32x32x16_bf16 v[64:79], a[24:27], a[92:95], v[64:79]
ds_read_b128 a[20:23], v5 offset:13312
v_add_f32 v16, 1.0, v16
v_add_f32 v20, 1.0, v20
v_add_f32 v17, 1.0, v17
v_add_f32 v21, 1.0, v21
v_add_f32 v18, 1.0, v18
v_add_f32 v22, 1.0, v22
v_mfma_f32_32x32x16_bf16 v[80:95], a[28:31], a[92:95], v[80:95]
ds_read_b128 a[24:27], v5 offset:14336
buffer_load_dwordx4 v3, s[8:11], s30 offen offset:1024 lds
v_add_f32 v19, 1.0, v19
v_add_f32 v23, 1.0, v23
s_waitcnt lgkmcnt(3)
v_mfma_f32_32x32x16_bf16 v[64:79], a[0:3], a[96:99], v[64:79]
ds_read_b128 a[28:31], v5 offset:15360
v_rcp_f32 v16, v16
v_rcp_f32 v20, v20
v_rcp_f32 v17, v17
v_mfma_f32_32x32x16_bf16 v[80:95], a[4:7], a[96:99], v[80:95]
ds_read_b128 a[0:3], v5 offset:16384
s_mov_b32 s30, s38
v_rcp_f32 v21, v21
v_rcp_f32 v18, v18
v_mfma_f32_32x32x16_bf16 v[64:79], a[8:11], a[100:103], v[64:79]
ds_read_b128 a[4:7], v5 offset:17408
v_rcp_f32 v22, v22
v_rcp_f32 v19, v19
v_rcp_f32 v23, v23
v_mfma_f32_32x32x16_bf16 v[80:95], a[12:15], a[100:103], v[80:95]
ds_read_b128 a[8:11], v5 offset:18432
s_add_u32 s31, s38, 27648
v_mul_f32 v16, v16, v40
v_mul_f32 v20, v20, v44
v_mul_f32 v17, v17, v41
s_waitcnt lgkmcnt(3)
v_mfma_f32_32x32x16_bf16 v[64:79], a[16:19], a[104:107], v[64:79]
ds_read_b128 a[12:15], v5 offset:19456
v_mul_f32 v21, v21, v45
v_mul_f32 v18, v18, v42
v_mul_f32 v22, v22, v46
v_mul_f32 v19, v19, v43
v_mul_f32 v23, v23, v47
v_cvt_pk_bf16_f32 v196, v16, v17
v_mfma_f32_32x32x16_bf16 v[80:95], a[20:23], a[104:107], v[80:95]
ds_read_b128 a[16:19], v5 offset:20480
v_cvt_pk_bf16_f32 v198, v20, v21
v_cvt_pk_bf16_f32 v197, v18, v19
v_cvt_pk_bf16_f32 v199, v22, v23
v_mul_f32 v48, v244, v48
v_mul_f32 v52, v244, v52
v_mul_f32 v49, v244, v49
v_mfma_f32_32x32x16_bf16 v[64:79], a[24:27], a[108:111], v[64:79]
ds_read_b128 a[20:23], v5 offset:21504
v_mul_f32 v53, v244, v53
v_mul_f32 v50, v244, v50
v_mul_f32 v54, v244, v54
v_mul_f32 v51, v244, v51
v_mul_f32 v55, v244, v55
v_mfma_f32_32x32x16_bf16 v[80:95], a[28:31], a[108:111], v[80:95]
ds_read_b128 a[24:27], v5 offset:22528
v_fma_f32 v16, -v48, v48, s49
v_fma_f32 v20, -v52, v52, s49
v_fma_f32 v17, -v49, v49, s49
v_fma_f32 v21, -v53, v53, s49
v_fma_f32 v18, -v50, v50, s49
s_waitcnt lgkmcnt(3)
v_mfma_f32_32x32x16_bf16 v[64:79], a[0:3], a[112:115], v[64:79]
ds_read_b128 a[28:31], v5 offset:23552
s_waitcnt vmcnt(18)
s_barrier
v_fma_f32 v22, -v54, v54, s49
v_fma_f32 v19, -v51, v51, s49
v_fma_f32 v23, -v55, v55, s49
v_mfma_f32_32x32x16_bf16 v[80:95], a[4:7], a[112:115], v[80:95]
ds_read_b128 a[0:3], v5 offset:24576
s_add_u32 m0, s34, 73728
v_mul_f32 v16, v16, v48
v_mul_f32 v20, v20, v52
v_mul_f32 v17, v17, v49
v_mul_f32 v21, v21, v53
v_mul_f32 v18, v18, v50
v_mfma_f32_32x32x16_bf16 v[64:79], a[8:11], a[116:119], v[64:79]
ds_read_b128 a[4:7], v5 offset:25600
v_mul_f32 v22, v22, v54
v_mul_f32 v19, v19, v51
v_mul_f32 v23, v23, v55
v_exp_f32 v16, v16
v_mfma_f32_32x32x16_bf16 v[80:95], a[12:15], a[116:119], v[80:95]
ds_read_b128 a[8:11], v5 offset:26624
buffer_load_dwordx4 v6, s[12:15], s30 offen lds
v_exp_f32 v20, v20
s_waitcnt lgkmcnt(3)
v_mfma_f32_32x32x16_bf16 v[64:79], a[16:19], a[120:123], v[64:79]
ds_read_b128 a[12:15], v5 offset:27648
v_exp_f32 v17, v17
v_exp_f32 v21, v21
v_exp_f32 v18, v18
v_mfma_f32_32x32x16_bf16 v[80:95], a[20:23], a[120:123], v[80:95]
ds_read_b128 a[16:19], v5 offset:28672
buffer_load_dwordx4 v7, s[12:15], s30 offen offset:1024 lds
v_exp_f32 v22, v22
v_mfma_f32_32x32x16_bf16 v[64:79], a[24:27], a[124:127], v[64:79]
ds_read_b128 a[20:23], v5 offset:29696
v_exp_f32 v19, v19
v_exp_f32 v23, v23
v_add_f32 v16, 1.0, v16
v_add_f32 v20, 1.0, v20
v_mfma_f32_32x32x16_bf16 v[80:95], a[28:31], a[124:127], v[80:95]
ds_read_b128 a[24:27], v5 offset:30720
buffer_load_dwordx4 v8, s[12:15], s30 offen offset:2048 lds
v_add_f32 v17, 1.0, v17
v_add_f32 v21, 1.0, v21
s_waitcnt lgkmcnt(3)
v_mfma_f32_32x32x16_bf16 v[64:79], a[0:3], a[128:131], v[64:79]
ds_read_b128 a[28:31], v5 offset:31744
v_add_f32 v18, 1.0, v18
v_add_f32 v22, 1.0, v22
v_add_f32 v19, 1.0, v19
v_add_f32 v23, 1.0, v23
v_rcp_f32 v16, v16
v_mfma_f32_32x32x16_bf16 v[80:95], a[4:7], a[128:131], v[80:95]
ds_read_b128 a[0:3], v5 offset:32768
s_add_u32 m0, s34, 76800
v_rcp_f32 v20, v20
v_rcp_f32 v17, v17
v_mfma_f32_32x32x16_bf16 v[64:79], a[8:11], a[132:135], v[64:79]
ds_read_b128 a[4:7], v5 offset:33792
v_rcp_f32 v21, v21
v_rcp_f32 v18, v18
v_rcp_f32 v22, v22
v_mfma_f32_32x32x16_bf16 v[80:95], a[12:15], a[132:135], v[80:95]
ds_read_b128 a[8:11], v5 offset:34816
buffer_load_dwordx4 v6, s[12:15], s31 offen lds
v_rcp_f32 v19, v19
v_mul_f32 v16, v16, v48
s_waitcnt lgkmcnt(3)
v_mfma_f32_32x32x16_bf16 v[64:79], a[16:19], a[136:139], v[64:79]
ds_read_b128 a[12:15], v5 offset:35840
v_rcp_f32 v23, v23
v_mul_f32 v20, v20, v52
v_mul_f32 v17, v17, v49
v_mul_f32 v21, v21, v53
v_mfma_f32_32x32x16_bf16 v[80:95], a[20:23], a[136:139], v[80:95]
ds_read_b128 a[16:19], v5 offset:36864
buffer_load_dwordx4 v7, s[12:15], s31 offen offset:1024 lds
v_mul_f32 v18, v18, v50
v_mul_f32 v22, v22, v54
v_mul_f32 v19, v19, v51
v_mul_f32 v23, v23, v55
v_mfma_f32_32x32x16_bf16 v[64:79], a[24:27], a[140:143], v[64:79]
ds_read_b128 a[20:23], v5 offset:37888
v_cvt_pk_bf16_f32 v200, v16, v17
v_cvt_pk_bf16_f32 v202, v20, v21
v_cvt_pk_bf16_f32 v201, v18, v19
v_cvt_pk_bf16_f32 v203, v22, v23
v_mul_f32 v56, v244, v56
v_mfma_f32_32x32x16_bf16 v[80:95], a[28:31], a[140:143], v[80:95]
ds_read_b128 a[24:27], v5 offset:38912
buffer_load_dwordx4 v8, s[12:15], s31 offen offset:2048 lds
v_mul_f32 v60, v244, v60
v_mul_f32 v57, v244, v57
v_mul_f32 v61, v244, v61
s_waitcnt lgkmcnt(3)
v_mfma_f32_32x32x16_bf16 v[64:79], a[0:3], a[144:147], v[64:79]
ds_read_b128 a[28:31], v5 offset:39936
v_mul_f32 v58, v244, v58
v_mul_f32 v62, v244, v62
v_mul_f32 v59, v244, v59
v_mul_f32 v63, v244, v63
v_fma_f32 v16, -v56, v56, s49
v_mfma_f32_32x32x16_bf16 v[80:95], a[4:7], a[144:147], v[80:95]
ds_read_b128 a[0:3], v5 offset:40960
s_add_u32 s30, s30, 0x36000
v_fma_f32 v20, -v60, v60, s49
v_fma_f32 v17, -v57, v57, s49
v_fma_f32 v21, -v61, v61, s49
v_fma_f32 v18, -v58, v58, s49
v_fma_f32 v22, -v62, v62, s49
v_mfma_f32_32x32x16_bf16 v[64:79], a[8:11], a[148:151], v[64:79]
ds_read_b128 a[4:7], v5 offset:41984
v_fma_f32 v19, -v59, v59, s49
v_fma_f32 v23, -v63, v63, s49
v_mul_f32 v16, v16, v56
v_mul_f32 v20, v20, v60
v_mul_f32 v17, v17, v57
v_mul_f32 v21, v21, v61
v_mfma_f32_32x32x16_bf16 v[80:95], a[12:15], a[148:151], v[80:95]
ds_read_b128 a[8:11], v5 offset:43008
s_add_u32 s31, s31, 0x36000
v_mul_f32 v18, v18, v58
v_mul_f32 v22, v22, v62
v_mul_f32 v19, v19, v59
s_waitcnt lgkmcnt(3)
v_mfma_f32_32x32x16_bf16 v[64:79], a[16:19], a[152:155], v[64:79]
ds_read_b128 a[12:15], v5 offset:44032
ds_read_b32 v248, v245 offset:1792
v_mul_f32 v23, v23, v63
v_exp_f32 v16, v16
v_exp_f32 v20, v20
v_mfma_f32_32x32x16_bf16 v[80:95], a[20:23], a[152:155], v[80:95]
ds_read_b128 a[16:19], v5 offset:45056
ds_read_b32 v250, v245 offset:1920
v_exp_f32 v17, v17
v_exp_f32 v21, v21
v_mfma_f32_32x32x16_bf16 v[64:79], a[24:27], a[156:159], v[64:79]
ds_read_b128 a[20:23], v5 offset:46080
v_exp_f32 v18, v18
v_exp_f32 v22, v22
v_exp_f32 v19, v19
v_mfma_f32_32x32x16_bf16 v[80:95], a[28:31], a[156:159], v[80:95]
ds_read_b128 a[24:27], v5 offset:47104
v_exp_f32 v23, v23
v_add_f32 v16, 1.0, v16
v_add_f32 v20, 1.0, v20
s_waitcnt lgkmcnt(5)
v_mfma_f32_32x32x16_bf16 v[64:79], a[0:3], a[160:163], v[64:79]
ds_read_b128 a[28:31], v5 offset:48128
s_waitcnt vmcnt(18)
s_barrier
v_add_f32 v17, 1.0, v17
v_add_f32 v21, 1.0, v21
v_add_f32 v18, 1.0, v18
v_add_f32 v22, 1.0, v22
v_mfma_f32_32x32x16_bf16 v[80:95], a[4:7], a[160:163], v[80:95]
ds_read_b128 a[0:3], v2 offset:0
s_add_u32 m0, s34, 98304
v_add_f32 v19, 1.0, v19
v_add_f32 v23, 1.0, v23
v_rcp_f32 v16, v16
v_mfma_f32_32x32x16_bf16 v[64:79], a[8:11], a[164:167], v[64:79]
ds_read_b128 a[4:7], v2 offset:1024
v_rcp_f32 v20, v20
v_rcp_f32 v17, v17
v_mfma_f32_32x32x16_bf16 v[80:95], a[12:15], a[164:167], v[80:95]
ds_read_b128 a[8:11], v2 offset:2048
buffer_load_dwordx4 v6, s[12:15], s30 offen lds
v_rcp_f32 v21, v21
s_waitcnt lgkmcnt(3)
v_mfma_f32_32x32x16_bf16 v[64:79], a[16:19], a[168:171], v[64:79]
ds_read_b128 a[12:15], v2 offset:3072
v_rcp_f32 v18, v18
v_rcp_f32 v22, v22
v_mfma_f32_32x32x16_bf16 v[80:95], a[20:23], a[168:171], v[80:95]
ds_read_b128 a[16:19], v2 offset:4096
buffer_load_dwordx4 v7, s[12:15], s30 offen offset:1024 lds
v_rcp_f32 v19, v19
v_rcp_f32 v23, v23
v_mfma_f32_32x32x16_bf16 v[64:79], a[24:27], a[172:175], v[64:79]
ds_read_b128 a[20:23], v2 offset:5120
v_mfma_f32_32x32x8bf16_1k v[64:79], v[248:249], v[246:247], v[64:79]
v_mul_f32 v16, v16, v56
v_mul_f32 v20, v20, v60
v_mul_f32 v17, v17, v57
v_mul_f32 v21, v21, v61
v_mul_f32 v18, v18, v58
v_mul_f32 v22, v22, v62
v_mul_f32 v19, v19, v59
v_mul_f32 v23, v23, v63
v_cvt_pk_bf16_f32 v204, v16, v17
v_cvt_pk_bf16_f32 v206, v20, v21
v_cvt_pk_bf16_f32 v205, v18, v19
v_cvt_pk_bf16_f32 v207, v22, v23
v_mfma_f32_32x32x16_bf16 v[80:95], a[28:31], a[172:175], v[80:95]
ds_read_b128 a[24:27], v2 offset:6144
buffer_load_dwordx4 v8, s[12:15], s30 offen offset:2048 lds
v_mfma_f32_32x32x8bf16_1k v[80:95], v[250:251], v[246:247], v[80:95]
s_waitcnt lgkmcnt(3)
v_mfma_f32_32x32x16_bf16 v[32:47], a[0:3], a[32:35], 0
ds_read_b128 a[28:31], v2 offset:7168
v_mfma_f32_32x32x16_bf16 v[48:63], a[4:7], a[32:35], 0
ds_read_b128 a[0:3], v2 offset:8192
s_add_u32 m0, s34, 101376
v_mfma_f32_32x32x16_bf16 v[32:47], a[8:11], a[36:39], v[32:47]
ds_read_b128 a[4:7], v2 offset:9216
v_mfma_f32_32x32x16_bf16 v[48:63], a[12:15], a[36:39], v[48:63]
ds_read_b128 a[8:11], v2 offset:10240
buffer_load_dwordx4 v6, s[12:15], s31 offen lds
v_mul_f32 v64, v244, v64
v_mul_f32 v68, v244, v68
v_mul_f32 v65, v244, v65
s_waitcnt lgkmcnt(3)
v_mfma_f32_32x32x16_bf16 v[32:47], a[16:19], a[40:43], v[32:47]
ds_read_b128 a[12:15], v2 offset:11264
v_mul_f32 v69, v244, v69
v_mul_f32 v66, v244, v66
v_mul_f32 v70, v244, v70
v_mul_f32 v67, v244, v67
v_mul_f32 v71, v244, v71
v_fma_f32 v16, -v64, v64, s49
v_mfma_f32_32x32x16_bf16 v[48:63], a[20:23], a[40:43], v[48:63]
ds_read_b128 a[16:19], v2 offset:12288
buffer_load_dwordx4 v7, s[12:15], s31 offen offset:1024 lds
v_fma_f32 v20, -v68, v68, s49
v_fma_f32 v17, -v65, v65, s49
v_fma_f32 v21, -v69, v69, s49
v_fma_f32 v18, -v66, v66, s49
v_mfma_f32_32x32x16_bf16 v[32:47], a[24:27], a[44:47], v[32:47]
ds_read_b128 a[20:23], v2 offset:13312
v_fma_f32 v22, -v70, v70, s49
v_fma_f32 v19, -v67, v67, s49
v_fma_f32 v23, -v71, v71, s49
v_mul_f32 v16, v16, v64
v_mul_f32 v20, v20, v68
v_mfma_f32_32x32x16_bf16 v[48:63], a[28:31], a[44:47], v[48:63]
ds_read_b128 a[24:27], v2 offset:14336
buffer_load_dwordx4 v8, s[12:15], s31 offen offset:2048 lds
v_mul_f32 v17, v17, v65
v_mul_f32 v21, v21, v69
v_mul_f32 v18, v18, v66
s_waitcnt lgkmcnt(3)
v_mfma_f32_32x32x16_bf16 v[32:47], a[0:3], a[48:51], v[32:47]
ds_read_b128 a[28:31], v2 offset:15360
v_mul_f32 v22, v22, v70
v_mul_f32 v19, v19, v67
v_mul_f32 v23, v23, v71
v_exp_f32 v16, v16
v_mfma_f32_32x32x16_bf16 v[48:63], a[4:7], a[48:51], v[48:63]
ds_read_b128 a[0:3], v2 offset:16384
s_add_u32 s30, s30, 0x36000
v_exp_f32 v20, v20
v_exp_f32 v17, v17
v_mfma_f32_32x32x16_bf16 v[32:47], a[8:11], a[52:55], v[32:47]
ds_read_b128 a[4:7], v2 offset:17408
v_exp_f32 v21, v21
v_exp_f32 v18, v18
v_exp_f32 v22, v22
v_mfma_f32_32x32x16_bf16 v[48:63], a[12:15], a[52:55], v[48:63]
ds_read_b128 a[8:11], v2 offset:18432
s_add_u32 s31, s31, 0x36000
v_exp_f32 v19, v19
v_exp_f32 v23, v23
s_waitcnt lgkmcnt(3)
v_mfma_f32_32x32x16_bf16 v[32:47], a[16:19], a[56:59], v[32:47]
ds_read_b128 a[12:15], v2 offset:19456
v_add_f32 v16, 1.0, v16
v_add_f32 v20, 1.0, v20
v_add_f32 v17, 1.0, v17
v_add_f32 v21, 1.0, v21
v_add_f32 v18, 1.0, v18
v_mfma_f32_32x32x16_bf16 v[48:63], a[20:23], a[56:59], v[48:63]
ds_read_b128 a[16:19], v2 offset:20480
v_add_f32 v22, 1.0, v22
v_add_f32 v19, 1.0, v19
v_add_f32 v23, 1.0, v23
v_rcp_f32 v16, v16
v_mfma_f32_32x32x16_bf16 v[32:47], a[24:27], a[60:63], v[32:47]
ds_read_b128 a[20:23], v2 offset:21504
v_rcp_f32 v20, v20
v_rcp_f32 v17, v17
v_rcp_f32 v21, v21
v_mfma_f32_32x32x16_bf16 v[48:63], a[28:31], a[60:63], v[48:63]
ds_read_b128 a[24:27], v2 offset:22528
v_rcp_f32 v18, v18
v_rcp_f32 v22, v22
s_waitcnt lgkmcnt(3)
v_mfma_f32_32x32x16_bf16 v[32:47], a[0:3], a[64:67], v[32:47]
ds_read_b128 a[28:31], v2 offset:23552
s_waitcnt vmcnt(18)
s_barrier
v_rcp_f32 v19, v19
v_rcp_f32 v23, v23
v_mfma_f32_32x32x16_bf16 v[48:63], a[4:7], a[64:67], v[48:63]
ds_read_b128 a[0:3], v2 offset:24576
s_add_u32 m0, s34, 122880
v_mul_f32 v16, v16, v64
v_mul_f32 v20, v20, v68
v_mul_f32 v17, v17, v65
v_mul_f32 v21, v21, v69
v_mul_f32 v18, v18, v66
v_mfma_f32_32x32x16_bf16 v[32:47], a[8:11], a[68:71], v[32:47]
ds_read_b128 a[4:7], v2 offset:25600
v_mul_f32 v22, v22, v70
v_mul_f32 v19, v19, v67
v_mul_f32 v23, v23, v71
v_cvt_pk_bf16_f32 v208, v16, v17
v_cvt_pk_bf16_f32 v210, v20, v21
v_mfma_f32_32x32x16_bf16 v[48:63], a[12:15], a[68:71], v[48:63]
ds_read_b128 a[8:11], v2 offset:26624
buffer_load_dwordx4 v6, s[12:15], s30 offen lds
v_cvt_pk_bf16_f32 v209, v18, v19
v_cvt_pk_bf16_f32 v211, v22, v23
v_mul_f32 v72, v244, v72
s_waitcnt lgkmcnt(3)
v_mfma_f32_32x32x16_bf16 v[32:47], a[16:19], a[72:75], v[32:47]
ds_read_b128 a[12:15], v2 offset:27648
v_mul_f32 v76, v244, v76
v_mul_f32 v73, v244, v73
v_mul_f32 v77, v244, v77
v_mul_f32 v74, v244, v74
v_mul_f32 v78, v244, v78
v_mul_f32 v75, v244, v75
v_mfma_f32_32x32x16_bf16 v[48:63], a[20:23], a[72:75], v[48:63]
ds_read_b128 a[16:19], v2 offset:28672
buffer_load_dwordx4 v7, s[12:15], s30 offen offset:1024 lds
v_mul_f32 v79, v244, v79
v_fma_f32 v16, -v72, v72, s49
v_fma_f32 v20, -v76, v76, s49
v_mfma_f32_32x32x16_bf16 v[32:47], a[24:27], a[76:79], v[32:47]
ds_read_b128 a[20:23], v2 offset:29696
v_fma_f32 v17, -v73, v73, s49
v_fma_f32 v21, -v77, v77, s49
v_fma_f32 v18, -v74, v74, s49
v_fma_f32 v22, -v78, v78, s49
v_fma_f32 v19, -v75, v75, s49
v_fma_f32 v23, -v79, v79, s49
v_mfma_f32_32x32x16_bf16 v[48:63], a[28:31], a[76:79], v[48:63]
ds_read_b128 a[24:27], v2 offset:30720
buffer_load_dwordx4 v8, s[12:15], s30 offen offset:2048 lds
v_mul_f32 v16, v16, v72
v_mul_f32 v20, v20, v76
v_mul_f32 v17, v17, v73
s_waitcnt lgkmcnt(3)
v_mfma_f32_32x32x16_bf16 v[32:47], a[0:3], a[80:83], v[32:47]
ds_read_b128 a[28:31], v2 offset:31744
v_mul_f32 v21, v21, v77
v_mul_f32 v18, v18, v74
v_mul_f32 v22, v22, v78
v_mul_f32 v19, v19, v75
v_mul_f32 v23, v23, v79
v_mfma_f32_32x32x16_bf16 v[48:63], a[4:7], a[80:83], v[48:63]
ds_read_b128 a[0:3], v2 offset:32768
s_add_u32 m0, s34, 125952
v_exp_f32 v16, v16
v_exp_f32 v20, v20
v_mfma_f32_32x32x16_bf16 v[32:47], a[8:11], a[84:87], v[32:47]
ds_read_b128 a[4:7], v2 offset:33792
v_exp_f32 v17, v17
v_exp_f32 v21, v21
v_exp_f32 v18, v18
v_mfma_f32_32x32x16_bf16 v[48:63], a[12:15], a[84:87], v[48:63]
ds_read_b128 a[8:11], v2 offset:34816
buffer_load_dwordx4 v6, s[12:15], s31 offen lds
v_exp_f32 v22, v22
s_waitcnt lgkmcnt(3)
v_mfma_f32_32x32x16_bf16 v[32:47], a[16:19], a[88:91], v[32:47]
ds_read_b128 a[12:15], v2 offset:35840
v_exp_f32 v19, v19
v_exp_f32 v23, v23
v_add_f32 v16, 1.0, v16
v_add_f32 v20, 1.0, v20
v_mfma_f32_32x32x16_bf16 v[48:63], a[20:23], a[88:91], v[48:63]
ds_read_b128 a[16:19], v2 offset:36864
buffer_load_dwordx4 v7, s[12:15], s31 offen offset:1024 lds
v_add_f32 v17, 1.0, v17
v_add_f32 v21, 1.0, v21
v_add_f32 v18, 1.0, v18
v_add_f32 v22, 1.0, v22
v_mfma_f32_32x32x16_bf16 v[32:47], a[24:27], a[92:95], v[32:47]
ds_read_b128 a[20:23], v2 offset:37888
v_add_f32 v19, 1.0, v19
v_add_f32 v23, 1.0, v23
v_rcp_f32 v16, v16
v_mfma_f32_32x32x16_bf16 v[48:63], a[28:31], a[92:95], v[48:63]
ds_read_b128 a[24:27], v2 offset:38912
buffer_load_dwordx4 v8, s[12:15], s31 offen offset:2048 lds
v_rcp_f32 v20, v20
s_waitcnt lgkmcnt(3)
v_mfma_f32_32x32x16_bf16 v[32:47], a[0:3], a[96:99], v[32:47]
ds_read_b128 a[28:31], v2 offset:39936
v_rcp_f32 v17, v17
v_rcp_f32 v21, v21
v_rcp_f32 v18, v18
v_mfma_f32_32x32x16_bf16 v[48:63], a[4:7], a[96:99], v[48:63]
ds_read_b128 a[0:3], v2 offset:40960
s_add_u32 s30, s30, 0xfff94080
v_rcp_f32 v22, v22
v_rcp_f32 v19, v19
v_mfma_f32_32x32x16_bf16 v[32:47], a[8:11], a[100:103], v[32:47]
ds_read_b128 a[4:7], v2 offset:41984
v_rcp_f32 v23, v23
v_mul_f32 v16, v16, v72
v_mul_f32 v20, v20, v76
v_mul_f32 v17, v17, v73
v_mul_f32 v21, v21, v77
v_mfma_f32_32x32x16_bf16 v[48:63], a[12:15], a[100:103], v[48:63]
ds_read_b128 a[8:11], v2 offset:43008
s_add_u32 s31, s31, 0xfff94080
v_mul_f32 v18, v18, v74
v_mul_f32 v22, v22, v78
v_mul_f32 v19, v19, v75
v_mul_f32 v23, v23, v79
s_waitcnt lgkmcnt(3)
v_mfma_f32_32x32x16_bf16 v[32:47], a[16:19], a[104:107], v[32:47]
ds_read_b128 a[12:15], v2 offset:44032
v_cvt_pk_bf16_f32 v212, v16, v17
v_cvt_pk_bf16_f32 v214, v20, v21
v_cvt_pk_bf16_f32 v213, v18, v19
v_cvt_pk_bf16_f32 v215, v22, v23
v_mul_f32 v80, v244, v80
v_mfma_f32_32x32x16_bf16 v[48:63], a[20:23], a[104:107], v[48:63]
ds_read_b128 a[16:19], v2 offset:45056
v_mul_f32 v84, v244, v84
v_mul_f32 v81, v244, v81
v_mul_f32 v85, v244, v85
v_mul_f32 v82, v244, v82
v_mul_f32 v86, v244, v86
v_mul_f32 v83, v244, v83
v_mfma_f32_32x32x16_bf16 v[32:47], a[24:27], a[108:111], v[32:47]
ds_read_b128 a[20:23], v2 offset:46080
v_mul_f32 v87, v244, v87
v_fma_f32 v16, -v80, v80, s49
v_fma_f32 v20, -v84, v84, s49
v_fma_f32 v17, -v81, v81, s49
v_fma_f32 v21, -v85, v85, s49
v_fma_f32 v18, -v82, v82, s49
v_mfma_f32_32x32x16_bf16 v[48:63], a[28:31], a[108:111], v[48:63]
ds_read_b128 a[24:27], v2 offset:47104
v_fma_f32 v22, -v86, v86, s49
v_fma_f32 v19, -v83, v83, s49
v_fma_f32 v23, -v87, v87, s49
v_mul_f32 v16, v16, v80
v_mul_f32 v20, v20, v84
s_waitcnt lgkmcnt(3)
v_mfma_f32_32x32x16_bf16 v[32:47], a[0:3], a[112:115], v[32:47]
ds_read_b128 a[28:31], v2 offset:48128
s_waitcnt vmcnt(18)
s_barrier
v_mul_f32 v17, v17, v81
v_mul_f32 v21, v21, v85
v_mul_f32 v18, v18, v82
v_mfma_f32_32x32x16_bf16 v[48:63], a[4:7], a[112:115], v[48:63]
ds_read_b128 a[0:3], v4 offset:0
s_add_u32 m0, s34, 0
v_mul_f32 v22, v22, v86
v_mul_f32 v19, v19, v83
v_mul_f32 v23, v23, v87
v_exp_f32 v16, v16
v_mfma_f32_32x32x16_bf16 v[32:47], a[8:11], a[116:119], v[32:47]
ds_read_b128 a[4:7], v4 offset:1024
v_exp_f32 v20, v20
v_exp_f32 v17, v17
v_exp_f32 v21, v21
v_mfma_f32_32x32x16_bf16 v[48:63], a[12:15], a[116:119], v[48:63]
ds_read_b128 a[8:11], v4 offset:2048
buffer_load_dwordx4 v6, s[12:15], s30 offen lds
v_exp_f32 v18, v18
s_waitcnt lgkmcnt(3)
v_mfma_f32_32x32x16_bf16 v[32:47], a[16:19], a[120:123], v[32:47]
ds_read_b128 a[12:15], v4 offset:3072
v_exp_f32 v22, v22
v_exp_f32 v19, v19
v_exp_f32 v23, v23
v_mfma_f32_32x32x16_bf16 v[48:63], a[20:23], a[120:123], v[48:63]
ds_read_b128 a[16:19], v4 offset:4096
buffer_load_dwordx4 v7, s[12:15], s30 offen offset:1024 lds
v_add_f32 v16, 1.0, v16
v_add_f32 v20, 1.0, v20
v_add_f32 v17, 1.0, v17
v_add_f32 v21, 1.0, v21
v_mfma_f32_32x32x16_bf16 v[32:47], a[24:27], a[124:127], v[32:47]
ds_read_b128 a[20:23], v4 offset:5120
v_add_f32 v18, 1.0, v18
v_add_f32 v22, 1.0, v22
v_add_f32 v19, 1.0, v19
v_add_f32 v23, 1.0, v23
v_mfma_f32_32x32x16_bf16 v[48:63], a[28:31], a[124:127], v[48:63]
ds_read_b128 a[24:27], v4 offset:6144
buffer_load_dwordx4 v8, s[12:15], s30 offen offset:2048 lds
v_rcp_f32 v16, v16
s_waitcnt lgkmcnt(3)
v_mfma_f32_32x32x16_bf16 v[32:47], a[0:3], a[128:131], v[32:47]
ds_read_b128 a[28:31], v4 offset:7168
v_rcp_f32 v20, v20
v_rcp_f32 v17, v17
v_rcp_f32 v21, v21
v_mfma_f32_32x32x16_bf16 v[48:63], a[4:7], a[128:131], v[48:63]
ds_read_b128 a[0:3], v4 offset:8192
s_add_u32 m0, s34, 3072
v_rcp_f32 v18, v18
v_rcp_f32 v22, v22
v_mfma_f32_32x32x16_bf16 v[32:47], a[8:11], a[132:135], v[32:47]
ds_read_b128 a[4:7], v4 offset:9216
v_rcp_f32 v19, v19
v_rcp_f32 v23, v23
v_mul_f32 v16, v16, v80
v_mul_f32 v20, v20, v84
v_mfma_f32_32x32x16_bf16 v[48:63], a[12:15], a[132:135], v[48:63]
ds_read_b128 a[8:11], v4 offset:10240
buffer_load_dwordx4 v6, s[12:15], s31 offen lds
v_mul_f32 v17, v17, v81
v_mul_f32 v21, v21, v85
v_mul_f32 v18, v18, v82
s_waitcnt lgkmcnt(3)
v_mfma_f32_32x32x16_bf16 v[32:47], a[16:19], a[136:139], v[32:47]
ds_read_b128 a[12:15], v4 offset:11264
v_mul_f32 v22, v22, v86
v_mul_f32 v19, v19, v83
v_mul_f32 v23, v23, v87
v_cvt_pk_bf16_f32 v216, v16, v17
v_cvt_pk_bf16_f32 v218, v20, v21
v_mfma_f32_32x32x16_bf16 v[48:63], a[20:23], a[136:139], v[48:63]
ds_read_b128 a[16:19], v4 offset:12288
buffer_load_dwordx4 v7, s[12:15], s31 offen offset:1024 lds
v_cvt_pk_bf16_f32 v217, v18, v19
v_cvt_pk_bf16_f32 v219, v22, v23
v_mul_f32 v88, v244, v88
v_mul_f32 v92, v244, v92
v_mfma_f32_32x32x16_bf16 v[32:47], a[24:27], a[140:143], v[32:47]
ds_read_b128 a[20:23], v4 offset:13312
v_mul_f32 v89, v244, v89
v_mul_f32 v93, v244, v93
v_mul_f32 v90, v244, v90
v_mul_f32 v94, v244, v94
v_mul_f32 v91, v244, v91
v_mul_f32 v95, v244, v95
v_mfma_f32_32x32x16_bf16 v[48:63], a[28:31], a[140:143], v[48:63]
ds_read_b128 a[24:27], v4 offset:14336
buffer_load_dwordx4 v8, s[12:15], s31 offen offset:2048 lds
v_fma_f32 v16, -v88, v88, s49
v_fma_f32 v20, -v92, v92, s49
s_waitcnt lgkmcnt(3)
v_mfma_f32_32x32x16_bf16 v[32:47], a[0:3], a[144:147], v[32:47]
ds_read_b128 a[28:31], v4 offset:15360
v_fma_f32 v17, -v89, v89, s49
v_fma_f32 v21, -v93, v93, s49
v_fma_f32 v18, -v90, v90, s49
v_fma_f32 v22, -v94, v94, s49
v_fma_f32 v19, -v91, v91, s49
v_fma_f32 v23, -v95, v95, s49
v_mfma_f32_32x32x16_bf16 v[48:63], a[4:7], a[144:147], v[48:63]
ds_read_b128 a[0:3], v4 offset:16384
s_add_u32 s30, s30, 0x36000
v_mul_f32 v16, v16, v88
v_mul_f32 v20, v20, v92
v_mul_f32 v17, v17, v89
v_mul_f32 v21, v21, v93
v_mul_f32 v18, v18, v90
v_mfma_f32_32x32x16_bf16 v[32:47], a[8:11], a[148:151], v[32:47]
ds_read_b128 a[4:7], v4 offset:17408
v_mul_f32 v22, v22, v94
v_mul_f32 v19, v19, v91
v_mul_f32 v23, v23, v95
v_exp_f32 v16, v16
v_mfma_f32_32x32x16_bf16 v[48:63], a[12:15], a[148:151], v[48:63]
ds_read_b128 a[8:11], v4 offset:18432
s_add_u32 s31, s31, 0x36000
v_exp_f32 v20, v20
v_exp_f32 v17, v17
s_waitcnt lgkmcnt(3)
v_mfma_f32_32x32x16_bf16 v[32:47], a[16:19], a[152:155], v[32:47]
ds_read_b128 a[12:15], v4 offset:19456
ds_read_b32 v248, v245 offset:2048
v_exp_f32 v21, v21
v_exp_f32 v18, v18
v_mfma_f32_32x32x16_bf16 v[48:63], a[20:23], a[152:155], v[48:63]
ds_read_b128 a[16:19], v4 offset:20480
ds_read_b32 v250, v245 offset:2176
v_exp_f32 v22, v22
v_exp_f32 v19, v19
v_mfma_f32_32x32x16_bf16 v[32:47], a[24:27], a[156:159], v[32:47]
ds_read_b128 a[20:23], v4 offset:21504
v_exp_f32 v23, v23
v_add_f32 v16, 1.0, v16
v_add_f32 v20, 1.0, v20
v_add_f32 v17, 1.0, v17
v_add_f32 v21, 1.0, v21
v_mfma_f32_32x32x16_bf16 v[48:63], a[28:31], a[156:159], v[48:63]
ds_read_b128 a[24:27], v4 offset:22528
v_add_f32 v18, 1.0, v18
v_add_f32 v22, 1.0, v22
v_add_f32 v19, 1.0, v19
v_add_f32 v23, 1.0, v23
s_waitcnt lgkmcnt(5)
v_mfma_f32_32x32x16_bf16 v[32:47], a[0:3], a[160:163], v[32:47]
ds_read_b128 a[28:31], v4 offset:23552
s_waitcnt vmcnt(18)
s_barrier
v_rcp_f32 v16, v16
v_mfma_f32_32x32x16_bf16 v[48:63], a[4:7], a[160:163], v[48:63]
ds_read_b64_tr_b16 a[0:1], v11 offset:24576
ds_read_b64_tr_b16 a[2:3], v11 offset:25600
s_add_u32 m0, s34, 24576
v_rcp_f32 v20, v20
v_rcp_f32 v17, v17
v_mfma_f32_32x32x16_bf16 v[32:47], a[8:11], a[164:167], v[32:47]
ds_read_b64_tr_b16 a[4:5], v12 offset:24576
ds_read_b64_tr_b16 a[6:7], v12 offset:25600
v_rcp_f32 v21, v21
v_rcp_f32 v18, v18
v_mfma_f32_32x32x16_bf16 v[48:63], a[12:15], a[164:167], v[48:63]
ds_read_b64_tr_b16 a[8:9], v11 offset:26624
ds_read_b64_tr_b16 a[10:11], v11 offset:27648
buffer_load_dwordx4 v6, s[12:15], s30 offen lds
s_waitcnt lgkmcnt(6)
v_mfma_f32_32x32x16_bf16 v[32:47], a[16:19], a[168:171], v[32:47]
ds_read_b64_tr_b16 a[12:13], v12 offset:26624
ds_read_b64_tr_b16 a[14:15], v12 offset:27648
v_rcp_f32 v22, v22
v_rcp_f32 v19, v19
v_mul_f32 v16, v16, v88
v_mfma_f32_32x32x16_bf16 v[48:63], a[20:23], a[168:171], v[48:63]
ds_read_b64_tr_b16 a[16:17], v11 offset:28672
ds_read_b64_tr_b16 a[18:19], v11 offset:29696
buffer_load_dwordx4 v7, s[12:15], s30 offen offset:1024 lds
v_rcp_f32 v23, v23
v_mul_f32 v20, v20, v92
v_mfma_f32_32x32x16_bf16 v[32:47], a[24:27], a[172:175], v[32:47]
ds_read_b64_tr_b16 a[20:21], v12 offset:28672
ds_read_b64_tr_b16 a[22:23], v12 offset:29696
v_mfma_f32_32x32x8bf16_1k v[32:47], v[248:249], v[246:247], v[32:47]
v_mul_f32 v17, v17, v89
v_mul_f32 v21, v21, v93
v_mul_f32 v18, v18, v90
v_mul_f32 v22, v22, v94
v_mul_f32 v19, v19, v91
v_mul_f32 v23, v23, v95
v_cvt_pk_bf16_f32 v220, v16, v17
v_cvt_pk_bf16_f32 v222, v20, v21
v_cvt_pk_bf16_f32 v221, v18, v19
v_cvt_pk_bf16_f32 v223, v22, v23
v_mfma_f32_32x32x16_bf16 v[48:63], a[28:31], a[172:175], v[48:63]
ds_read_b64_tr_b16 a[24:25], v11 offset:30720
ds_read_b64_tr_b16 a[26:27], v11 offset:31744
buffer_load_dwordx4 v8, s[12:15], s30 offen offset:2048 lds
v_mfma_f32_32x32x8bf16_1k v[48:63], v[250:251], v[246:247], v[48:63]
s_waitcnt lgkmcnt(6)
v_mfma_f32_32x32x16_bf16 v[64:79], a[0:3], v[96:99], 0
ds_read_b64_tr_b16 a[28:29], v12 offset:30720
ds_read_b64_tr_b16 a[30:31], v12 offset:31744
v_mfma_f32_32x32x16_bf16 v[80:95], a[4:7], v[96:99], 0
ds_read_b64_tr_b16 a[0:1], v11 offset:32768
ds_read_b64_tr_b16 a[2:3], v11 offset:33792
s_add_u32 m0, s34, 27648
v_mfma_f32_32x32x16_bf16 v[64:79], a[8:11], v[100:103], v[64:79]
ds_read_b64_tr_b16 a[4:5], v12 offset:32768
ds_read_b64_tr_b16 a[6:7], v12 offset:33792
v_mfma_f32_32x32x16_bf16 v[80:95], a[12:15], v[100:103], v[80:95]
ds_read_b64_tr_b16 a[8:9], v11 offset:34816
ds_read_b64_tr_b16 a[10:11], v11 offset:35840
buffer_load_dwordx4 v6, s[12:15], s31 offen lds
v_mul_f32 v32, v244, v32
v_mul_f32 v36, v244, v36
v_mul_f32 v33, v244, v33
v_mul_f32 v37, v244, v37
s_waitcnt lgkmcnt(6)
v_mfma_f32_32x32x16_bf16 v[64:79], a[16:19], v[104:107], v[64:79]
ds_read_b64_tr_b16 a[12:13], v12 offset:34816
ds_read_b64_tr_b16 a[14:15], v12 offset:35840
v_mul_f32 v34, v244, v34
v_mul_f32 v38, v244, v38
v_mul_f32 v35, v244, v35
v_mul_f32 v39, v244, v39
v_fma_f32 v16, -v32, v32, s49
v_fma_f32 v20, -v36, v36, s49
v_mfma_f32_32x32x16_bf16 v[80:95], a[20:23], v[104:107], v[80:95]
ds_read_b64_tr_b16 a[16:17], v11 offset:36864
ds_read_b64_tr_b16 a[18:19], v11 offset:37888
buffer_load_dwordx4 v7, s[12:15], s31 offen offset:1024 lds
v_fma_f32 v17, -v33, v33, s49
v_fma_f32 v21, -v37, v37, s49
v_fma_f32 v18, -v34, v34, s49
v_fma_f32 v22, -v38, v38, s49
v_fma_f32 v19, -v35, v35, s49
v_mfma_f32_32x32x16_bf16 v[64:79], a[24:27], v[108:111], v[64:79]
ds_read_b64_tr_b16 a[20:21], v12 offset:36864
ds_read_b64_tr_b16 a[22:23], v12 offset:37888
v_fma_f32 v23, -v39, v39, s49
v_mul_f32 v16, v16, v32
v_mul_f32 v20, v20, v36
v_mul_f32 v17, v17, v33
v_mul_f32 v21, v21, v37
v_mul_f32 v18, v18, v34
v_mfma_f32_32x32x16_bf16 v[80:95], a[28:31], v[108:111], v[80:95]
ds_read_b64_tr_b16 a[24:25], v11 offset:38912
ds_read_b64_tr_b16 a[26:27], v11 offset:39936
buffer_load_dwordx4 v8, s[12:15], s31 offen offset:2048 lds
v_mul_f32 v22, v22, v38
v_mul_f32 v19, v19, v35
v_mul_f32 v23, v23, v39
s_waitcnt lgkmcnt(6)
v_mfma_f32_32x32x16_bf16 v[64:79], a[0:3], v[112:115], v[64:79]
ds_read_b64_tr_b16 a[28:29], v12 offset:38912
ds_read_b64_tr_b16 a[30:31], v12 offset:39936
v_exp_f32 v16, v16
v_exp_f32 v20, v20
v_exp_f32 v17, v17
v_mfma_f32_32x32x16_bf16 v[80:95], a[4:7], v[112:115], v[80:95]
ds_read_b64_tr_b16 a[0:1], v11 offset:40960
ds_read_b64_tr_b16 a[2:3], v11 offset:41984
s_add_u32 s30, s30, 0x36000
v_exp_f32 v21, v21
v_exp_f32 v18, v18
v_exp_f32 v22, v22
v_mfma_f32_32x32x16_bf16 v[64:79], a[8:11], v[116:119], v[64:79]
ds_read_b64_tr_b16 a[4:5], v12 offset:40960
ds_read_b64_tr_b16 a[6:7], v12 offset:41984
v_exp_f32 v19, v19
v_exp_f32 v23, v23
v_add_f32 v16, 1.0, v16
v_add_f32 v20, 1.0, v20
v_mfma_f32_32x32x16_bf16 v[80:95], a[12:15], v[116:119], v[80:95]
ds_read_b64_tr_b16 a[8:9], v11 offset:43008
ds_read_b64_tr_b16 a[10:11], v11 offset:44032
s_add_u32 s31, s31, 0x36000
v_add_f32 v17, 1.0, v17
v_add_f32 v21, 1.0, v21
v_add_f32 v18, 1.0, v18
v_add_f32 v22, 1.0, v22
v_add_f32 v19, 1.0, v19
s_waitcnt lgkmcnt(6)
v_mfma_f32_32x32x16_bf16 v[64:79], a[16:19], v[120:123], v[64:79]
ds_read_b64_tr_b16 a[12:13], v12 offset:43008
ds_read_b64_tr_b16 a[14:15], v12 offset:44032
v_add_f32 v23, 1.0, v23
v_rcp_f32 v16, v16
v_rcp_f32 v20, v20
v_mfma_f32_32x32x16_bf16 v[80:95], a[20:23], v[120:123], v[80:95]
ds_read_b64_tr_b16 a[16:17], v11 offset:45056
ds_read_b64_tr_b16 a[18:19], v11 offset:46080
v_rcp_f32 v17, v17
v_rcp_f32 v21, v21
v_rcp_f32 v18, v18
v_mfma_f32_32x32x16_bf16 v[64:79], a[24:27], v[124:127], v[64:79]
ds_read_b64_tr_b16 a[20:21], v12 offset:45056
ds_read_b64_tr_b16 a[22:23], v12 offset:46080
v_rcp_f32 v22, v22
v_rcp_f32 v19, v19
v_rcp_f32 v23, v23
v_mfma_f32_32x32x16_bf16 v[80:95], a[28:31], v[124:127], v[80:95]
ds_read_b64_tr_b16 a[24:25], v11 offset:47104
ds_read_b64_tr_b16 a[26:27], v11 offset:48128
v_mul_f32 v16, v16, v32
v_mul_f32 v20, v20, v36
v_mul_f32 v17, v17, v33
v_mul_f32 v21, v21, v37
v_mul_f32 v18, v18, v34
v_mul_f32 v22, v22, v38
s_waitcnt lgkmcnt(6)
v_mfma_f32_32x32x16_bf16 v[64:79], a[0:3], v[128:131], v[64:79]
ds_read_b64_tr_b16 a[28:29], v12 offset:47104
ds_read_b64_tr_b16 a[30:31], v12 offset:48128
s_waitcnt vmcnt(18)
s_barrier
v_mul_f32 v19, v19, v35
v_mul_f32 v23, v23, v39
v_cvt_pk_bf16_f32 v224, v16, v17
v_cvt_pk_bf16_f32 v226, v20, v21
v_mfma_f32_32x32x16_bf16 v[80:95], a[4:7], v[128:131], v[80:95]
ds_read_b64_tr_b16 a[0:1], v13 offset:0
ds_read_b64_tr_b16 a[2:3], v13 offset:1024
s_add_u32 m0, s34, 49152
v_cvt_pk_bf16_f32 v225, v18, v19
v_cvt_pk_bf16_f32 v227, v22, v23
v_mul_f32 v40, v244, v40
v_mul_f32 v44, v244, v44
v_mul_f32 v41, v244, v41
v_mul_f32 v45, v244, v45
v_mfma_f32_32x32x16_bf16 v[64:79], a[8:11], v[132:135], v[64:79]
ds_read_b64_tr_b16 a[4:5], v14 offset:0
ds_read_b64_tr_b16 a[6:7], v14 offset:1024
v_mul_f32 v42, v244, v42
v_mul_f32 v46, v244, v46
v_mul_f32 v43, v244, v43
v_mul_f32 v47, v244, v47
v_fma_f32 v16, -v40, v40, s49
v_fma_f32 v20, -v44, v44, s49
v_mfma_f32_32x32x16_bf16 v[80:95], a[12:15], v[132:135], v[80:95]
ds_read_b64_tr_b16 a[8:9], v13 offset:2048
ds_read_b64_tr_b16 a[10:11], v13 offset:3072
buffer_load_dwordx4 v6, s[12:15], s30 offen lds
v_fma_f32 v17, -v41, v41, s49
v_fma_f32 v21, -v45, v45, s49
v_fma_f32 v18, -v42, v42, s49
v_fma_f32 v22, -v46, v46, s49
s_waitcnt lgkmcnt(6)
v_mfma_f32_32x32x16_bf16 v[64:79], a[16:19], v[136:139], v[64:79]
ds_read_b64_tr_b16 a[12:13], v14 offset:2048
ds_read_b64_tr_b16 a[14:15], v14 offset:3072
v_fma_f32 v19, -v43, v43, s49
v_fma_f32 v23, -v47, v47, s49
v_mul_f32 v16, v16, v40
v_mul_f32 v20, v20, v44
v_mul_f32 v17, v17, v41
v_mul_f32 v21, v21, v45
v_mfma_f32_32x32x16_bf16 v[80:95], a[20:23], v[136:139], v[80:95]
ds_read_b64_tr_b16 a[16:17], v13 offset:4096
ds_read_b64_tr_b16 a[18:19], v13 offset:5120
buffer_load_dwordx4 v7, s[12:15], s30 offen offset:1024 lds
v_mul_f32 v18, v18, v42
v_mul_f32 v22, v22, v46
v_mul_f32 v19, v19, v43
v_mul_f32 v23, v23, v47
v_mfma_f32_32x32x16_bf16 v[64:79], a[24:27], v[140:143], v[64:79]
ds_read_b64_tr_b16 a[20:21], v14 offset:4096
ds_read_b64_tr_b16 a[22:23], v14 offset:5120
v_exp_f32 v16, v16
v_exp_f32 v20, v20
v_exp_f32 v17, v17
v_mfma_f32_32x32x16_bf16 v[80:95], a[28:31], v[140:143], v[80:95]
ds_read_b64_tr_b16 a[24:25], v13 offset:6144
ds_read_b64_tr_b16 a[26:27], v13 offset:7168
buffer_load_dwordx4 v8, s[12:15], s30 offen offset:2048 lds
v_exp_f32 v21, v21
v_exp_f32 v18, v18
s_waitcnt lgkmcnt(6)
v_mfma_f32_32x32x16_bf16 v[64:79], a[0:3], v[144:147], v[64:79]
ds_read_b64_tr_b16 a[28:29], v14 offset:6144
ds_read_b64_tr_b16 a[30:31], v14 offset:7168
v_exp_f32 v22, v22
v_exp_f32 v19, v19
v_exp_f32 v23, v23
v_mfma_f32_32x32x16_bf16 v[80:95], a[4:7], v[144:147], v[80:95]
ds_read_b64_tr_b16 a[0:1], v13 offset:8192
ds_read_b64_tr_b16 a[2:3], v13 offset:9216
s_add_u32 m0, s34, 52224
v_add_f32 v16, 1.0, v16
v_add_f32 v20, 1.0, v20
v_add_f32 v17, 1.0, v17
v_add_f32 v21, 1.0, v21
v_add_f32 v18, 1.0, v18
v_add_f32 v22, 1.0, v22
v_mfma_f32_32x32x16_bf16 v[64:79], a[8:11], v[148:151], v[64:79]
ds_read_b64_tr_b16 a[4:5], v14 offset:8192
ds_read_b64_tr_b16 a[6:7], v14 offset:9216
v_add_f32 v19, 1.0, v19
v_add_f32 v23, 1.0, v23
v_rcp_f32 v16, v16
v_rcp_f32 v20, v20
v_mfma_f32_32x32x16_bf16 v[80:95], a[12:15], v[148:151], v[80:95]
ds_read_b64_tr_b16 a[8:9], v13 offset:10240
ds_read_b64_tr_b16 a[10:11], v13 offset:11264
buffer_load_dwordx4 v6, s[12:15], s31 offen lds
v_rcp_f32 v17, v17
v_rcp_f32 v21, v21
s_waitcnt lgkmcnt(6)
v_mfma_f32_32x32x16_bf16 v[64:79], a[16:19], v[152:155], v[64:79]
ds_read_b64_tr_b16 a[12:13], v14 offset:10240
ds_read_b64_tr_b16 a[14:15], v14 offset:11264
v_rcp_f32 v18, v18
v_rcp_f32 v22, v22
v_rcp_f32 v19, v19
v_mfma_f32_32x32x16_bf16 v[80:95], a[20:23], v[152:155], v[80:95]
ds_read_b64_tr_b16 a[16:17], v13 offset:12288
ds_read_b64_tr_b16 a[18:19], v13 offset:13312
buffer_load_dwordx4 v7, s[12:15], s31 offen offset:1024 lds
v_rcp_f32 v23, v23
v_mul_f32 v16, v16, v40
v_mul_f32 v20, v20, v44
v_mul_f32 v17, v17, v41
v_mfma_f32_32x32x16_bf16 v[64:79], a[24:27], v[156:159], v[64:79]
ds_read_b64_tr_b16 a[20:21], v14 offset:12288
ds_read_b64_tr_b16 a[22:23], v14 offset:13312
v_mul_f32 v21, v21, v45
v_mul_f32 v18, v18, v42
v_mul_f32 v22, v22, v46
v_mul_f32 v19, v19, v43
v_mul_f32 v23, v23, v47
v_cvt_pk_bf16_f32 v228, v16, v17
v_mfma_f32_32x32x16_bf16 v[80:95], a[28:31], v[156:159], v[80:95]
ds_read_b64_tr_b16 a[24:25], v13 offset:14336
ds_read_b64_tr_b16 a[26:27], v13 offset:15360
buffer_load_dwordx4 v8, s[12:15], s31 offen offset:2048 lds
v_cvt_pk_bf16_f32 v230, v20, v21
v_cvt_pk_bf16_f32 v229, v18, v19
v_cvt_pk_bf16_f32 v231, v22, v23
s_waitcnt lgkmcnt(6)
v_mfma_f32_32x32x16_bf16 v[64:79], a[0:3], v[160:163], v[64:79]
ds_read_b64_tr_b16 a[28:29], v14 offset:14336
ds_read_b64_tr_b16 a[30:31], v14 offset:15360
v_mul_f32 v48, v244, v48
v_mul_f32 v52, v244, v52
v_mul_f32 v49, v244, v49
v_mul_f32 v53, v244, v53
v_mul_f32 v50, v244, v50
v_mul_f32 v54, v244, v54
v_mul_f32 v51, v244, v51
v_mfma_f32_32x32x16_bf16 v[80:95], a[4:7], v[160:163], v[80:95]
ds_read_b64_tr_b16 a[0:1], v13 offset:16384
ds_read_b64_tr_b16 a[2:3], v13 offset:17408
s_add_u32 s30, s30, 0xfff94080
v_mul_f32 v55, v244, v55
v_fma_f32 v16, -v48, v48, s49
v_fma_f32 v20, -v52, v52, s49
v_fma_f32 v17, -v49, v49, s49
v_fma_f32 v21, -v53, v53, s49
v_mfma_f32_32x32x16_bf16 v[64:79], a[8:11], v[164:167], v[64:79]
ds_read_b64_tr_b16 a[4:5], v14 offset:16384
ds_read_b64_tr_b16 a[6:7], v14 offset:17408
v_fma_f32 v18, -v50, v50, s49
v_fma_f32 v22, -v54, v54, s49
v_fma_f32 v19, -v51, v51, s49
v_fma_f32 v23, -v55, v55, s49
v_mul_f32 v16, v16, v48
v_mul_f32 v20, v20, v52
v_mul_f32 v17, v17, v49
v_mfma_f32_32x32x16_bf16 v[80:95], a[12:15], v[164:167], v[80:95]
ds_read_b64_tr_b16 a[8:9], v13 offset:18432
ds_read_b64_tr_b16 a[10:11], v13 offset:19456
s_add_u32 s31, s31, 0xfff94080
v_mul_f32 v21, v21, v53
v_mul_f32 v18, v18, v50
v_mul_f32 v22, v22, v54
v_mul_f32 v19, v19, v51
s_waitcnt lgkmcnt(6)
v_mfma_f32_32x32x16_bf16 v[64:79], a[16:19], v[168:171], v[64:79]
ds_read_b64_tr_b16 a[12:13], v14 offset:18432
ds_read_b64_tr_b16 a[14:15], v14 offset:19456
v_mul_f32 v23, v23, v55
v_exp_f32 v16, v16
v_exp_f32 v20, v20
v_exp_f32 v17, v17
v_mfma_f32_32x32x16_bf16 v[80:95], a[20:23], v[168:171], v[80:95]
ds_read_b64_tr_b16 a[16:17], v13 offset:20480
ds_read_b64_tr_b16 a[18:19], v13 offset:21504
v_exp_f32 v21, v21
v_exp_f32 v18, v18
v_exp_f32 v22, v22
v_mfma_f32_32x32x16_bf16 v[64:79], a[24:27], v[172:175], v[64:79]
ds_read_b64_tr_b16 a[20:21], v14 offset:20480
ds_read_b64_tr_b16 a[22:23], v14 offset:21504
v_exp_f32 v19, v19
v_exp_f32 v23, v23
v_add_f32 v16, 1.0, v16
v_add_f32 v20, 1.0, v20
v_add_f32 v17, 1.0, v17
v_mfma_f32_32x32x16_bf16 v[80:95], a[28:31], v[172:175], v[80:95]
ds_read_b64_tr_b16 a[24:25], v13 offset:22528
ds_read_b64_tr_b16 a[26:27], v13 offset:23552
v_add_f32 v21, 1.0, v21
v_add_f32 v18, 1.0, v18
v_add_f32 v22, 1.0, v22
v_add_f32 v19, 1.0, v19
v_add_f32 v23, 1.0, v23
s_waitcnt lgkmcnt(6)
v_mfma_f32_32x32x16_bf16 v[64:79], a[0:3], v[176:179], v[64:79]
ds_read_b64_tr_b16 a[28:29], v14 offset:22528
ds_read_b64_tr_b16 a[30:31], v14 offset:23552
s_waitcnt vmcnt(18)
s_barrier
v_rcp_f32 v16, v16
v_rcp_f32 v20, v20
v_mfma_f32_32x32x16_bf16 v[80:95], a[4:7], v[176:179], v[80:95]
ds_read_b64_tr_b16 a[0:1], v13 offset:24576
ds_read_b64_tr_b16 a[2:3], v13 offset:25600
s_add_u32 m0, s34, 73728
v_rcp_f32 v17, v17
v_rcp_f32 v21, v21
v_mfma_f32_32x32x16_bf16 v[64:79], a[8:11], v[180:183], v[64:79]
ds_read_b64_tr_b16 a[4:5], v14 offset:24576
ds_read_b64_tr_b16 a[6:7], v14 offset:25600
v_rcp_f32 v18, v18
v_rcp_f32 v22, v22
v_rcp_f32 v19, v19
v_mul_f32 v16, v16, v48
v_mfma_f32_32x32x16_bf16 v[80:95], a[12:15], v[180:183], v[80:95]
ds_read_b64_tr_b16 a[8:9], v13 offset:26624
ds_read_b64_tr_b16 a[10:11], v13 offset:27648
buffer_load_dwordx4 v6, s[12:15], s30 offen lds
v_rcp_f32 v23, v23
v_mul_f32 v20, v20, v52
s_waitcnt lgkmcnt(6)
v_mfma_f32_32x32x16_bf16 v[64:79], a[16:19], v[184:187], v[64:79]
ds_read_b64_tr_b16 a[12:13], v14 offset:26624
ds_read_b64_tr_b16 a[14:15], v14 offset:27648
v_mul_f32 v17, v17, v49
v_mul_f32 v21, v21, v53
v_mul_f32 v18, v18, v50
v_mul_f32 v22, v22, v54
v_mul_f32 v19, v19, v51
v_mul_f32 v23, v23, v55
v_cvt_pk_bf16_f32 v232, v16, v17
v_mfma_f32_32x32x16_bf16 v[80:95], a[20:23], v[184:187], v[80:95]
ds_read_b64_tr_b16 a[16:17], v13 offset:28672
ds_read_b64_tr_b16 a[18:19], v13 offset:29696
buffer_load_dwordx4 v7, s[12:15], s30 offen offset:1024 lds
v_cvt_pk_bf16_f32 v234, v20, v21
v_cvt_pk_bf16_f32 v233, v18, v19
v_cvt_pk_bf16_f32 v235, v22, v23
v_mul_f32 v56, v244, v56
v_mfma_f32_32x32x16_bf16 v[64:79], a[24:27], v[188:191], v[64:79]
ds_read_b64_tr_b16 a[20:21], v14 offset:28672
ds_read_b64_tr_b16 a[22:23], v14 offset:29696
v_mul_f32 v60, v244, v60
v_mul_f32 v57, v244, v57
v_mul_f32 v61, v244, v61
v_mul_f32 v58, v244, v58
v_mul_f32 v62, v244, v62
v_mul_f32 v59, v244, v59
v_mul_f32 v63, v244, v63
v_mfma_f32_32x32x16_bf16 v[80:95], a[28:31], v[188:191], v[80:95]
ds_read_b64_tr_b16 a[24:25], v13 offset:30720
ds_read_b64_tr_b16 a[26:27], v13 offset:31744
buffer_load_dwordx4 v8, s[12:15], s30 offen offset:2048 lds
v_fma_f32 v16, -v56, v56, s49
v_fma_f32 v20, -v60, v60, s49
v_fma_f32 v17, -v57, v57, s49
s_waitcnt lgkmcnt(6)
v_mfma_f32_32x32x16_bf16 v[64:79], a[0:3], v[192:195], v[64:79]
ds_read_b64_tr_b16 a[28:29], v14 offset:30720
ds_read_b64_tr_b16 a[30:31], v14 offset:31744
v_fma_f32 v21, -v61, v61, s49
v_fma_f32 v18, -v58, v58, s49
v_fma_f32 v22, -v62, v62, s49
v_fma_f32 v19, -v59, v59, s49
v_fma_f32 v23, -v63, v63, s49
v_mul_f32 v16, v16, v56
v_mul_f32 v20, v20, v60
v_mfma_f32_32x32x16_bf16 v[80:95], a[4:7], v[192:195], v[80:95]
ds_read_b64_tr_b16 a[0:1], v13 offset:32768
ds_read_b64_tr_b16 a[2:3], v13 offset:33792
s_add_u32 m0, s34, 76800
v_mul_f32 v17, v17, v57
v_mul_f32 v21, v21, v61
v_mul_f32 v18, v18, v58
v_mul_f32 v22, v22, v62
v_mul_f32 v19, v19, v59
v_mfma_f32_32x32x16_bf16 v[64:79], a[8:11], v[196:199], v[64:79]
ds_read_b64_tr_b16 a[4:5], v14 offset:32768
ds_read_b64_tr_b16 a[6:7], v14 offset:33792
v_mul_f32 v23, v23, v63
v_exp_f32 v16, v16
v_exp_f32 v20, v20
v_exp_f32 v17, v17
v_mfma_f32_32x32x16_bf16 v[80:95], a[12:15], v[196:199], v[80:95]
ds_read_b64_tr_b16 a[8:9], v13 offset:34816
ds_read_b64_tr_b16 a[10:11], v13 offset:35840
buffer_load_dwordx4 v6, s[12:15], s31 offen lds
v_exp_f32 v21, v21
s_waitcnt lgkmcnt(6)
v_mfma_f32_32x32x16_bf16 v[64:79], a[16:19], v[200:203], v[64:79]
ds_read_b64_tr_b16 a[12:13], v14 offset:34816
ds_read_b64_tr_b16 a[14:15], v14 offset:35840
v_exp_f32 v18, v18
v_exp_f32 v22, v22
v_exp_f32 v19, v19
v_add_f32 v16, 1.0, v16
v_mfma_f32_32x32x16_bf16 v[80:95], a[20:23], v[200:203], v[80:95]
ds_read_b64_tr_b16 a[16:17], v13 offset:36864
ds_read_b64_tr_b16 a[18:19], v13 offset:37888
buffer_load_dwordx4 v7, s[12:15], s31 offen offset:1024 lds
v_exp_f32 v23, v23
v_add_f32 v20, 1.0, v20
v_add_f32 v17, 1.0, v17
v_mfma_f32_32x32x16_bf16 v[64:79], a[24:27], v[204:207], v[64:79]
ds_read_b64_tr_b16 a[20:21], v14 offset:36864
ds_read_b64_tr_b16 a[22:23], v14 offset:37888
v_add_f32 v21, 1.0, v21
v_add_f32 v18, 1.0, v18
v_add_f32 v22, 1.0, v22
v_add_f32 v19, 1.0, v19
v_add_f32 v23, 1.0, v23
v_rcp_f32 v16, v16
v_mfma_f32_32x32x16_bf16 v[80:95], a[28:31], v[204:207], v[80:95]
ds_read_b64_tr_b16 a[24:25], v13 offset:38912
ds_read_b64_tr_b16 a[26:27], v13 offset:39936
buffer_load_dwordx4 v8, s[12:15], s31 offen offset:2048 lds
v_rcp_f32 v20, v20
s_waitcnt lgkmcnt(6)
v_mfma_f32_32x32x16_bf16 v[64:79], a[0:3], v[208:211], v[64:79]
ds_read_b64_tr_b16 a[28:29], v14 offset:38912
ds_read_b64_tr_b16 a[30:31], v14 offset:39936
v_rcp_f32 v17, v17
v_rcp_f32 v21, v21
v_rcp_f32 v18, v18
v_mfma_f32_32x32x16_bf16 v[80:95], a[4:7], v[208:211], v[80:95]
ds_read_b64_tr_b16 a[0:1], v13 offset:40960
ds_read_b64_tr_b16 a[2:3], v13 offset:41984
s_add_u32 s30, s30, 0x36000
v_rcp_f32 v22, v22
v_rcp_f32 v19, v19
v_mul_f32 v16, v16, v56
v_mfma_f32_32x32x16_bf16 v[64:79], a[8:11], v[212:215], v[64:79]
ds_read_b64_tr_b16 a[4:5], v14 offset:40960
ds_read_b64_tr_b16 a[6:7], v14 offset:41984
v_rcp_f32 v23, v23
v_mul_f32 v20, v20, v60
v_mul_f32 v17, v17, v57
v_mul_f32 v21, v21, v61
v_mul_f32 v18, v18, v58
v_mul_f32 v22, v22, v62
v_mul_f32 v19, v19, v59
v_mul_f32 v23, v23, v63
v_cvt_pk_bf16_f32 v236, v16, v17
v_cvt_pk_bf16_f32 v238, v20, v21
v_cvt_pk_bf16_f32 v237, v18, v19
v_cvt_pk_bf16_f32 v239, v22, v23
v_mfma_f32_32x32x16_bf16 v[80:95], a[12:15], v[212:215], v[80:95]
ds_read_b64_tr_b16 a[8:9], v13 offset:43008
ds_read_b64_tr_b16 a[10:11], v13 offset:44032
s_add_u32 s31, s31, 0x36000
s_waitcnt lgkmcnt(6)
v_mfma_f32_32x32x16_bf16 v[64:79], a[16:19], v[216:219], v[64:79]
ds_read_b64_tr_b16 a[12:13], v14 offset:43008
ds_read_b64_tr_b16 a[14:15], v14 offset:44032
v_mfma_f32_32x32x16_bf16 v[80:95], a[20:23], v[216:219], v[80:95]
ds_read_b64_tr_b16 a[16:17], v13 offset:45056
ds_read_b64_tr_b16 a[18:19], v13 offset:46080
v_mfma_f32_32x32x16_bf16 v[64:79], a[24:27], v[220:223], v[64:79]
ds_read_b64_tr_b16 a[20:21], v14 offset:45056
ds_read_b64_tr_b16 a[22:23], v14 offset:46080
v_mfma_f32_32x32x16_bf16 v[80:95], a[28:31], v[220:223], v[80:95]
ds_read_b64_tr_b16 a[24:25], v13 offset:47104
ds_read_b64_tr_b16 a[26:27], v13 offset:48128
s_waitcnt lgkmcnt(6)
v_mfma_f32_32x32x16_bf16 v[64:79], a[0:3], v[224:227], v[64:79]
ds_read_b64_tr_b16 a[28:29], v14 offset:47104
ds_read_b64_tr_b16 a[30:31], v14 offset:48128
s_waitcnt vmcnt(18)
s_barrier
v_mfma_f32_32x32x16_bf16 v[80:95], a[4:7], v[224:227], v[80:95]
ds_read_b64_tr_b16 a[0:1], v9 offset:0
ds_read_b64_tr_b16 a[2:3], v9 offset:1024
s_add_u32 m0, s34, 98304
v_mfma_f32_32x32x16_bf16 v[64:79], a[8:11], v[228:231], v[64:79]
ds_read_b64_tr_b16 a[4:5], v10 offset:0
ds_read_b64_tr_b16 a[6:7], v10 offset:1024
v_mfma_f32_32x32x16_bf16 v[80:95], a[12:15], v[228:231], v[80:95]
ds_read_b64_tr_b16 a[8:9], v9 offset:2048
ds_read_b64_tr_b16 a[10:11], v9 offset:3072
buffer_load_dwordx4 v6, s[12:15], s30 offen lds
s_waitcnt lgkmcnt(6)
v_mfma_f32_32x32x16_bf16 v[64:79], a[16:19], v[232:235], v[64:79]
ds_read_b64_tr_b16 a[12:13], v10 offset:2048
ds_read_b64_tr_b16 a[14:15], v10 offset:3072
v_mfma_f32_32x32x16_bf16 v[80:95], a[20:23], v[232:235], v[80:95]
ds_read_b64_tr_b16 a[16:17], v9 offset:4096
ds_read_b64_tr_b16 a[18:19], v9 offset:5120
buffer_load_dwordx4 v7, s[12:15], s30 offen offset:1024 lds
v_mfma_f32_32x32x16_bf16 v[64:79], a[24:27], v[236:239], v[64:79]
ds_read_b64_tr_b16 a[20:21], v10 offset:4096
ds_read_b64_tr_b16 a[22:23], v10 offset:5120
v_mfma_f32_32x32x16_bf16 v[80:95], a[28:31], v[236:239], v[80:95]
ds_read_b64_tr_b16 a[24:25], v9 offset:6144
ds_read_b64_tr_b16 a[26:27], v9 offset:7168
buffer_load_dwordx4 v8, s[12:15], s30 offen offset:2048 lds
s_waitcnt lgkmcnt(6)
v_mfma_f32_32x32x16_bf16 v[32:47], a[0:3], v[96:99], 0
ds_read_b64_tr_b16 a[28:29], v10 offset:6144
ds_read_b64_tr_b16 a[30:31], v10 offset:7168
v_mfma_f32_32x32x16_bf16 v[48:63], a[4:7], v[96:99], 0
ds_read_b64_tr_b16 a[0:1], v9 offset:8192
ds_read_b64_tr_b16 a[2:3], v9 offset:9216
s_add_u32 m0, s34, 101376
v_mfma_f32_32x32x16_bf16 v[32:47], a[8:11], v[100:103], v[32:47]
ds_read_b64_tr_b16 a[4:5], v10 offset:8192
ds_read_b64_tr_b16 a[6:7], v10 offset:9216
v_mfma_f32_32x32x16_bf16 v[48:63], a[12:15], v[100:103], v[48:63]
ds_read_b64_tr_b16 a[8:9], v9 offset:10240
ds_read_b64_tr_b16 a[10:11], v9 offset:11264
buffer_load_dwordx4 v6, s[12:15], s31 offen lds
s_waitcnt lgkmcnt(6)
v_mfma_f32_32x32x16_bf16 v[32:47], a[16:19], v[104:107], v[32:47]
ds_read_b64_tr_b16 a[12:13], v10 offset:10240
ds_read_b64_tr_b16 a[14:15], v10 offset:11264
v_mul_f32 v64, s48, v64
v_mul_f32 v65, s48, v65
v_mfma_f32_32x32x16_bf16 v[48:63], a[20:23], v[104:107], v[48:63]
ds_read_b64_tr_b16 a[16:17], v9 offset:12288
ds_read_b64_tr_b16 a[18:19], v9 offset:13312
buffer_load_dwordx4 v7, s[12:15], s31 offen offset:1024 lds
v_mfma_f32_32x32x16_bf16 v[32:47], a[24:27], v[108:111], v[32:47]
ds_read_b64_tr_b16 a[20:21], v10 offset:12288
ds_read_b64_tr_b16 a[22:23], v10 offset:13312
v_mul_f32 v66, s48, v66
v_mul_f32 v67, s48, v67
v_mfma_f32_32x32x16_bf16 v[48:63], a[28:31], v[108:111], v[48:63]
ds_read_b64_tr_b16 a[24:25], v9 offset:14336
ds_read_b64_tr_b16 a[26:27], v9 offset:15360
buffer_load_dwordx4 v8, s[12:15], s31 offen offset:2048 lds
s_waitcnt lgkmcnt(6)
v_mfma_f32_32x32x16_bf16 v[32:47], a[0:3], v[112:115], v[32:47]
ds_read_b64_tr_b16 a[28:29], v10 offset:14336
ds_read_b64_tr_b16 a[30:31], v10 offset:15360
v_mul_f32 v68, s48, v68
v_mul_f32 v69, s48, v69
v_mfma_f32_32x32x16_bf16 v[48:63], a[4:7], v[112:115], v[48:63]
ds_read_b64_tr_b16 a[0:1], v9 offset:16384
ds_read_b64_tr_b16 a[2:3], v9 offset:17408
s_add_u32 s30, s30, 0x36000
v_mul_f32 v70, s48, v70
v_mfma_f32_32x32x16_bf16 v[32:47], a[8:11], v[116:119], v[32:47]
ds_read_b64_tr_b16 a[4:5], v10 offset:16384
ds_read_b64_tr_b16 a[6:7], v10 offset:17408
v_mul_f32 v71, s48, v71
v_mul_f32 v72, s48, v72
v_mfma_f32_32x32x16_bf16 v[48:63], a[12:15], v[116:119], v[48:63]
ds_read_b64_tr_b16 a[8:9], v9 offset:18432
ds_read_b64_tr_b16 a[10:11], v9 offset:19456
s_add_u32 s31, s31, 0x36000
s_waitcnt lgkmcnt(6)
v_mfma_f32_32x32x16_bf16 v[32:47], a[16:19], v[120:123], v[32:47]
ds_read_b64_tr_b16 a[12:13], v10 offset:18432
ds_read_b64_tr_b16 a[14:15], v10 offset:19456
v_mul_f32 v73, s48, v73
v_mul_f32 v74, s48, v74
v_mfma_f32_32x32x16_bf16 v[48:63], a[20:23], v[120:123], v[48:63]
ds_read_b64_tr_b16 a[16:17], v9 offset:20480
ds_read_b64_tr_b16 a[18:19], v9 offset:21504
v_mul_f32 v75, s48, v75
v_mul_f32 v76, s48, v76
v_mfma_f32_32x32x16_bf16 v[32:47], a[24:27], v[124:127], v[32:47]
ds_read_b64_tr_b16 a[20:21], v10 offset:20480
ds_read_b64_tr_b16 a[22:23], v10 offset:21504
v_mul_f32 v77, s48, v77
v_mul_f32 v78, s48, v78
v_mfma_f32_32x32x16_bf16 v[48:63], a[28:31], v[124:127], v[48:63]
ds_read_b64_tr_b16 a[24:25], v9 offset:22528
ds_read_b64_tr_b16 a[26:27], v9 offset:23552
v_mul_f32 v79, s48, v79
s_waitcnt lgkmcnt(6)
v_mfma_f32_32x32x16_bf16 v[32:47], a[0:3], v[128:131], v[32:47]
ds_read_b64_tr_b16 a[28:29], v10 offset:22528
ds_read_b64_tr_b16 a[30:31], v10 offset:23552
s_waitcnt vmcnt(18)
s_barrier
v_mfma_f32_32x32x16_bf16 v[48:63], a[4:7], v[128:131], v[48:63]
ds_read_b64_tr_b16 a[0:1], v9 offset:24576
ds_read_b64_tr_b16 a[2:3], v9 offset:25600
s_add_u32 m0, s34, 122880
v_cvt_pk_bf16_f32 v64, v64, v65
v_mfma_f32_32x32x16_bf16 v[32:47], a[8:11], v[132:135], v[32:47]
ds_read_b64_tr_b16 a[4:5], v10 offset:24576
ds_read_b64_tr_b16 a[6:7], v10 offset:25600
v_cvt_pk_bf16_f32 v65, v66, v67
v_cvt_pk_bf16_f32 v66, v68, v69
v_mfma_f32_32x32x16_bf16 v[48:63], a[12:15], v[132:135], v[48:63]
ds_read_b64_tr_b16 a[8:9], v9 offset:26624
ds_read_b64_tr_b16 a[10:11], v9 offset:27648
buffer_load_dwordx4 v6, s[12:15], s30 offen lds
s_waitcnt lgkmcnt(6)
v_mfma_f32_32x32x16_bf16 v[32:47], a[16:19], v[136:139], v[32:47]
ds_read_b64_tr_b16 a[12:13], v10 offset:26624
ds_read_b64_tr_b16 a[14:15], v10 offset:27648
v_cvt_pk_bf16_f32 v67, v70, v71
v_cvt_pk_bf16_f32 v68, v72, v73
v_mfma_f32_32x32x16_bf16 v[48:63], a[20:23], v[136:139], v[48:63]
ds_read_b64_tr_b16 a[16:17], v9 offset:28672
ds_read_b64_tr_b16 a[18:19], v9 offset:29696
buffer_load_dwordx4 v7, s[12:15], s30 offen offset:1024 lds
v_mfma_f32_32x32x16_bf16 v[32:47], a[24:27], v[140:143], v[32:47]
ds_read_b64_tr_b16 a[20:21], v10 offset:28672
ds_read_b64_tr_b16 a[22:23], v10 offset:29696
v_cvt_pk_bf16_f32 v69, v74, v75
v_cvt_pk_bf16_f32 v70, v76, v77
v_mfma_f32_32x32x16_bf16 v[48:63], a[28:31], v[140:143], v[48:63]
ds_read_b64_tr_b16 a[24:25], v9 offset:30720
ds_read_b64_tr_b16 a[26:27], v9 offset:31744
buffer_load_dwordx4 v8, s[12:15], s30 offen offset:2048 lds
s_waitcnt lgkmcnt(6)
v_mfma_f32_32x32x16_bf16 v[32:47], a[0:3], v[144:147], v[32:47]
ds_read_b64_tr_b16 a[28:29], v10 offset:30720
ds_read_b64_tr_b16 a[30:31], v10 offset:31744
v_cvt_pk_bf16_f32 v71, v78, v79
v_mfma_f32_32x32x16_bf16 v[48:63], a[4:7], v[144:147], v[48:63]
ds_read_b64_tr_b16 a[0:1], v9 offset:32768
ds_read_b64_tr_b16 a[2:3], v9 offset:33792
s_add_u32 m0, s34, 125952
v_mfma_f32_32x32x16_bf16 v[32:47], a[8:11], v[148:151], v[32:47]
ds_read_b64_tr_b16 a[4:5], v10 offset:32768
ds_read_b64_tr_b16 a[6:7], v10 offset:33792
buffer_store_dwordx4 v[64:67], v2, s[16:19], s40 offen offset:0 sc1
v_mfma_f32_32x32x16_bf16 v[48:63], a[12:15], v[148:151], v[48:63]
ds_read_b64_tr_b16 a[8:9], v9 offset:34816
ds_read_b64_tr_b16 a[10:11], v9 offset:35840
buffer_load_dwordx4 v6, s[12:15], s31 offen lds
s_waitcnt lgkmcnt(6)
v_mfma_f32_32x32x16_bf16 v[32:47], a[16:19], v[152:155], v[32:47]
ds_read_b64_tr_b16 a[12:13], v10 offset:34816
ds_read_b64_tr_b16 a[14:15], v10 offset:35840
buffer_store_dwordx4 v[68:71], v2, s[16:19], s40 offen offset:1024 sc1
v_mfma_f32_32x32x16_bf16 v[48:63], a[20:23], v[152:155], v[48:63]
ds_read_b64_tr_b16 a[16:17], v9 offset:36864
ds_read_b64_tr_b16 a[18:19], v9 offset:37888
buffer_load_dwordx4 v7, s[12:15], s31 offen offset:1024 lds
v_mfma_f32_32x32x16_bf16 v[32:47], a[24:27], v[156:159], v[32:47]
ds_read_b64_tr_b16 a[20:21], v10 offset:36864
ds_read_b64_tr_b16 a[22:23], v10 offset:37888
v_mul_f32 v80, s48, v80
v_mul_f32 v81, s48, v81
v_mfma_f32_32x32x16_bf16 v[48:63], a[28:31], v[156:159], v[48:63]
ds_read_b64_tr_b16 a[24:25], v9 offset:38912
ds_read_b64_tr_b16 a[26:27], v9 offset:39936
buffer_load_dwordx4 v8, s[12:15], s31 offen offset:2048 lds
s_waitcnt lgkmcnt(6)
v_mfma_f32_32x32x16_bf16 v[32:47], a[0:3], v[160:163], v[32:47]
ds_read_b64_tr_b16 a[28:29], v10 offset:38912
ds_read_b64_tr_b16 a[30:31], v10 offset:39936
v_mul_f32 v82, s48, v82
v_mul_f32 v83, s48, v83
v_mfma_f32_32x32x16_bf16 v[48:63], a[4:7], v[160:163], v[48:63]
ds_read_b64_tr_b16 a[0:1], v9 offset:40960
ds_read_b64_tr_b16 a[2:3], v9 offset:41984
s_add_u32 s30, s30, 0xfff94080
v_mul_f32 v84, s48, v84
v_mfma_f32_32x32x16_bf16 v[32:47], a[8:11], v[164:167], v[32:47]
ds_read_b64_tr_b16 a[4:5], v10 offset:40960
ds_read_b64_tr_b16 a[6:7], v10 offset:41984
v_mul_f32 v85, s48, v85
v_mul_f32 v86, s48, v86
v_mfma_f32_32x32x16_bf16 v[48:63], a[12:15], v[164:167], v[48:63]
ds_read_b64_tr_b16 a[8:9], v9 offset:43008
ds_read_b64_tr_b16 a[10:11], v9 offset:44032
s_add_u32 s31, s31, 0xfff94080
s_waitcnt lgkmcnt(6)
v_mfma_f32_32x32x16_bf16 v[32:47], a[16:19], v[168:171], v[32:47]
ds_read_b64_tr_b16 a[12:13], v10 offset:43008
ds_read_b64_tr_b16 a[14:15], v10 offset:44032
v_mul_f32 v87, s48, v87
v_mul_f32 v88, s48, v88
v_mfma_f32_32x32x16_bf16 v[48:63], a[20:23], v[168:171], v[48:63]
ds_read_b64_tr_b16 a[16:17], v9 offset:45056
ds_read_b64_tr_b16 a[18:19], v9 offset:46080
v_mul_f32 v89, s48, v89
v_mul_f32 v90, s48, v90
v_mfma_f32_32x32x16_bf16 v[32:47], a[24:27], v[172:175], v[32:47]
ds_read_b64_tr_b16 a[20:21], v10 offset:45056
ds_read_b64_tr_b16 a[22:23], v10 offset:46080
v_mul_f32 v91, s48, v91
v_mul_f32 v92, s48, v92
v_mfma_f32_32x32x16_bf16 v[48:63], a[28:31], v[172:175], v[48:63]
ds_read_b64_tr_b16 a[24:25], v9 offset:47104
ds_read_b64_tr_b16 a[26:27], v9 offset:48128
v_mul_f32 v93, s48, v93
s_waitcnt lgkmcnt(6)
v_mfma_f32_32x32x16_bf16 v[32:47], a[0:3], v[176:179], v[32:47]
ds_read_b64_tr_b16 a[28:29], v10 offset:47104
ds_read_b64_tr_b16 a[30:31], v10 offset:48128
s_waitcnt vmcnt(20)
s_barrier
v_mfma_f32_32x32x16_bf16 v[48:63], a[4:7], v[176:179], v[48:63]
ds_read_b64_tr_b16 a[0:1], v11 offset:0
ds_read_b64_tr_b16 a[2:3], v11 offset:1024
s_add_u32 m0, s34, 0
v_mul_f32 v94, s48, v94
v_mfma_f32_32x32x16_bf16 v[32:47], a[8:11], v[180:183], v[32:47]
ds_read_b64_tr_b16 a[4:5], v12 offset:0
ds_read_b64_tr_b16 a[6:7], v12 offset:1024
v_mul_f32 v95, s48, v95
v_cvt_pk_bf16_f32 v80, v80, v81
v_mfma_f32_32x32x16_bf16 v[48:63], a[12:15], v[180:183], v[48:63]
ds_read_b64_tr_b16 a[8:9], v11 offset:2048
ds_read_b64_tr_b16 a[10:11], v11 offset:3072
buffer_load_dwordx4 v6, s[12:15], s30 offen lds
s_waitcnt lgkmcnt(6)
v_mfma_f32_32x32x16_bf16 v[32:47], a[16:19], v[184:187], v[32:47]
ds_read_b64_tr_b16 a[12:13], v12 offset:2048
ds_read_b64_tr_b16 a[14:15], v12 offset:3072
v_cvt_pk_bf16_f32 v81, v82, v83
v_cvt_pk_bf16_f32 v82, v84, v85
v_mfma_f32_32x32x16_bf16 v[48:63], a[20:23], v[184:187], v[48:63]
ds_read_b64_tr_b16 a[16:17], v11 offset:4096
ds_read_b64_tr_b16 a[18:19], v11 offset:5120
buffer_load_dwordx4 v7, s[12:15], s30 offen offset:1024 lds
v_mfma_f32_32x32x16_bf16 v[32:47], a[24:27], v[188:191], v[32:47]
ds_read_b64_tr_b16 a[20:21], v12 offset:4096
ds_read_b64_tr_b16 a[22:23], v12 offset:5120
v_cvt_pk_bf16_f32 v83, v86, v87
v_cvt_pk_bf16_f32 v84, v88, v89
v_mfma_f32_32x32x16_bf16 v[48:63], a[28:31], v[188:191], v[48:63]
ds_read_b64_tr_b16 a[24:25], v11 offset:6144
ds_read_b64_tr_b16 a[26:27], v11 offset:7168
buffer_load_dwordx4 v8, s[12:15], s30 offen offset:2048 lds
s_waitcnt lgkmcnt(6)
v_mfma_f32_32x32x16_bf16 v[32:47], a[0:3], v[192:195], v[32:47]
ds_read_b64_tr_b16 a[28:29], v12 offset:6144
ds_read_b64_tr_b16 a[30:31], v12 offset:7168
v_cvt_pk_bf16_f32 v85, v90, v91
v_cvt_pk_bf16_f32 v86, v92, v93
v_mfma_f32_32x32x16_bf16 v[48:63], a[4:7], v[192:195], v[48:63]
ds_read_b64_tr_b16 a[0:1], v11 offset:8192
ds_read_b64_tr_b16 a[2:3], v11 offset:9216
s_add_u32 m0, s34, 3072
v_cvt_pk_bf16_f32 v87, v94, v95
v_mfma_f32_32x32x16_bf16 v[32:47], a[8:11], v[196:199], v[32:47]
ds_read_b64_tr_b16 a[4:5], v12 offset:8192
ds_read_b64_tr_b16 a[6:7], v12 offset:9216
buffer_store_dwordx4 v[80:83], v2, s[16:19], s40 offen offset:2048 sc1
v_mfma_f32_32x32x16_bf16 v[48:63], a[12:15], v[196:199], v[48:63]
ds_read_b64_tr_b16 a[8:9], v11 offset:10240
ds_read_b64_tr_b16 a[10:11], v11 offset:11264
buffer_load_dwordx4 v6, s[12:15], s31 offen lds
s_waitcnt lgkmcnt(6)
v_mfma_f32_32x32x16_bf16 v[32:47], a[16:19], v[200:203], v[32:47]
ds_read_b64_tr_b16 a[12:13], v12 offset:10240
ds_read_b64_tr_b16 a[14:15], v12 offset:11264
buffer_store_dwordx4 v[84:87], v2, s[16:19], s40 offen offset:3072 sc1
v_mfma_f32_32x32x16_bf16 v[48:63], a[20:23], v[200:203], v[48:63]
ds_read_b64_tr_b16 a[16:17], v11 offset:12288
ds_read_b64_tr_b16 a[18:19], v11 offset:13312
buffer_load_dwordx4 v7, s[12:15], s31 offen offset:1024 lds
v_mfma_f32_32x32x16_bf16 v[32:47], a[24:27], v[204:207], v[32:47]
ds_read_b64_tr_b16 a[20:21], v12 offset:12288
ds_read_b64_tr_b16 a[22:23], v12 offset:13312
s_add_u32 s40, s40, 4096
v_mfma_f32_32x32x16_bf16 v[48:63], a[28:31], v[204:207], v[48:63]
ds_read_b64_tr_b16 a[24:25], v11 offset:14336
ds_read_b64_tr_b16 a[26:27], v11 offset:15360
buffer_load_dwordx4 v8, s[12:15], s31 offen offset:2048 lds
s_waitcnt lgkmcnt(6)
v_mfma_f32_32x32x16_bf16 v[32:47], a[0:3], v[208:211], v[32:47]
ds_read_b64_tr_b16 a[28:29], v12 offset:14336
ds_read_b64_tr_b16 a[30:31], v12 offset:15360
v_mfma_f32_32x32x16_bf16 v[48:63], a[4:7], v[208:211], v[48:63]
ds_read_b64_tr_b16 a[0:1], v11 offset:16384
ds_read_b64_tr_b16 a[2:3], v11 offset:17408
s_add_u32 s30, s30, 0x36000
v_mfma_f32_32x32x16_bf16 v[32:47], a[8:11], v[212:215], v[32:47]
ds_read_b64_tr_b16 a[4:5], v12 offset:16384
ds_read_b64_tr_b16 a[6:7], v12 offset:17408
v_mfma_f32_32x32x16_bf16 v[48:63], a[12:15], v[212:215], v[48:63]
ds_read_b64_tr_b16 a[8:9], v11 offset:18432
ds_read_b64_tr_b16 a[10:11], v11 offset:19456
s_add_u32 s31, s31, 0x36000
s_waitcnt lgkmcnt(6)
v_mfma_f32_32x32x16_bf16 v[32:47], a[16:19], v[216:219], v[32:47]
ds_read_b64_tr_b16 a[12:13], v12 offset:18432
ds_read_b64_tr_b16 a[14:15], v12 offset:19456
v_mfma_f32_32x32x16_bf16 v[48:63], a[20:23], v[216:219], v[48:63]
ds_read_b64_tr_b16 a[16:17], v11 offset:20480
ds_read_b64_tr_b16 a[18:19], v11 offset:21504
v_mfma_f32_32x32x16_bf16 v[32:47], a[24:27], v[220:223], v[32:47]
ds_read_b64_tr_b16 a[20:21], v12 offset:20480
ds_read_b64_tr_b16 a[22:23], v12 offset:21504
v_mfma_f32_32x32x16_bf16 v[48:63], a[28:31], v[220:223], v[48:63]
ds_read_b64_tr_b16 a[24:25], v11 offset:22528
ds_read_b64_tr_b16 a[26:27], v11 offset:23552
s_waitcnt lgkmcnt(6)
v_mfma_f32_32x32x16_bf16 v[32:47], a[0:3], v[224:227], v[32:47]
ds_read_b64_tr_b16 a[28:29], v12 offset:22528
ds_read_b64_tr_b16 a[30:31], v12 offset:23552
s_waitcnt vmcnt(22)
s_barrier
v_mfma_f32_32x32x16_bf16 v[48:63], a[4:7], v[224:227], v[48:63]
ds_read_b64_tr_b16 a[0:1], v11 offset:24576
ds_read_b64_tr_b16 a[2:3], v11 offset:25600
s_add_u32 m0, s34, 24576
v_mfma_f32_32x32x16_bf16 v[32:47], a[8:11], v[228:231], v[32:47]
ds_read_b64_tr_b16 a[4:5], v12 offset:24576
ds_read_b64_tr_b16 a[6:7], v12 offset:25600
v_mfma_f32_32x32x16_bf16 v[48:63], a[12:15], v[228:231], v[48:63]
ds_read_b64_tr_b16 a[8:9], v11 offset:26624
ds_read_b64_tr_b16 a[10:11], v11 offset:27648
buffer_load_dwordx4 v6, s[12:15], s30 offen lds
s_waitcnt lgkmcnt(6)
v_mfma_f32_32x32x16_bf16 v[32:47], a[16:19], v[232:235], v[32:47]
ds_read_b64_tr_b16 a[12:13], v12 offset:26624
ds_read_b64_tr_b16 a[14:15], v12 offset:27648
v_mfma_f32_32x32x16_bf16 v[48:63], a[20:23], v[232:235], v[48:63]
ds_read_b64_tr_b16 a[16:17], v11 offset:28672
ds_read_b64_tr_b16 a[18:19], v11 offset:29696
buffer_load_dwordx4 v7, s[12:15], s30 offen offset:1024 lds
v_mfma_f32_32x32x16_bf16 v[32:47], a[24:27], v[236:239], v[32:47]
ds_read_b64_tr_b16 a[20:21], v12 offset:28672
ds_read_b64_tr_b16 a[22:23], v12 offset:29696
v_mfma_f32_32x32x16_bf16 v[48:63], a[28:31], v[236:239], v[48:63]
ds_read_b64_tr_b16 a[24:25], v11 offset:30720
ds_read_b64_tr_b16 a[26:27], v11 offset:31744
buffer_load_dwordx4 v8, s[12:15], s30 offen offset:2048 lds
s_waitcnt lgkmcnt(6)
v_mfma_f32_32x32x16_bf16 v[64:79], a[0:3], v[96:99], 0
ds_read_b64_tr_b16 a[28:29], v12 offset:30720
ds_read_b64_tr_b16 a[30:31], v12 offset:31744
v_mfma_f32_32x32x16_bf16 v[80:95], a[4:7], v[96:99], 0
ds_read_b64_tr_b16 a[0:1], v11 offset:32768
ds_read_b64_tr_b16 a[2:3], v11 offset:33792
s_add_u32 m0, s34, 27648
v_mfma_f32_32x32x16_bf16 v[64:79], a[8:11], v[100:103], v[64:79]
ds_read_b64_tr_b16 a[4:5], v12 offset:32768
ds_read_b64_tr_b16 a[6:7], v12 offset:33792
v_mfma_f32_32x32x16_bf16 v[80:95], a[12:15], v[100:103], v[80:95]
ds_read_b64_tr_b16 a[8:9], v11 offset:34816
ds_read_b64_tr_b16 a[10:11], v11 offset:35840
buffer_load_dwordx4 v6, s[12:15], s31 offen lds
s_waitcnt lgkmcnt(6)
v_mfma_f32_32x32x16_bf16 v[64:79], a[16:19], v[104:107], v[64:79]
ds_read_b64_tr_b16 a[12:13], v12 offset:34816
ds_read_b64_tr_b16 a[14:15], v12 offset:35840
v_mul_f32 v32, s48, v32
v_mul_f32 v33, s48, v33
v_mfma_f32_32x32x16_bf16 v[80:95], a[20:23], v[104:107], v[80:95]
ds_read_b64_tr_b16 a[16:17], v11 offset:36864
ds_read_b64_tr_b16 a[18:19], v11 offset:37888
buffer_load_dwordx4 v7, s[12:15], s31 offen offset:1024 lds
v_mfma_f32_32x32x16_bf16 v[64:79], a[24:27], v[108:111], v[64:79]
ds_read_b64_tr_b16 a[20:21], v12 offset:36864
ds_read_b64_tr_b16 a[22:23], v12 offset:37888
v_mul_f32 v34, s48, v34
v_mul_f32 v35, s48, v35
v_mfma_f32_32x32x16_bf16 v[80:95], a[28:31], v[108:111], v[80:95]
ds_read_b64_tr_b16 a[24:25], v11 offset:38912
ds_read_b64_tr_b16 a[26:27], v11 offset:39936
buffer_load_dwordx4 v8, s[12:15], s31 offen offset:2048 lds
s_waitcnt lgkmcnt(6)
v_mfma_f32_32x32x16_bf16 v[64:79], a[0:3], v[112:115], v[64:79]
ds_read_b64_tr_b16 a[28:29], v12 offset:38912
ds_read_b64_tr_b16 a[30:31], v12 offset:39936
v_mul_f32 v36, s48, v36
v_mul_f32 v37, s48, v37
v_mfma_f32_32x32x16_bf16 v[80:95], a[4:7], v[112:115], v[80:95]
ds_read_b64_tr_b16 a[0:1], v11 offset:40960
ds_read_b64_tr_b16 a[2:3], v11 offset:41984
s_add_u32 s30, s30, 0x36000
v_mul_f32 v38, s48, v38
v_mfma_f32_32x32x16_bf16 v[64:79], a[8:11], v[116:119], v[64:79]
ds_read_b64_tr_b16 a[4:5], v12 offset:40960
ds_read_b64_tr_b16 a[6:7], v12 offset:41984
v_mul_f32 v39, s48, v39
v_mul_f32 v40, s48, v40
v_mfma_f32_32x32x16_bf16 v[80:95], a[12:15], v[116:119], v[80:95]
ds_read_b64_tr_b16 a[8:9], v11 offset:43008
ds_read_b64_tr_b16 a[10:11], v11 offset:44032
s_add_u32 s31, s31, 0x36000
s_waitcnt lgkmcnt(6)
v_mfma_f32_32x32x16_bf16 v[64:79], a[16:19], v[120:123], v[64:79]
ds_read_b64_tr_b16 a[12:13], v12 offset:43008
ds_read_b64_tr_b16 a[14:15], v12 offset:44032
v_mul_f32 v41, s48, v41
v_mul_f32 v42, s48, v42
v_mfma_f32_32x32x16_bf16 v[80:95], a[20:23], v[120:123], v[80:95]
ds_read_b64_tr_b16 a[16:17], v11 offset:45056
ds_read_b64_tr_b16 a[18:19], v11 offset:46080
v_mul_f32 v43, s48, v43
v_mul_f32 v44, s48, v44
v_mfma_f32_32x32x16_bf16 v[64:79], a[24:27], v[124:127], v[64:79]
ds_read_b64_tr_b16 a[20:21], v12 offset:45056
ds_read_b64_tr_b16 a[22:23], v12 offset:46080
v_mul_f32 v45, s48, v45
v_mul_f32 v46, s48, v46
v_mfma_f32_32x32x16_bf16 v[80:95], a[28:31], v[124:127], v[80:95]
ds_read_b64_tr_b16 a[24:25], v11 offset:47104
ds_read_b64_tr_b16 a[26:27], v11 offset:48128
v_mul_f32 v47, s48, v47
s_waitcnt lgkmcnt(6)
v_mfma_f32_32x32x16_bf16 v[64:79], a[0:3], v[128:131], v[64:79]
ds_read_b64_tr_b16 a[28:29], v12 offset:47104
ds_read_b64_tr_b16 a[30:31], v12 offset:48128
s_waitcnt vmcnt(22)
s_barrier
v_mfma_f32_32x32x16_bf16 v[80:95], a[4:7], v[128:131], v[80:95]
ds_read_b64_tr_b16 a[0:1], v13 offset:0
ds_read_b64_tr_b16 a[2:3], v13 offset:1024
s_add_u32 m0, s34, 49152
v_cvt_pk_bf16_f32 v32, v32, v33
v_mfma_f32_32x32x16_bf16 v[64:79], a[8:11], v[132:135], v[64:79]
ds_read_b64_tr_b16 a[4:5], v14 offset:0
ds_read_b64_tr_b16 a[6:7], v14 offset:1024
v_cvt_pk_bf16_f32 v33, v34, v35
v_cvt_pk_bf16_f32 v34, v36, v37
v_mfma_f32_32x32x16_bf16 v[80:95], a[12:15], v[132:135], v[80:95]
ds_read_b64_tr_b16 a[8:9], v13 offset:2048
ds_read_b64_tr_b16 a[10:11], v13 offset:3072
buffer_load_dwordx4 v6, s[12:15], s30 offen lds
s_waitcnt lgkmcnt(6)
v_mfma_f32_32x32x16_bf16 v[64:79], a[16:19], v[136:139], v[64:79]
ds_read_b64_tr_b16 a[12:13], v14 offset:2048
ds_read_b64_tr_b16 a[14:15], v14 offset:3072
v_cvt_pk_bf16_f32 v35, v38, v39
v_cvt_pk_bf16_f32 v36, v40, v41
v_mfma_f32_32x32x16_bf16 v[80:95], a[20:23], v[136:139], v[80:95]
ds_read_b64_tr_b16 a[16:17], v13 offset:4096
ds_read_b64_tr_b16 a[18:19], v13 offset:5120
buffer_load_dwordx4 v7, s[12:15], s30 offen offset:1024 lds
v_mfma_f32_32x32x16_bf16 v[64:79], a[24:27], v[140:143], v[64:79]
ds_read_b64_tr_b16 a[20:21], v14 offset:4096
ds_read_b64_tr_b16 a[22:23], v14 offset:5120
v_cvt_pk_bf16_f32 v37, v42, v43
v_cvt_pk_bf16_f32 v38, v44, v45
v_mfma_f32_32x32x16_bf16 v[80:95], a[28:31], v[140:143], v[80:95]
ds_read_b64_tr_b16 a[24:25], v13 offset:6144
ds_read_b64_tr_b16 a[26:27], v13 offset:7168
buffer_load_dwordx4 v8, s[12:15], s30 offen offset:2048 lds
s_waitcnt lgkmcnt(6)
v_mfma_f32_32x32x16_bf16 v[64:79], a[0:3], v[144:147], v[64:79]
ds_read_b64_tr_b16 a[28:29], v14 offset:6144
ds_read_b64_tr_b16 a[30:31], v14 offset:7168
v_cvt_pk_bf16_f32 v39, v46, v47
v_mfma_f32_32x32x16_bf16 v[80:95], a[4:7], v[144:147], v[80:95]
ds_read_b64_tr_b16 a[0:1], v13 offset:8192
ds_read_b64_tr_b16 a[2:3], v13 offset:9216
s_add_u32 m0, s34, 52224
v_mfma_f32_32x32x16_bf16 v[64:79], a[8:11], v[148:151], v[64:79]
ds_read_b64_tr_b16 a[4:5], v14 offset:8192
ds_read_b64_tr_b16 a[6:7], v14 offset:9216
buffer_store_dwordx4 v[32:35], v2, s[16:19], s40 offen offset:0 sc1
v_mfma_f32_32x32x16_bf16 v[80:95], a[12:15], v[148:151], v[80:95]
ds_read_b64_tr_b16 a[8:9], v13 offset:10240
ds_read_b64_tr_b16 a[10:11], v13 offset:11264
buffer_load_dwordx4 v6, s[12:15], s31 offen lds
s_waitcnt lgkmcnt(6)
v_mfma_f32_32x32x16_bf16 v[64:79], a[16:19], v[152:155], v[64:79]
ds_read_b64_tr_b16 a[12:13], v14 offset:10240
ds_read_b64_tr_b16 a[14:15], v14 offset:11264
buffer_store_dwordx4 v[36:39], v2, s[16:19], s40 offen offset:1024 sc1
v_mfma_f32_32x32x16_bf16 v[80:95], a[20:23], v[152:155], v[80:95]
ds_read_b64_tr_b16 a[16:17], v13 offset:12288
ds_read_b64_tr_b16 a[18:19], v13 offset:13312
buffer_load_dwordx4 v7, s[12:15], s31 offen offset:1024 lds
v_mfma_f32_32x32x16_bf16 v[64:79], a[24:27], v[156:159], v[64:79]
ds_read_b64_tr_b16 a[20:21], v14 offset:12288
ds_read_b64_tr_b16 a[22:23], v14 offset:13312
v_mul_f32 v48, s48, v48
v_mul_f32 v49, s48, v49
v_mfma_f32_32x32x16_bf16 v[80:95], a[28:31], v[156:159], v[80:95]
ds_read_b64_tr_b16 a[24:25], v13 offset:14336
ds_read_b64_tr_b16 a[26:27], v13 offset:15360
buffer_load_dwordx4 v8, s[12:15], s31 offen offset:2048 lds
s_waitcnt lgkmcnt(6)
v_mfma_f32_32x32x16_bf16 v[64:79], a[0:3], v[160:163], v[64:79]
ds_read_b64_tr_b16 a[28:29], v14 offset:14336
ds_read_b64_tr_b16 a[30:31], v14 offset:15360
v_mul_f32 v50, s48, v50
v_mul_f32 v51, s48, v51
v_mfma_f32_32x32x16_bf16 v[80:95], a[4:7], v[160:163], v[80:95]
ds_read_b64_tr_b16 a[0:1], v13 offset:16384
ds_read_b64_tr_b16 a[2:3], v13 offset:17408
s_add_u32 s30, s30, 0xfff94080
v_mul_f32 v52, s48, v52
v_mfma_f32_32x32x16_bf16 v[64:79], a[8:11], v[164:167], v[64:79]
ds_read_b64_tr_b16 a[4:5], v14 offset:16384
ds_read_b64_tr_b16 a[6:7], v14 offset:17408
v_mul_f32 v53, s48, v53
v_mul_f32 v54, s48, v54
v_mfma_f32_32x32x16_bf16 v[80:95], a[12:15], v[164:167], v[80:95]
ds_read_b64_tr_b16 a[8:9], v13 offset:18432
ds_read_b64_tr_b16 a[10:11], v13 offset:19456
s_add_u32 s31, s31, 0xfff94080
s_waitcnt lgkmcnt(6)
v_mfma_f32_32x32x16_bf16 v[64:79], a[16:19], v[168:171], v[64:79]
ds_read_b64_tr_b16 a[12:13], v14 offset:18432
ds_read_b64_tr_b16 a[14:15], v14 offset:19456
v_mul_f32 v55, s48, v55
v_mul_f32 v56, s48, v56
v_mfma_f32_32x32x16_bf16 v[80:95], a[20:23], v[168:171], v[80:95]
ds_read_b64_tr_b16 a[16:17], v13 offset:20480
ds_read_b64_tr_b16 a[18:19], v13 offset:21504
v_mul_f32 v57, s48, v57
v_mul_f32 v58, s48, v58
v_mfma_f32_32x32x16_bf16 v[64:79], a[24:27], v[172:175], v[64:79]
ds_read_b64_tr_b16 a[20:21], v14 offset:20480
ds_read_b64_tr_b16 a[22:23], v14 offset:21504
v_mul_f32 v59, s48, v59
v_mul_f32 v60, s48, v60
v_mfma_f32_32x32x16_bf16 v[80:95], a[28:31], v[172:175], v[80:95]
ds_read_b64_tr_b16 a[24:25], v13 offset:22528
ds_read_b64_tr_b16 a[26:27], v13 offset:23552
v_mul_f32 v61, s48, v61
s_waitcnt lgkmcnt(6)
v_mfma_f32_32x32x16_bf16 v[64:79], a[0:3], v[176:179], v[64:79]
ds_read_b64_tr_b16 a[28:29], v14 offset:22528
ds_read_b64_tr_b16 a[30:31], v14 offset:23552
s_waitcnt vmcnt(16)
s_barrier
v_add_u32 v254, 1024, v254
buffer_store_dword v255, v254, s[60:63], 0 offen sc1
v_mfma_f32_32x32x16_bf16 v[80:95], a[4:7], v[176:179], v[80:95]
ds_read_b64_tr_b16 a[0:1], v13 offset:24576
ds_read_b64_tr_b16 a[2:3], v13 offset:25600
s_add_u32 m0, s34, 73728
v_mul_f32 v62, s48, v62
v_mfma_f32_32x32x16_bf16 v[64:79], a[8:11], v[180:183], v[64:79]
ds_read_b64_tr_b16 a[4:5], v14 offset:24576
ds_read_b64_tr_b16 a[6:7], v14 offset:25600
v_mul_f32 v63, s48, v63
v_cvt_pk_bf16_f32 v48, v48, v49
v_mfma_f32_32x32x16_bf16 v[80:95], a[12:15], v[180:183], v[80:95]
ds_read_b64_tr_b16 a[8:9], v13 offset:26624
ds_read_b64_tr_b16 a[10:11], v13 offset:27648
buffer_load_dwordx4 v6, s[12:15], s30 offen lds
s_waitcnt lgkmcnt(6)
v_mfma_f32_32x32x16_bf16 v[64:79], a[16:19], v[184:187], v[64:79]
ds_read_b64_tr_b16 a[12:13], v14 offset:26624
ds_read_b64_tr_b16 a[14:15], v14 offset:27648
v_cvt_pk_bf16_f32 v49, v50, v51
v_cvt_pk_bf16_f32 v50, v52, v53
v_mfma_f32_32x32x16_bf16 v[80:95], a[20:23], v[184:187], v[80:95]
ds_read_b64_tr_b16 a[16:17], v13 offset:28672
ds_read_b64_tr_b16 a[18:19], v13 offset:29696
buffer_load_dwordx4 v7, s[12:15], s30 offen offset:1024 lds
v_mfma_f32_32x32x16_bf16 v[64:79], a[24:27], v[188:191], v[64:79]
ds_read_b64_tr_b16 a[20:21], v14 offset:28672
ds_read_b64_tr_b16 a[22:23], v14 offset:29696
v_cvt_pk_bf16_f32 v51, v54, v55
v_cvt_pk_bf16_f32 v52, v56, v57
v_mfma_f32_32x32x16_bf16 v[80:95], a[28:31], v[188:191], v[80:95]
ds_read_b64_tr_b16 a[24:25], v13 offset:30720
ds_read_b64_tr_b16 a[26:27], v13 offset:31744
buffer_load_dwordx4 v8, s[12:15], s30 offen offset:2048 lds
s_waitcnt lgkmcnt(6)
v_mfma_f32_32x32x16_bf16 v[64:79], a[0:3], v[192:195], v[64:79]
ds_read_b64_tr_b16 a[28:29], v14 offset:30720
ds_read_b64_tr_b16 a[30:31], v14 offset:31744
v_cvt_pk_bf16_f32 v53, v58, v59
v_cvt_pk_bf16_f32 v54, v60, v61
v_mfma_f32_32x32x16_bf16 v[80:95], a[4:7], v[192:195], v[80:95]
ds_read_b64_tr_b16 a[0:1], v13 offset:32768
ds_read_b64_tr_b16 a[2:3], v13 offset:33792
s_add_u32 m0, s34, 76800
v_cvt_pk_bf16_f32 v55, v62, v63
v_mfma_f32_32x32x16_bf16 v[64:79], a[8:11], v[196:199], v[64:79]
ds_read_b64_tr_b16 a[4:5], v14 offset:32768
ds_read_b64_tr_b16 a[6:7], v14 offset:33792
buffer_store_dwordx4 v[48:51], v2, s[16:19], s40 offen offset:2048 sc1
v_mfma_f32_32x32x16_bf16 v[80:95], a[12:15], v[196:199], v[80:95]
ds_read_b64_tr_b16 a[8:9], v13 offset:34816
ds_read_b64_tr_b16 a[10:11], v13 offset:35840
buffer_load_dwordx4 v6, s[12:15], s31 offen lds
s_waitcnt lgkmcnt(6)
v_mfma_f32_32x32x16_bf16 v[64:79], a[16:19], v[200:203], v[64:79]
ds_read_b64_tr_b16 a[12:13], v14 offset:34816
ds_read_b64_tr_b16 a[14:15], v14 offset:35840
buffer_store_dwordx4 v[52:55], v2, s[16:19], s40 offen offset:3072 sc1
v_mfma_f32_32x32x16_bf16 v[80:95], a[20:23], v[200:203], v[80:95]
ds_read_b64_tr_b16 a[16:17], v13 offset:36864
ds_read_b64_tr_b16 a[18:19], v13 offset:37888
buffer_load_dwordx4 v7, s[12:15], s31 offen offset:1024 lds
v_mfma_f32_32x32x16_bf16 v[64:79], a[24:27], v[204:207], v[64:79]
ds_read_b64_tr_b16 a[20:21], v14 offset:36864
ds_read_b64_tr_b16 a[22:23], v14 offset:37888
s_add_u32 s40, s40, 4096
v_mfma_f32_32x32x16_bf16 v[80:95], a[28:31], v[204:207], v[80:95]
ds_read_b64_tr_b16 a[24:25], v13 offset:38912
ds_read_b64_tr_b16 a[26:27], v13 offset:39936
buffer_load_dwordx4 v8, s[12:15], s31 offen offset:2048 lds
s_waitcnt lgkmcnt(6)
v_mfma_f32_32x32x16_bf16 v[64:79], a[0:3], v[208:211], v[64:79]
ds_read_b64_tr_b16 a[28:29], v14 offset:38912
ds_read_b64_tr_b16 a[30:31], v14 offset:39936
v_mfma_f32_32x32x16_bf16 v[80:95], a[4:7], v[208:211], v[80:95]
ds_read_b64_tr_b16 a[0:1], v13 offset:40960
ds_read_b64_tr_b16 a[2:3], v13 offset:41984
s_add_u32 s30, s30, 0x36000
v_mfma_f32_32x32x16_bf16 v[64:79], a[8:11], v[212:215], v[64:79]
ds_read_b64_tr_b16 a[4:5], v14 offset:40960
ds_read_b64_tr_b16 a[6:7], v14 offset:41984
v_mfma_f32_32x32x16_bf16 v[80:95], a[12:15], v[212:215], v[80:95]
ds_read_b64_tr_b16 a[8:9], v13 offset:43008
ds_read_b64_tr_b16 a[10:11], v13 offset:44032
s_add_u32 s31, s31, 0x36000
s_waitcnt lgkmcnt(6)
v_mfma_f32_32x32x16_bf16 v[64:79], a[16:19], v[216:219], v[64:79]
ds_read_b64_tr_b16 a[12:13], v14 offset:43008
ds_read_b64_tr_b16 a[14:15], v14 offset:44032
v_mfma_f32_32x32x16_bf16 v[80:95], a[20:23], v[216:219], v[80:95]
ds_read_b64_tr_b16 a[16:17], v13 offset:45056
ds_read_b64_tr_b16 a[18:19], v13 offset:46080
v_mfma_f32_32x32x16_bf16 v[64:79], a[24:27], v[220:223], v[64:79]
ds_read_b64_tr_b16 a[20:21], v14 offset:45056
ds_read_b64_tr_b16 a[22:23], v14 offset:46080
v_mfma_f32_32x32x16_bf16 v[80:95], a[28:31], v[220:223], v[80:95]
ds_read_b64_tr_b16 a[24:25], v13 offset:47104
ds_read_b64_tr_b16 a[26:27], v13 offset:48128
s_waitcnt lgkmcnt(6)
v_mfma_f32_32x32x16_bf16 v[64:79], a[0:3], v[224:227], v[64:79]
ds_read_b64_tr_b16 a[28:29], v14 offset:47104
ds_read_b64_tr_b16 a[30:31], v14 offset:48128
s_waitcnt vmcnt(23)
s_barrier
v_mfma_f32_32x32x16_bf16 v[80:95], a[4:7], v[224:227], v[80:95]
ds_read_b64_tr_b16 a[0:1], v9 offset:0
ds_read_b64_tr_b16 a[2:3], v9 offset:1024
s_add_u32 m0, s34, 98304
v_mfma_f32_32x32x16_bf16 v[64:79], a[8:11], v[228:231], v[64:79]
ds_read_b64_tr_b16 a[4:5], v10 offset:0
ds_read_b64_tr_b16 a[6:7], v10 offset:1024
v_mfma_f32_32x32x16_bf16 v[80:95], a[12:15], v[228:231], v[80:95]
ds_read_b64_tr_b16 a[8:9], v9 offset:2048
ds_read_b64_tr_b16 a[10:11], v9 offset:3072
buffer_load_dwordx4 v6, s[12:15], s30 offen lds
s_waitcnt lgkmcnt(6)
v_mfma_f32_32x32x16_bf16 v[64:79], a[16:19], v[232:235], v[64:79]
ds_read_b64_tr_b16 a[12:13], v10 offset:2048
ds_read_b64_tr_b16 a[14:15], v10 offset:3072
v_mfma_f32_32x32x16_bf16 v[80:95], a[20:23], v[232:235], v[80:95]
ds_read_b64_tr_b16 a[16:17], v9 offset:4096
ds_read_b64_tr_b16 a[18:19], v9 offset:5120
buffer_load_dwordx4 v7, s[12:15], s30 offen offset:1024 lds
v_mfma_f32_32x32x16_bf16 v[64:79], a[24:27], v[236:239], v[64:79]
ds_read_b64_tr_b16 a[20:21], v10 offset:4096
ds_read_b64_tr_b16 a[22:23], v10 offset:5120
v_mfma_f32_32x32x16_bf16 v[80:95], a[28:31], v[236:239], v[80:95]
ds_read_b64_tr_b16 a[24:25], v9 offset:6144
ds_read_b64_tr_b16 a[26:27], v9 offset:7168
buffer_load_dwordx4 v8, s[12:15], s30 offen offset:2048 lds
s_waitcnt lgkmcnt(6)
v_mfma_f32_32x32x16_bf16 v[32:47], a[0:3], v[96:99], 0
ds_read_b64_tr_b16 a[28:29], v10 offset:6144
ds_read_b64_tr_b16 a[30:31], v10 offset:7168
v_mfma_f32_32x32x16_bf16 v[48:63], a[4:7], v[96:99], 0
ds_read_b64_tr_b16 a[0:1], v9 offset:8192
ds_read_b64_tr_b16 a[2:3], v9 offset:9216
s_add_u32 m0, s34, 101376
v_mfma_f32_32x32x16_bf16 v[32:47], a[8:11], v[100:103], v[32:47]
ds_read_b64_tr_b16 a[4:5], v10 offset:8192
ds_read_b64_tr_b16 a[6:7], v10 offset:9216
v_mfma_f32_32x32x16_bf16 v[48:63], a[12:15], v[100:103], v[48:63]
ds_read_b64_tr_b16 a[8:9], v9 offset:10240
ds_read_b64_tr_b16 a[10:11], v9 offset:11264
buffer_load_dwordx4 v6, s[12:15], s31 offen lds
s_waitcnt lgkmcnt(6)
v_mfma_f32_32x32x16_bf16 v[32:47], a[16:19], v[104:107], v[32:47]
ds_read_b64_tr_b16 a[12:13], v10 offset:10240
ds_read_b64_tr_b16 a[14:15], v10 offset:11264
v_mul_f32 v64, s48, v64
v_mul_f32 v65, s48, v65
v_mfma_f32_32x32x16_bf16 v[48:63], a[20:23], v[104:107], v[48:63]
ds_read_b64_tr_b16 a[16:17], v9 offset:12288
ds_read_b64_tr_b16 a[18:19], v9 offset:13312
buffer_load_dwordx4 v7, s[12:15], s31 offen offset:1024 lds
v_mfma_f32_32x32x16_bf16 v[32:47], a[24:27], v[108:111], v[32:47]
ds_read_b64_tr_b16 a[20:21], v10 offset:12288
ds_read_b64_tr_b16 a[22:23], v10 offset:13312
v_mul_f32 v66, s48, v66
v_mul_f32 v67, s48, v67
v_mfma_f32_32x32x16_bf16 v[48:63], a[28:31], v[108:111], v[48:63]
ds_read_b64_tr_b16 a[24:25], v9 offset:14336
ds_read_b64_tr_b16 a[26:27], v9 offset:15360
buffer_load_dwordx4 v8, s[12:15], s31 offen offset:2048 lds
s_waitcnt lgkmcnt(6)
v_mfma_f32_32x32x16_bf16 v[32:47], a[0:3], v[112:115], v[32:47]
ds_read_b64_tr_b16 a[28:29], v10 offset:14336
ds_read_b64_tr_b16 a[30:31], v10 offset:15360
v_mul_f32 v68, s48, v68
v_mul_f32 v69, s48, v69
v_mfma_f32_32x32x16_bf16 v[48:63], a[4:7], v[112:115], v[48:63]
ds_read_b64_tr_b16 a[0:1], v9 offset:16384
ds_read_b64_tr_b16 a[2:3], v9 offset:17408
s_add_u32 s30, s30, 0x36000
v_mul_f32 v70, s48, v70
v_mfma_f32_32x32x16_bf16 v[32:47], a[8:11], v[116:119], v[32:47]
ds_read_b64_tr_b16 a[4:5], v10 offset:16384
ds_read_b64_tr_b16 a[6:7], v10 offset:17408
v_mul_f32 v71, s48, v71
v_mul_f32 v72, s48, v72
v_mfma_f32_32x32x16_bf16 v[48:63], a[12:15], v[116:119], v[48:63]
ds_read_b64_tr_b16 a[8:9], v9 offset:18432
ds_read_b64_tr_b16 a[10:11], v9 offset:19456
s_add_u32 s31, s31, 0x36000
s_waitcnt lgkmcnt(6)
v_mfma_f32_32x32x16_bf16 v[32:47], a[16:19], v[120:123], v[32:47]
ds_read_b64_tr_b16 a[12:13], v10 offset:18432
ds_read_b64_tr_b16 a[14:15], v10 offset:19456
v_mul_f32 v73, s48, v73
v_mul_f32 v74, s48, v74
v_mfma_f32_32x32x16_bf16 v[48:63], a[20:23], v[120:123], v[48:63]
ds_read_b64_tr_b16 a[16:17], v9 offset:20480
ds_read_b64_tr_b16 a[18:19], v9 offset:21504
v_mul_f32 v75, s48, v75
v_mul_f32 v76, s48, v76
v_mfma_f32_32x32x16_bf16 v[32:47], a[24:27], v[124:127], v[32:47]
ds_read_b64_tr_b16 a[20:21], v10 offset:20480
ds_read_b64_tr_b16 a[22:23], v10 offset:21504
v_mul_f32 v77, s48, v77
v_mul_f32 v78, s48, v78
v_mfma_f32_32x32x16_bf16 v[48:63], a[28:31], v[124:127], v[48:63]
ds_read_b64_tr_b16 a[24:25], v9 offset:22528
ds_read_b64_tr_b16 a[26:27], v9 offset:23552
v_mul_f32 v79, s48, v79
s_waitcnt lgkmcnt(6)
v_mfma_f32_32x32x16_bf16 v[32:47], a[0:3], v[128:131], v[32:47]
ds_read_b64_tr_b16 a[28:29], v10 offset:22528
ds_read_b64_tr_b16 a[30:31], v10 offset:23552
s_waitcnt vmcnt(23)
s_barrier
v_mfma_f32_32x32x16_bf16 v[48:63], a[4:7], v[128:131], v[48:63]
ds_read_b64_tr_b16 a[0:1], v9 offset:24576
ds_read_b64_tr_b16 a[2:3], v9 offset:25600
s_add_u32 m0, s34, 122880
v_cvt_pk_bf16_f32 v64, v64, v65
v_mfma_f32_32x32x16_bf16 v[32:47], a[8:11], v[132:135], v[32:47]
ds_read_b64_tr_b16 a[4:5], v10 offset:24576
ds_read_b64_tr_b16 a[6:7], v10 offset:25600
v_cvt_pk_bf16_f32 v65, v66, v67
v_cvt_pk_bf16_f32 v66, v68, v69
v_mfma_f32_32x32x16_bf16 v[48:63], a[12:15], v[132:135], v[48:63]
ds_read_b64_tr_b16 a[8:9], v9 offset:26624
ds_read_b64_tr_b16 a[10:11], v9 offset:27648
buffer_load_dwordx4 v6, s[12:15], s30 offen lds
s_waitcnt lgkmcnt(6)
v_mfma_f32_32x32x16_bf16 v[32:47], a[16:19], v[136:139], v[32:47]
ds_read_b64_tr_b16 a[12:13], v10 offset:26624
ds_read_b64_tr_b16 a[14:15], v10 offset:27648
v_cvt_pk_bf16_f32 v67, v70, v71
v_cvt_pk_bf16_f32 v68, v72, v73
v_mfma_f32_32x32x16_bf16 v[48:63], a[20:23], v[136:139], v[48:63]
ds_read_b64_tr_b16 a[16:17], v9 offset:28672
ds_read_b64_tr_b16 a[18:19], v9 offset:29696
buffer_load_dwordx4 v7, s[12:15], s30 offen offset:1024 lds
v_mfma_f32_32x32x16_bf16 v[32:47], a[24:27], v[140:143], v[32:47]
ds_read_b64_tr_b16 a[20:21], v10 offset:28672
ds_read_b64_tr_b16 a[22:23], v10 offset:29696
v_cvt_pk_bf16_f32 v69, v74, v75
v_cvt_pk_bf16_f32 v70, v76, v77
v_mfma_f32_32x32x16_bf16 v[48:63], a[28:31], v[140:143], v[48:63]
ds_read_b64_tr_b16 a[24:25], v9 offset:30720
ds_read_b64_tr_b16 a[26:27], v9 offset:31744
buffer_load_dwordx4 v8, s[12:15], s30 offen offset:2048 lds
s_waitcnt lgkmcnt(6)
v_mfma_f32_32x32x16_bf16 v[32:47], a[0:3], v[144:147], v[32:47]
ds_read_b64_tr_b16 a[28:29], v10 offset:30720
ds_read_b64_tr_b16 a[30:31], v10 offset:31744
v_cvt_pk_bf16_f32 v71, v78, v79
v_mfma_f32_32x32x16_bf16 v[48:63], a[4:7], v[144:147], v[48:63]
ds_read_b64_tr_b16 a[0:1], v9 offset:32768
ds_read_b64_tr_b16 a[2:3], v9 offset:33792
s_add_u32 m0, s34, 125952
v_mfma_f32_32x32x16_bf16 v[32:47], a[8:11], v[148:151], v[32:47]
ds_read_b64_tr_b16 a[4:5], v10 offset:32768
ds_read_b64_tr_b16 a[6:7], v10 offset:33792
buffer_store_dwordx4 v[64:67], v2, s[16:19], s40 offen offset:0 sc1
v_mfma_f32_32x32x16_bf16 v[48:63], a[12:15], v[148:151], v[48:63]
ds_read_b64_tr_b16 a[8:9], v9 offset:34816
ds_read_b64_tr_b16 a[10:11], v9 offset:35840
buffer_load_dwordx4 v6, s[12:15], s31 offen lds
s_waitcnt lgkmcnt(6)
v_mfma_f32_32x32x16_bf16 v[32:47], a[16:19], v[152:155], v[32:47]
ds_read_b64_tr_b16 a[12:13], v10 offset:34816
ds_read_b64_tr_b16 a[14:15], v10 offset:35840
buffer_store_dwordx4 v[68:71], v2, s[16:19], s40 offen offset:1024 sc1
v_mfma_f32_32x32x16_bf16 v[48:63], a[20:23], v[152:155], v[48:63]
ds_read_b64_tr_b16 a[16:17], v9 offset:36864
ds_read_b64_tr_b16 a[18:19], v9 offset:37888
buffer_load_dwordx4 v7, s[12:15], s31 offen offset:1024 lds
v_mfma_f32_32x32x16_bf16 v[32:47], a[24:27], v[156:159], v[32:47]
ds_read_b64_tr_b16 a[20:21], v10 offset:36864
ds_read_b64_tr_b16 a[22:23], v10 offset:37888
v_mul_f32 v80, s48, v80
v_mul_f32 v81, s48, v81
v_mfma_f32_32x32x16_bf16 v[48:63], a[28:31], v[156:159], v[48:63]
ds_read_b64_tr_b16 a[24:25], v9 offset:38912
ds_read_b64_tr_b16 a[26:27], v9 offset:39936
buffer_load_dwordx4 v8, s[12:15], s31 offen offset:2048 lds
s_waitcnt lgkmcnt(6)
v_mfma_f32_32x32x16_bf16 v[32:47], a[0:3], v[160:163], v[32:47]
ds_read_b64_tr_b16 a[28:29], v10 offset:38912
ds_read_b64_tr_b16 a[30:31], v10 offset:39936
v_mul_f32 v82, s48, v82
v_mul_f32 v83, s48, v83
v_mfma_f32_32x32x16_bf16 v[48:63], a[4:7], v[160:163], v[48:63]
ds_read_b64_tr_b16 a[0:1], v9 offset:40960
ds_read_b64_tr_b16 a[2:3], v9 offset:41984
s_add_u32 s30, s30, 0xfff94080
v_mul_f32 v84, s48, v84
v_mfma_f32_32x32x16_bf16 v[32:47], a[8:11], v[164:167], v[32:47]
ds_read_b64_tr_b16 a[4:5], v10 offset:40960
ds_read_b64_tr_b16 a[6:7], v10 offset:41984
v_mul_f32 v85, s48, v85
v_mul_f32 v86, s48, v86
v_mfma_f32_32x32x16_bf16 v[48:63], a[12:15], v[164:167], v[48:63]
ds_read_b64_tr_b16 a[8:9], v9 offset:43008
ds_read_b64_tr_b16 a[10:11], v9 offset:44032
s_add_u32 s31, s31, 0xfff94080
s_waitcnt lgkmcnt(6)
v_mfma_f32_32x32x16_bf16 v[32:47], a[16:19], v[168:171], v[32:47]
ds_read_b64_tr_b16 a[12:13], v10 offset:43008
ds_read_b64_tr_b16 a[14:15], v10 offset:44032
v_mul_f32 v87, s48, v87
v_mul_f32 v88, s48, v88
v_mfma_f32_32x32x16_bf16 v[48:63], a[20:23], v[168:171], v[48:63]
ds_read_b64_tr_b16 a[16:17], v9 offset:45056
ds_read_b64_tr_b16 a[18:19], v9 offset:46080
v_mul_f32 v89, s48, v89
v_mul_f32 v90, s48, v90
v_mfma_f32_32x32x16_bf16 v[32:47], a[24:27], v[172:175], v[32:47]
ds_read_b64_tr_b16 a[20:21], v10 offset:45056
ds_read_b64_tr_b16 a[22:23], v10 offset:46080
v_mul_f32 v91, s48, v91
v_mul_f32 v92, s48, v92
v_mfma_f32_32x32x16_bf16 v[48:63], a[28:31], v[172:175], v[48:63]
ds_read_b64_tr_b16 a[24:25], v9 offset:47104
ds_read_b64_tr_b16 a[26:27], v9 offset:48128
v_mul_f32 v93, s48, v93
s_waitcnt lgkmcnt(6)
v_mfma_f32_32x32x16_bf16 v[32:47], a[0:3], v[176:179], v[32:47]
ds_read_b64_tr_b16 a[28:29], v10 offset:47104
ds_read_b64_tr_b16 a[30:31], v10 offset:48128
s_waitcnt vmcnt(16)
s_barrier
v_add_u32 v254, 1024, v254
buffer_store_dword v255, v254, s[60:63], 0 offen sc1
v_mfma_f32_32x32x16_bf16 v[48:63], a[4:7], v[176:179], v[48:63]
ds_read_b64_tr_b16 a[0:1], v11 offset:0
ds_read_b64_tr_b16 a[2:3], v11 offset:1024
s_add_u32 m0, s34, 0
v_mul_f32 v94, s48, v94
v_mfma_f32_32x32x16_bf16 v[32:47], a[8:11], v[180:183], v[32:47]
ds_read_b64_tr_b16 a[4:5], v12 offset:0
ds_read_b64_tr_b16 a[6:7], v12 offset:1024
v_mul_f32 v95, s48, v95
v_cvt_pk_bf16_f32 v80, v80, v81
v_mfma_f32_32x32x16_bf16 v[48:63], a[12:15], v[180:183], v[48:63]
ds_read_b64_tr_b16 a[8:9], v11 offset:2048
ds_read_b64_tr_b16 a[10:11], v11 offset:3072
buffer_load_dwordx4 v6, s[12:15], s30 offen lds
s_waitcnt lgkmcnt(6)
v_mfma_f32_32x32x16_bf16 v[32:47], a[16:19], v[184:187], v[32:47]
ds_read_b64_tr_b16 a[12:13], v12 offset:2048
ds_read_b64_tr_b16 a[14:15], v12 offset:3072
v_cvt_pk_bf16_f32 v81, v82, v83
v_cvt_pk_bf16_f32 v82, v84, v85
v_mfma_f32_32x32x16_bf16 v[48:63], a[20:23], v[184:187], v[48:63]
ds_read_b64_tr_b16 a[16:17], v11 offset:4096
ds_read_b64_tr_b16 a[18:19], v11 offset:5120
buffer_load_dwordx4 v7, s[12:15], s30 offen offset:1024 lds
v_mfma_f32_32x32x16_bf16 v[32:47], a[24:27], v[188:191], v[32:47]
ds_read_b64_tr_b16 a[20:21], v12 offset:4096
ds_read_b64_tr_b16 a[22:23], v12 offset:5120
v_cvt_pk_bf16_f32 v83, v86, v87
v_cvt_pk_bf16_f32 v84, v88, v89
v_mfma_f32_32x32x16_bf16 v[48:63], a[28:31], v[188:191], v[48:63]
ds_read_b64_tr_b16 a[24:25], v11 offset:6144
ds_read_b64_tr_b16 a[26:27], v11 offset:7168
buffer_load_dwordx4 v8, s[12:15], s30 offen offset:2048 lds
s_waitcnt lgkmcnt(6)
v_mfma_f32_32x32x16_bf16 v[32:47], a[0:3], v[192:195], v[32:47]
ds_read_b64_tr_b16 a[28:29], v12 offset:6144
ds_read_b64_tr_b16 a[30:31], v12 offset:7168
v_cvt_pk_bf16_f32 v85, v90, v91
v_cvt_pk_bf16_f32 v86, v92, v93
v_mfma_f32_32x32x16_bf16 v[48:63], a[4:7], v[192:195], v[48:63]
ds_read_b64_tr_b16 a[0:1], v11 offset:8192
ds_read_b64_tr_b16 a[2:3], v11 offset:9216
s_add_u32 m0, s34, 3072
v_cvt_pk_bf16_f32 v87, v94, v95
v_mfma_f32_32x32x16_bf16 v[32:47], a[8:11], v[196:199], v[32:47]
ds_read_b64_tr_b16 a[4:5], v12 offset:8192
ds_read_b64_tr_b16 a[6:7], v12 offset:9216
buffer_store_dwordx4 v[80:83], v2, s[16:19], s40 offen offset:2048 sc1
v_mfma_f32_32x32x16_bf16 v[48:63], a[12:15], v[196:199], v[48:63]
ds_read_b64_tr_b16 a[8:9], v11 offset:10240
ds_read_b64_tr_b16 a[10:11], v11 offset:11264
buffer_load_dwordx4 v6, s[12:15], s31 offen lds
s_waitcnt lgkmcnt(6)
v_mfma_f32_32x32x16_bf16 v[32:47], a[16:19], v[200:203], v[32:47]
ds_read_b64_tr_b16 a[12:13], v12 offset:10240
ds_read_b64_tr_b16 a[14:15], v12 offset:11264
buffer_store_dwordx4 v[84:87], v2, s[16:19], s40 offen offset:3072 sc1
v_mfma_f32_32x32x16_bf16 v[48:63], a[20:23], v[200:203], v[48:63]
ds_read_b64_tr_b16 a[16:17], v11 offset:12288
ds_read_b64_tr_b16 a[18:19], v11 offset:13312
buffer_load_dwordx4 v7, s[12:15], s31 offen offset:1024 lds
v_mfma_f32_32x32x16_bf16 v[32:47], a[24:27], v[204:207], v[32:47]
ds_read_b64_tr_b16 a[20:21], v12 offset:12288
ds_read_b64_tr_b16 a[22:23], v12 offset:13312
s_add_u32 s40, s40, 4096
v_mfma_f32_32x32x16_bf16 v[48:63], a[28:31], v[204:207], v[48:63]
ds_read_b64_tr_b16 a[24:25], v11 offset:14336
ds_read_b64_tr_b16 a[26:27], v11 offset:15360
buffer_load_dwordx4 v8, s[12:15], s31 offen offset:2048 lds
s_waitcnt lgkmcnt(6)
v_mfma_f32_32x32x16_bf16 v[32:47], a[0:3], v[208:211], v[32:47]
ds_read_b64_tr_b16 a[28:29], v12 offset:14336
ds_read_b64_tr_b16 a[30:31], v12 offset:15360
v_mfma_f32_32x32x16_bf16 v[48:63], a[4:7], v[208:211], v[48:63]
ds_read_b64_tr_b16 a[0:1], v11 offset:16384
ds_read_b64_tr_b16 a[2:3], v11 offset:17408
s_add_u32 s30, s30, 0x36000
v_mfma_f32_32x32x16_bf16 v[32:47], a[8:11], v[212:215], v[32:47]
ds_read_b64_tr_b16 a[4:5], v12 offset:16384
ds_read_b64_tr_b16 a[6:7], v12 offset:17408
v_mfma_f32_32x32x16_bf16 v[48:63], a[12:15], v[212:215], v[48:63]
ds_read_b64_tr_b16 a[8:9], v11 offset:18432
ds_read_b64_tr_b16 a[10:11], v11 offset:19456
s_add_u32 s31, s31, 0x36000
s_waitcnt lgkmcnt(6)
v_mfma_f32_32x32x16_bf16 v[32:47], a[16:19], v[216:219], v[32:47]
ds_read_b64_tr_b16 a[12:13], v12 offset:18432
ds_read_b64_tr_b16 a[14:15], v12 offset:19456
v_mfma_f32_32x32x16_bf16 v[48:63], a[20:23], v[216:219], v[48:63]
ds_read_b64_tr_b16 a[16:17], v11 offset:20480
ds_read_b64_tr_b16 a[18:19], v11 offset:21504
v_mfma_f32_32x32x16_bf16 v[32:47], a[24:27], v[220:223], v[32:47]
ds_read_b64_tr_b16 a[20:21], v12 offset:20480
ds_read_b64_tr_b16 a[22:23], v12 offset:21504
v_mfma_f32_32x32x16_bf16 v[48:63], a[28:31], v[220:223], v[48:63]
ds_read_b64_tr_b16 a[24:25], v11 offset:22528
ds_read_b64_tr_b16 a[26:27], v11 offset:23552
s_waitcnt lgkmcnt(6)
v_mfma_f32_32x32x16_bf16 v[32:47], a[0:3], v[224:227], v[32:47]
ds_read_b64_tr_b16 a[28:29], v12 offset:22528
ds_read_b64_tr_b16 a[30:31], v12 offset:23552
s_waitcnt vmcnt(23)
s_barrier
v_mfma_f32_32x32x16_bf16 v[48:63], a[4:7], v[224:227], v[48:63]
ds_read_b64_tr_b16 a[0:1], v11 offset:24576
ds_read_b64_tr_b16 a[2:3], v11 offset:25600
s_add_u32 m0, s34, 24576
v_mfma_f32_32x32x16_bf16 v[32:47], a[8:11], v[228:231], v[32:47]
ds_read_b64_tr_b16 a[4:5], v12 offset:24576
ds_read_b64_tr_b16 a[6:7], v12 offset:25600
v_mfma_f32_32x32x16_bf16 v[48:63], a[12:15], v[228:231], v[48:63]
ds_read_b64_tr_b16 a[8:9], v11 offset:26624
ds_read_b64_tr_b16 a[10:11], v11 offset:27648
buffer_load_dwordx4 v6, s[12:15], s30 offen lds
s_waitcnt lgkmcnt(6)
v_mfma_f32_32x32x16_bf16 v[32:47], a[16:19], v[232:235], v[32:47]
ds_read_b64_tr_b16 a[12:13], v12 offset:26624
ds_read_b64_tr_b16 a[14:15], v12 offset:27648
v_mfma_f32_32x32x16_bf16 v[48:63], a[20:23], v[232:235], v[48:63]
ds_read_b64_tr_b16 a[16:17], v11 offset:28672
ds_read_b64_tr_b16 a[18:19], v11 offset:29696
buffer_load_dwordx4 v7, s[12:15], s30 offen offset:1024 lds
v_mfma_f32_32x32x16_bf16 v[32:47], a[24:27], v[236:239], v[32:47]
ds_read_b64_tr_b16 a[20:21], v12 offset:28672
ds_read_b64_tr_b16 a[22:23], v12 offset:29696
v_mfma_f32_32x32x16_bf16 v[48:63], a[28:31], v[236:239], v[48:63]
ds_read_b64_tr_b16 a[24:25], v11 offset:30720
ds_read_b64_tr_b16 a[26:27], v11 offset:31744
buffer_load_dwordx4 v8, s[12:15], s30 offen offset:2048 lds
s_waitcnt lgkmcnt(6)
v_mfma_f32_32x32x16_bf16 v[64:79], a[0:3], v[96:99], 0
ds_read_b64_tr_b16 a[28:29], v12 offset:30720
ds_read_b64_tr_b16 a[30:31], v12 offset:31744
v_mfma_f32_32x32x16_bf16 v[80:95], a[4:7], v[96:99], 0
ds_read_b64_tr_b16 a[0:1], v11 offset:32768
ds_read_b64_tr_b16 a[2:3], v11 offset:33792
s_add_u32 m0, s34, 27648
v_mfma_f32_32x32x16_bf16 v[64:79], a[8:11], v[100:103], v[64:79]
ds_read_b64_tr_b16 a[4:5], v12 offset:32768
ds_read_b64_tr_b16 a[6:7], v12 offset:33792
v_mfma_f32_32x32x16_bf16 v[80:95], a[12:15], v[100:103], v[80:95]
ds_read_b64_tr_b16 a[8:9], v11 offset:34816
ds_read_b64_tr_b16 a[10:11], v11 offset:35840
buffer_load_dwordx4 v6, s[12:15], s31 offen lds
s_waitcnt lgkmcnt(6)
v_mfma_f32_32x32x16_bf16 v[64:79], a[16:19], v[104:107], v[64:79]
ds_read_b64_tr_b16 a[12:13], v12 offset:34816
ds_read_b64_tr_b16 a[14:15], v12 offset:35840
v_mul_f32 v32, s48, v32
v_mul_f32 v33, s48, v33
v_mfma_f32_32x32x16_bf16 v[80:95], a[20:23], v[104:107], v[80:95]
ds_read_b64_tr_b16 a[16:17], v11 offset:36864
ds_read_b64_tr_b16 a[18:19], v11 offset:37888
buffer_load_dwordx4 v7, s[12:15], s31 offen offset:1024 lds
v_mfma_f32_32x32x16_bf16 v[64:79], a[24:27], v[108:111], v[64:79]
ds_read_b64_tr_b16 a[20:21], v12 offset:36864
ds_read_b64_tr_b16 a[22:23], v12 offset:37888
v_mul_f32 v34, s48, v34
v_mul_f32 v35, s48, v35
v_mfma_f32_32x32x16_bf16 v[80:95], a[28:31], v[108:111], v[80:95]
ds_read_b64_tr_b16 a[24:25], v11 offset:38912
ds_read_b64_tr_b16 a[26:27], v11 offset:39936
buffer_load_dwordx4 v8, s[12:15], s31 offen offset:2048 lds
s_waitcnt lgkmcnt(6)
v_mfma_f32_32x32x16_bf16 v[64:79], a[0:3], v[112:115], v[64:79]
ds_read_b64_tr_b16 a[28:29], v12 offset:38912
ds_read_b64_tr_b16 a[30:31], v12 offset:39936
v_mul_f32 v36, s48, v36
v_mul_f32 v37, s48, v37
v_mfma_f32_32x32x16_bf16 v[80:95], a[4:7], v[112:115], v[80:95]
ds_read_b64_tr_b16 a[0:1], v11 offset:40960
ds_read_b64_tr_b16 a[2:3], v11 offset:41984
s_add_u32 s30, s30, 0x36000
v_mul_f32 v38, s48, v38
v_mfma_f32_32x32x16_bf16 v[64:79], a[8:11], v[116:119], v[64:79]
ds_read_b64_tr_b16 a[4:5], v12 offset:40960
ds_read_b64_tr_b16 a[6:7], v12 offset:41984
v_mul_f32 v39, s48, v39
v_mul_f32 v40, s48, v40
v_mfma_f32_32x32x16_bf16 v[80:95], a[12:15], v[116:119], v[80:95]
ds_read_b64_tr_b16 a[8:9], v11 offset:43008
ds_read_b64_tr_b16 a[10:11], v11 offset:44032
s_add_u32 s31, s31, 0x36000
s_waitcnt lgkmcnt(6)
v_mfma_f32_32x32x16_bf16 v[64:79], a[16:19], v[120:123], v[64:79]
ds_read_b64_tr_b16 a[12:13], v12 offset:43008
ds_read_b64_tr_b16 a[14:15], v12 offset:44032
v_mul_f32 v41, s48, v41
v_mul_f32 v42, s48, v42
v_mfma_f32_32x32x16_bf16 v[80:95], a[20:23], v[120:123], v[80:95]
ds_read_b64_tr_b16 a[16:17], v11 offset:45056
ds_read_b64_tr_b16 a[18:19], v11 offset:46080
v_mul_f32 v43, s48, v43
v_mul_f32 v44, s48, v44
v_mfma_f32_32x32x16_bf16 v[64:79], a[24:27], v[124:127], v[64:79]
ds_read_b64_tr_b16 a[20:21], v12 offset:45056
ds_read_b64_tr_b16 a[22:23], v12 offset:46080
v_mul_f32 v45, s48, v45
v_mul_f32 v46, s48, v46
v_mfma_f32_32x32x16_bf16 v[80:95], a[28:31], v[124:127], v[80:95]
ds_read_b64_tr_b16 a[24:25], v11 offset:47104
ds_read_b64_tr_b16 a[26:27], v11 offset:48128
v_mul_f32 v47, s48, v47
s_waitcnt lgkmcnt(6)
v_mfma_f32_32x32x16_bf16 v[64:79], a[0:3], v[128:131], v[64:79]
ds_read_b64_tr_b16 a[28:29], v12 offset:47104
ds_read_b64_tr_b16 a[30:31], v12 offset:48128
s_waitcnt vmcnt(23)
s_barrier
v_mfma_f32_32x32x16_bf16 v[80:95], a[4:7], v[128:131], v[80:95]
ds_read_b64_tr_b16 a[0:1], v13 offset:0
ds_read_b64_tr_b16 a[2:3], v13 offset:1024
s_add_u32 m0, s34, 49152
v_cvt_pk_bf16_f32 v32, v32, v33
v_mfma_f32_32x32x16_bf16 v[64:79], a[8:11], v[132:135], v[64:79]
ds_read_b64_tr_b16 a[4:5], v14 offset:0
ds_read_b64_tr_b16 a[6:7], v14 offset:1024
v_cvt_pk_bf16_f32 v33, v34, v35
v_cvt_pk_bf16_f32 v34, v36, v37
v_mfma_f32_32x32x16_bf16 v[80:95], a[12:15], v[132:135], v[80:95]
ds_read_b64_tr_b16 a[8:9], v13 offset:2048
ds_read_b64_tr_b16 a[10:11], v13 offset:3072
buffer_load_dwordx4 v6, s[12:15], s30 offen lds
s_waitcnt lgkmcnt(6)
v_mfma_f32_32x32x16_bf16 v[64:79], a[16:19], v[136:139], v[64:79]
ds_read_b64_tr_b16 a[12:13], v14 offset:2048
ds_read_b64_tr_b16 a[14:15], v14 offset:3072
v_cvt_pk_bf16_f32 v35, v38, v39
v_cvt_pk_bf16_f32 v36, v40, v41
v_mfma_f32_32x32x16_bf16 v[80:95], a[20:23], v[136:139], v[80:95]
ds_read_b64_tr_b16 a[16:17], v13 offset:4096
ds_read_b64_tr_b16 a[18:19], v13 offset:5120
buffer_load_dwordx4 v7, s[12:15], s30 offen offset:1024 lds
v_mfma_f32_32x32x16_bf16 v[64:79], a[24:27], v[140:143], v[64:79]
ds_read_b64_tr_b16 a[20:21], v14 offset:4096
ds_read_b64_tr_b16 a[22:23], v14 offset:5120
v_cvt_pk_bf16_f32 v37, v42, v43
v_cvt_pk_bf16_f32 v38, v44, v45
v_mfma_f32_32x32x16_bf16 v[80:95], a[28:31], v[140:143], v[80:95]
ds_read_b64_tr_b16 a[24:25], v13 offset:6144
ds_read_b64_tr_b16 a[26:27], v13 offset:7168
buffer_load_dwordx4 v8, s[12:15], s30 offen offset:2048 lds
s_waitcnt lgkmcnt(6)
v_mfma_f32_32x32x16_bf16 v[64:79], a[0:3], v[144:147], v[64:79]
ds_read_b64_tr_b16 a[28:29], v14 offset:6144
ds_read_b64_tr_b16 a[30:31], v14 offset:7168
v_cvt_pk_bf16_f32 v39, v46, v47
v_mfma_f32_32x32x16_bf16 v[80:95], a[4:7], v[144:147], v[80:95]
ds_read_b64_tr_b16 a[0:1], v13 offset:8192
ds_read_b64_tr_b16 a[2:3], v13 offset:9216
s_add_u32 m0, s34, 52224
v_mfma_f32_32x32x16_bf16 v[64:79], a[8:11], v[148:151], v[64:79]
ds_read_b64_tr_b16 a[4:5], v14 offset:8192
ds_read_b64_tr_b16 a[6:7], v14 offset:9216
buffer_store_dwordx4 v[32:35], v2, s[16:19], s40 offen offset:0 sc1
v_mfma_f32_32x32x16_bf16 v[80:95], a[12:15], v[148:151], v[80:95]
ds_read_b64_tr_b16 a[8:9], v13 offset:10240
ds_read_b64_tr_b16 a[10:11], v13 offset:11264
buffer_load_dwordx4 v6, s[12:15], s31 offen lds
s_waitcnt lgkmcnt(6)
v_mfma_f32_32x32x16_bf16 v[64:79], a[16:19], v[152:155], v[64:79]
ds_read_b64_tr_b16 a[12:13], v14 offset:10240
ds_read_b64_tr_b16 a[14:15], v14 offset:11264
buffer_store_dwordx4 v[36:39], v2, s[16:19], s40 offen offset:1024 sc1
v_mfma_f32_32x32x16_bf16 v[80:95], a[20:23], v[152:155], v[80:95]
ds_read_b64_tr_b16 a[16:17], v13 offset:12288
ds_read_b64_tr_b16 a[18:19], v13 offset:13312
buffer_load_dwordx4 v7, s[12:15], s31 offen offset:1024 lds
v_mfma_f32_32x32x16_bf16 v[64:79], a[24:27], v[156:159], v[64:79]
ds_read_b64_tr_b16 a[20:21], v14 offset:12288
ds_read_b64_tr_b16 a[22:23], v14 offset:13312
v_mul_f32 v48, s48, v48
v_mul_f32 v49, s48, v49
v_mfma_f32_32x32x16_bf16 v[80:95], a[28:31], v[156:159], v[80:95]
ds_read_b64_tr_b16 a[24:25], v13 offset:14336
ds_read_b64_tr_b16 a[26:27], v13 offset:15360
buffer_load_dwordx4 v8, s[12:15], s31 offen offset:2048 lds
s_waitcnt lgkmcnt(6)
v_mfma_f32_32x32x16_bf16 v[64:79], a[0:3], v[160:163], v[64:79]
ds_read_b64_tr_b16 a[28:29], v14 offset:14336
ds_read_b64_tr_b16 a[30:31], v14 offset:15360
v_mul_f32 v50, s48, v50
v_mul_f32 v51, s48, v51
v_mfma_f32_32x32x16_bf16 v[80:95], a[4:7], v[160:163], v[80:95]
ds_read_b64_tr_b16 a[0:1], v13 offset:16384
ds_read_b64_tr_b16 a[2:3], v13 offset:17408
s_add_u32 s30, s30, 0xfff94080
v_mul_f32 v52, s48, v52
v_mfma_f32_32x32x16_bf16 v[64:79], a[8:11], v[164:167], v[64:79]
ds_read_b64_tr_b16 a[4:5], v14 offset:16384
ds_read_b64_tr_b16 a[6:7], v14 offset:17408
v_mul_f32 v53, s48, v53
v_mul_f32 v54, s48, v54
v_mfma_f32_32x32x16_bf16 v[80:95], a[12:15], v[164:167], v[80:95]
ds_read_b64_tr_b16 a[8:9], v13 offset:18432
ds_read_b64_tr_b16 a[10:11], v13 offset:19456
s_add_u32 s31, s31, 0xfff94080
s_waitcnt lgkmcnt(6)
v_mfma_f32_32x32x16_bf16 v[64:79], a[16:19], v[168:171], v[64:79]
ds_read_b64_tr_b16 a[12:13], v14 offset:18432
ds_read_b64_tr_b16 a[14:15], v14 offset:19456
v_mul_f32 v55, s48, v55
v_mul_f32 v56, s48, v56
v_mfma_f32_32x32x16_bf16 v[80:95], a[20:23], v[168:171], v[80:95]
ds_read_b64_tr_b16 a[16:17], v13 offset:20480
ds_read_b64_tr_b16 a[18:19], v13 offset:21504
v_mul_f32 v57, s48, v57
v_mul_f32 v58, s48, v58
v_mfma_f32_32x32x16_bf16 v[64:79], a[24:27], v[172:175], v[64:79]
ds_read_b64_tr_b16 a[20:21], v14 offset:20480
ds_read_b64_tr_b16 a[22:23], v14 offset:21504
v_mul_f32 v59, s48, v59
v_mul_f32 v60, s48, v60
v_mfma_f32_32x32x16_bf16 v[80:95], a[28:31], v[172:175], v[80:95]
ds_read_b64_tr_b16 a[24:25], v13 offset:22528
ds_read_b64_tr_b16 a[26:27], v13 offset:23552
v_mul_f32 v61, s48, v61
s_waitcnt lgkmcnt(6)
v_mfma_f32_32x32x16_bf16 v[64:79], a[0:3], v[176:179], v[64:79]
ds_read_b64_tr_b16 a[28:29], v14 offset:22528
ds_read_b64_tr_b16 a[30:31], v14 offset:23552
s_waitcnt vmcnt(16)
s_barrier
v_add_u32 v254, 1024, v254
buffer_store_dword v255, v254, s[60:63], 0 offen sc1
v_mfma_f32_32x32x16_bf16 v[80:95], a[4:7], v[176:179], v[80:95]
ds_read_b64_tr_b16 a[0:1], v13 offset:24576
ds_read_b64_tr_b16 a[2:3], v13 offset:25600
s_add_u32 m0, s34, 73728
v_mul_f32 v62, s48, v62
v_mfma_f32_32x32x16_bf16 v[64:79], a[8:11], v[180:183], v[64:79]
ds_read_b64_tr_b16 a[4:5], v14 offset:24576
ds_read_b64_tr_b16 a[6:7], v14 offset:25600
v_mul_f32 v63, s48, v63
v_cvt_pk_bf16_f32 v48, v48, v49
v_mfma_f32_32x32x16_bf16 v[80:95], a[12:15], v[180:183], v[80:95]
ds_read_b64_tr_b16 a[8:9], v13 offset:26624
ds_read_b64_tr_b16 a[10:11], v13 offset:27648
buffer_load_dwordx4 v6, s[12:15], s30 offen lds
s_waitcnt lgkmcnt(6)
v_mfma_f32_32x32x16_bf16 v[64:79], a[16:19], v[184:187], v[64:79]
ds_read_b64_tr_b16 a[12:13], v14 offset:26624
ds_read_b64_tr_b16 a[14:15], v14 offset:27648
v_cvt_pk_bf16_f32 v49, v50, v51
v_cvt_pk_bf16_f32 v50, v52, v53
v_mfma_f32_32x32x16_bf16 v[80:95], a[20:23], v[184:187], v[80:95]
ds_read_b64_tr_b16 a[16:17], v13 offset:28672
ds_read_b64_tr_b16 a[18:19], v13 offset:29696
buffer_load_dwordx4 v7, s[12:15], s30 offen offset:1024 lds
v_mfma_f32_32x32x16_bf16 v[64:79], a[24:27], v[188:191], v[64:79]
ds_read_b64_tr_b16 a[20:21], v14 offset:28672
ds_read_b64_tr_b16 a[22:23], v14 offset:29696
v_cvt_pk_bf16_f32 v51, v54, v55
v_cvt_pk_bf16_f32 v52, v56, v57
v_mfma_f32_32x32x16_bf16 v[80:95], a[28:31], v[188:191], v[80:95]
ds_read_b64_tr_b16 a[24:25], v13 offset:30720
ds_read_b64_tr_b16 a[26:27], v13 offset:31744
buffer_load_dwordx4 v8, s[12:15], s30 offen offset:2048 lds
s_waitcnt lgkmcnt(6)
v_mfma_f32_32x32x16_bf16 v[64:79], a[0:3], v[192:195], v[64:79]
ds_read_b64_tr_b16 a[28:29], v14 offset:30720
ds_read_b64_tr_b16 a[30:31], v14 offset:31744
v_cvt_pk_bf16_f32 v53, v58, v59
v_cvt_pk_bf16_f32 v54, v60, v61
v_mfma_f32_32x32x16_bf16 v[80:95], a[4:7], v[192:195], v[80:95]
ds_read_b64_tr_b16 a[0:1], v13 offset:32768
ds_read_b64_tr_b16 a[2:3], v13 offset:33792
s_add_u32 m0, s34, 76800
v_cvt_pk_bf16_f32 v55, v62, v63
v_mfma_f32_32x32x16_bf16 v[64:79], a[8:11], v[196:199], v[64:79]
ds_read_b64_tr_b16 a[4:5], v14 offset:32768
ds_read_b64_tr_b16 a[6:7], v14 offset:33792
buffer_store_dwordx4 v[48:51], v2, s[16:19], s40 offen offset:2048 sc1
v_mfma_f32_32x32x16_bf16 v[80:95], a[12:15], v[196:199], v[80:95]
ds_read_b64_tr_b16 a[8:9], v13 offset:34816
ds_read_b64_tr_b16 a[10:11], v13 offset:35840
buffer_load_dwordx4 v6, s[12:15], s31 offen lds
s_waitcnt lgkmcnt(6)
v_mfma_f32_32x32x16_bf16 v[64:79], a[16:19], v[200:203], v[64:79]
ds_read_b64_tr_b16 a[12:13], v14 offset:34816
ds_read_b64_tr_b16 a[14:15], v14 offset:35840
buffer_store_dwordx4 v[52:55], v2, s[16:19], s40 offen offset:3072 sc1
v_mfma_f32_32x32x16_bf16 v[80:95], a[20:23], v[200:203], v[80:95]
ds_read_b64_tr_b16 a[16:17], v13 offset:36864
ds_read_b64_tr_b16 a[18:19], v13 offset:37888
buffer_load_dwordx4 v7, s[12:15], s31 offen offset:1024 lds
v_mfma_f32_32x32x16_bf16 v[64:79], a[24:27], v[204:207], v[64:79]
ds_read_b64_tr_b16 a[20:21], v14 offset:36864
ds_read_b64_tr_b16 a[22:23], v14 offset:37888
s_add_u32 s40, s40, 4096
v_mfma_f32_32x32x16_bf16 v[80:95], a[28:31], v[204:207], v[80:95]
ds_read_b64_tr_b16 a[24:25], v13 offset:38912
ds_read_b64_tr_b16 a[26:27], v13 offset:39936
buffer_load_dwordx4 v8, s[12:15], s31 offen offset:2048 lds
s_waitcnt lgkmcnt(6)
v_mfma_f32_32x32x16_bf16 v[64:79], a[0:3], v[208:211], v[64:79]
ds_read_b64_tr_b16 a[28:29], v14 offset:38912
ds_read_b64_tr_b16 a[30:31], v14 offset:39936
v_mfma_f32_32x32x16_bf16 v[80:95], a[4:7], v[208:211], v[80:95]
ds_read_b64_tr_b16 a[0:1], v13 offset:40960
ds_read_b64_tr_b16 a[2:3], v13 offset:41984
s_add_u32 s30, s30, 0x36000
v_mfma_f32_32x32x16_bf16 v[64:79], a[8:11], v[212:215], v[64:79]
ds_read_b64_tr_b16 a[4:5], v14 offset:40960
ds_read_b64_tr_b16 a[6:7], v14 offset:41984
v_mfma_f32_32x32x16_bf16 v[80:95], a[12:15], v[212:215], v[80:95]
ds_read_b64_tr_b16 a[8:9], v13 offset:43008
ds_read_b64_tr_b16 a[10:11], v13 offset:44032
s_add_u32 s31, s31, 0x36000
s_waitcnt lgkmcnt(6)
v_mfma_f32_32x32x16_bf16 v[64:79], a[16:19], v[216:219], v[64:79]
ds_read_b64_tr_b16 a[12:13], v14 offset:43008
ds_read_b64_tr_b16 a[14:15], v14 offset:44032
v_mfma_f32_32x32x16_bf16 v[80:95], a[20:23], v[216:219], v[80:95]
ds_read_b64_tr_b16 a[16:17], v13 offset:45056
ds_read_b64_tr_b16 a[18:19], v13 offset:46080
v_mfma_f32_32x32x16_bf16 v[64:79], a[24:27], v[220:223], v[64:79]
ds_read_b64_tr_b16 a[20:21], v14 offset:45056
ds_read_b64_tr_b16 a[22:23], v14 offset:46080
v_mfma_f32_32x32x16_bf16 v[80:95], a[28:31], v[220:223], v[80:95]
ds_read_b64_tr_b16 a[24:25], v13 offset:47104
ds_read_b64_tr_b16 a[26:27], v13 offset:48128
s_waitcnt lgkmcnt(6)
v_mfma_f32_32x32x16_bf16 v[64:79], a[0:3], v[224:227], v[64:79]
ds_read_b64_tr_b16 a[28:29], v14 offset:47104
ds_read_b64_tr_b16 a[30:31], v14 offset:48128
s_waitcnt vmcnt(23)
s_barrier
v_mfma_f32_32x32x16_bf16 v[80:95], a[4:7], v[224:227], v[80:95]
ds_read_b64_tr_b16 a[0:1], v9 offset:0
ds_read_b64_tr_b16 a[2:3], v9 offset:1024
s_add_u32 m0, s34, 98304
v_mfma_f32_32x32x16_bf16 v[64:79], a[8:11], v[228:231], v[64:79]
ds_read_b64_tr_b16 a[4:5], v10 offset:0
ds_read_b64_tr_b16 a[6:7], v10 offset:1024
v_mfma_f32_32x32x16_bf16 v[80:95], a[12:15], v[228:231], v[80:95]
ds_read_b64_tr_b16 a[8:9], v9 offset:2048
ds_read_b64_tr_b16 a[10:11], v9 offset:3072
buffer_load_dwordx4 v6, s[12:15], s30 offen lds
s_waitcnt lgkmcnt(6)
v_mfma_f32_32x32x16_bf16 v[64:79], a[16:19], v[232:235], v[64:79]
ds_read_b64_tr_b16 a[12:13], v10 offset:2048
ds_read_b64_tr_b16 a[14:15], v10 offset:3072
v_mfma_f32_32x32x16_bf16 v[80:95], a[20:23], v[232:235], v[80:95]
ds_read_b64_tr_b16 a[16:17], v9 offset:4096
ds_read_b64_tr_b16 a[18:19], v9 offset:5120
buffer_load_dwordx4 v7, s[12:15], s30 offen offset:1024 lds
v_mfma_f32_32x32x16_bf16 v[64:79], a[24:27], v[236:239], v[64:79]
ds_read_b64_tr_b16 a[20:21], v10 offset:4096
ds_read_b64_tr_b16 a[22:23], v10 offset:5120
v_mfma_f32_32x32x16_bf16 v[80:95], a[28:31], v[236:239], v[80:95]
ds_read_b64_tr_b16 a[24:25], v9 offset:6144
ds_read_b64_tr_b16 a[26:27], v9 offset:7168
buffer_load_dwordx4 v8, s[12:15], s30 offen offset:2048 lds
s_waitcnt lgkmcnt(6)
v_mfma_f32_32x32x16_bf16 v[32:47], a[0:3], v[96:99], 0
ds_read_b64_tr_b16 a[28:29], v10 offset:6144
ds_read_b64_tr_b16 a[30:31], v10 offset:7168
v_mfma_f32_32x32x16_bf16 v[48:63], a[4:7], v[96:99], 0
ds_read_b64_tr_b16 a[0:1], v9 offset:8192
ds_read_b64_tr_b16 a[2:3], v9 offset:9216
s_add_u32 m0, s34, 101376
v_mfma_f32_32x32x16_bf16 v[32:47], a[8:11], v[100:103], v[32:47]
ds_read_b64_tr_b16 a[4:5], v10 offset:8192
ds_read_b64_tr_b16 a[6:7], v10 offset:9216
v_mfma_f32_32x32x16_bf16 v[48:63], a[12:15], v[100:103], v[48:63]
ds_read_b64_tr_b16 a[8:9], v9 offset:10240
ds_read_b64_tr_b16 a[10:11], v9 offset:11264
buffer_load_dwordx4 v6, s[12:15], s31 offen lds
s_waitcnt lgkmcnt(6)
v_mfma_f32_32x32x16_bf16 v[32:47], a[16:19], v[104:107], v[32:47]
ds_read_b64_tr_b16 a[12:13], v10 offset:10240
ds_read_b64_tr_b16 a[14:15], v10 offset:11264
v_mul_f32 v64, s48, v64
v_mul_f32 v65, s48, v65
v_mfma_f32_32x32x16_bf16 v[48:63], a[20:23], v[104:107], v[48:63]
ds_read_b64_tr_b16 a[16:17], v9 offset:12288
ds_read_b64_tr_b16 a[18:19], v9 offset:13312
buffer_load_dwordx4 v7, s[12:15], s31 offen offset:1024 lds
v_mfma_f32_32x32x16_bf16 v[32:47], a[24:27], v[108:111], v[32:47]
ds_read_b64_tr_b16 a[20:21], v10 offset:12288
ds_read_b64_tr_b16 a[22:23], v10 offset:13312
v_mul_f32 v66, s48, v66
v_mul_f32 v67, s48, v67
v_mfma_f32_32x32x16_bf16 v[48:63], a[28:31], v[108:111], v[48:63]
ds_read_b64_tr_b16 a[24:25], v9 offset:14336
ds_read_b64_tr_b16 a[26:27], v9 offset:15360
buffer_load_dwordx4 v8, s[12:15], s31 offen offset:2048 lds
s_waitcnt lgkmcnt(6)
v_mfma_f32_32x32x16_bf16 v[32:47], a[0:3], v[112:115], v[32:47]
ds_read_b64_tr_b16 a[28:29], v10 offset:14336
ds_read_b64_tr_b16 a[30:31], v10 offset:15360
v_mul_f32 v68, s48, v68
v_mul_f32 v69, s48, v69
v_mfma_f32_32x32x16_bf16 v[48:63], a[4:7], v[112:115], v[48:63]
ds_read_b64_tr_b16 a[0:1], v9 offset:16384
ds_read_b64_tr_b16 a[2:3], v9 offset:17408
s_add_u32 s30, s30, 0x36000
v_mul_f32 v70, s48, v70
v_mfma_f32_32x32x16_bf16 v[32:47], a[8:11], v[116:119], v[32:47]
ds_read_b64_tr_b16 a[4:5], v10 offset:16384
ds_read_b64_tr_b16 a[6:7], v10 offset:17408
v_mul_f32 v71, s48, v71
v_mul_f32 v72, s48, v72
v_mfma_f32_32x32x16_bf16 v[48:63], a[12:15], v[116:119], v[48:63]
ds_read_b64_tr_b16 a[8:9], v9 offset:18432
ds_read_b64_tr_b16 a[10:11], v9 offset:19456
s_add_u32 s31, s31, 0x36000
s_waitcnt lgkmcnt(6)
v_mfma_f32_32x32x16_bf16 v[32:47], a[16:19], v[120:123], v[32:47]
ds_read_b64_tr_b16 a[12:13], v10 offset:18432
ds_read_b64_tr_b16 a[14:15], v10 offset:19456
v_mul_f32 v73, s48, v73
v_mul_f32 v74, s48, v74
v_mfma_f32_32x32x16_bf16 v[48:63], a[20:23], v[120:123], v[48:63]
ds_read_b64_tr_b16 a[16:17], v9 offset:20480
ds_read_b64_tr_b16 a[18:19], v9 offset:21504
v_mul_f32 v75, s48, v75
v_mul_f32 v76, s48, v76
v_mfma_f32_32x32x16_bf16 v[32:47], a[24:27], v[124:127], v[32:47]
ds_read_b64_tr_b16 a[20:21], v10 offset:20480
ds_read_b64_tr_b16 a[22:23], v10 offset:21504
v_mul_f32 v77, s48, v77
v_mul_f32 v78, s48, v78
v_mfma_f32_32x32x16_bf16 v[48:63], a[28:31], v[124:127], v[48:63]
ds_read_b64_tr_b16 a[24:25], v9 offset:22528
ds_read_b64_tr_b16 a[26:27], v9 offset:23552
v_mul_f32 v79, s48, v79
s_waitcnt lgkmcnt(6)
v_mfma_f32_32x32x16_bf16 v[32:47], a[0:3], v[128:131], v[32:47]
ds_read_b64_tr_b16 a[28:29], v10 offset:22528
ds_read_b64_tr_b16 a[30:31], v10 offset:23552
s_waitcnt vmcnt(23)
s_barrier
v_mfma_f32_32x32x16_bf16 v[48:63], a[4:7], v[128:131], v[48:63]
ds_read_b64_tr_b16 a[0:1], v9 offset:24576
ds_read_b64_tr_b16 a[2:3], v9 offset:25600
s_add_u32 m0, s34, 122880
v_cvt_pk_bf16_f32 v64, v64, v65
v_mfma_f32_32x32x16_bf16 v[32:47], a[8:11], v[132:135], v[32:47]
ds_read_b64_tr_b16 a[4:5], v10 offset:24576
ds_read_b64_tr_b16 a[6:7], v10 offset:25600
v_cvt_pk_bf16_f32 v65, v66, v67
v_cvt_pk_bf16_f32 v66, v68, v69
v_mfma_f32_32x32x16_bf16 v[48:63], a[12:15], v[132:135], v[48:63]
ds_read_b64_tr_b16 a[8:9], v9 offset:26624
ds_read_b64_tr_b16 a[10:11], v9 offset:27648
buffer_load_dwordx4 v6, s[12:15], s30 offen lds
s_waitcnt lgkmcnt(6)
v_mfma_f32_32x32x16_bf16 v[32:47], a[16:19], v[136:139], v[32:47]
ds_read_b64_tr_b16 a[12:13], v10 offset:26624
ds_read_b64_tr_b16 a[14:15], v10 offset:27648
v_cvt_pk_bf16_f32 v67, v70, v71
v_cvt_pk_bf16_f32 v68, v72, v73
v_mfma_f32_32x32x16_bf16 v[48:63], a[20:23], v[136:139], v[48:63]
ds_read_b64_tr_b16 a[16:17], v9 offset:28672
ds_read_b64_tr_b16 a[18:19], v9 offset:29696
buffer_load_dwordx4 v7, s[12:15], s30 offen offset:1024 lds
v_mfma_f32_32x32x16_bf16 v[32:47], a[24:27], v[140:143], v[32:47]
ds_read_b64_tr_b16 a[20:21], v10 offset:28672
ds_read_b64_tr_b16 a[22:23], v10 offset:29696
v_cvt_pk_bf16_f32 v69, v74, v75
v_cvt_pk_bf16_f32 v70, v76, v77
v_mfma_f32_32x32x16_bf16 v[48:63], a[28:31], v[140:143], v[48:63]
ds_read_b64_tr_b16 a[24:25], v9 offset:30720
ds_read_b64_tr_b16 a[26:27], v9 offset:31744
buffer_load_dwordx4 v8, s[12:15], s30 offen offset:2048 lds
s_waitcnt lgkmcnt(6)
v_mfma_f32_32x32x16_bf16 v[32:47], a[0:3], v[144:147], v[32:47]
ds_read_b64_tr_b16 a[28:29], v10 offset:30720
ds_read_b64_tr_b16 a[30:31], v10 offset:31744
v_cvt_pk_bf16_f32 v71, v78, v79
v_mfma_f32_32x32x16_bf16 v[48:63], a[4:7], v[144:147], v[48:63]
ds_read_b64_tr_b16 a[0:1], v9 offset:32768
ds_read_b64_tr_b16 a[2:3], v9 offset:33792
s_add_u32 m0, s34, 125952
v_mfma_f32_32x32x16_bf16 v[32:47], a[8:11], v[148:151], v[32:47]
ds_read_b64_tr_b16 a[4:5], v10 offset:32768
ds_read_b64_tr_b16 a[6:7], v10 offset:33792
buffer_store_dwordx4 v[64:67], v2, s[16:19], s40 offen offset:0 sc1
v_mfma_f32_32x32x16_bf16 v[48:63], a[12:15], v[148:151], v[48:63]
ds_read_b64_tr_b16 a[8:9], v9 offset:34816
ds_read_b64_tr_b16 a[10:11], v9 offset:35840
buffer_load_dwordx4 v6, s[12:15], s31 offen lds
s_waitcnt lgkmcnt(6)
v_mfma_f32_32x32x16_bf16 v[32:47], a[16:19], v[152:155], v[32:47]
ds_read_b64_tr_b16 a[12:13], v10 offset:34816
ds_read_b64_tr_b16 a[14:15], v10 offset:35840
buffer_store_dwordx4 v[68:71], v2, s[16:19], s40 offen offset:1024 sc1
v_mfma_f32_32x32x16_bf16 v[48:63], a[20:23], v[152:155], v[48:63]
ds_read_b64_tr_b16 a[16:17], v9 offset:36864
ds_read_b64_tr_b16 a[18:19], v9 offset:37888
buffer_load_dwordx4 v7, s[12:15], s31 offen offset:1024 lds
v_mfma_f32_32x32x16_bf16 v[32:47], a[24:27], v[156:159], v[32:47]
ds_read_b64_tr_b16 a[20:21], v10 offset:36864
ds_read_b64_tr_b16 a[22:23], v10 offset:37888
v_mul_f32 v80, s48, v80
v_mul_f32 v81, s48, v81
v_mfma_f32_32x32x16_bf16 v[48:63], a[28:31], v[156:159], v[48:63]
ds_read_b64_tr_b16 a[24:25], v9 offset:38912
ds_read_b64_tr_b16 a[26:27], v9 offset:39936
buffer_load_dwordx4 v8, s[12:15], s31 offen offset:2048 lds
s_waitcnt lgkmcnt(6)
v_mfma_f32_32x32x16_bf16 v[32:47], a[0:3], v[160:163], v[32:47]
ds_read_b64_tr_b16 a[28:29], v10 offset:38912
ds_read_b64_tr_b16 a[30:31], v10 offset:39936
v_mul_f32 v82, s48, v82
v_mul_f32 v83, s48, v83
v_mfma_f32_32x32x16_bf16 v[48:63], a[4:7], v[160:163], v[48:63]
ds_read_b64_tr_b16 a[0:1], v9 offset:40960
ds_read_b64_tr_b16 a[2:3], v9 offset:41984
s_add_u32 s30, s30, 0xfff94080
v_mul_f32 v84, s48, v84
v_mfma_f32_32x32x16_bf16 v[32:47], a[8:11], v[164:167], v[32:47]
ds_read_b64_tr_b16 a[4:5], v10 offset:40960
ds_read_b64_tr_b16 a[6:7], v10 offset:41984
v_mul_f32 v85, s48, v85
v_mul_f32 v86, s48, v86
v_mfma_f32_32x32x16_bf16 v[48:63], a[12:15], v[164:167], v[48:63]
ds_read_b64_tr_b16 a[8:9], v9 offset:43008
ds_read_b64_tr_b16 a[10:11], v9 offset:44032
s_add_u32 s31, s31, 0xfff94080
s_waitcnt lgkmcnt(6)
v_mfma_f32_32x32x16_bf16 v[32:47], a[16:19], v[168:171], v[32:47]
ds_read_b64_tr_b16 a[12:13], v10 offset:43008
ds_read_b64_tr_b16 a[14:15], v10 offset:44032
v_mul_f32 v87, s48, v87
v_mul_f32 v88, s48, v88
v_mfma_f32_32x32x16_bf16 v[48:63], a[20:23], v[168:171], v[48:63]
ds_read_b64_tr_b16 a[16:17], v9 offset:45056
ds_read_b64_tr_b16 a[18:19], v9 offset:46080
v_mul_f32 v89, s48, v89
v_mul_f32 v90, s48, v90
v_mfma_f32_32x32x16_bf16 v[32:47], a[24:27], v[172:175], v[32:47]
ds_read_b64_tr_b16 a[20:21], v10 offset:45056
ds_read_b64_tr_b16 a[22:23], v10 offset:46080
v_mul_f32 v91, s48, v91
v_mul_f32 v92, s48, v92
v_mfma_f32_32x32x16_bf16 v[48:63], a[28:31], v[172:175], v[48:63]
ds_read_b64_tr_b16 a[24:25], v9 offset:47104
ds_read_b64_tr_b16 a[26:27], v9 offset:48128
v_mul_f32 v93, s48, v93
s_waitcnt lgkmcnt(6)
v_mfma_f32_32x32x16_bf16 v[32:47], a[0:3], v[176:179], v[32:47]
ds_read_b64_tr_b16 a[28:29], v10 offset:47104
ds_read_b64_tr_b16 a[30:31], v10 offset:48128
s_waitcnt vmcnt(16)
s_barrier
v_add_u32 v254, 1024, v254
buffer_store_dword v255, v254, s[60:63], 0 offen sc1
v_mfma_f32_32x32x16_bf16 v[48:63], a[4:7], v[176:179], v[48:63]
ds_read_b64_tr_b16 a[0:1], v11 offset:0
ds_read_b64_tr_b16 a[2:3], v11 offset:1024
s_add_u32 m0, s34, 0
v_mul_f32 v94, s48, v94
v_mfma_f32_32x32x16_bf16 v[32:47], a[8:11], v[180:183], v[32:47]
ds_read_b64_tr_b16 a[4:5], v12 offset:0
ds_read_b64_tr_b16 a[6:7], v12 offset:1024
v_mul_f32 v95, s48, v95
v_cvt_pk_bf16_f32 v80, v80, v81
v_mfma_f32_32x32x16_bf16 v[48:63], a[12:15], v[180:183], v[48:63]
ds_read_b64_tr_b16 a[8:9], v11 offset:2048
ds_read_b64_tr_b16 a[10:11], v11 offset:3072
buffer_load_dwordx4 v6, s[12:15], s30 offen lds
s_waitcnt lgkmcnt(6)
v_mfma_f32_32x32x16_bf16 v[32:47], a[16:19], v[184:187], v[32:47]
ds_read_b64_tr_b16 a[12:13], v12 offset:2048
ds_read_b64_tr_b16 a[14:15], v12 offset:3072
v_cvt_pk_bf16_f32 v81, v82, v83
v_cvt_pk_bf16_f32 v82, v84, v85
v_mfma_f32_32x32x16_bf16 v[48:63], a[20:23], v[184:187], v[48:63]
ds_read_b64_tr_b16 a[16:17], v11 offset:4096
ds_read_b64_tr_b16 a[18:19], v11 offset:5120
buffer_load_dwordx4 v7, s[12:15], s30 offen offset:1024 lds
v_mfma_f32_32x32x16_bf16 v[32:47], a[24:27], v[188:191], v[32:47]
ds_read_b64_tr_b16 a[20:21], v12 offset:4096
ds_read_b64_tr_b16 a[22:23], v12 offset:5120
v_cvt_pk_bf16_f32 v83, v86, v87
v_cvt_pk_bf16_f32 v84, v88, v89
v_mfma_f32_32x32x16_bf16 v[48:63], a[28:31], v[188:191], v[48:63]
ds_read_b64_tr_b16 a[24:25], v11 offset:6144
ds_read_b64_tr_b16 a[26:27], v11 offset:7168
buffer_load_dwordx4 v8, s[12:15], s30 offen offset:2048 lds
s_waitcnt lgkmcnt(6)
v_mfma_f32_32x32x16_bf16 v[32:47], a[0:3], v[192:195], v[32:47]
ds_read_b64_tr_b16 a[28:29], v12 offset:6144
ds_read_b64_tr_b16 a[30:31], v12 offset:7168
v_cvt_pk_bf16_f32 v85, v90, v91
v_cvt_pk_bf16_f32 v86, v92, v93
v_mfma_f32_32x32x16_bf16 v[48:63], a[4:7], v[192:195], v[48:63]
ds_read_b64_tr_b16 a[0:1], v11 offset:8192
ds_read_b64_tr_b16 a[2:3], v11 offset:9216
s_add_u32 m0, s34, 3072
v_cvt_pk_bf16_f32 v87, v94, v95
v_mfma_f32_32x32x16_bf16 v[32:47], a[8:11], v[196:199], v[32:47]
ds_read_b64_tr_b16 a[4:5], v12 offset:8192
ds_read_b64_tr_b16 a[6:7], v12 offset:9216
buffer_store_dwordx4 v[80:83], v2, s[16:19], s40 offen offset:2048 sc1
v_mfma_f32_32x32x16_bf16 v[48:63], a[12:15], v[196:199], v[48:63]
ds_read_b64_tr_b16 a[8:9], v11 offset:10240
ds_read_b64_tr_b16 a[10:11], v11 offset:11264
buffer_load_dwordx4 v6, s[12:15], s31 offen lds
s_waitcnt lgkmcnt(6)
v_mfma_f32_32x32x16_bf16 v[32:47], a[16:19], v[200:203], v[32:47]
ds_read_b64_tr_b16 a[12:13], v12 offset:10240
ds_read_b64_tr_b16 a[14:15], v12 offset:11264
buffer_store_dwordx4 v[84:87], v2, s[16:19], s40 offen offset:3072 sc1
v_mfma_f32_32x32x16_bf16 v[48:63], a[20:23], v[200:203], v[48:63]
ds_read_b64_tr_b16 a[16:17], v11 offset:12288
ds_read_b64_tr_b16 a[18:19], v11 offset:13312
buffer_load_dwordx4 v7, s[12:15], s31 offen offset:1024 lds
v_mfma_f32_32x32x16_bf16 v[32:47], a[24:27], v[204:207], v[32:47]
ds_read_b64_tr_b16 a[20:21], v12 offset:12288
ds_read_b64_tr_b16 a[22:23], v12 offset:13312
s_add_u32 s40, s40, 4096
v_mfma_f32_32x32x16_bf16 v[48:63], a[28:31], v[204:207], v[48:63]
ds_read_b64_tr_b16 a[24:25], v11 offset:14336
ds_read_b64_tr_b16 a[26:27], v11 offset:15360
buffer_load_dwordx4 v8, s[12:15], s31 offen offset:2048 lds
s_waitcnt lgkmcnt(6)
v_mfma_f32_32x32x16_bf16 v[32:47], a[0:3], v[208:211], v[32:47]
ds_read_b64_tr_b16 a[28:29], v12 offset:14336
ds_read_b64_tr_b16 a[30:31], v12 offset:15360
v_mfma_f32_32x32x16_bf16 v[48:63], a[4:7], v[208:211], v[48:63]
ds_read_b64_tr_b16 a[0:1], v11 offset:16384
ds_read_b64_tr_b16 a[2:3], v11 offset:17408
s_add_u32 s30, s30, 0x36000
v_mfma_f32_32x32x16_bf16 v[32:47], a[8:11], v[212:215], v[32:47]
ds_read_b64_tr_b16 a[4:5], v12 offset:16384
ds_read_b64_tr_b16 a[6:7], v12 offset:17408
v_mfma_f32_32x32x16_bf16 v[48:63], a[12:15], v[212:215], v[48:63]
ds_read_b64_tr_b16 a[8:9], v11 offset:18432
ds_read_b64_tr_b16 a[10:11], v11 offset:19456
s_add_u32 s31, s31, 0x36000
s_waitcnt lgkmcnt(6)
v_mfma_f32_32x32x16_bf16 v[32:47], a[16:19], v[216:219], v[32:47]
ds_read_b64_tr_b16 a[12:13], v12 offset:18432
ds_read_b64_tr_b16 a[14:15], v12 offset:19456
v_mfma_f32_32x32x16_bf16 v[48:63], a[20:23], v[216:219], v[48:63]
ds_read_b64_tr_b16 a[16:17], v11 offset:20480
ds_read_b64_tr_b16 a[18:19], v11 offset:21504
v_mfma_f32_32x32x16_bf16 v[32:47], a[24:27], v[220:223], v[32:47]
ds_read_b64_tr_b16 a[20:21], v12 offset:20480
ds_read_b64_tr_b16 a[22:23], v12 offset:21504
v_mfma_f32_32x32x16_bf16 v[48:63], a[28:31], v[220:223], v[48:63]
ds_read_b64_tr_b16 a[24:25], v11 offset:22528
ds_read_b64_tr_b16 a[26:27], v11 offset:23552
s_waitcnt lgkmcnt(6)
v_mfma_f32_32x32x16_bf16 v[32:47], a[0:3], v[224:227], v[32:47]
ds_read_b64_tr_b16 a[28:29], v12 offset:22528
ds_read_b64_tr_b16 a[30:31], v12 offset:23552
s_waitcnt vmcnt(23)
s_barrier
v_mfma_f32_32x32x16_bf16 v[48:63], a[4:7], v[224:227], v[48:63]
ds_read_b64_tr_b16 a[0:1], v11 offset:24576
ds_read_b64_tr_b16 a[2:3], v11 offset:25600
s_add_u32 m0, s34, 24576
v_mfma_f32_32x32x16_bf16 v[32:47], a[8:11], v[228:231], v[32:47]
ds_read_b64_tr_b16 a[4:5], v12 offset:24576
ds_read_b64_tr_b16 a[6:7], v12 offset:25600
v_mfma_f32_32x32x16_bf16 v[48:63], a[12:15], v[228:231], v[48:63]
ds_read_b64_tr_b16 a[8:9], v11 offset:26624
ds_read_b64_tr_b16 a[10:11], v11 offset:27648
buffer_load_dwordx4 v6, s[12:15], s30 offen lds
s_waitcnt lgkmcnt(6)
v_mfma_f32_32x32x16_bf16 v[32:47], a[16:19], v[232:235], v[32:47]
ds_read_b64_tr_b16 a[12:13], v12 offset:26624
ds_read_b64_tr_b16 a[14:15], v12 offset:27648
v_mfma_f32_32x32x16_bf16 v[48:63], a[20:23], v[232:235], v[48:63]
ds_read_b64_tr_b16 a[16:17], v11 offset:28672
ds_read_b64_tr_b16 a[18:19], v11 offset:29696
buffer_load_dwordx4 v7, s[12:15], s30 offen offset:1024 lds
v_mfma_f32_32x32x16_bf16 v[32:47], a[24:27], v[236:239], v[32:47]
ds_read_b64_tr_b16 a[20:21], v12 offset:28672
ds_read_b64_tr_b16 a[22:23], v12 offset:29696
v_mfma_f32_32x32x16_bf16 v[48:63], a[28:31], v[236:239], v[48:63]
ds_read_b64_tr_b16 a[24:25], v11 offset:30720
ds_read_b64_tr_b16 a[26:27], v11 offset:31744
buffer_load_dwordx4 v8, s[12:15], s30 offen offset:2048 lds
s_waitcnt lgkmcnt(6)
v_mfma_f32_32x32x16_bf16 v[64:79], a[0:3], v[96:99], 0
ds_read_b64_tr_b16 a[28:29], v12 offset:30720
ds_read_b64_tr_b16 a[30:31], v12 offset:31744
v_mfma_f32_32x32x16_bf16 v[80:95], a[4:7], v[96:99], 0
ds_read_b64_tr_b16 a[0:1], v11 offset:32768
ds_read_b64_tr_b16 a[2:3], v11 offset:33792
s_add_u32 m0, s34, 27648
v_mfma_f32_32x32x16_bf16 v[64:79], a[8:11], v[100:103], v[64:79]
ds_read_b64_tr_b16 a[4:5], v12 offset:32768
ds_read_b64_tr_b16 a[6:7], v12 offset:33792
v_mfma_f32_32x32x16_bf16 v[80:95], a[12:15], v[100:103], v[80:95]
ds_read_b64_tr_b16 a[8:9], v11 offset:34816
ds_read_b64_tr_b16 a[10:11], v11 offset:35840
buffer_load_dwordx4 v6, s[12:15], s31 offen lds
s_waitcnt lgkmcnt(6)
v_mfma_f32_32x32x16_bf16 v[64:79], a[16:19], v[104:107], v[64:79]
ds_read_b64_tr_b16 a[12:13], v12 offset:34816
ds_read_b64_tr_b16 a[14:15], v12 offset:35840
v_mul_f32 v32, s48, v32
v_mul_f32 v33, s48, v33
v_mfma_f32_32x32x16_bf16 v[80:95], a[20:23], v[104:107], v[80:95]
ds_read_b64_tr_b16 a[16:17], v11 offset:36864
ds_read_b64_tr_b16 a[18:19], v11 offset:37888
buffer_load_dwordx4 v7, s[12:15], s31 offen offset:1024 lds
v_mfma_f32_32x32x16_bf16 v[64:79], a[24:27], v[108:111], v[64:79]
ds_read_b64_tr_b16 a[20:21], v12 offset:36864
ds_read_b64_tr_b16 a[22:23], v12 offset:37888
v_mul_f32 v34, s48, v34
v_mul_f32 v35, s48, v35
v_mfma_f32_32x32x16_bf16 v[80:95], a[28:31], v[108:111], v[80:95]
ds_read_b64_tr_b16 a[24:25], v11 offset:38912
ds_read_b64_tr_b16 a[26:27], v11 offset:39936
buffer_load_dwordx4 v8, s[12:15], s31 offen offset:2048 lds
s_waitcnt lgkmcnt(6)
v_mfma_f32_32x32x16_bf16 v[64:79], a[0:3], v[112:115], v[64:79]
ds_read_b64_tr_b16 a[28:29], v12 offset:38912
ds_read_b64_tr_b16 a[30:31], v12 offset:39936
v_mul_f32 v36, s48, v36
v_mul_f32 v37, s48, v37
v_mfma_f32_32x32x16_bf16 v[80:95], a[4:7], v[112:115], v[80:95]
ds_read_b64_tr_b16 a[0:1], v11 offset:40960
ds_read_b64_tr_b16 a[2:3], v11 offset:41984
s_add_u32 s30, s30, 0x36000
v_mul_f32 v38, s48, v38
v_mfma_f32_32x32x16_bf16 v[64:79], a[8:11], v[116:119], v[64:79]
ds_read_b64_tr_b16 a[4:5], v12 offset:40960
ds_read_b64_tr_b16 a[6:7], v12 offset:41984
v_mul_f32 v39, s48, v39
v_mul_f32 v40, s48, v40
v_mfma_f32_32x32x16_bf16 v[80:95], a[12:15], v[116:119], v[80:95]
ds_read_b64_tr_b16 a[8:9], v11 offset:43008
ds_read_b64_tr_b16 a[10:11], v11 offset:44032
s_add_u32 s31, s31, 0x36000
s_waitcnt lgkmcnt(6)
v_mfma_f32_32x32x16_bf16 v[64:79], a[16:19], v[120:123], v[64:79]
ds_read_b64_tr_b16 a[12:13], v12 offset:43008
ds_read_b64_tr_b16 a[14:15], v12 offset:44032
v_mul_f32 v41, s48, v41
v_mul_f32 v42, s48, v42
v_mfma_f32_32x32x16_bf16 v[80:95], a[20:23], v[120:123], v[80:95]
ds_read_b64_tr_b16 a[16:17], v11 offset:45056
ds_read_b64_tr_b16 a[18:19], v11 offset:46080
v_mul_f32 v43, s48, v43
v_mul_f32 v44, s48, v44
v_mfma_f32_32x32x16_bf16 v[64:79], a[24:27], v[124:127], v[64:79]
ds_read_b64_tr_b16 a[20:21], v12 offset:45056
ds_read_b64_tr_b16 a[22:23], v12 offset:46080
v_mul_f32 v45, s48, v45
v_mul_f32 v46, s48, v46
v_mfma_f32_32x32x16_bf16 v[80:95], a[28:31], v[124:127], v[80:95]
ds_read_b64_tr_b16 a[24:25], v11 offset:47104
ds_read_b64_tr_b16 a[26:27], v11 offset:48128
v_mul_f32 v47, s48, v47
s_waitcnt lgkmcnt(6)
v_mfma_f32_32x32x16_bf16 v[64:79], a[0:3], v[128:131], v[64:79]
ds_read_b64_tr_b16 a[28:29], v12 offset:47104
ds_read_b64_tr_b16 a[30:31], v12 offset:48128
s_waitcnt vmcnt(23)
s_barrier
v_mfma_f32_32x32x16_bf16 v[80:95], a[4:7], v[128:131], v[80:95]
ds_read_b64_tr_b16 a[0:1], v13 offset:0
ds_read_b64_tr_b16 a[2:3], v13 offset:1024
s_add_u32 m0, s34, 49152
v_cvt_pk_bf16_f32 v32, v32, v33
v_mfma_f32_32x32x16_bf16 v[64:79], a[8:11], v[132:135], v[64:79]
ds_read_b64_tr_b16 a[4:5], v14 offset:0
ds_read_b64_tr_b16 a[6:7], v14 offset:1024
v_cvt_pk_bf16_f32 v33, v34, v35
v_cvt_pk_bf16_f32 v34, v36, v37
v_mfma_f32_32x32x16_bf16 v[80:95], a[12:15], v[132:135], v[80:95]
ds_read_b64_tr_b16 a[8:9], v13 offset:2048
ds_read_b64_tr_b16 a[10:11], v13 offset:3072
buffer_load_dwordx4 v6, s[12:15], s30 offen lds
s_waitcnt lgkmcnt(6)
v_mfma_f32_32x32x16_bf16 v[64:79], a[16:19], v[136:139], v[64:79]
ds_read_b64_tr_b16 a[12:13], v14 offset:2048
ds_read_b64_tr_b16 a[14:15], v14 offset:3072
v_cvt_pk_bf16_f32 v35, v38, v39
v_cvt_pk_bf16_f32 v36, v40, v41
v_mfma_f32_32x32x16_bf16 v[80:95], a[20:23], v[136:139], v[80:95]
ds_read_b64_tr_b16 a[16:17], v13 offset:4096
ds_read_b64_tr_b16 a[18:19], v13 offset:5120
buffer_load_dwordx4 v7, s[12:15], s30 offen offset:1024 lds
v_mfma_f32_32x32x16_bf16 v[64:79], a[24:27], v[140:143], v[64:79]
ds_read_b64_tr_b16 a[20:21], v14 offset:4096
ds_read_b64_tr_b16 a[22:23], v14 offset:5120
v_cvt_pk_bf16_f32 v37, v42, v43
v_cvt_pk_bf16_f32 v38, v44, v45
v_mfma_f32_32x32x16_bf16 v[80:95], a[28:31], v[140:143], v[80:95]
ds_read_b64_tr_b16 a[24:25], v13 offset:6144
ds_read_b64_tr_b16 a[26:27], v13 offset:7168
buffer_load_dwordx4 v8, s[12:15], s30 offen offset:2048 lds
s_waitcnt lgkmcnt(6)
v_mfma_f32_32x32x16_bf16 v[64:79], a[0:3], v[144:147], v[64:79]
ds_read_b64_tr_b16 a[28:29], v14 offset:6144
ds_read_b64_tr_b16 a[30:31], v14 offset:7168
v_cvt_pk_bf16_f32 v39, v46, v47
v_mfma_f32_32x32x16_bf16 v[80:95], a[4:7], v[144:147], v[80:95]
ds_read_b64_tr_b16 a[0:1], v13 offset:8192
ds_read_b64_tr_b16 a[2:3], v13 offset:9216
s_add_u32 m0, s34, 52224
v_mfma_f32_32x32x16_bf16 v[64:79], a[8:11], v[148:151], v[64:79]
ds_read_b64_tr_b16 a[4:5], v14 offset:8192
ds_read_b64_tr_b16 a[6:7], v14 offset:9216
buffer_store_dwordx4 v[32:35], v2, s[16:19], s40 offen offset:0 sc1
v_mfma_f32_32x32x16_bf16 v[80:95], a[12:15], v[148:151], v[80:95]
ds_read_b64_tr_b16 a[8:9], v13 offset:10240
ds_read_b64_tr_b16 a[10:11], v13 offset:11264
buffer_load_dwordx4 v6, s[12:15], s31 offen lds
s_waitcnt lgkmcnt(6)
v_mfma_f32_32x32x16_bf16 v[64:79], a[16:19], v[152:155], v[64:79]
ds_read_b64_tr_b16 a[12:13], v14 offset:10240
ds_read_b64_tr_b16 a[14:15], v14 offset:11264
buffer_store_dwordx4 v[36:39], v2, s[16:19], s40 offen offset:1024 sc1
v_mfma_f32_32x32x16_bf16 v[80:95], a[20:23], v[152:155], v[80:95]
ds_read_b64_tr_b16 a[16:17], v13 offset:12288
ds_read_b64_tr_b16 a[18:19], v13 offset:13312
buffer_load_dwordx4 v7, s[12:15], s31 offen offset:1024 lds
v_mfma_f32_32x32x16_bf16 v[64:79], a[24:27], v[156:159], v[64:79]
ds_read_b64_tr_b16 a[20:21], v14 offset:12288
ds_read_b64_tr_b16 a[22:23], v14 offset:13312
v_mul_f32 v48, s48, v48
v_mul_f32 v49, s48, v49
v_mfma_f32_32x32x16_bf16 v[80:95], a[28:31], v[156:159], v[80:95]
ds_read_b64_tr_b16 a[24:25], v13 offset:14336
ds_read_b64_tr_b16 a[26:27], v13 offset:15360
buffer_load_dwordx4 v8, s[12:15], s31 offen offset:2048 lds
s_waitcnt lgkmcnt(6)
v_mfma_f32_32x32x16_bf16 v[64:79], a[0:3], v[160:163], v[64:79]
ds_read_b64_tr_b16 a[28:29], v14 offset:14336
ds_read_b64_tr_b16 a[30:31], v14 offset:15360
v_mul_f32 v50, s48, v50
v_mul_f32 v51, s48, v51
v_mfma_f32_32x32x16_bf16 v[80:95], a[4:7], v[160:163], v[80:95]
ds_read_b64_tr_b16 a[0:1], v13 offset:16384
ds_read_b64_tr_b16 a[2:3], v13 offset:17408
s_add_u32 s30, s30, 0xfff94080
v_mul_f32 v52, s48, v52
v_mfma_f32_32x32x16_bf16 v[64:79], a[8:11], v[164:167], v[64:79]
ds_read_b64_tr_b16 a[4:5], v14 offset:16384
ds_read_b64_tr_b16 a[6:7], v14 offset:17408
v_mul_f32 v53, s48, v53
v_mul_f32 v54, s48, v54
v_mfma_f32_32x32x16_bf16 v[80:95], a[12:15], v[164:167], v[80:95]
ds_read_b64_tr_b16 a[8:9], v13 offset:18432
ds_read_b64_tr_b16 a[10:11], v13 offset:19456
s_add_u32 s31, s31, 0xfff94080
s_waitcnt lgkmcnt(6)
v_mfma_f32_32x32x16_bf16 v[64:79], a[16:19], v[168:171], v[64:79]
ds_read_b64_tr_b16 a[12:13], v14 offset:18432
ds_read_b64_tr_b16 a[14:15], v14 offset:19456
v_mul_f32 v55, s48, v55
v_mul_f32 v56, s48, v56
v_mfma_f32_32x32x16_bf16 v[80:95], a[20:23], v[168:171], v[80:95]
ds_read_b64_tr_b16 a[16:17], v13 offset:20480
ds_read_b64_tr_b16 a[18:19], v13 offset:21504
v_mul_f32 v57, s48, v57
v_mul_f32 v58, s48, v58
v_mfma_f32_32x32x16_bf16 v[64:79], a[24:27], v[172:175], v[64:79]
ds_read_b64_tr_b16 a[20:21], v14 offset:20480
ds_read_b64_tr_b16 a[22:23], v14 offset:21504
v_mul_f32 v59, s48, v59
v_mul_f32 v60, s48, v60
v_mfma_f32_32x32x16_bf16 v[80:95], a[28:31], v[172:175], v[80:95]
ds_read_b64_tr_b16 a[24:25], v13 offset:22528
ds_read_b64_tr_b16 a[26:27], v13 offset:23552
v_mul_f32 v61, s48, v61
s_waitcnt lgkmcnt(6)
v_mfma_f32_32x32x16_bf16 v[64:79], a[0:3], v[176:179], v[64:79]
ds_read_b64_tr_b16 a[28:29], v14 offset:22528
ds_read_b64_tr_b16 a[30:31], v14 offset:23552
s_waitcnt vmcnt(16)
s_barrier
v_add_u32 v254, 1024, v254
buffer_store_dword v255, v254, s[60:63], 0 offen sc1
v_mfma_f32_32x32x16_bf16 v[80:95], a[4:7], v[176:179], v[80:95]
ds_read_b64_tr_b16 a[0:1], v13 offset:24576
ds_read_b64_tr_b16 a[2:3], v13 offset:25600
s_add_u32 m0, s34, 73728
v_mul_f32 v62, s48, v62
v_mfma_f32_32x32x16_bf16 v[64:79], a[8:11], v[180:183], v[64:79]
ds_read_b64_tr_b16 a[4:5], v14 offset:24576
ds_read_b64_tr_b16 a[6:7], v14 offset:25600
v_mul_f32 v63, s48, v63
v_cvt_pk_bf16_f32 v48, v48, v49
v_mfma_f32_32x32x16_bf16 v[80:95], a[12:15], v[180:183], v[80:95]
ds_read_b64_tr_b16 a[8:9], v13 offset:26624
ds_read_b64_tr_b16 a[10:11], v13 offset:27648
buffer_load_dwordx4 v6, s[12:15], s30 offen lds
s_waitcnt lgkmcnt(6)
v_mfma_f32_32x32x16_bf16 v[64:79], a[16:19], v[184:187], v[64:79]
ds_read_b64_tr_b16 a[12:13], v14 offset:26624
ds_read_b64_tr_b16 a[14:15], v14 offset:27648
v_cvt_pk_bf16_f32 v49, v50, v51
v_cvt_pk_bf16_f32 v50, v52, v53
v_mfma_f32_32x32x16_bf16 v[80:95], a[20:23], v[184:187], v[80:95]
ds_read_b64_tr_b16 a[16:17], v13 offset:28672
ds_read_b64_tr_b16 a[18:19], v13 offset:29696
buffer_load_dwordx4 v7, s[12:15], s30 offen offset:1024 lds
v_mfma_f32_32x32x16_bf16 v[64:79], a[24:27], v[188:191], v[64:79]
ds_read_b64_tr_b16 a[20:21], v14 offset:28672
ds_read_b64_tr_b16 a[22:23], v14 offset:29696
v_cvt_pk_bf16_f32 v51, v54, v55
v_cvt_pk_bf16_f32 v52, v56, v57
v_mfma_f32_32x32x16_bf16 v[80:95], a[28:31], v[188:191], v[80:95]
ds_read_b64_tr_b16 a[24:25], v13 offset:30720
ds_read_b64_tr_b16 a[26:27], v13 offset:31744
buffer_load_dwordx4 v8, s[12:15], s30 offen offset:2048 lds
s_waitcnt lgkmcnt(6)
v_mfma_f32_32x32x16_bf16 v[64:79], a[0:3], v[192:195], v[64:79]
ds_read_b64_tr_b16 a[28:29], v14 offset:30720
ds_read_b64_tr_b16 a[30:31], v14 offset:31744
v_cvt_pk_bf16_f32 v53, v58, v59
v_cvt_pk_bf16_f32 v54, v60, v61
v_mfma_f32_32x32x16_bf16 v[80:95], a[4:7], v[192:195], v[80:95]
ds_read_b64_tr_b16 a[0:1], v13 offset:32768
ds_read_b64_tr_b16 a[2:3], v13 offset:33792
s_add_u32 m0, s34, 76800
v_cvt_pk_bf16_f32 v55, v62, v63
v_mfma_f32_32x32x16_bf16 v[64:79], a[8:11], v[196:199], v[64:79]
ds_read_b64_tr_b16 a[4:5], v14 offset:32768
ds_read_b64_tr_b16 a[6:7], v14 offset:33792
buffer_store_dwordx4 v[48:51], v2, s[16:19], s40 offen offset:2048 sc1
v_mfma_f32_32x32x16_bf16 v[80:95], a[12:15], v[196:199], v[80:95]
ds_read_b64_tr_b16 a[8:9], v13 offset:34816
ds_read_b64_tr_b16 a[10:11], v13 offset:35840
buffer_load_dwordx4 v6, s[12:15], s31 offen lds
s_waitcnt lgkmcnt(6)
v_mfma_f32_32x32x16_bf16 v[64:79], a[16:19], v[200:203], v[64:79]
ds_read_b64_tr_b16 a[12:13], v14 offset:34816
ds_read_b64_tr_b16 a[14:15], v14 offset:35840
buffer_store_dwordx4 v[52:55], v2, s[16:19], s40 offen offset:3072 sc1
v_mfma_f32_32x32x16_bf16 v[80:95], a[20:23], v[200:203], v[80:95]
ds_read_b64_tr_b16 a[16:17], v13 offset:36864
ds_read_b64_tr_b16 a[18:19], v13 offset:37888
buffer_load_dwordx4 v7, s[12:15], s31 offen offset:1024 lds
v_mfma_f32_32x32x16_bf16 v[64:79], a[24:27], v[204:207], v[64:79]
ds_read_b64_tr_b16 a[20:21], v14 offset:36864
ds_read_b64_tr_b16 a[22:23], v14 offset:37888
s_add_u32 s40, s40, 4096
v_mfma_f32_32x32x16_bf16 v[80:95], a[28:31], v[204:207], v[80:95]
ds_read_b64_tr_b16 a[24:25], v13 offset:38912
ds_read_b64_tr_b16 a[26:27], v13 offset:39936
buffer_load_dwordx4 v8, s[12:15], s31 offen offset:2048 lds
s_waitcnt lgkmcnt(6)
v_mfma_f32_32x32x16_bf16 v[64:79], a[0:3], v[208:211], v[64:79]
ds_read_b64_tr_b16 a[28:29], v14 offset:38912
ds_read_b64_tr_b16 a[30:31], v14 offset:39936
v_mfma_f32_32x32x16_bf16 v[80:95], a[4:7], v[208:211], v[80:95]
ds_read_b64_tr_b16 a[0:1], v13 offset:40960
ds_read_b64_tr_b16 a[2:3], v13 offset:41984
s_add_u32 s30, s30, 0x36000
v_mfma_f32_32x32x16_bf16 v[64:79], a[8:11], v[212:215], v[64:79]
ds_read_b64_tr_b16 a[4:5], v14 offset:40960
ds_read_b64_tr_b16 a[6:7], v14 offset:41984
v_mfma_f32_32x32x16_bf16 v[80:95], a[12:15], v[212:215], v[80:95]
ds_read_b64_tr_b16 a[8:9], v13 offset:43008
ds_read_b64_tr_b16 a[10:11], v13 offset:44032
s_add_u32 s31, s31, 0x36000
s_waitcnt lgkmcnt(6)
v_mfma_f32_32x32x16_bf16 v[64:79], a[16:19], v[216:219], v[64:79]
ds_read_b64_tr_b16 a[12:13], v14 offset:43008
ds_read_b64_tr_b16 a[14:15], v14 offset:44032
v_mfma_f32_32x32x16_bf16 v[80:95], a[20:23], v[216:219], v[80:95]
ds_read_b64_tr_b16 a[16:17], v13 offset:45056
ds_read_b64_tr_b16 a[18:19], v13 offset:46080
v_mfma_f32_32x32x16_bf16 v[64:79], a[24:27], v[220:223], v[64:79]
ds_read_b64_tr_b16 a[20:21], v14 offset:45056
ds_read_b64_tr_b16 a[22:23], v14 offset:46080
v_mfma_f32_32x32x16_bf16 v[80:95], a[28:31], v[220:223], v[80:95]
ds_read_b64_tr_b16 a[24:25], v13 offset:47104
ds_read_b64_tr_b16 a[26:27], v13 offset:48128
s_waitcnt lgkmcnt(6)
v_mfma_f32_32x32x16_bf16 v[64:79], a[0:3], v[224:227], v[64:79]
ds_read_b64_tr_b16 a[28:29], v14 offset:47104
ds_read_b64_tr_b16 a[30:31], v14 offset:48128
s_waitcnt vmcnt(23)
s_barrier
v_mfma_f32_32x32x16_bf16 v[80:95], a[4:7], v[224:227], v[80:95]
ds_read_b64_tr_b16 a[0:1], v9 offset:0
ds_read_b64_tr_b16 a[2:3], v9 offset:1024
s_add_u32 m0, s34, 98304
v_mfma_f32_32x32x16_bf16 v[64:79], a[8:11], v[228:231], v[64:79]
ds_read_b64_tr_b16 a[4:5], v10 offset:0
ds_read_b64_tr_b16 a[6:7], v10 offset:1024
v_mfma_f32_32x32x16_bf16 v[80:95], a[12:15], v[228:231], v[80:95]
ds_read_b64_tr_b16 a[8:9], v9 offset:2048
ds_read_b64_tr_b16 a[10:11], v9 offset:3072
buffer_load_dwordx4 v6, s[12:15], s30 offen lds
s_waitcnt lgkmcnt(6)
v_mfma_f32_32x32x16_bf16 v[64:79], a[16:19], v[232:235], v[64:79]
ds_read_b64_tr_b16 a[12:13], v10 offset:2048
ds_read_b64_tr_b16 a[14:15], v10 offset:3072
v_mfma_f32_32x32x16_bf16 v[80:95], a[20:23], v[232:235], v[80:95]
ds_read_b64_tr_b16 a[16:17], v9 offset:4096
ds_read_b64_tr_b16 a[18:19], v9 offset:5120
buffer_load_dwordx4 v7, s[12:15], s30 offen offset:1024 lds
v_mfma_f32_32x32x16_bf16 v[64:79], a[24:27], v[236:239], v[64:79]
ds_read_b64_tr_b16 a[20:21], v10 offset:4096
ds_read_b64_tr_b16 a[22:23], v10 offset:5120
v_mfma_f32_32x32x16_bf16 v[80:95], a[28:31], v[236:239], v[80:95]
ds_read_b64_tr_b16 a[24:25], v9 offset:6144
ds_read_b64_tr_b16 a[26:27], v9 offset:7168
buffer_load_dwordx4 v8, s[12:15], s30 offen offset:2048 lds
s_waitcnt lgkmcnt(6)
v_mfma_f32_32x32x16_bf16 v[32:47], a[0:3], v[96:99], 0
ds_read_b64_tr_b16 a[28:29], v10 offset:6144
ds_read_b64_tr_b16 a[30:31], v10 offset:7168
v_mfma_f32_32x32x16_bf16 v[48:63], a[4:7], v[96:99], 0
ds_read_b64_tr_b16 a[0:1], v9 offset:8192
ds_read_b64_tr_b16 a[2:3], v9 offset:9216
s_add_u32 m0, s34, 101376
v_mfma_f32_32x32x16_bf16 v[32:47], a[8:11], v[100:103], v[32:47]
ds_read_b64_tr_b16 a[4:5], v10 offset:8192
ds_read_b64_tr_b16 a[6:7], v10 offset:9216
v_mfma_f32_32x32x16_bf16 v[48:63], a[12:15], v[100:103], v[48:63]
ds_read_b64_tr_b16 a[8:9], v9 offset:10240
ds_read_b64_tr_b16 a[10:11], v9 offset:11264
buffer_load_dwordx4 v6, s[12:15], s31 offen lds
s_waitcnt lgkmcnt(6)
v_mfma_f32_32x32x16_bf16 v[32:47], a[16:19], v[104:107], v[32:47]
ds_read_b64_tr_b16 a[12:13], v10 offset:10240
ds_read_b64_tr_b16 a[14:15], v10 offset:11264
v_mul_f32 v64, s48, v64
v_mul_f32 v65, s48, v65
v_mfma_f32_32x32x16_bf16 v[48:63], a[20:23], v[104:107], v[48:63]
ds_read_b64_tr_b16 a[16:17], v9 offset:12288
ds_read_b64_tr_b16 a[18:19], v9 offset:13312
buffer_load_dwordx4 v7, s[12:15], s31 offen offset:1024 lds
v_mfma_f32_32x32x16_bf16 v[32:47], a[24:27], v[108:111], v[32:47]
ds_read_b64_tr_b16 a[20:21], v10 offset:12288
ds_read_b64_tr_b16 a[22:23], v10 offset:13312
v_mul_f32 v66, s48, v66
v_mul_f32 v67, s48, v67
v_mfma_f32_32x32x16_bf16 v[48:63], a[28:31], v[108:111], v[48:63]
ds_read_b64_tr_b16 a[24:25], v9 offset:14336
ds_read_b64_tr_b16 a[26:27], v9 offset:15360
buffer_load_dwordx4 v8, s[12:15], s31 offen offset:2048 lds
s_waitcnt lgkmcnt(6)
v_mfma_f32_32x32x16_bf16 v[32:47], a[0:3], v[112:115], v[32:47]
ds_read_b64_tr_b16 a[28:29], v10 offset:14336
ds_read_b64_tr_b16 a[30:31], v10 offset:15360
v_mul_f32 v68, s48, v68
v_mul_f32 v69, s48, v69
v_mfma_f32_32x32x16_bf16 v[48:63], a[4:7], v[112:115], v[48:63]
ds_read_b64_tr_b16 a[0:1], v9 offset:16384
ds_read_b64_tr_b16 a[2:3], v9 offset:17408
s_add_u32 s30, s30, 0x36000
v_mul_f32 v70, s48, v70
v_mfma_f32_32x32x16_bf16 v[32:47], a[8:11], v[116:119], v[32:47]
ds_read_b64_tr_b16 a[4:5], v10 offset:16384
ds_read_b64_tr_b16 a[6:7], v10 offset:17408
v_mul_f32 v71, s48, v71
v_mul_f32 v72, s48, v72
v_mfma_f32_32x32x16_bf16 v[48:63], a[12:15], v[116:119], v[48:63]
ds_read_b64_tr_b16 a[8:9], v9 offset:18432
ds_read_b64_tr_b16 a[10:11], v9 offset:19456
s_add_u32 s31, s31, 0x36000
s_waitcnt lgkmcnt(6)
v_mfma_f32_32x32x16_bf16 v[32:47], a[16:19], v[120:123], v[32:47]
ds_read_b64_tr_b16 a[12:13], v10 offset:18432
ds_read_b64_tr_b16 a[14:15], v10 offset:19456
v_mul_f32 v73, s48, v73
v_mul_f32 v74, s48, v74
v_mfma_f32_32x32x16_bf16 v[48:63], a[20:23], v[120:123], v[48:63]
ds_read_b64_tr_b16 a[16:17], v9 offset:20480
ds_read_b64_tr_b16 a[18:19], v9 offset:21504
v_mul_f32 v75, s48, v75
v_mul_f32 v76, s48, v76
v_mfma_f32_32x32x16_bf16 v[32:47], a[24:27], v[124:127], v[32:47]
ds_read_b64_tr_b16 a[20:21], v10 offset:20480
ds_read_b64_tr_b16 a[22:23], v10 offset:21504
v_mul_f32 v77, s48, v77
v_mul_f32 v78, s48, v78
v_mfma_f32_32x32x16_bf16 v[48:63], a[28:31], v[124:127], v[48:63]
ds_read_b64_tr_b16 a[24:25], v9 offset:22528
ds_read_b64_tr_b16 a[26:27], v9 offset:23552
v_mul_f32 v79, s48, v79
s_waitcnt lgkmcnt(6)
v_mfma_f32_32x32x16_bf16 v[32:47], a[0:3], v[128:131], v[32:47]
ds_read_b64_tr_b16 a[28:29], v10 offset:22528
ds_read_b64_tr_b16 a[30:31], v10 offset:23552
s_waitcnt vmcnt(23)
s_barrier
v_mfma_f32_32x32x16_bf16 v[48:63], a[4:7], v[128:131], v[48:63]
ds_read_b64_tr_b16 a[0:1], v9 offset:24576
ds_read_b64_tr_b16 a[2:3], v9 offset:25600
s_add_u32 m0, s34, 122880
v_cvt_pk_bf16_f32 v64, v64, v65
v_mfma_f32_32x32x16_bf16 v[32:47], a[8:11], v[132:135], v[32:47]
ds_read_b64_tr_b16 a[4:5], v10 offset:24576
ds_read_b64_tr_b16 a[6:7], v10 offset:25600
v_cvt_pk_bf16_f32 v65, v66, v67
v_cvt_pk_bf16_f32 v66, v68, v69
v_mfma_f32_32x32x16_bf16 v[48:63], a[12:15], v[132:135], v[48:63]
ds_read_b64_tr_b16 a[8:9], v9 offset:26624
ds_read_b64_tr_b16 a[10:11], v9 offset:27648
buffer_load_dwordx4 v6, s[12:15], s30 offen lds
s_waitcnt lgkmcnt(6)
v_mfma_f32_32x32x16_bf16 v[32:47], a[16:19], v[136:139], v[32:47]
ds_read_b64_tr_b16 a[12:13], v10 offset:26624
ds_read_b64_tr_b16 a[14:15], v10 offset:27648
v_cvt_pk_bf16_f32 v67, v70, v71
v_cvt_pk_bf16_f32 v68, v72, v73
v_mfma_f32_32x32x16_bf16 v[48:63], a[20:23], v[136:139], v[48:63]
ds_read_b64_tr_b16 a[16:17], v9 offset:28672
ds_read_b64_tr_b16 a[18:19], v9 offset:29696
buffer_load_dwordx4 v7, s[12:15], s30 offen offset:1024 lds
v_mfma_f32_32x32x16_bf16 v[32:47], a[24:27], v[140:143], v[32:47]
ds_read_b64_tr_b16 a[20:21], v10 offset:28672
ds_read_b64_tr_b16 a[22:23], v10 offset:29696
v_cvt_pk_bf16_f32 v69, v74, v75
v_cvt_pk_bf16_f32 v70, v76, v77
v_mfma_f32_32x32x16_bf16 v[48:63], a[28:31], v[140:143], v[48:63]
ds_read_b64_tr_b16 a[24:25], v9 offset:30720
ds_read_b64_tr_b16 a[26:27], v9 offset:31744
buffer_load_dwordx4 v8, s[12:15], s30 offen offset:2048 lds
s_waitcnt lgkmcnt(6)
v_mfma_f32_32x32x16_bf16 v[32:47], a[0:3], v[144:147], v[32:47]
ds_read_b64_tr_b16 a[28:29], v10 offset:30720
ds_read_b64_tr_b16 a[30:31], v10 offset:31744
v_cvt_pk_bf16_f32 v71, v78, v79
v_mfma_f32_32x32x16_bf16 v[48:63], a[4:7], v[144:147], v[48:63]
ds_read_b64_tr_b16 a[0:1], v9 offset:32768
ds_read_b64_tr_b16 a[2:3], v9 offset:33792
s_add_u32 m0, s34, 125952
v_mfma_f32_32x32x16_bf16 v[32:47], a[8:11], v[148:151], v[32:47]
ds_read_b64_tr_b16 a[4:5], v10 offset:32768
ds_read_b64_tr_b16 a[6:7], v10 offset:33792
buffer_store_dwordx4 v[64:67], v2, s[16:19], s40 offen offset:0 sc1
v_mfma_f32_32x32x16_bf16 v[48:63], a[12:15], v[148:151], v[48:63]
ds_read_b64_tr_b16 a[8:9], v9 offset:34816
ds_read_b64_tr_b16 a[10:11], v9 offset:35840
buffer_load_dwordx4 v6, s[12:15], s31 offen lds
s_waitcnt lgkmcnt(6)
v_mfma_f32_32x32x16_bf16 v[32:47], a[16:19], v[152:155], v[32:47]
ds_read_b64_tr_b16 a[12:13], v10 offset:34816
ds_read_b64_tr_b16 a[14:15], v10 offset:35840
buffer_store_dwordx4 v[68:71], v2, s[16:19], s40 offen offset:1024 sc1
v_mfma_f32_32x32x16_bf16 v[48:63], a[20:23], v[152:155], v[48:63]
ds_read_b64_tr_b16 a[16:17], v9 offset:36864
ds_read_b64_tr_b16 a[18:19], v9 offset:37888
buffer_load_dwordx4 v7, s[12:15], s31 offen offset:1024 lds
v_mfma_f32_32x32x16_bf16 v[32:47], a[24:27], v[156:159], v[32:47]
ds_read_b64_tr_b16 a[20:21], v10 offset:36864
ds_read_b64_tr_b16 a[22:23], v10 offset:37888
v_mul_f32 v80, s48, v80
v_mul_f32 v81, s48, v81
v_mfma_f32_32x32x16_bf16 v[48:63], a[28:31], v[156:159], v[48:63]
ds_read_b64_tr_b16 a[24:25], v9 offset:38912
ds_read_b64_tr_b16 a[26:27], v9 offset:39936
buffer_load_dwordx4 v8, s[12:15], s31 offen offset:2048 lds
s_waitcnt lgkmcnt(6)
v_mfma_f32_32x32x16_bf16 v[32:47], a[0:3], v[160:163], v[32:47]
ds_read_b64_tr_b16 a[28:29], v10 offset:38912
ds_read_b64_tr_b16 a[30:31], v10 offset:39936
v_mul_f32 v82, s48, v82
v_mul_f32 v83, s48, v83
v_mfma_f32_32x32x16_bf16 v[48:63], a[4:7], v[160:163], v[48:63]
ds_read_b64_tr_b16 a[0:1], v9 offset:40960
ds_read_b64_tr_b16 a[2:3], v9 offset:41984
s_add_u32 s30, s30, 0xfff94080
v_mul_f32 v84, s48, v84
v_mfma_f32_32x32x16_bf16 v[32:47], a[8:11], v[164:167], v[32:47]
ds_read_b64_tr_b16 a[4:5], v10 offset:40960
ds_read_b64_tr_b16 a[6:7], v10 offset:41984
v_mul_f32 v85, s48, v85
v_mul_f32 v86, s48, v86
v_mfma_f32_32x32x16_bf16 v[48:63], a[12:15], v[164:167], v[48:63]
ds_read_b64_tr_b16 a[8:9], v9 offset:43008
ds_read_b64_tr_b16 a[10:11], v9 offset:44032
s_add_u32 s31, s31, 0xfff94080
s_waitcnt lgkmcnt(6)
v_mfma_f32_32x32x16_bf16 v[32:47], a[16:19], v[168:171], v[32:47]
ds_read_b64_tr_b16 a[12:13], v10 offset:43008
ds_read_b64_tr_b16 a[14:15], v10 offset:44032
v_mul_f32 v87, s48, v87
v_mul_f32 v88, s48, v88
v_mfma_f32_32x32x16_bf16 v[48:63], a[20:23], v[168:171], v[48:63]
ds_read_b64_tr_b16 a[16:17], v9 offset:45056
ds_read_b64_tr_b16 a[18:19], v9 offset:46080
v_mul_f32 v89, s48, v89
v_mul_f32 v90, s48, v90
v_mfma_f32_32x32x16_bf16 v[32:47], a[24:27], v[172:175], v[32:47]
ds_read_b64_tr_b16 a[20:21], v10 offset:45056
ds_read_b64_tr_b16 a[22:23], v10 offset:46080
v_mul_f32 v91, s48, v91
v_mul_f32 v92, s48, v92
v_mfma_f32_32x32x16_bf16 v[48:63], a[28:31], v[172:175], v[48:63]
ds_read_b64_tr_b16 a[24:25], v9 offset:47104
ds_read_b64_tr_b16 a[26:27], v9 offset:48128
v_mul_f32 v93, s48, v93
s_waitcnt lgkmcnt(6)
v_mfma_f32_32x32x16_bf16 v[32:47], a[0:3], v[176:179], v[32:47]
ds_read_b64_tr_b16 a[28:29], v10 offset:47104
ds_read_b64_tr_b16 a[30:31], v10 offset:48128
s_waitcnt vmcnt(16)
s_barrier
v_add_u32 v254, 1024, v254
buffer_store_dword v255, v254, s[60:63], 0 offen sc1
v_mfma_f32_32x32x16_bf16 v[48:63], a[4:7], v[176:179], v[48:63]
ds_read_b64_tr_b16 a[0:1], v11 offset:0
ds_read_b64_tr_b16 a[2:3], v11 offset:1024
v_mul_f32 v94, s48, v94
v_mul_f32 v95, s48, v95
v_mfma_f32_32x32x16_bf16 v[32:47], a[8:11], v[180:183], v[32:47]
ds_read_b64_tr_b16 a[4:5], v12 offset:0
ds_read_b64_tr_b16 a[6:7], v12 offset:1024
v_cvt_pk_bf16_f32 v80, v80, v81
v_cvt_pk_bf16_f32 v81, v82, v83
v_mfma_f32_32x32x16_bf16 v[48:63], a[12:15], v[180:183], v[48:63]
ds_read_b64_tr_b16 a[8:9], v11 offset:2048
ds_read_b64_tr_b16 a[10:11], v11 offset:3072
v_cvt_pk_bf16_f32 v82, v84, v85
s_waitcnt lgkmcnt(6)
v_mfma_f32_32x32x16_bf16 v[32:47], a[16:19], v[184:187], v[32:47]
ds_read_b64_tr_b16 a[12:13], v12 offset:2048
ds_read_b64_tr_b16 a[14:15], v12 offset:3072
v_cvt_pk_bf16_f32 v83, v86, v87
v_cvt_pk_bf16_f32 v84, v88, v89
v_mfma_f32_32x32x16_bf16 v[48:63], a[20:23], v[184:187], v[48:63]
ds_read_b64_tr_b16 a[16:17], v11 offset:4096
ds_read_b64_tr_b16 a[18:19], v11 offset:5120
v_cvt_pk_bf16_f32 v85, v90, v91
v_cvt_pk_bf16_f32 v86, v92, v93
v_mfma_f32_32x32x16_bf16 v[32:47], a[24:27], v[188:191], v[32:47]
ds_read_b64_tr_b16 a[20:21], v12 offset:4096
ds_read_b64_tr_b16 a[22:23], v12 offset:5120
v_cvt_pk_bf16_f32 v87, v94, v95
v_mfma_f32_32x32x16_bf16 v[48:63], a[28:31], v[188:191], v[48:63]
ds_read_b64_tr_b16 a[24:25], v11 offset:6144
ds_read_b64_tr_b16 a[26:27], v11 offset:7168
s_waitcnt lgkmcnt(6)
v_mfma_f32_32x32x16_bf16 v[32:47], a[0:3], v[192:195], v[32:47]
ds_read_b64_tr_b16 a[28:29], v12 offset:6144
ds_read_b64_tr_b16 a[30:31], v12 offset:7168
buffer_store_dwordx4 v[80:83], v2, s[16:19], s40 offen offset:2048 sc1
v_mfma_f32_32x32x16_bf16 v[48:63], a[4:7], v[192:195], v[48:63]
ds_read_b64_tr_b16 a[0:1], v11 offset:8192
ds_read_b64_tr_b16 a[2:3], v11 offset:9216
buffer_store_dwordx4 v[84:87], v2, s[16:19], s40 offen offset:3072 sc1
v_mfma_f32_32x32x16_bf16 v[32:47], a[8:11], v[196:199], v[32:47]
ds_read_b64_tr_b16 a[4:5], v12 offset:8192
ds_read_b64_tr_b16 a[6:7], v12 offset:9216
s_add_u32 s40, s40, 4096
v_mfma_f32_32x32x16_bf16 v[48:63], a[12:15], v[196:199], v[48:63]
ds_read_b64_tr_b16 a[8:9], v11 offset:10240
ds_read_b64_tr_b16 a[10:11], v11 offset:11264
s_waitcnt lgkmcnt(6)
v_mfma_f32_32x32x16_bf16 v[32:47], a[16:19], v[200:203], v[32:47]
ds_read_b64_tr_b16 a[12:13], v12 offset:10240
ds_read_b64_tr_b16 a[14:15], v12 offset:11264
v_mfma_f32_32x32x16_bf16 v[48:63], a[20:23], v[200:203], v[48:63]
ds_read_b64_tr_b16 a[16:17], v11 offset:12288
ds_read_b64_tr_b16 a[18:19], v11 offset:13312
v_mfma_f32_32x32x16_bf16 v[32:47], a[24:27], v[204:207], v[32:47]
ds_read_b64_tr_b16 a[20:21], v12 offset:12288
ds_read_b64_tr_b16 a[22:23], v12 offset:13312
v_mfma_f32_32x32x16_bf16 v[48:63], a[28:31], v[204:207], v[48:63]
ds_read_b64_tr_b16 a[24:25], v11 offset:14336
ds_read_b64_tr_b16 a[26:27], v11 offset:15360
s_waitcnt lgkmcnt(6)
v_mfma_f32_32x32x16_bf16 v[32:47], a[0:3], v[208:211], v[32:47]
ds_read_b64_tr_b16 a[28:29], v12 offset:14336
ds_read_b64_tr_b16 a[30:31], v12 offset:15360
v_mfma_f32_32x32x16_bf16 v[48:63], a[4:7], v[208:211], v[48:63]
ds_read_b64_tr_b16 a[0:1], v11 offset:16384
ds_read_b64_tr_b16 a[2:3], v11 offset:17408
v_mfma_f32_32x32x16_bf16 v[32:47], a[8:11], v[212:215], v[32:47]
ds_read_b64_tr_b16 a[4:5], v12 offset:16384
ds_read_b64_tr_b16 a[6:7], v12 offset:17408
v_mfma_f32_32x32x16_bf16 v[48:63], a[12:15], v[212:215], v[48:63]
ds_read_b64_tr_b16 a[8:9], v11 offset:18432
ds_read_b64_tr_b16 a[10:11], v11 offset:19456
s_waitcnt lgkmcnt(6)
v_mfma_f32_32x32x16_bf16 v[32:47], a[16:19], v[216:219], v[32:47]
ds_read_b64_tr_b16 a[12:13], v12 offset:18432
ds_read_b64_tr_b16 a[14:15], v12 offset:19456
v_mfma_f32_32x32x16_bf16 v[48:63], a[20:23], v[216:219], v[48:63]
ds_read_b64_tr_b16 a[16:17], v11 offset:20480
ds_read_b64_tr_b16 a[18:19], v11 offset:21504
v_mfma_f32_32x32x16_bf16 v[32:47], a[24:27], v[220:223], v[32:47]
ds_read_b64_tr_b16 a[20:21], v12 offset:20480
ds_read_b64_tr_b16 a[22:23], v12 offset:21504
v_mfma_f32_32x32x16_bf16 v[48:63], a[28:31], v[220:223], v[48:63]
ds_read_b64_tr_b16 a[24:25], v11 offset:22528
ds_read_b64_tr_b16 a[26:27], v11 offset:23552
s_waitcnt lgkmcnt(6)
v_mfma_f32_32x32x16_bf16 v[32:47], a[0:3], v[224:227], v[32:47]
ds_read_b64_tr_b16 a[28:29], v12 offset:22528
ds_read_b64_tr_b16 a[30:31], v12 offset:23552
s_waitcnt vmcnt(17)
s_barrier
v_mfma_f32_32x32x16_bf16 v[48:63], a[4:7], v[224:227], v[48:63]
ds_read_b64_tr_b16 a[0:1], v11 offset:24576
ds_read_b64_tr_b16 a[2:3], v11 offset:25600
v_mfma_f32_32x32x16_bf16 v[32:47], a[8:11], v[228:231], v[32:47]
ds_read_b64_tr_b16 a[4:5], v12 offset:24576
ds_read_b64_tr_b16 a[6:7], v12 offset:25600
v_mfma_f32_32x32x16_bf16 v[48:63], a[12:15], v[228:231], v[48:63]
ds_read_b64_tr_b16 a[8:9], v11 offset:26624
ds_read_b64_tr_b16 a[10:11], v11 offset:27648
s_waitcnt lgkmcnt(6)
v_mfma_f32_32x32x16_bf16 v[32:47], a[16:19], v[232:235], v[32:47]
ds_read_b64_tr_b16 a[12:13], v12 offset:26624
ds_read_b64_tr_b16 a[14:15], v12 offset:27648
v_mfma_f32_32x32x16_bf16 v[48:63], a[20:23], v[232:235], v[48:63]
ds_read_b64_tr_b16 a[16:17], v11 offset:28672
ds_read_b64_tr_b16 a[18:19], v11 offset:29696
v_mfma_f32_32x32x16_bf16 v[32:47], a[24:27], v[236:239], v[32:47]
ds_read_b64_tr_b16 a[20:21], v12 offset:28672
ds_read_b64_tr_b16 a[22:23], v12 offset:29696
v_mfma_f32_32x32x16_bf16 v[48:63], a[28:31], v[236:239], v[48:63]
ds_read_b64_tr_b16 a[24:25], v11 offset:30720
ds_read_b64_tr_b16 a[26:27], v11 offset:31744
s_waitcnt lgkmcnt(6)
v_mfma_f32_32x32x16_bf16 v[64:79], a[0:3], v[96:99], 0
ds_read_b64_tr_b16 a[28:29], v12 offset:30720
ds_read_b64_tr_b16 a[30:31], v12 offset:31744
v_mfma_f32_32x32x16_bf16 v[80:95], a[4:7], v[96:99], 0
ds_read_b64_tr_b16 a[0:1], v11 offset:32768
ds_read_b64_tr_b16 a[2:3], v11 offset:33792
v_mfma_f32_32x32x16_bf16 v[64:79], a[8:11], v[100:103], v[64:79]
ds_read_b64_tr_b16 a[4:5], v12 offset:32768
ds_read_b64_tr_b16 a[6:7], v12 offset:33792
v_mfma_f32_32x32x16_bf16 v[80:95], a[12:15], v[100:103], v[80:95]
ds_read_b64_tr_b16 a[8:9], v11 offset:34816
ds_read_b64_tr_b16 a[10:11], v11 offset:35840
v_mul_f32 v32, s48, v32
v_mul_f32 v33, s48, v33
s_waitcnt lgkmcnt(6)
v_mfma_f32_32x32x16_bf16 v[64:79], a[16:19], v[104:107], v[64:79]
ds_read_b64_tr_b16 a[12:13], v12 offset:34816
ds_read_b64_tr_b16 a[14:15], v12 offset:35840
v_mul_f32 v34, s48, v34
v_mul_f32 v35, s48, v35
v_mul_f32 v36, s48, v36
v_mfma_f32_32x32x16_bf16 v[80:95], a[20:23], v[104:107], v[80:95]
ds_read_b64_tr_b16 a[16:17], v11 offset:36864
ds_read_b64_tr_b16 a[18:19], v11 offset:37888
v_mul_f32 v37, s48, v37
v_mul_f32 v38, s48, v38
v_mul_f32 v39, s48, v39
v_mfma_f32_32x32x16_bf16 v[64:79], a[24:27], v[108:111], v[64:79]
ds_read_b64_tr_b16 a[20:21], v12 offset:36864
ds_read_b64_tr_b16 a[22:23], v12 offset:37888
v_mul_f32 v40, s48, v40
v_mul_f32 v41, s48, v41
v_mul_f32 v42, s48, v42
v_mfma_f32_32x32x16_bf16 v[80:95], a[28:31], v[108:111], v[80:95]
ds_read_b64_tr_b16 a[24:25], v11 offset:38912
ds_read_b64_tr_b16 a[26:27], v11 offset:39936
v_mul_f32 v43, s48, v43
v_mul_f32 v44, s48, v44
s_waitcnt lgkmcnt(6)
v_mfma_f32_32x32x16_bf16 v[64:79], a[0:3], v[112:115], v[64:79]
ds_read_b64_tr_b16 a[28:29], v12 offset:38912
ds_read_b64_tr_b16 a[30:31], v12 offset:39936
v_mul_f32 v45, s48, v45
v_mul_f32 v46, s48, v46
v_mul_f32 v47, s48, v47
v_mfma_f32_32x32x16_bf16 v[80:95], a[4:7], v[112:115], v[80:95]
ds_read_b64_tr_b16 a[0:1], v11 offset:40960
ds_read_b64_tr_b16 a[2:3], v11 offset:41984
v_cvt_pk_bf16_f32 v32, v32, v33
v_cvt_pk_bf16_f32 v33, v34, v35
v_cvt_pk_bf16_f32 v34, v36, v37
v_mfma_f32_32x32x16_bf16 v[64:79], a[8:11], v[116:119], v[64:79]
ds_read_b64_tr_b16 a[4:5], v12 offset:40960
ds_read_b64_tr_b16 a[6:7], v12 offset:41984
v_cvt_pk_bf16_f32 v35, v38, v39
v_cvt_pk_bf16_f32 v36, v40, v41
v_cvt_pk_bf16_f32 v37, v42, v43
v_mfma_f32_32x32x16_bf16 v[80:95], a[12:15], v[116:119], v[80:95]
ds_read_b64_tr_b16 a[8:9], v11 offset:43008
ds_read_b64_tr_b16 a[10:11], v11 offset:44032
v_cvt_pk_bf16_f32 v38, v44, v45
v_cvt_pk_bf16_f32 v39, v46, v47
s_waitcnt lgkmcnt(6)
v_mfma_f32_32x32x16_bf16 v[64:79], a[16:19], v[120:123], v[64:79]
ds_read_b64_tr_b16 a[12:13], v12 offset:43008
ds_read_b64_tr_b16 a[14:15], v12 offset:44032
buffer_store_dwordx4 v[32:35], v2, s[16:19], s40 offen offset:0 sc1
v_mfma_f32_32x32x16_bf16 v[80:95], a[20:23], v[120:123], v[80:95]
ds_read_b64_tr_b16 a[16:17], v11 offset:45056
ds_read_b64_tr_b16 a[18:19], v11 offset:46080
buffer_store_dwordx4 v[36:39], v2, s[16:19], s40 offen offset:1024 sc1
v_mul_f32 v48, s48, v48
v_mfma_f32_32x32x16_bf16 v[64:79], a[24:27], v[124:127], v[64:79]
ds_read_b64_tr_b16 a[20:21], v12 offset:45056
ds_read_b64_tr_b16 a[22:23], v12 offset:46080
v_mul_f32 v49, s48, v49
v_mul_f32 v50, s48, v50
v_mul_f32 v51, s48, v51
v_mfma_f32_32x32x16_bf16 v[80:95], a[28:31], v[124:127], v[80:95]
ds_read_b64_tr_b16 a[24:25], v11 offset:47104
ds_read_b64_tr_b16 a[26:27], v11 offset:48128
v_mul_f32 v52, s48, v52
v_mul_f32 v53, s48, v53
s_waitcnt lgkmcnt(6)
v_mfma_f32_32x32x16_bf16 v[64:79], a[0:3], v[128:131], v[64:79]
ds_read_b64_tr_b16 a[28:29], v12 offset:47104
ds_read_b64_tr_b16 a[30:31], v12 offset:48128
s_waitcnt vmcnt(13)
s_barrier
v_mul_f32 v54, s48, v54
v_mfma_f32_32x32x16_bf16 v[80:95], a[4:7], v[128:131], v[80:95]
ds_read_b64_tr_b16 a[0:1], v13 offset:0
ds_read_b64_tr_b16 a[2:3], v13 offset:1024
v_mul_f32 v55, s48, v55
v_mul_f32 v56, s48, v56
v_mul_f32 v57, s48, v57
v_mfma_f32_32x32x16_bf16 v[64:79], a[8:11], v[132:135], v[64:79]
ds_read_b64_tr_b16 a[4:5], v14 offset:0
ds_read_b64_tr_b16 a[6:7], v14 offset:1024
v_mul_f32 v58, s48, v58
v_mul_f32 v59, s48, v59
v_mul_f32 v60, s48, v60
v_mfma_f32_32x32x16_bf16 v[80:95], a[12:15], v[132:135], v[80:95]
ds_read_b64_tr_b16 a[8:9], v13 offset:2048
ds_read_b64_tr_b16 a[10:11], v13 offset:3072
v_mul_f32 v61, s48, v61
v_mul_f32 v62, s48, v62
s_waitcnt lgkmcnt(6)
v_mfma_f32_32x32x16_bf16 v[64:79], a[16:19], v[136:139], v[64:79]
ds_read_b64_tr_b16 a[12:13], v14 offset:2048
ds_read_b64_tr_b16 a[14:15], v14 offset:3072
v_mul_f32 v63, s48, v63
v_cvt_pk_bf16_f32 v48, v48, v49
v_cvt_pk_bf16_f32 v49, v50, v51
v_mfma_f32_32x32x16_bf16 v[80:95], a[20:23], v[136:139], v[80:95]
ds_read_b64_tr_b16 a[16:17], v13 offset:4096
ds_read_b64_tr_b16 a[18:19], v13 offset:5120
v_cvt_pk_bf16_f32 v50, v52, v53
v_cvt_pk_bf16_f32 v51, v54, v55
v_cvt_pk_bf16_f32 v52, v56, v57
v_mfma_f32_32x32x16_bf16 v[64:79], a[24:27], v[140:143], v[64:79]
ds_read_b64_tr_b16 a[20:21], v14 offset:4096
ds_read_b64_tr_b16 a[22:23], v14 offset:5120
v_cvt_pk_bf16_f32 v53, v58, v59
v_cvt_pk_bf16_f32 v54, v60, v61
v_cvt_pk_bf16_f32 v55, v62, v63
v_mfma_f32_32x32x16_bf16 v[80:95], a[28:31], v[140:143], v[80:95]
ds_read_b64_tr_b16 a[24:25], v13 offset:6144
ds_read_b64_tr_b16 a[26:27], v13 offset:7168
buffer_store_dwordx4 v[48:51], v2, s[16:19], s40 offen offset:2048 sc1
s_waitcnt lgkmcnt(6)
v_mfma_f32_32x32x16_bf16 v[64:79], a[0:3], v[144:147], v[64:79]
ds_read_b64_tr_b16 a[28:29], v14 offset:6144
ds_read_b64_tr_b16 a[30:31], v14 offset:7168
buffer_store_dwordx4 v[52:55], v2, s[16:19], s40 offen offset:3072 sc1
s_add_u32 s40, s40, 4096
v_mfma_f32_32x32x16_bf16 v[80:95], a[4:7], v[144:147], v[80:95]
ds_read_b64_tr_b16 a[0:1], v13 offset:8192
ds_read_b64_tr_b16 a[2:3], v13 offset:9216
v_mfma_f32_32x32x16_bf16 v[64:79], a[8:11], v[148:151], v[64:79]
ds_read_b64_tr_b16 a[4:5], v14 offset:8192
ds_read_b64_tr_b16 a[6:7], v14 offset:9216
v_mfma_f32_32x32x16_bf16 v[80:95], a[12:15], v[148:151], v[80:95]
ds_read_b64_tr_b16 a[8:9], v13 offset:10240
ds_read_b64_tr_b16 a[10:11], v13 offset:11264
s_waitcnt lgkmcnt(6)
v_mfma_f32_32x32x16_bf16 v[64:79], a[16:19], v[152:155], v[64:79]
ds_read_b64_tr_b16 a[12:13], v14 offset:10240
ds_read_b64_tr_b16 a[14:15], v14 offset:11264
v_mfma_f32_32x32x16_bf16 v[80:95], a[20:23], v[152:155], v[80:95]
ds_read_b64_tr_b16 a[16:17], v13 offset:12288
ds_read_b64_tr_b16 a[18:19], v13 offset:13312
v_mfma_f32_32x32x16_bf16 v[64:79], a[24:27], v[156:159], v[64:79]
ds_read_b64_tr_b16 a[20:21], v14 offset:12288
ds_read_b64_tr_b16 a[22:23], v14 offset:13312
v_mfma_f32_32x32x16_bf16 v[80:95], a[28:31], v[156:159], v[80:95]
ds_read_b64_tr_b16 a[24:25], v13 offset:14336
ds_read_b64_tr_b16 a[26:27], v13 offset:15360
s_waitcnt lgkmcnt(6)
v_mfma_f32_32x32x16_bf16 v[64:79], a[0:3], v[160:163], v[64:79]
ds_read_b64_tr_b16 a[28:29], v14 offset:14336
ds_read_b64_tr_b16 a[30:31], v14 offset:15360
v_mfma_f32_32x32x16_bf16 v[80:95], a[4:7], v[160:163], v[80:95]
ds_read_b64_tr_b16 a[0:1], v13 offset:16384
ds_read_b64_tr_b16 a[2:3], v13 offset:17408
v_mfma_f32_32x32x16_bf16 v[64:79], a[8:11], v[164:167], v[64:79]
ds_read_b64_tr_b16 a[4:5], v14 offset:16384
ds_read_b64_tr_b16 a[6:7], v14 offset:17408
v_mfma_f32_32x32x16_bf16 v[80:95], a[12:15], v[164:167], v[80:95]
ds_read_b64_tr_b16 a[8:9], v13 offset:18432
ds_read_b64_tr_b16 a[10:11], v13 offset:19456
s_waitcnt lgkmcnt(6)
v_mfma_f32_32x32x16_bf16 v[64:79], a[16:19], v[168:171], v[64:79]
ds_read_b64_tr_b16 a[12:13], v14 offset:18432
ds_read_b64_tr_b16 a[14:15], v14 offset:19456
v_mfma_f32_32x32x16_bf16 v[80:95], a[20:23], v[168:171], v[80:95]
ds_read_b64_tr_b16 a[16:17], v13 offset:20480
ds_read_b64_tr_b16 a[18:19], v13 offset:21504
v_mfma_f32_32x32x16_bf16 v[64:79], a[24:27], v[172:175], v[64:79]
ds_read_b64_tr_b16 a[20:21], v14 offset:20480
ds_read_b64_tr_b16 a[22:23], v14 offset:21504
v_mfma_f32_32x32x16_bf16 v[80:95], a[28:31], v[172:175], v[80:95]
ds_read_b64_tr_b16 a[24:25], v13 offset:22528
ds_read_b64_tr_b16 a[26:27], v13 offset:23552
s_waitcnt lgkmcnt(6)
v_mfma_f32_32x32x16_bf16 v[64:79], a[0:3], v[176:179], v[64:79]
ds_read_b64_tr_b16 a[28:29], v14 offset:22528
ds_read_b64_tr_b16 a[30:31], v14 offset:23552
s_waitcnt vmcnt(4)
s_barrier
v_add_u32 v254, 1024, v254
buffer_store_dword v255, v254, s[60:63], 0 offen sc1
v_mfma_f32_32x32x16_bf16 v[80:95], a[4:7], v[176:179], v[80:95]
ds_read_b64_tr_b16 a[0:1], v13 offset:24576
ds_read_b64_tr_b16 a[2:3], v13 offset:25600
v_mfma_f32_32x32x16_bf16 v[64:79], a[8:11], v[180:183], v[64:79]
ds_read_b64_tr_b16 a[4:5], v14 offset:24576
ds_read_b64_tr_b16 a[6:7], v14 offset:25600
v_mfma_f32_32x32x16_bf16 v[80:95], a[12:15], v[180:183], v[80:95]
ds_read_b64_tr_b16 a[8:9], v13 offset:26624
ds_read_b64_tr_b16 a[10:11], v13 offset:27648
s_waitcnt lgkmcnt(6)
v_mfma_f32_32x32x16_bf16 v[64:79], a[16:19], v[184:187], v[64:79]
ds_read_b64_tr_b16 a[12:13], v14 offset:26624
ds_read_b64_tr_b16 a[14:15], v14 offset:27648
v_mfma_f32_32x32x16_bf16 v[80:95], a[20:23], v[184:187], v[80:95]
ds_read_b64_tr_b16 a[16:17], v13 offset:28672
ds_read_b64_tr_b16 a[18:19], v13 offset:29696
v_mfma_f32_32x32x16_bf16 v[64:79], a[24:27], v[188:191], v[64:79]
ds_read_b64_tr_b16 a[20:21], v14 offset:28672
ds_read_b64_tr_b16 a[22:23], v14 offset:29696
v_mfma_f32_32x32x16_bf16 v[80:95], a[28:31], v[188:191], v[80:95]
ds_read_b64_tr_b16 a[24:25], v13 offset:30720
ds_read_b64_tr_b16 a[26:27], v13 offset:31744
s_waitcnt lgkmcnt(6)
v_mfma_f32_32x32x16_bf16 v[64:79], a[0:3], v[192:195], v[64:79]
ds_read_b64_tr_b16 a[28:29], v14 offset:30720
ds_read_b64_tr_b16 a[30:31], v14 offset:31744
v_mfma_f32_32x32x16_bf16 v[80:95], a[4:7], v[192:195], v[80:95]
ds_read_b64_tr_b16 a[0:1], v13 offset:32768
ds_read_b64_tr_b16 a[2:3], v13 offset:33792
v_mfma_f32_32x32x16_bf16 v[64:79], a[8:11], v[196:199], v[64:79]
ds_read_b64_tr_b16 a[4:5], v14 offset:32768
ds_read_b64_tr_b16 a[6:7], v14 offset:33792
v_mfma_f32_32x32x16_bf16 v[80:95], a[12:15], v[196:199], v[80:95]
ds_read_b64_tr_b16 a[8:9], v13 offset:34816
ds_read_b64_tr_b16 a[10:11], v13 offset:35840
s_waitcnt lgkmcnt(6)
v_mfma_f32_32x32x16_bf16 v[64:79], a[16:19], v[200:203], v[64:79]
ds_read_b64_tr_b16 a[12:13], v14 offset:34816
ds_read_b64_tr_b16 a[14:15], v14 offset:35840
v_mfma_f32_32x32x16_bf16 v[80:95], a[20:23], v[200:203], v[80:95]
ds_read_b64_tr_b16 a[16:17], v13 offset:36864
ds_read_b64_tr_b16 a[18:19], v13 offset:37888
v_mfma_f32_32x32x16_bf16 v[64:79], a[24:27], v[204:207], v[64:79]
ds_read_b64_tr_b16 a[20:21], v14 offset:36864
ds_read_b64_tr_b16 a[22:23], v14 offset:37888
v_mfma_f32_32x32x16_bf16 v[80:95], a[28:31], v[204:207], v[80:95]
ds_read_b64_tr_b16 a[24:25], v13 offset:38912
ds_read_b64_tr_b16 a[26:27], v13 offset:39936
s_waitcnt lgkmcnt(6)
v_mfma_f32_32x32x16_bf16 v[64:79], a[0:3], v[208:211], v[64:79]
ds_read_b64_tr_b16 a[28:29], v14 offset:38912
ds_read_b64_tr_b16 a[30:31], v14 offset:39936
v_mfma_f32_32x32x16_bf16 v[80:95], a[4:7], v[208:211], v[80:95]
ds_read_b64_tr_b16 a[0:1], v13 offset:40960
ds_read_b64_tr_b16 a[2:3], v13 offset:41984
v_mfma_f32_32x32x16_bf16 v[64:79], a[8:11], v[212:215], v[64:79]
ds_read_b64_tr_b16 a[4:5], v14 offset:40960
ds_read_b64_tr_b16 a[6:7], v14 offset:41984
v_mfma_f32_32x32x16_bf16 v[80:95], a[12:15], v[212:215], v[80:95]
ds_read_b64_tr_b16 a[8:9], v13 offset:43008
ds_read_b64_tr_b16 a[10:11], v13 offset:44032
s_waitcnt lgkmcnt(6)
v_mfma_f32_32x32x16_bf16 v[64:79], a[16:19], v[216:219], v[64:79]
ds_read_b64_tr_b16 a[12:13], v14 offset:43008
ds_read_b64_tr_b16 a[14:15], v14 offset:44032
v_mfma_f32_32x32x16_bf16 v[80:95], a[20:23], v[216:219], v[80:95]
ds_read_b64_tr_b16 a[16:17], v13 offset:45056
ds_read_b64_tr_b16 a[18:19], v13 offset:46080
v_mfma_f32_32x32x16_bf16 v[64:79], a[24:27], v[220:223], v[64:79]
ds_read_b64_tr_b16 a[20:21], v14 offset:45056
ds_read_b64_tr_b16 a[22:23], v14 offset:46080
v_mfma_f32_32x32x16_bf16 v[80:95], a[28:31], v[220:223], v[80:95]
ds_read_b64_tr_b16 a[24:25], v13 offset:47104
ds_read_b64_tr_b16 a[26:27], v13 offset:48128
s_waitcnt lgkmcnt(6)
v_mfma_f32_32x32x16_bf16 v[64:79], a[0:3], v[224:227], v[64:79]
ds_read_b64_tr_b16 a[28:29], v14 offset:47104
ds_read_b64_tr_b16 a[30:31], v14 offset:48128
v_mfma_f32_32x32x16_bf16 v[80:95], a[4:7], v[224:227], v[80:95]
v_mfma_f32_32x32x16_bf16 v[64:79], a[8:11], v[228:231], v[64:79]
v_mfma_f32_32x32x16_bf16 v[80:95], a[12:15], v[228:231], v[80:95]
s_waitcnt lgkmcnt(0)
v_mfma_f32_32x32x16_bf16 v[64:79], a[16:19], v[232:235], v[64:79]
v_mfma_f32_32x32x16_bf16 v[80:95], a[20:23], v[232:235], v[80:95]
v_mfma_f32_32x32x16_bf16 v[64:79], a[24:27], v[236:239], v[64:79]
v_mfma_f32_32x32x16_bf16 v[80:95], a[28:31], v[236:239], v[80:95]
s_nop 10
v_mul_f32 v64, s48, v64
v_mul_f32 v65, s48, v65
v_mul_f32 v66, s48, v66
v_mul_f32 v67, s48, v67
v_mul_f32 v68, s48, v68
v_mul_f32 v69, s48, v69
v_mul_f32 v70, s48, v70
v_mul_f32 v71, s48, v71
v_mul_f32 v72, s48, v72
v_mul_f32 v73, s48, v73
v_mul_f32 v74, s48, v74
v_mul_f32 v75, s48, v75
v_mul_f32 v76, s48, v76
v_mul_f32 v77, s48, v77
v_mul_f32 v78, s48, v78
v_mul_f32 v79, s48, v79
v_cvt_pk_bf16_f32 v64, v64, v65
v_cvt_pk_bf16_f32 v65, v66, v67
v_cvt_pk_bf16_f32 v66, v68, v69
v_cvt_pk_bf16_f32 v67, v70, v71
v_cvt_pk_bf16_f32 v68, v72, v73
v_cvt_pk_bf16_f32 v69, v74, v75
v_cvt_pk_bf16_f32 v70, v76, v77
v_cvt_pk_bf16_f32 v71, v78, v79
s_waitcnt vmcnt(1)
s_barrier
v_add_u32 v254, 1024, v254
buffer_store_dword v255, v254, s[60:63], 0 offen sc1
buffer_store_dwordx4 v[64:67], v2, s[16:19], s40 offen offset:0 sc1
buffer_store_dwordx4 v[68:71], v2, s[16:19], s40 offen offset:1024 sc1
v_mul_f32 v80, s48, v80
v_mul_f32 v81, s48, v81
v_mul_f32 v82, s48, v82
v_mul_f32 v83, s48, v83
v_mul_f32 v84, s48, v84
v_mul_f32 v85, s48, v85
v_mul_f32 v86, s48, v86
v_mul_f32 v87, s48, v87
v_mul_f32 v88, s48, v88
v_mul_f32 v89, s48, v89
v_mul_f32 v90, s48, v90
v_mul_f32 v91, s48, v91
v_mul_f32 v92, s48, v92
v_mul_f32 v93, s48, v93
v_mul_f32 v94, s48, v94
v_mul_f32 v95, s48, v95
v_cvt_pk_bf16_f32 v80, v80, v81
v_cvt_pk_bf16_f32 v81, v82, v83
v_cvt_pk_bf16_f32 v82, v84, v85
v_cvt_pk_bf16_f32 v83, v86, v87
v_cvt_pk_bf16_f32 v84, v88, v89
v_cvt_pk_bf16_f32 v85, v90, v91
v_cvt_pk_bf16_f32 v86, v92, v93
v_cvt_pk_bf16_f32 v87, v94, v95
buffer_store_dwordx4 v[80:83], v2, s[16:19], s40 offen offset:2048 sc1
buffer_store_dwordx4 v[84:87], v2, s[16:19], s40 offen offset:3072 sc1
s_add_u32 s40, s40, 4096
s_waitcnt vmcnt(0)
s_barrier
v_add_u32 v254, 1024, v254
buffer_store_dword v255, v254, s[60:63], 0 offen sc1
s_endpgm
L_mlp_three:
s_add_u32 m0, s34, 0
s_nop 0
buffer_load_dwordx4 v6, s[8:11], s30 offen lds
buffer_load_dwordx4 v7, s[8:11], s30 offen offset:1024 lds
buffer_load_dwordx4 v8, s[8:11], s30 offen offset:2048 lds
s_add_u32 m0, s34, 3072
s_nop 0
buffer_load_dwordx4 v6, s[8:11], s31 offen lds
buffer_load_dwordx4 v7, s[8:11], s31 offen offset:1024 lds
buffer_load_dwordx4 v8, s[8:11], s31 offen offset:2048 lds
s_add_u32 s30, s30, 221184
s_add_u32 s31, s31, 221184
buffer_load_dwordx4 a[32:35], v16, s[44:47], s50 offen offset:0
buffer_load_dwordx4 a[36:39], v16, s[44:47], s50 offen offset:1024
buffer_load_dwordx4 a[40:43], v16, s[44:47], s50 offen offset:2048
buffer_load_dwordx4 a[44:47], v16, s[44:47], s50 offen offset:3072
buffer_load_dwordx4 a[48:51], v16, s[44:47], s51 offen offset:0
buffer_load_dwordx4 a[52:55], v16, s[44:47], s51 offen offset:1024
buffer_load_dwordx4 a[56:59], v16, s[44:47], s51 offen offset:2048
buffer_load_dwordx4 a[60:63], v16, s[44:47], s51 offen offset:3072
buffer_load_dwordx4 a[64:67], v16, s[44:47], s52 offen offset:0
buffer_load_dwordx4 a[68:71], v17, s[44:47], s52 offen offset:1024
buffer_load_dwordx4 a[72:75], v17, s[44:47], s52 offen offset:2048
buffer_load_dwordx4 a[76:79], v17, s[44:47], s52 offen offset:3072
s_add_u32 m0, s34, 24576
s_nop 0
buffer_load_dwordx4 v6, s[8:11], s30 offen lds
buffer_load_dwordx4 v7, s[8:11], s30 offen offset:1024 lds
buffer_load_dwordx4 v8, s[8:11], s30 offen offset:2048 lds
s_add_u32 m0, s34, 27648
s_nop 0
buffer_load_dwordx4 v6, s[8:11], s31 offen lds
buffer_load_dwordx4 v7, s[8:11], s31 offen offset:1024 lds
buffer_load_dwordx4 v8, s[8:11], s31 offen offset:2048 lds
s_add_u32 s30, s30, 221184
s_add_u32 s31, s31, 221184
buffer_load_dwordx4 a[80:83], v17, s[44:47], s53 offen offset:0
buffer_load_dwordx4 a[84:87], v17, s[44:47], s53 offen offset:1024
buffer_load_dwordx4 a[88:91], v17, s[44:47], s53 offen offset:2048
buffer_load_dwordx4 a[92:95], v17, s[44:47], s53 offen offset:3072
s_waitcnt vmcnt(22)
s_barrier
ds_read_b64_tr_b16 a[0:1], v9 offset:0
ds_read_b64_tr_b16 a[2:3], v9 offset:1024
ds_read_b64_tr_b16 a[4:5], v10 offset:0
ds_read_b64_tr_b16 a[6:7], v10 offset:1024
ds_read_b64_tr_b16 a[8:9], v9 offset:2048
ds_read_b64_tr_b16 a[10:11], v9 offset:3072
ds_read_b64_tr_b16 a[12:13], v10 offset:2048
ds_read_b64_tr_b16 a[14:15], v10 offset:3072
ds_read_b64_tr_b16 a[16:17], v9 offset:4096
ds_read_b64_tr_b16 a[18:19], v9 offset:5120
ds_read_b64_tr_b16 a[20:21], v10 offset:4096
ds_read_b64_tr_b16 a[22:23], v10 offset:5120
ds_read_b64_tr_b16 a[24:25], v9 offset:6144
ds_read_b64_tr_b16 a[26:27], v9 offset:7168
s_waitcnt vmcnt(18)
s_waitcnt lgkmcnt(6)
v_mfma_f32_32x32x16_bf16 v[32:47], a[0:3], a[32:35], 0
ds_read_b64_tr_b16 a[28:29], v10 offset:6144
ds_read_b64_tr_b16 a[30:31], v10 offset:7168
buffer_load_dwordx4 a[96:99], v17, s[44:47], s54 offen offset:0
v_mfma_f32_32x32x16_bf16 v[48:63], a[4:7], a[32:35], 0
ds_read_b64_tr_b16 a[0:1], v9 offset:8192
ds_read_b64_tr_b16 a[2:3], v9 offset:9216
buffer_load_dwordx4 a[100:103], v17, s[44:47], s54 offen offset:1024
v_mfma_f32_32x32x16_bf16 v[32:47], a[8:11], a[36:39], v[32:47]
ds_read_b64_tr_b16 a[4:5], v10 offset:8192
ds_read_b64_tr_b16 a[6:7], v10 offset:9216
buffer_load_dwordx4 a[104:107], v18, s[44:47], s54 offen offset:2048
v_mfma_f32_32x32x16_bf16 v[48:63], a[12:15], a[36:39], v[48:63]
ds_read_b64_tr_b16 a[8:9], v9 offset:10240
ds_read_b64_tr_b16 a[10:11], v9 offset:11264
buffer_load_dwordx4 a[108:111], v18, s[44:47], s54 offen offset:3072
s_waitcnt lgkmcnt(6)
v_mfma_f32_32x32x16_bf16 v[32:47], a[16:19], a[40:43], v[32:47]
ds_read_b64_tr_b16 a[12:13], v10 offset:10240
ds_read_b64_tr_b16 a[14:15], v10 offset:11264
buffer_load_dwordx4 a[112:115], v18, s[44:47], s55 offen offset:0
v_mfma_f32_32x32x16_bf16 v[48:63], a[20:23], a[40:43], v[48:63]
ds_read_b64_tr_b16 a[16:17], v9 offset:12288
ds_read_b64_tr_b16 a[18:19], v9 offset:13312
buffer_load_dwordx4 a[116:119], v18, s[44:47], s55 offen offset:1024
v_mfma_f32_32x32x16_bf16 v[32:47], a[24:27], a[44:47], v[32:47]
ds_read_b64_tr_b16 a[20:21], v10 offset:12288
ds_read_b64_tr_b16 a[22:23], v10 offset:13312
buffer_load_dwordx4 a[120:123], v18, s[44:47], s55 offen offset:2048
v_mfma_f32_32x32x16_bf16 v[48:63], a[28:31], a[44:47], v[48:63]
ds_read_b64_tr_b16 a[24:25], v9 offset:14336
ds_read_b64_tr_b16 a[26:27], v9 offset:15360
buffer_load_dwordx4 a[124:127], v18, s[44:47], s55 offen offset:3072
s_waitcnt vmcnt(22)
s_waitcnt lgkmcnt(6)
v_mfma_f32_32x32x16_bf16 v[32:47], a[0:3], a[48:51], v[32:47]
ds_read_b64_tr_b16 a[28:29], v10 offset:14336
ds_read_b64_tr_b16 a[30:31], v10 offset:15360
s_add_u32 m0, s34, 49152
s_nop 0
buffer_load_dwordx4 v6, s[8:11], s30 offen lds
v_mfma_f32_32x32x16_bf16 v[48:63], a[4:7], a[48:51], v[48:63]
ds_read_b64_tr_b16 a[0:1], v9 offset:16384
ds_read_b64_tr_b16 a[2:3], v9 offset:17408
buffer_load_dwordx4 v7, s[8:11], s30 offen offset:1024 lds
v_mfma_f32_32x32x16_bf16 v[32:47], a[8:11], a[52:55], v[32:47]
ds_read_b64_tr_b16 a[4:5], v10 offset:16384
ds_read_b64_tr_b16 a[6:7], v10 offset:17408
buffer_load_dwordx4 v8, s[8:11], s30 offen offset:2048 lds
v_mfma_f32_32x32x16_bf16 v[48:63], a[12:15], a[52:55], v[48:63]
ds_read_b64_tr_b16 a[8:9], v9 offset:18432
ds_read_b64_tr_b16 a[10:11], v9 offset:19456
s_add_u32 m0, s34, 52224
s_nop 0
buffer_load_dwordx4 v6, s[8:11], s31 offen lds
s_waitcnt lgkmcnt(6)
v_mfma_f32_32x32x16_bf16 v[32:47], a[16:19], a[56:59], v[32:47]
ds_read_b64_tr_b16 a[12:13], v10 offset:18432
ds_read_b64_tr_b16 a[14:15], v10 offset:19456
buffer_load_dwordx4 v7, s[8:11], s31 offen offset:1024 lds
v_mfma_f32_32x32x16_bf16 v[48:63], a[20:23], a[56:59], v[48:63]
ds_read_b64_tr_b16 a[16:17], v9 offset:20480
ds_read_b64_tr_b16 a[18:19], v9 offset:21504
buffer_load_dwordx4 v8, s[8:11], s31 offen offset:2048 lds
v_mfma_f32_32x32x16_bf16 v[32:47], a[24:27], a[60:63], v[32:47]
ds_read_b64_tr_b16 a[20:21], v10 offset:20480
ds_read_b64_tr_b16 a[22:23], v10 offset:21504
buffer_load_dwordx4 a[128:131], v18, s[44:47], s56 offen offset:0
v_mfma_f32_32x32x16_bf16 v[48:63], a[28:31], a[60:63], v[48:63]
ds_read_b64_tr_b16 a[24:25], v9 offset:22528
ds_read_b64_tr_b16 a[26:27], v9 offset:23552
buffer_load_dwordx4 a[132:135], v18, s[44:47], s56 offen offset:1024
s_waitcnt vmcnt(26)
s_waitcnt lgkmcnt(6)
v_mfma_f32_32x32x16_bf16 v[32:47], a[0:3], a[64:67], v[32:47]
ds_read_b64_tr_b16 a[28:29], v10 offset:22528
ds_read_b64_tr_b16 a[30:31], v10 offset:23552
s_waitcnt vmcnt(20)
s_barrier
buffer_load_dwordx4 a[136:139], v18, s[44:47], s56 offen offset:2048
v_mfma_f32_32x32x16_bf16 v[48:63], a[4:7], a[64:67], v[48:63]
ds_read_b64_tr_b16 a[0:1], v9 offset:24576
ds_read_b64_tr_b16 a[2:3], v9 offset:25600
buffer_load_dwordx4 a[140:143], v19, s[44:47], s56 offen offset:3072
v_mfma_f32_32x32x16_bf16 v[32:47], a[8:11], a[68:71], v[32:47]
ds_read_b64_tr_b16 a[4:5], v10 offset:24576
ds_read_b64_tr_b16 a[6:7], v10 offset:25600
buffer_load_dwordx4 a[144:147], v19, s[44:47], s57 offen offset:0
v_mfma_f32_32x32x16_bf16 v[48:63], a[12:15], a[68:71], v[48:63]
ds_read_b64_tr_b16 a[8:9], v9 offset:26624
ds_read_b64_tr_b16 a[10:11], v9 offset:27648
buffer_load_dwordx4 a[148:151], v19, s[44:47], s57 offen offset:1024
s_waitcnt lgkmcnt(6)
v_mfma_f32_32x32x16_bf16 v[32:47], a[16:19], a[72:75], v[32:47]
ds_read_b64_tr_b16 a[12:13], v10 offset:26624
ds_read_b64_tr_b16 a[14:15], v10 offset:27648
buffer_load_dwordx4 a[152:155], v19, s[44:47], s57 offen offset:2048
v_mfma_f32_32x32x16_bf16 v[48:63], a[20:23], a[72:75], v[48:63]
ds_read_b64_tr_b16 a[16:17], v9 offset:28672
ds_read_b64_tr_b16 a[18:19], v9 offset:29696
buffer_load_dwordx4 a[156:159], v19, s[44:47], s57 offen offset:3072
v_mfma_f32_32x32x16_bf16 v[32:47], a[24:27], a[76:79], v[32:47]
ds_read_b64_tr_b16 a[20:21], v10 offset:28672
ds_read_b64_tr_b16 a[22:23], v10 offset:29696
buffer_load_dwordx4 a[160:163], v19, s[44:47], s58 offen offset:0
v_mfma_f32_32x32x16_bf16 v[48:63], a[28:31], a[76:79], v[48:63]
ds_read_b64_tr_b16 a[24:25], v9 offset:30720
ds_read_b64_tr_b16 a[26:27], v9 offset:31744
buffer_load_dwordx4 a[164:167], v19, s[44:47], s58 offen offset:1024
s_waitcnt vmcnt(24)
s_waitcnt lgkmcnt(6)
v_mfma_f32_32x32x16_bf16 v[32:47], a[0:3], a[80:83], v[32:47]
ds_read_b64_tr_b16 a[28:29], v10 offset:30720
ds_read_b64_tr_b16 a[30:31], v10 offset:31744
buffer_load_dwordx4 a[168:171], v19, s[44:47], s58 offen offset:2048
v_mfma_f32_32x32x16_bf16 v[48:63], a[4:7], a[80:83], v[48:63]
ds_read_b64_tr_b16 a[0:1], v9 offset:32768
ds_read_b64_tr_b16 a[2:3], v9 offset:33792
buffer_load_dwordx4 a[172:175], v19, s[44:47], s58 offen offset:3072
v_mfma_f32_32x32x16_bf16 v[32:47], a[8:11], a[84:87], v[32:47]
ds_read_b64_tr_b16 a[4:5], v10 offset:32768
ds_read_b64_tr_b16 a[6:7], v10 offset:33792
buffer_load_dwordx4 v[96:99], v2, s[64:67], s42 offen offset:0
v_mfma_f32_32x32x16_bf16 v[48:63], a[12:15], a[84:87], v[48:63]
ds_read_b64_tr_b16 a[8:9], v9 offset:34816
ds_read_b64_tr_b16 a[10:11], v9 offset:35840
buffer_load_dwordx4 v[100:103], v2, s[64:67], s42 offen offset:1024
s_waitcnt lgkmcnt(6)
v_mfma_f32_32x32x16_bf16 v[32:47], a[16:19], a[88:91], v[32:47]
ds_read_b64_tr_b16 a[12:13], v10 offset:34816
ds_read_b64_tr_b16 a[14:15], v10 offset:35840
buffer_load_dwordx4 v[104:107], v2, s[64:67], s42 offen offset:2048
v_mfma_f32_32x32x16_bf16 v[48:63], a[20:23], a[88:91], v[48:63]
ds_read_b64_tr_b16 a[16:17], v9 offset:36864
ds_read_b64_tr_b16 a[18:19], v9 offset:37888
buffer_load_dwordx4 v[108:111], v2, s[64:67], s42 offen offset:3072
v_mfma_f32_32x32x16_bf16 v[32:47], a[24:27], a[92:95], v[32:47]
ds_read_b64_tr_b16 a[20:21], v10 offset:36864
ds_read_b64_tr_b16 a[22:23], v10 offset:37888
buffer_load_dword v128, v15, s[68:71], s28 offen offset:0
v_mfma_f32_32x32x16_bf16 v[48:63], a[28:31], a[92:95], v[48:63]
ds_read_b64_tr_b16 a[24:25], v9 offset:38912
ds_read_b64_tr_b16 a[26:27], v9 offset:39936
buffer_load_dword v129, v15, s[68:71], s33 offen offset:0
s_waitcnt vmcnt(28)
s_waitcnt lgkmcnt(6)
v_mfma_f32_32x32x16_bf16 v[32:47], a[0:3], a[96:99], v[32:47]
ds_read_b64_tr_b16 a[28:29], v10 offset:38912
ds_read_b64_tr_b16 a[30:31], v10 offset:39936
buffer_load_dword v130, v15, s[68:71], s40 offen offset:0
v_mfma_f32_32x32x16_bf16 v[48:63], a[4:7], a[96:99], v[48:63]
ds_read_b64_tr_b16 a[0:1], v9 offset:40960
ds_read_b64_tr_b16 a[2:3], v9 offset:41984
buffer_load_dword v131, v15, s[68:71], s29 offen offset:0
v_mfma_f32_32x32x16_bf16 v[32:47], a[8:11], a[100:103], v[32:47]
ds_read_b64_tr_b16 a[4:5], v10 offset:40960
ds_read_b64_tr_b16 a[6:7], v10 offset:41984
buffer_load_dword v132, v15, s[68:71], s28 offen offset:1024
v_mfma_f32_32x32x16_bf16 v[48:63], a[12:15], a[100:103], v[48:63]
ds_read_b64_tr_b16 a[8:9], v9 offset:43008
ds_read_b64_tr_b16 a[10:11], v9 offset:44032
buffer_load_dword v133, v15, s[68:71], s33 offen offset:1024
s_waitcnt lgkmcnt(6)
v_mfma_f32_32x32x16_bf16 v[32:47], a[16:19], a[104:107], v[32:47]
ds_read_b64_tr_b16 a[12:13], v10 offset:43008
ds_read_b64_tr_b16 a[14:15], v10 offset:44032
buffer_load_dword v134, v15, s[68:71], s40 offen offset:1024
v_mfma_f32_32x32x16_bf16 v[48:63], a[20:23], a[104:107], v[48:63]
ds_read_b64_tr_b16 a[16:17], v9 offset:45056
ds_read_b64_tr_b16 a[18:19], v9 offset:46080
buffer_load_dword v135, v15, s[68:71], s29 offen offset:1024
v_mfma_f32_32x32x16_bf16 v[32:47], a[24:27], a[108:111], v[32:47]
ds_read_b64_tr_b16 a[20:21], v10 offset:45056
ds_read_b64_tr_b16 a[22:23], v10 offset:46080
buffer_load_dword v136, v15, s[68:71], s28 offen offset:2048
v_mfma_f32_32x32x16_bf16 v[48:63], a[28:31], a[108:111], v[48:63]
ds_read_b64_tr_b16 a[24:25], v9 offset:47104
ds_read_b64_tr_b16 a[26:27], v9 offset:48128
buffer_load_dword v137, v15, s[68:71], s33 offen offset:2048
s_waitcnt vmcnt(32)
s_waitcnt lgkmcnt(6)
v_mfma_f32_32x32x16_bf16 v[32:47], a[0:3], a[112:115], v[32:47]
ds_read_b64_tr_b16 a[28:29], v10 offset:47104
ds_read_b64_tr_b16 a[30:31], v10 offset:48128
s_waitcnt vmcnt(26)
s_barrier
buffer_load_dword v138, v15, s[68:71], s40 offen offset:2048
v_mfma_f32_32x32x16_bf16 v[48:63], a[4:7], a[112:115], v[48:63]
ds_read_b64_tr_b16 a[0:1], v11 offset:0
ds_read_b64_tr_b16 a[2:3], v11 offset:1024
buffer_load_dword v139, v15, s[68:71], s29 offen offset:2048
v_mfma_f32_32x32x16_bf16 v[32:47], a[8:11], a[116:119], v[32:47]
ds_read_b64_tr_b16 a[4:5], v12 offset:0
ds_read_b64_tr_b16 a[6:7], v12 offset:1024
s_add_u32 m0, s34, 73728
s_nop 0
buffer_load_dwordx4 v6, s[8:11], s39 offen lds
v_mfma_f32_32x32x16_bf16 v[48:63], a[12:15], a[116:119], v[48:63]
ds_read_b64_tr_b16 a[8:9], v11 offset:2048
ds_read_b64_tr_b16 a[10:11], v11 offset:3072
buffer_load_dwordx4 v7, s[8:11], s39 offen offset:1024 lds
s_waitcnt lgkmcnt(6)
v_mfma_f32_32x32x16_bf16 v[32:47], a[16:19], a[120:123], v[32:47]
ds_read_b64_tr_b16 a[12:13], v12 offset:2048
ds_read_b64_tr_b16 a[14:15], v12 offset:3072
buffer_load_dwordx4 v8, s[8:11], s39 offen offset:2048 lds
v_mfma_f32_32x32x16_bf16 v[48:63], a[20:23], a[120:123], v[48:63]
ds_read_b64_tr_b16 a[16:17], v11 offset:4096
ds_read_b64_tr_b16 a[18:19], v11 offset:5120
s_add_u32 m0, s34, 76800
s_nop 0
buffer_load_dwordx4 v6, s[8:11], s48 offen lds
v_mfma_f32_32x32x16_bf16 v[32:47], a[24:27], a[124:127], v[32:47]
ds_read_b64_tr_b16 a[20:21], v12 offset:4096
ds_read_b64_tr_b16 a[22:23], v12 offset:5120
buffer_load_dwordx4 v7, s[8:11], s48 offen offset:1024 lds
v_mfma_f32_32x32x16_bf16 v[48:63], a[28:31], a[124:127], v[48:63]
ds_read_b64_tr_b16 a[24:25], v11 offset:6144
ds_read_b64_tr_b16 a[26:27], v11 offset:7168
buffer_load_dwordx4 v8, s[8:11], s48 offen offset:2048 lds
s_add_u32 s39, s39, 221184
s_add_u32 s48, s48, 221184
s_waitcnt vmcnt(30)
s_waitcnt lgkmcnt(6)
v_mfma_f32_32x32x16_bf16 v[32:47], a[0:3], a[128:131], v[32:47]
ds_read_b64_tr_b16 a[28:29], v12 offset:6144
ds_read_b64_tr_b16 a[30:31], v12 offset:7168
s_add_u32 m0, s34, 98304
s_nop 0
buffer_load_dwordx4 v6, s[8:11], s39 offen lds
v_mfma_f32_32x32x16_bf16 v[48:63], a[4:7], a[128:131], v[48:63]
ds_read_b64_tr_b16 a[0:1], v11 offset:8192
ds_read_b64_tr_b16 a[2:3], v11 offset:9216
buffer_load_dwordx4 v7, s[8:11], s39 offen offset:1024 lds
v_mfma_f32_32x32x16_bf16 v[32:47], a[8:11], a[132:135], v[32:47]
ds_read_b64_tr_b16 a[4:5], v12 offset:8192
ds_read_b64_tr_b16 a[6:7], v12 offset:9216
buffer_load_dwordx4 v8, s[8:11], s39 offen offset:2048 lds
v_mfma_f32_32x32x16_bf16 v[48:63], a[12:15], a[132:135], v[48:63]
ds_read_b64_tr_b16 a[8:9], v11 offset:10240
ds_read_b64_tr_b16 a[10:11], v11 offset:11264
s_add_u32 m0, s34, 101376
s_nop 0
buffer_load_dwordx4 v6, s[8:11], s48 offen lds
s_waitcnt lgkmcnt(6)
v_mfma_f32_32x32x16_bf16 v[32:47], a[16:19], a[136:139], v[32:47]
ds_read_b64_tr_b16 a[12:13], v12 offset:10240
ds_read_b64_tr_b16 a[14:15], v12 offset:11264
buffer_load_dwordx4 v7, s[8:11], s48 offen offset:1024 lds
v_mfma_f32_32x32x16_bf16 v[48:63], a[20:23], a[136:139], v[48:63]
ds_read_b64_tr_b16 a[16:17], v11 offset:12288
ds_read_b64_tr_b16 a[18:19], v11 offset:13312
buffer_load_dwordx4 v8, s[8:11], s48 offen offset:2048 lds
s_add_u32 s39, s39, 221184
s_add_u32 s48, s48, 221184
v_mfma_f32_32x32x16_bf16 v[32:47], a[24:27], a[140:143], v[32:47]
ds_read_b64_tr_b16 a[20:21], v12 offset:12288
ds_read_b64_tr_b16 a[22:23], v12 offset:13312
s_add_u32 m0, s34, 122880
s_nop 0
buffer_load_dwordx4 v6, s[8:11], s39 offen lds
v_mfma_f32_32x32x16_bf16 v[48:63], a[28:31], a[140:143], v[48:63]
ds_read_b64_tr_b16 a[24:25], v11 offset:14336
ds_read_b64_tr_b16 a[26:27], v11 offset:15360
buffer_load_dwordx4 v7, s[8:11], s39 offen offset:1024 lds
s_waitcnt vmcnt(34)
s_waitcnt lgkmcnt(6)
v_mfma_f32_32x32x16_bf16 v[32:47], a[0:3], a[144:147], v[32:47]
ds_read_b64_tr_b16 a[28:29], v12 offset:14336
ds_read_b64_tr_b16 a[30:31], v12 offset:15360
buffer_load_dwordx4 v8, s[8:11], s39 offen offset:2048 lds
v_mfma_f32_32x32x16_bf16 v[48:63], a[4:7], a[144:147], v[48:63]
ds_read_b64_tr_b16 a[0:1], v11 offset:16384
ds_read_b64_tr_b16 a[2:3], v11 offset:17408
s_add_u32 m0, s34, 125952
s_nop 0
buffer_load_dwordx4 v6, s[8:11], s48 offen lds
v_mfma_f32_32x32x16_bf16 v[32:47], a[8:11], a[148:151], v[32:47]
ds_read_b64_tr_b16 a[4:5], v12 offset:16384
ds_read_b64_tr_b16 a[6:7], v12 offset:17408
buffer_load_dwordx4 v7, s[8:11], s48 offen offset:1024 lds
v_mfma_f32_32x32x16_bf16 v[48:63], a[12:15], a[148:151], v[48:63]
ds_read_b64_tr_b16 a[8:9], v11 offset:18432
ds_read_b64_tr_b16 a[10:11], v11 offset:19456
buffer_load_dwordx4 v8, s[8:11], s48 offen offset:2048 lds
s_waitcnt lgkmcnt(6)
v_mfma_f32_32x32x16_bf16 v[32:47], a[16:19], a[152:155], v[32:47]
ds_read_b64_tr_b16 a[12:13], v12 offset:18432
ds_read_b64_tr_b16 a[14:15], v12 offset:19456
buffer_load_dwordx4 v[112:115], v2, s[64:67], s43 offen offset:0
v_mfma_f32_32x32x16_bf16 v[48:63], a[20:23], a[152:155], v[48:63]
ds_read_b64_tr_b16 a[16:17], v11 offset:20480
ds_read_b64_tr_b16 a[18:19], v11 offset:21504
buffer_load_dwordx4 v[116:119], v2, s[64:67], s43 offen offset:1024
v_mfma_f32_32x32x16_bf16 v[32:47], a[24:27], a[156:159], v[32:47]
ds_read_b64_tr_b16 a[20:21], v12 offset:20480
ds_read_b64_tr_b16 a[22:23], v12 offset:21504
v_mfma_f32_32x32x16_bf16 v[48:63], a[28:31], a[156:159], v[48:63]
ds_read_b64_tr_b16 a[24:25], v11 offset:22528
ds_read_b64_tr_b16 a[26:27], v11 offset:23552
s_waitcnt vmcnt(36)
s_waitcnt lgkmcnt(6)
v_mfma_f32_32x32x16_bf16 v[32:47], a[0:3], a[160:163], v[32:47]
ds_read_b64_tr_b16 a[28:29], v12 offset:22528
ds_read_b64_tr_b16 a[30:31], v12 offset:23552
v_mfma_f32_32x32x16_bf16 v[48:63], a[4:7], a[160:163], v[48:63]
v_mfma_f32_32x32x16_bf16 v[32:47], a[8:11], a[164:167], v[32:47]
v_mfma_f32_32x32x16_bf16 v[48:63], a[12:15], a[164:167], v[48:63]
s_waitcnt lgkmcnt(0)
v_mfma_f32_32x32x16_bf16 v[32:47], a[16:19], a[168:171], v[32:47]
v_mfma_f32_32x32x16_bf16 v[48:63], a[20:23], a[168:171], v[48:63]
v_mfma_f32_32x32x16_bf16 v[32:47], a[24:27], a[172:175], v[32:47]
v_mfma_f32_32x32x16_bf16 v[48:63], a[28:31], a[172:175], v[48:63]
s_waitcnt vmcnt(20)
v_add_f32 v128, v128, v129
v_add_f32 v130, v130, v131
v_add_f32 v128, v128, v130
v_cvt_pk_bf16_f32 v129, v128, v128
v_and_b32 v129, 0xffff0000, v129
v_sub_f32 v128, v128, v129
v_cvt_pk_bf16_f32 v128, v128, v129
ds_write_b32 v23, v128 offset:16384
v_add_f32 v132, v132, v133
v_add_f32 v134, v134, v135
v_add_f32 v132, v132, v134
v_cvt_pk_bf16_f32 v133, v132, v132
v_and_b32 v133, 0xffff0000, v133
v_sub_f32 v132, v132, v133
v_cvt_pk_bf16_f32 v132, v132, v133
ds_write_b32 v23, v132 offset:17408
v_add_f32 v136, v136, v137
v_add_f32 v138, v138, v139
v_add_f32 v136, v136, v138
v_cvt_pk_bf16_f32 v137, v136, v136
v_and_b32 v137, 0xffff0000, v137
v_sub_f32 v136, v136, v137
v_cvt_pk_bf16_f32 v136, v136, v137
ds_write_b32 v23, v136 offset:18432
v_lshlrev_b32 v24, 16, v96
v_and_b32 v25, 0xffff0000, v96
v_fmac_f32 v24, s49, v32
v_fmac_f32 v25, s49, v33
v_cvt_pk_bf16_f32 v96, v24, v25
v_add_f32 v240, v240, v24
v_fmac_f32 v241, v24, v24
v_add_f32 v240, v240, v25
v_fmac_f32 v241, v25, v25
v_lshlrev_b32 v26, 16, v97
v_and_b32 v27, 0xffff0000, v97
v_fmac_f32 v26, s49, v34
v_fmac_f32 v27, s49, v35
v_cvt_pk_bf16_f32 v97, v26, v27
v_add_f32 v240, v240, v26
v_fmac_f32 v241, v26, v26
v_add_f32 v240, v240, v27
v_fmac_f32 v241, v27, v27
v_lshlrev_b32 v28, 16, v98
v_and_b32 v29, 0xffff0000, v98
v_fmac_f32 v28, s49, v36
v_fmac_f32 v29, s49, v37
v_cvt_pk_bf16_f32 v98, v28, v29
v_add_f32 v240, v240, v28
v_fmac_f32 v241, v28, v28
v_add_f32 v240, v240, v29
v_fmac_f32 v241, v29, v29
v_lshlrev_b32 v30, 16, v99
v_and_b32 v31, 0xffff0000, v99
v_fmac_f32 v30, s49, v38
v_fmac_f32 v31, s49, v39
v_cvt_pk_bf16_f32 v99, v30, v31
v_add_f32 v240, v240, v30
v_fmac_f32 v241, v30, v30
v_add_f32 v240, v240, v31
v_fmac_f32 v241, v31, v31
buffer_store_dwordx4 v[96:99], v2, s[20:23], s42 offen offset:0 sc1
v_lshlrev_b32 v24, 16, v100
v_and_b32 v25, 0xffff0000, v100
v_fmac_f32 v24, s49, v40
v_fmac_f32 v25, s49, v41
v_cvt_pk_bf16_f32 v100, v24, v25
v_add_f32 v240, v240, v24
v_fmac_f32 v241, v24, v24
v_add_f32 v240, v240, v25
v_fmac_f32 v241, v25, v25
v_lshlrev_b32 v26, 16, v101
v_and_b32 v27, 0xffff0000, v101
v_fmac_f32 v26, s49, v42
v_fmac_f32 v27, s49, v43
v_cvt_pk_bf16_f32 v101, v26, v27
v_add_f32 v240, v240, v26
v_fmac_f32 v241, v26, v26
v_add_f32 v240, v240, v27
v_fmac_f32 v241, v27, v27
v_lshlrev_b32 v28, 16, v102
v_and_b32 v29, 0xffff0000, v102
v_fmac_f32 v28, s49, v44
v_fmac_f32 v29, s49, v45
v_cvt_pk_bf16_f32 v102, v28, v29
v_add_f32 v240, v240, v28
v_fmac_f32 v241, v28, v28
v_add_f32 v240, v240, v29
v_fmac_f32 v241, v29, v29
v_lshlrev_b32 v30, 16, v103
v_and_b32 v31, 0xffff0000, v103
v_fmac_f32 v30, s49, v46
v_fmac_f32 v31, s49, v47
v_cvt_pk_bf16_f32 v103, v30, v31
v_add_f32 v240, v240, v30
v_fmac_f32 v241, v30, v30
v_add_f32 v240, v240, v31
v_fmac_f32 v241, v31, v31
buffer_store_dwordx4 v[100:103], v2, s[20:23], s42 offen offset:1024 sc1
v_lshlrev_b32 v24, 16, v104
v_and_b32 v25, 0xffff0000, v104
v_fmac_f32 v24, s49, v48
v_fmac_f32 v25, s49, v49
v_cvt_pk_bf16_f32 v104, v24, v25
v_add_f32 v240, v240, v24
v_fmac_f32 v241, v24, v24
v_add_f32 v240, v240, v25
v_fmac_f32 v241, v25, v25
v_lshlrev_b32 v26, 16, v105
v_and_b32 v27, 0xffff0000, v105
v_fmac_f32 v26, s49, v50
v_fmac_f32 v27, s49, v51
v_cvt_pk_bf16_f32 v105, v26, v27
v_add_f32 v240, v240, v26
v_fmac_f32 v241, v26, v26
v_add_f32 v240, v240, v27
v_fmac_f32 v241, v27, v27
v_lshlrev_b32 v28, 16, v106
v_and_b32 v29, 0xffff0000, v106
v_fmac_f32 v28, s49, v52
v_fmac_f32 v29, s49, v53
v_cvt_pk_bf16_f32 v106, v28, v29
v_add_f32 v240, v240, v28
v_fmac_f32 v241, v28, v28
v_add_f32 v240, v240, v29
v_fmac_f32 v241, v29, v29
v_lshlrev_b32 v30, 16, v107
v_and_b32 v31, 0xffff0000, v107
v_fmac_f32 v30, s49, v54
v_fmac_f32 v31, s49, v55
v_cvt_pk_bf16_f32 v107, v30, v31
v_add_f32 v240, v240, v30
v_fmac_f32 v241, v30, v30
v_add_f32 v240, v240, v31
v_fmac_f32 v241, v31, v31
buffer_store_dwordx4 v[104:107], v2, s[20:23], s42 offen offset:2048 sc1
v_lshlrev_b32 v24, 16, v108
v_and_b32 v25, 0xffff0000, v108
v_fmac_f32 v24, s49, v56
v_fmac_f32 v25, s49, v57
v_cvt_pk_bf16_f32 v108, v24, v25
v_add_f32 v240, v240, v24
v_fmac_f32 v241, v24, v24
v_add_f32 v240, v240, v25
v_fmac_f32 v241, v25, v25
v_lshlrev_b32 v26, 16, v109
v_and_b32 v27, 0xffff0000, v109
v_fmac_f32 v26, s49, v58
v_fmac_f32 v27, s49, v59
v_cvt_pk_bf16_f32 v109, v26, v27
v_add_f32 v240, v240, v26
v_fmac_f32 v241, v26, v26
v_add_f32 v240, v240, v27
v_fmac_f32 v241, v27, v27
v_lshlrev_b32 v28, 16, v110
v_and_b32 v29, 0xffff0000, v110
v_fmac_f32 v28, s49, v60
v_fmac_f32 v29, s49, v61
v_cvt_pk_bf16_f32 v110, v28, v29
v_add_f32 v240, v240, v28
v_fmac_f32 v241, v28, v28
v_add_f32 v240, v240, v29
v_fmac_f32 v241, v29, v29
v_lshlrev_b32 v30, 16, v111
v_and_b32 v31, 0xffff0000, v111
v_fmac_f32 v30, s49, v62
v_fmac_f32 v31, s49, v63
v_cvt_pk_bf16_f32 v111, v30, v31
v_add_f32 v240, v240, v30
v_fmac_f32 v241, v30, v30
v_add_f32 v240, v240, v31
v_fmac_f32 v241, v31, v31
buffer_store_dwordx4 v[108:111], v2, s[20:23], s42 offen offset:3072 sc1
s_mul_i32 s33, s35, 5120
s_add_u32 s33, s33, 0x20000
s_lshl_b32 s32, s25, 9
s_add_u32 s42, s32, s33
v_lshlrev_b32 v15, 3, v1
buffer_store_dwordx2 v[240:241], v15, s[68:71], s42 offen sc1
s_mul_i32 s32, s26, 11264
v_and_b32 v22, 7, v1
v_lshl_add_u32 v242, v22, 7, s32
v_and_b32 v22, 1, v1
v_lshl_add_u32 v243, v22, 7, s32
v_add_u32 v243, 10240, v243
s_lshl_b32 s59, s25, 7
s_add_u32 s32, s32, s59
v_mov_b32 v254, s32
v_mov_b32 v255, 1
v_mov_b32 v22, 0x80000000
v_cmp_eq_u32 vcc, 0, v0
s_nop 1
v_cndmask_b32 v254, v22, v254, vcc
s_waitcnt vmcnt(0) lgkmcnt(0)
s_barrier
v_mov_b32 v240, 0
v_mov_b32 v241, 0
buffer_store_dword v255, v254, s[60:63], 0 offen sc1
s_add_u32 s8, s6, 0x2600000
s_addc_u32 s9, s7, 0
s_mov_b32 s10, 0xa20000
s_mov_b32 s11, 0x00020000
s_mul_i32 s32, s25, 663552
s_add_u32 s30, s34, s32
s_add_u32 m0, s34, 0
s_nop 0
buffer_load_dwordx4 v2, s[8:11], s30 offen lds
buffer_load_dwordx4 v2, s[8:11], s30 offen offset:1024 lds
buffer_load_dwordx4 v2, s[8:11], s30 offen offset:2048 lds
buffer_load_dwordx4 v2, s[8:11], s30 offen offset:3072 lds
s_add_u32 m0, s34, 4096
s_nop 0
buffer_load_dwordx4 v3, s[8:11], s30 offen lds
buffer_load_dwordx4 v3, s[8:11], s30 offen offset:1024 lds
s_add_u32 s30, s30, 24576
s_add_u32 m0, s34, 24576
s_nop 0
buffer_load_dwordx4 v2, s[8:11], s30 offen lds
buffer_load_dwordx4 v2, s[8:11], s30 offen offset:1024 lds
buffer_load_dwordx4 v2, s[8:11], s30 offen offset:2048 lds
buffer_load_dwordx4 v2, s[8:11], s30 offen offset:3072 lds
s_add_u32 m0, s34, 28672
s_nop 0
buffer_load_dwordx4 v3, s[8:11], s30 offen lds
buffer_load_dwordx4 v3, s[8:11], s30 offen offset:1024 lds
s_add_u32 s30, s30, 24576
ds_read_b64_tr_b16 a[0:1], v20 offset:24576
ds_read_b64_tr_b16 a[2:3], v20 offset:25600
ds_read_b64_tr_b16 a[4:5], v20 offset:26624
ds_read_b64_tr_b16 a[6:7], v20 offset:27648
ds_read_b64_tr_b16 a[8:9], v20 offset:28672
ds_read_b64_tr_b16 a[10:11], v20 offset:29696
ds_read_b64_tr_b16 a[12:13], v20 offset:30720
ds_read_b64_tr_b16 a[14:15], v20 offset:31744
ds_read_b64_tr_b16 a[16:17], v20 offset:32768
ds_read_b64_tr_b16 a[18:19], v20 offset:33792
ds_read_b64_tr_b16 a[20:21], v20 offset:34816
ds_read_b64_tr_b16 a[22:23], v20 offset:35840
ds_read_b64_tr_b16 a[24:25], v20 offset:36864
ds_read_b64_tr_b16 a[26:27], v20 offset:37888
s_waitcnt lgkmcnt(6)
v_mfma_f32_32x32x16_bf16 v[64:79], a[0:3], a[32:35], 0
ds_read_b64_tr_b16 a[28:29], v20 offset:38912
ds_read_b64_tr_b16 a[30:31], v20 offset:39936
v_mfma_f32_32x32x16_bf16 v[64:79], a[4:7], a[36:39], v[64:79]
ds_read_b64_tr_b16 a[0:1], v20 offset:40960
ds_read_b64_tr_b16 a[2:3], v20 offset:41984
v_mfma_f32_32x32x16_bf16 v[64:79], a[8:11], a[40:43], v[64:79]
ds_read_b64_tr_b16 a[4:5], v20 offset:43008
ds_read_b64_tr_b16 a[6:7], v20 offset:44032
v_mfma_f32_32x32x16_bf16 v[64:79], a[12:15], a[44:47], v[64:79]
ds_read_b64_tr_b16 a[8:9], v20 offset:45056
ds_read_b64_tr_b16 a[10:11], v20 offset:46080
s_waitcnt lgkmcnt(6)
v_mfma_f32_32x32x16_bf16 v[64:79], a[16:19], a[48:51], v[64:79]
ds_read_b64_tr_b16 a[12:13], v20 offset:47104
ds_read_b64_tr_b16 a[14:15], v20 offset:48128
v_mfma_f32_32x32x16_bf16 v[64:79], a[20:23], a[52:55], v[64:79]
ds_read_b64_tr_b16 a[16:17], v21 offset:0
ds_read_b64_tr_b16 a[18:19], v21 offset:1024
v_mfma_f32_32x32x16_bf16 v[64:79], a[24:27], a[56:59], v[64:79]
ds_read_b64_tr_b16 a[20:21], v21 offset:2048
ds_read_b64_tr_b16 a[22:23], v21 offset:3072
v_mfma_f32_32x32x16_bf16 v[64:79], a[28:31], a[60:63], v[64:79]
ds_read_b64_tr_b16 a[24:25], v21 offset:4096
ds_read_b64_tr_b16 a[26:27], v21 offset:5120
s_waitcnt lgkmcnt(6)
v_mfma_f32_32x32x16_bf16 v[64:79], a[0:3], a[64:67], v[64:79]
ds_read_b64_tr_b16 a[28:29], v21 offset:6144
ds_read_b64_tr_b16 a[30:31], v21 offset:7168
v_mfma_f32_32x32x16_bf16 v[64:79], a[4:7], a[68:71], v[64:79]
ds_read_b64_tr_b16 a[0:1], v21 offset:8192
ds_read_b64_tr_b16 a[2:3], v21 offset:9216
v_mfma_f32_32x32x16_bf16 v[64:79], a[8:11], a[72:75], v[64:79]
ds_read_b64_tr_b16 a[4:5], v21 offset:10240
ds_read_b64_tr_b16 a[6:7], v21 offset:11264
v_mfma_f32_32x32x16_bf16 v[64:79], a[12:15], a[76:79], v[64:79]
ds_read_b64_tr_b16 a[8:9], v21 offset:12288
ds_read_b64_tr_b16 a[10:11], v21 offset:13312
s_waitcnt lgkmcnt(6)
v_mfma_f32_32x32x16_bf16 v[64:79], a[16:19], a[80:83], v[64:79]
ds_read_b64_tr_b16 a[12:13], v21 offset:14336
ds_read_b64_tr_b16 a[14:15], v21 offset:15360
v_mfma_f32_32x32x16_bf16 v[64:79], a[20:23], a[84:87], v[64:79]
ds_read_b64_tr_b16 a[16:17], v21 offset:16384
ds_read_b64_tr_b16 a[18:19], v21 offset:17408
v_mfma_f32_32x32x16_bf16 v[64:79], a[24:27], a[88:91], v[64:79]
ds_read_b64_tr_b16 a[20:21], v21 offset:18432
ds_read_b64_tr_b16 a[22:23], v21 offset:19456
v_mfma_f32_32x32x16_bf16 v[64:79], a[28:31], a[92:95], v[64:79]
ds_read_b64_tr_b16 a[24:25], v21 offset:20480
ds_read_b64_tr_b16 a[26:27], v21 offset:21504
s_waitcnt lgkmcnt(6)
v_mfma_f32_32x32x16_bf16 v[64:79], a[0:3], a[96:99], v[64:79]
ds_read_b64_tr_b16 a[28:29], v21 offset:22528
ds_read_b64_tr_b16 a[30:31], v21 offset:23552
v_mfma_f32_32x32x16_bf16 v[64:79], a[4:7], a[100:103], v[64:79]
ds_read_b64_tr_b16 a[0:1], v21 offset:24576
ds_read_b64_tr_b16 a[2:3], v21 offset:25600
v_mfma_f32_32x32x16_bf16 v[64:79], a[8:11], a[104:107], v[64:79]
ds_read_b64_tr_b16 a[4:5], v21 offset:26624
ds_read_b64_tr_b16 a[6:7], v21 offset:27648
v_mfma_f32_32x32x16_bf16 v[64:79], a[12:15], a[108:111], v[64:79]
ds_read_b64_tr_b16 a[8:9], v21 offset:28672
ds_read_b64_tr_b16 a[10:11], v21 offset:29696
s_waitcnt lgkmcnt(6)
v_mfma_f32_32x32x16_bf16 v[64:79], a[16:19], a[112:115], v[64:79]
ds_read_b64_tr_b16 a[12:13], v21 offset:30720
ds_read_b64_tr_b16 a[14:15], v21 offset:31744
v_mfma_f32_32x32x16_bf16 v[64:79], a[20:23], a[116:119], v[64:79]
ds_read_b64_tr_b16 a[16:17], v21 offset:32768
ds_read_b64_tr_b16 a[18:19], v21 offset:33792
v_mfma_f32_32x32x16_bf16 v[64:79], a[24:27], a[120:123], v[64:79]
ds_read_b64_tr_b16 a[20:21], v21 offset:34816
ds_read_b64_tr_b16 a[22:23], v21 offset:35840
v_mfma_f32_32x32x16_bf16 v[64:79], a[28:31], a[124:127], v[64:79]
ds_read_b64_tr_b16 a[24:25], v21 offset:36864
ds_read_b64_tr_b16 a[26:27], v21 offset:37888
s_waitcnt lgkmcnt(6)
v_mfma_f32_32x32x16_bf16 v[64:79], a[0:3], a[128:131], v[64:79]
ds_read_b64_tr_b16 a[28:29], v21 offset:38912
ds_read_b64_tr_b16 a[30:31], v21 offset:39936
v_mfma_f32_32x32x16_bf16 v[64:79], a[4:7], a[132:135], v[64:79]
ds_read_b64_tr_b16 a[0:1], v21 offset:40960
ds_read_b64_tr_b16 a[2:3], v21 offset:41984
v_mfma_f32_32x32x16_bf16 v[64:79], a[8:11], a[136:139], v[64:79]
ds_read_b64_tr_b16 a[4:5], v21 offset:43008
ds_read_b64_tr_b16 a[6:7], v21 offset:44032
v_mfma_f32_32x32x16_bf16 v[64:79], a[12:15], a[140:143], v[64:79]
ds_read_b64_tr_b16 a[8:9], v21 offset:45056
ds_read_b64_tr_b16 a[10:11], v21 offset:46080
s_waitcnt lgkmcnt(6)
v_mfma_f32_32x32x16_bf16 v[64:79], a[16:19], a[144:147], v[64:79]
ds_read_b64_tr_b16 a[12:13], v21 offset:47104
ds_read_b64_tr_b16 a[14:15], v21 offset:48128
v_mfma_f32_32x32x16_bf16 v[64:79], a[20:23], a[148:151], v[64:79]
v_mfma_f32_32x32x16_bf16 v[64:79], a[24:27], a[152:155], v[64:79]
v_mfma_f32_32x32x16_bf16 v[64:79], a[28:31], a[156:159], v[64:79]
s_waitcnt lgkmcnt(0)
v_mfma_f32_32x32x16_bf16 v[64:79], a[0:3], a[160:163], v[64:79]
v_mfma_f32_32x32x16_bf16 v[64:79], a[4:7], a[164:167], v[64:79]
v_mfma_f32_32x32x16_bf16 v[64:79], a[8:11], a[168:171], v[64:79]
v_mfma_f32_32x32x16_bf16 v[64:79], a[12:15], a[172:175], v[64:79]
v_lshlrev_b32 v24, 16, v112
v_and_b32 v25, 0xffff0000, v112
s_nop 9
v_fmac_f32 v24, s49, v64
v_fmac_f32 v25, s49, v65
v_cvt_pk_bf16_f32 v112, v24, v25
v_add_f32 v240, v240, v24
v_fmac_f32 v241, v24, v24
v_add_f32 v240, v240, v25
v_fmac_f32 v241, v25, v25
v_lshlrev_b32 v26, 16, v113
v_and_b32 v27, 0xffff0000, v113
v_fmac_f32 v26, s49, v66
v_fmac_f32 v27, s49, v67
v_cvt_pk_bf16_f32 v113, v26, v27
v_add_f32 v240, v240, v26
v_fmac_f32 v241, v26, v26
v_add_f32 v240, v240, v27
v_fmac_f32 v241, v27, v27
v_lshlrev_b32 v28, 16, v114
v_and_b32 v29, 0xffff0000, v114
v_fmac_f32 v28, s49, v68
v_fmac_f32 v29, s49, v69
v_cvt_pk_bf16_f32 v114, v28, v29
v_add_f32 v240, v240, v28
v_fmac_f32 v241, v28, v28
v_add_f32 v240, v240, v29
v_fmac_f32 v241, v29, v29
v_lshlrev_b32 v30, 16, v115
v_and_b32 v31, 0xffff0000, v115
v_fmac_f32 v30, s49, v70
v_fmac_f32 v31, s49, v71
v_cvt_pk_bf16_f32 v115, v30, v31
v_add_f32 v240, v240, v30
v_fmac_f32 v241, v30, v30
v_add_f32 v240, v240, v31
v_fmac_f32 v241, v31, v31
buffer_store_dwordx4 v[112:115], v2, s[20:23], s43 offen offset:0 sc1
v_lshlrev_b32 v24, 16, v116
v_and_b32 v25, 0xffff0000, v116
v_fmac_f32 v24, s49, v72
v_fmac_f32 v25, s49, v73
v_cvt_pk_bf16_f32 v116, v24, v25
v_add_f32 v240, v240, v24
v_fmac_f32 v241, v24, v24
v_add_f32 v240, v240, v25
v_fmac_f32 v241, v25, v25
v_lshlrev_b32 v26, 16, v117
v_and_b32 v27, 0xffff0000, v117
v_fmac_f32 v26, s49, v74
v_fmac_f32 v27, s49, v75
v_cvt_pk_bf16_f32 v117, v26, v27
v_add_f32 v240, v240, v26
v_fmac_f32 v241, v26, v26
v_add_f32 v240, v240, v27
v_fmac_f32 v241, v27, v27
v_lshlrev_b32 v28, 16, v118
v_and_b32 v29, 0xffff0000, v118
v_fmac_f32 v28, s49, v76
v_fmac_f32 v29, s49, v77
v_cvt_pk_bf16_f32 v118, v28, v29
v_add_f32 v240, v240, v28
v_fmac_f32 v241, v28, v28
v_add_f32 v240, v240, v29
v_fmac_f32 v241, v29, v29
v_lshlrev_b32 v30, 16, v119
v_and_b32 v31, 0xffff0000, v119
v_fmac_f32 v30, s49, v78
v_fmac_f32 v31, s49, v79
v_cvt_pk_bf16_f32 v119, v30, v31
v_add_f32 v240, v240, v30
v_fmac_f32 v241, v30, v30
v_add_f32 v240, v240, v31
v_fmac_f32 v241, v31, v31
buffer_store_dwordx4 v[116:119], v2, s[20:23], s43 offen offset:1024 sc1
s_add_u32 s32, s42, 4096
buffer_store_dwordx2 v[240:241], v15, s[68:71], s32 offen sc1
s_waitcnt vmcnt(0)
s_barrier
s_mov_b32 s59, 10240
buffer_store_dword v255, v254, s[60:63], s59 offen sc1
s_branch L_mlp_pub
L_kc_end:
s_endpgm
L_code_end:
.section .rodata,"a"
.p2align 6
.amdhsa_kernel ka_kernel
  .amdhsa_next_free_vgpr 288
  .amdhsa_next_free_sgpr 100
  .amdhsa_accum_offset 256
  .amdhsa_group_segment_fixed_size 0
  .amdhsa_kernarg_size 88
  .amdhsa_user_sgpr_count 2
  .amdhsa_user_sgpr_kernarg_segment_ptr 1
  .amdhsa_system_sgpr_workgroup_id_x 1
.end_amdhsa_kernel
.p2align 6
.amdhsa_kernel kc_kernel
  .amdhsa_next_free_vgpr 440
  .amdhsa_next_free_sgpr 100
  .amdhsa_accum_offset 256
  .amdhsa_group_segment_fixed_size 0
  .amdhsa_kernarg_size 88
  .amdhsa_user_sgpr_count 2
  .amdhsa_user_sgpr_kernarg_segment_ptr 1
  .amdhsa_system_sgpr_workgroup_id_x 1
.end_amdhsa_kernel
```
